```python
import torch

def _softmax(x, axis=-1):
    return torch.softmax(x, dim=axis)

def _gelu(x):
    return torch.nn.functional.gelu(x, approximate='tanh')

def _silu(x):
    return torch.nn.functional.silu(x)

def _sigmoid(x):
    return torch.sigmoid(x)

def _layernorm(x, axis=-1, eps=1e-05):
    m = x.mean(dim=axis, keepdim=True)
    v = x.var(dim=axis, keepdim=True, unbiased=False)
    return (x - m) / torch.sqrt(v + eps)

def _scatter_add(tgt, idx, src, axis=0):
    return tgt.clone().index_add_(axis, idx, src)

def _segment_sum(src, seg, n):
    out = torch.zeros((n,) + src.shape[1:], dtype=src.dtype)
    return out.index_add_(0, seg, src)

def _pad(x, pw):
    flat = tuple((v for pair in reversed(pw) for v in pair))
    return torch.nn.functional.pad(x, flat)
kernel_name = 'sequential_preLN__memory_aug_recurrent_mem_tr__dense_activation_relu__prompt'

def setup_inputs():

    _w = lambda a: (lambda t: t.to(torch.bfloat16) if t.is_floating_point() else t)(torch.as_tensor(a))

    def _A_setup():
        B, S, Dm = (1, 2048, 512)
        H, Dh = (32, 128)
        M, seg = (8, 32)
        seg = min(seg, S)
        S = S // seg * seg
        return {'x': _w((lambda *s: torch.randn(*s, dtype=torch.bfloat16) * 0.05)(B, S, Dm)), 'mem0': _w((lambda *s: torch.randn(*s, dtype=torch.bfloat16) * 0.2)(B, M, Dm)), 'Wq': _w((lambda *s: torch.randn(*s, dtype=torch.bfloat16) * 1.6)(Dm, H, Dh) * Dm ** (-0.5)), 'Wk': _w((lambda *s: torch.randn(*s, dtype=torch.bfloat16) * 1.6)(Dm, H, Dh) * Dm ** (-0.5)), 'Wv': _w((lambda *s: torch.randn(*s, dtype=torch.bfloat16) * 0.2)(Dm, H, Dh) * Dm ** (-0.5)), 'Wo': _w((lambda *s: torch.randn(*s, dtype=torch.bfloat16) * 0.2)(H, Dh, Dm) * (H * Dh) ** (-0.5)), 'seg_len': seg}
    _A_in = _A_setup()

    def _B_setup():
        B, S, D, Dff = (1, 2048, 512, 1376)
        return {'x': _w((lambda *s: torch.randn(*s, dtype=torch.bfloat16) * 0.05)(B, S, D)), 'w1': _w((lambda *s: torch.randn(*s, dtype=torch.bfloat16) * 0.05)(D, Dff)), 'w2': _w((lambda *s: torch.randn(*s, dtype=torch.bfloat16) * 0.05)(Dff, D))}
    _B_in = _B_setup()
    return {'A_x': _A_in['x'], 'A_mem0': _A_in['mem0'], 'A_Wq': _A_in['Wq'], 'A_Wk': _A_in['Wk'], 'A_Wv': _A_in['Wv'], 'A_Wo': _A_in['Wo'], 'A_seg_len': _A_in['seg_len'], 'B_x': _B_in['x'], 'B_w1': _B_in['w1'], 'B_w2': _B_in['w2']}

def reference(A_x, A_mem0, A_Wq, A_Wk, A_Wv, A_Wo, A_seg_len, B_x, B_w1, B_w2):

    def _A_ref(x, mem0, Wq, Wk, Wv, Wo, seg_len):
        B, S, Dm = x.shape
        H, Dh = (Wq.shape[1], Wq.shape[2])
        M = mem0.shape[1]
        scale = Dh ** (-0.5)
        n_seg = S // seg_len
        L = M + seg_len
        idx = torch.arange(L)
        mask = (idx[:, None] < M) | (idx[:, None] >= idx[None, :])
        mem = mem0
        outs = []
        for s in range(n_seg):
            xs = x[:, s * seg_len:(s + 1) * seg_len, :].clone()
            h = torch.concatenate([mem, xs], axis=1)
            q = torch.einsum('btd,dhe->bhte', h, Wq)
            k = torch.einsum('btd,dhe->bhte', h, Wk)
            v = torch.einsum('btd,dhe->bhte', h, Wv)
            scores = torch.einsum('bhqe,bhke->bhqk', q, k) * scale
            scores = torch.where(mask[None, None], scores, -1000000000.0)
            p = _softmax(scores, axis=-1)
            o = torch.einsum('bhqk,bhke->bhqe', p, v)
            o = torch.einsum('bhte,hed->btd', o, Wo)
            mem = o[:, :M, :].clone()
            outs.append(o[:, M:, :])
        return torch.concatenate(outs, axis=1)

    def _B_ref(x, w1, w2):
        h = torch.einsum('bsd,df->bsf', x, w1)
        zero = torch.zeros_like(h)
        h = torch.maximum(h, zero)
        return torch.einsum('bsf,fd->bsd', h, w2)
    x = A_x
    h = x + _A_ref(_layernorm(x, axis=-1), A_mem0, A_Wq, A_Wk, A_Wv, A_Wo, A_seg_len)
    h2 = h + _B_ref(_layernorm(h, axis=-1), B_w1, B_w2)
    return h2
```

```asm
; @launch grid=(256,1,1) block=(256,1,1) lds=163840
.amdgcn_target "amdgcn-amd-amdhsa--gfx950"
.text
.globl sequential_preLN__memory_aug_recurrent_mem_tr__dense_activation_relu__prompt_kernel
.p2align 8
.type sequential_preLN__memory_aug_recurrent_mem_tr__dense_activation_relu__prompt_kernel,@function
sequential_preLN__memory_aug_recurrent_mem_tr__dense_activation_relu__prompt_kernel:
s_cmp_ge_u32 s2, 256
s_cbranch_scc1 L_end
s_load_dwordx2 s[4:5], s[0:1], 0
s_load_dwordx2 s[8:9], s[0:1], 8
s_load_dwordx2 s[12:13], s[0:1], 16
s_load_dwordx2 s[16:17], s[0:1], 24
s_load_dwordx2 s[20:21], s[0:1], 32
s_load_dwordx2 s[24:25], s[0:1], 40
s_load_dwordx2 s[28:29], s[0:1], 64
s_load_dwordx2 s[32:33], s[0:1], 72
s_load_dwordx2 s[36:37], s[0:1], 80
s_load_dwordx2 s[40:41], s[0:1], 88
s_load_dwordx2 s[44:45], s[0:1], 96
s_getreg_b32 s51, hwreg(HW_REG_XCC_ID, 0, 4)
v_lshrrev_b32 v1, 6, v0
v_and_b32 v0, 63, v0
v_readfirstlane_b32 s48, v1
v_lshlrev_b32 v1, 4, v0
s_mov_b32 s6, 0x200000
s_mov_b32 s7, 0x20000
s_mov_b32 s10, 0x2000
s_mov_b32 s11, 0x20000
s_mov_b32 s14, 0x400000
s_mov_b32 s15, 0x20000
s_mov_b32 s18, 0x400000
s_mov_b32 s19, 0x20000
s_mov_b32 s22, 0x400000
s_mov_b32 s23, 0x20000
s_mov_b32 s26, 0x400000
s_mov_b32 s27, 0x20000
s_mov_b32 s30, 0x158000
s_mov_b32 s31, 0x20000
s_mov_b32 s34, 0x158000
s_mov_b32 s35, 0x20000
s_mov_b32 s38, 0x200000
s_mov_b32 s39, 0x20000
s_mov_b32 s42, 0x100
s_mov_b32 s43, 0x20000
s_mov_b32 s46, 0x10000000
s_mov_b32 s47, 0x20000
s_and_b32 s51, s51, 7
s_lshl_b32 s51, s51, 2
s_lshr_b32 s51, 0x65210743, s51
s_and_b32 s51, s51, 7
s_mov_b32 s49, s51
s_lshr_b32 s50, s2, 3
s_mov_b32 s52, 0
s_mov_b32 s53, 0
s_mov_b32 s54, 0
s_waitcnt lgkmcnt(0)
s_and_b32 s5, s5, 0xffff
s_and_b32 s9, s9, 0xffff
s_and_b32 s13, s13, 0xffff
s_and_b32 s17, s17, 0xffff
s_and_b32 s21, s21, 0xffff
s_and_b32 s25, s25, 0xffff
s_and_b32 s29, s29, 0xffff
s_and_b32 s33, s33, 0xffff
s_and_b32 s37, s37, 0xffff
s_and_b32 s41, s41, 0xffff
s_and_b32 s45, s45, 0xffff
L_dispatch:
s_cmp_eq_u32 s49, 0
s_cbranch_scc1 L_chain
s_cmp_ge_u32 s49, 3
s_cbranch_scc1 L_bteam
s_branch L_ateam
L_ateam:
v_lshrrev_b32 v50, 4, v0
v_and_b32 v51, 15, v0
v_lshlrev_b32 v52, 1, v50
v_xor_b32 v51, v51, v52
v_lshlrev_b32 v51, 4, v51
v_lshl_add_u32 v48, v50, 13, v51
v_xor_b32 v49, 128, v48
s_lshl_b32 s61, s50, 8
s_lshl_b32 s55, s48, 18
s_add_u32 s61, s61, s55
s_lshl_b32 s62, s48, 13
s_add_u32 s63, s49, 1
s_lshl_b32 s67, s48, 13
s_lshl_b32 s64, s63, 15
s_add_u32 s64, s64, s67
s_or_b32 s55, s48, s52
s_cbranch_scc1 L_ci_1
s_lshl_b32 s55, 1, s50
s_lshl_b32 s56, s49, 5
v_mov_b32 v56, s55
s_cmp_lg_u32 s49, s51
s_cselect_b32 s55, s55, 0
v_mov_b32 v57, s55
v_mov_b32 v58, s56
s_mov_b64 exec, 1
buffer_atomic_or_x2 v[56:57], v58, s[40:43], 0 offen sc0
s_mov_b64 exec, -1
L_ci_1:
s_add_u32 s55, s64, 4096
buffer_load_dwordx4 v[64:67], v1, s[4:7], s64 offen offset:0
buffer_load_dwordx4 v[68:71], v1, s[4:7], s64 offen offset:1024
buffer_load_dwordx4 v[72:75], v1, s[4:7], s64 offen offset:2048
buffer_load_dwordx4 v[76:79], v1, s[4:7], s64 offen offset:3072
buffer_load_dwordx4 v[80:83], v1, s[4:7], s55 offen offset:0
buffer_load_dwordx4 v[84:87], v1, s[4:7], s55 offen offset:1024
buffer_load_dwordx4 v[88:91], v1, s[4:7], s55 offen offset:2048
buffer_load_dwordx4 v[92:95], v1, s[4:7], s55 offen offset:3072
s_add_u32 m0, s62, 0
s_add_u32 s60, s61, 0
buffer_load_dwordx4 v48, s[20:23], s60 offen offset:0  lds
s_add_u32 s60, s61, 31744
buffer_load_dwordx4 v48, s[20:23], s60 offen offset:1024  lds
s_add_u32 s60, s61, 63488
buffer_load_dwordx4 v49, s[20:23], s60 offen offset:2048  lds
s_add_u32 s60, s61, 95232
buffer_load_dwordx4 v49, s[20:23], s60 offen offset:3072  lds
s_add_u32 m0, s62, 4096
s_add_u32 s60, s61, 131072
buffer_load_dwordx4 v48, s[20:23], s60 offen offset:0  lds
s_add_u32 s60, s61, 162816
buffer_load_dwordx4 v48, s[20:23], s60 offen offset:1024  lds
s_add_u32 s60, s61, 194560
buffer_load_dwordx4 v49, s[20:23], s60 offen offset:2048  lds
s_add_u32 s60, s61, 226304
buffer_load_dwordx4 v49, s[20:23], s60 offen offset:3072  lds
s_add_u32 m0, s62, 32768
s_add_u32 s60, s61, 1048576
buffer_load_dwordx4 v48, s[20:23], s60 offen offset:0  lds
s_add_u32 s60, s61, 1080320
buffer_load_dwordx4 v48, s[20:23], s60 offen offset:1024  lds
s_add_u32 s60, s61, 1112064
buffer_load_dwordx4 v49, s[20:23], s60 offen offset:2048  lds
s_add_u32 s60, s61, 1143808
buffer_load_dwordx4 v49, s[20:23], s60 offen offset:3072  lds
s_add_u32 m0, s62, 36864
s_add_u32 s60, s61, 1179648
buffer_load_dwordx4 v48, s[20:23], s60 offen offset:0  lds
s_add_u32 s60, s61, 1211392
buffer_load_dwordx4 v48, s[20:23], s60 offen offset:1024  lds
s_add_u32 s60, s61, 1243136
buffer_load_dwordx4 v49, s[20:23], s60 offen offset:2048  lds
s_add_u32 s60, s61, 1274880
buffer_load_dwordx4 v49, s[20:23], s60 offen offset:3072  lds
v_lshrrev_b32 v4, 4, v0
v_bfe_u32 v5, v0, 2, 2
v_and_b32 v6, 3, v0
v_lshl_add_u32 v7, v4, 3, v5
v_lshlrev_b32 v7, 8, v7
v_lshrrev_b32 v8, 1, v6
s_lshl_b32 s55, s48, 2
v_add_u32 v8, s55, v8
v_and_b32 v9, 1, v4
v_lshlrev_b32 v9, 3, v9
v_lshl_add_u32 v9, v5, 1, v9
v_xor_b32 v8, v8, v9
v_lshl_add_u32 v7, v8, 4, v7
v_and_b32 v6, 1, v6
v_lshl_add_u32 v52, v6, 3, v7
v_add_u32 v53, 0x10000, v52
v_xor_b32 v54, 32, v52
v_xor_b32 v55, 32, v53
v_and_b32 v10, 15, v0
v_lshrrev_b32 v11, 4, v0
v_add_u32 v12, 0, v11
v_xor_b32 v12, v12, v10
v_lshlrev_b32 v12, 4, v12
v_lshl_add_u32 v12, v10, 10, v12
v_add_u32 v4, 98304, v12
v_add_u32 v12, 4, v11
v_xor_b32 v12, v12, v10
v_lshlrev_b32 v12, 4, v12
v_lshl_add_u32 v12, v10, 10, v12
v_add_u32 v5, 98304, v12
v_add_u32 v12, 8, v11
v_xor_b32 v12, v12, v10
v_lshlrev_b32 v12, 4, v12
v_lshl_add_u32 v12, v10, 10, v12
v_add_u32 v6, 98304, v12
v_add_u32 v12, 12, v11
v_xor_b32 v12, v12, v10
v_lshlrev_b32 v12, 4, v12
v_lshl_add_u32 v12, v10, 10, v12
v_add_u32 v7, 98304, v12
s_and_b32 s55, s48, 1
s_lshl_b32 s55, s55, 7
v_xor_b32 v8, s55, v1
s_add_u32 s55, s67, 131072
v_add_u32 v19, s55, v8
s_lshl_b32 s55, s63, 5
s_add_u32 s55, s55, s50
s_mul_i32 s65, s55, 24576
s_add_u32 s65, s65, 0x200000
s_lshl_b32 s66, s55, 7
s_add_u32 s66, s66, 0x5040000
s_lshl_b32 s55, s48, 10
v_add_u32 v13, s55, v1
v_add_u32 v14, s55, v13
v_mov_b32 v2, 1
v_mov_b32 v3, 1
s_cmp_lg_u32 s48, 0
s_cselect_b32 s66, 0x40000000, s66
s_mov_b32 s68, 0x40000000
s_mov_b32 s69, s65
s_waitcnt vmcnt(8) lgkmcnt(0)
s_or_b32 s55, s48, s52
s_cbranch_scc1 L_cc_rd_2
s_mov_b32 s57, s49
s_mov_b32 s58, s50
L_cc_lp_3:
v_readfirstlane_b32 s55, v56
s_nop 0
s_lshr_b32 s56, s55, s58
s_and_b32 s56, s56, 1
s_cbranch_scc0 L_cc_ok_4
s_ff0_i32_b32 s58, s55
s_cmp_lg_u32 s55, -1
s_cbranch_scc1 L_cc_nf_5
s_add_u32 s57, s57, 1
s_and_b32 s57, s57, 7
s_mov_b32 s58, 0
L_cc_nf_5:
s_add_u32 s54, s54, 1
s_cmp_gt_u32 s54, 400000
s_cbranch_scc1 L_end
s_lshl_b32 s55, 1, s58
s_lshl_b32 s56, s57, 5
v_mov_b32 v56, s55
s_cmp_lg_u32 s57, s51
s_cselect_b32 s55, s55, 0
v_mov_b32 v57, s55
v_mov_b32 v58, s56
s_mov_b64 exec, 1
buffer_atomic_or_x2 v[56:57], v58, s[40:43], 0 offen sc0
s_mov_b64 exec, -1
s_waitcnt vmcnt(0)
s_branch L_cc_lp_3
L_cc_ok_4:
s_lshl_b32 s57, s57, 8
s_or_b32 s57, s57, s58
v_mov_b32 v56, s57
v_mov_b32 v57, 162816
ds_write_b32 v57, v56
s_waitcnt lgkmcnt(0)
L_cc_rd_2:
s_barrier
s_add_u32 m0, s62, 65536
s_add_u32 s60, s61, 2097152
buffer_load_dwordx4 v48, s[20:23], s60 offen offset:0  lds
s_add_u32 s60, s61, 2128896
buffer_load_dwordx4 v48, s[20:23], s60 offen offset:1024  lds
s_add_u32 s60, s61, 2160640
buffer_load_dwordx4 v49, s[20:23], s60 offen offset:2048  lds
s_add_u32 s60, s61, 2192384
buffer_load_dwordx4 v49, s[20:23], s60 offen offset:3072  lds
s_add_u32 m0, s62, 69632
s_add_u32 s60, s61, 2228224
buffer_load_dwordx4 v48, s[20:23], s60 offen offset:0  lds
s_add_u32 s60, s61, 2259968
buffer_load_dwordx4 v48, s[20:23], s60 offen offset:1024  lds
s_add_u32 s60, s61, 2291712
buffer_load_dwordx4 v49, s[20:23], s60 offen offset:2048  lds
s_add_u32 s60, s61, 2323456
buffer_load_dwordx4 v49, s[20:23], s60 offen offset:3072  lds
s_cmp_lg_u32 s52, 0
s_cbranch_scc1 L_cc_done_6
v_mov_b32 v57, 162816
ds_read_b32 v56, v57
s_mov_b32 s52, 1
s_lshl_b32 s56, s49, 8
s_or_b32 s56, s56, s50
s_waitcnt lgkmcnt(0)
v_readfirstlane_b32 s55, v56
s_nop 0
s_cmp_eq_u32 s55, s56
s_cbranch_scc1 L_cc_done_6
s_lshr_b32 s49, s55, 8
s_and_b32 s50, s55, 31
s_waitcnt vmcnt(0)
s_barrier
s_branch L_dispatch
L_cc_done_6:
v_lshlrev_b32 v96, 16, v64
v_and_b32 v97, 0xffff0000, v64
v_lshlrev_b32 v98, 16, v65
v_and_b32 v99, 0xffff0000, v65
v_lshlrev_b32 v100, 16, v66
v_and_b32 v101, 0xffff0000, v66
v_lshlrev_b32 v102, 16, v67
v_and_b32 v103, 0xffff0000, v67
v_lshlrev_b32 v104, 16, v68
v_and_b32 v105, 0xffff0000, v68
v_lshlrev_b32 v106, 16, v69
v_and_b32 v107, 0xffff0000, v69
v_lshlrev_b32 v108, 16, v70
v_and_b32 v109, 0xffff0000, v70
v_lshlrev_b32 v110, 16, v71
v_and_b32 v111, 0xffff0000, v71
v_add_f32 v112, v96, v97
v_add_f32 v112, v112, v98
v_add_f32 v112, v112, v99
v_add_f32 v112, v112, v100
v_add_f32 v112, v112, v101
v_add_f32 v112, v112, v102
v_add_f32 v112, v112, v103
v_add_f32 v113, v104, v105
v_add_f32 v113, v113, v106
v_add_f32 v113, v113, v107
v_add_f32 v113, v113, v108
v_add_f32 v113, v113, v109
v_add_f32 v113, v113, v110
v_add_f32 v113, v113, v111
v_add_f32_dpp v112, v112, v112 row_ror:8 row_mask:0xf bank_mask:0xf
s_nop 0
v_add_f32_dpp v113, v113, v113 row_ror:8 row_mask:0xf bank_mask:0xf
v_add_f32_dpp v112, v112, v112 row_ror:4 row_mask:0xf bank_mask:0xf
s_nop 0
v_add_f32_dpp v113, v113, v113 row_ror:4 row_mask:0xf bank_mask:0xf
v_add_f32_dpp v112, v112, v112 row_ror:2 row_mask:0xf bank_mask:0xf
s_nop 0
v_add_f32_dpp v113, v113, v113 row_ror:2 row_mask:0xf bank_mask:0xf
v_add_f32_dpp v112, v112, v112 row_ror:1 row_mask:0xf bank_mask:0xf
s_nop 0
v_add_f32_dpp v113, v113, v113 row_ror:1 row_mask:0xf bank_mask:0xf
v_mov_b32 v114, v112
v_mov_b32 v115, v113
s_nop 0
v_permlane16_swap_b32 v112, v114
v_permlane16_swap_b32 v113, v115
v_add_f32 v112, v112, v114
v_add_f32 v113, v113, v115
v_mov_b32 v114, v112
v_mov_b32 v115, v113
s_nop 0
v_permlane32_swap_b32 v112, v114
v_permlane32_swap_b32 v113, v115
v_add_f32 v112, v112, v114
v_add_f32 v113, v113, v115
v_mul_f32 v112, 0x3b000000, v112
v_mul_f32 v113, 0x3b000000, v113
v_sub_f32 v96, v96, v112
v_sub_f32 v97, v97, v112
v_sub_f32 v98, v98, v112
v_sub_f32 v99, v99, v112
v_sub_f32 v100, v100, v112
v_sub_f32 v101, v101, v112
v_sub_f32 v102, v102, v112
v_sub_f32 v103, v103, v112
v_mul_f32 v116, v96, v96
v_fmac_f32 v116, v97, v97
v_fmac_f32 v116, v98, v98
v_fmac_f32 v116, v99, v99
v_fmac_f32 v116, v100, v100
v_fmac_f32 v116, v101, v101
v_fmac_f32 v116, v102, v102
v_fmac_f32 v116, v103, v103
v_sub_f32 v104, v104, v113
v_sub_f32 v105, v105, v113
v_sub_f32 v106, v106, v113
v_sub_f32 v107, v107, v113
v_sub_f32 v108, v108, v113
v_sub_f32 v109, v109, v113
v_sub_f32 v110, v110, v113
v_sub_f32 v111, v111, v113
v_mul_f32 v117, v104, v104
v_fmac_f32 v117, v105, v105
v_fmac_f32 v117, v106, v106
v_fmac_f32 v117, v107, v107
v_fmac_f32 v117, v108, v108
v_fmac_f32 v117, v109, v109
v_fmac_f32 v117, v110, v110
v_fmac_f32 v117, v111, v111
v_add_f32_dpp v116, v116, v116 row_ror:8 row_mask:0xf bank_mask:0xf
s_nop 0
v_add_f32_dpp v117, v117, v117 row_ror:8 row_mask:0xf bank_mask:0xf
v_add_f32_dpp v116, v116, v116 row_ror:4 row_mask:0xf bank_mask:0xf
s_nop 0
v_add_f32_dpp v117, v117, v117 row_ror:4 row_mask:0xf bank_mask:0xf
v_add_f32_dpp v116, v116, v116 row_ror:2 row_mask:0xf bank_mask:0xf
s_nop 0
v_add_f32_dpp v117, v117, v117 row_ror:2 row_mask:0xf bank_mask:0xf
v_add_f32_dpp v116, v116, v116 row_ror:1 row_mask:0xf bank_mask:0xf
s_nop 0
v_add_f32_dpp v117, v117, v117 row_ror:1 row_mask:0xf bank_mask:0xf
v_mov_b32 v114, v116
v_mov_b32 v115, v117
s_nop 0
v_permlane16_swap_b32 v116, v114
v_permlane16_swap_b32 v117, v115
v_add_f32 v116, v116, v114
v_add_f32 v117, v117, v115
v_mov_b32 v114, v116
v_mov_b32 v115, v117
s_nop 0
v_permlane32_swap_b32 v116, v114
v_permlane32_swap_b32 v117, v115
v_add_f32 v116, v116, v114
v_add_f32 v117, v117, v115
v_mov_b32 v118, 0x3727c5ac
v_mul_f32 v116, 0x3b000000, v116
v_add_f32 v116, v116, v118
v_rsq_f32 v116, v116
v_mul_f32 v117, 0x3b000000, v117
v_add_f32 v117, v117, v118
v_rsq_f32 v117, v117
v_mul_f32 v96, v96, v116
v_mul_f32 v97, v97, v116
v_mul_f32 v98, v98, v116
v_mul_f32 v99, v99, v116
v_mul_f32 v100, v100, v116
v_mul_f32 v101, v101, v116
v_mul_f32 v102, v102, v116
v_mul_f32 v103, v103, v116
v_cvt_pk_bf16_f32 v64, v96, v97
v_cvt_pk_bf16_f32 v65, v98, v99
v_cvt_pk_bf16_f32 v66, v100, v101
v_cvt_pk_bf16_f32 v67, v102, v103
v_xor_b32 v9, 0, v19
ds_write_b128 v9, v[64:67] offset:0
v_mul_f32 v104, v104, v117
v_mul_f32 v105, v105, v117
v_mul_f32 v106, v106, v117
v_mul_f32 v107, v107, v117
v_mul_f32 v108, v108, v117
v_mul_f32 v109, v109, v117
v_mul_f32 v110, v110, v117
v_mul_f32 v111, v111, v117
v_cvt_pk_bf16_f32 v68, v104, v105
v_cvt_pk_bf16_f32 v69, v106, v107
v_cvt_pk_bf16_f32 v70, v108, v109
v_cvt_pk_bf16_f32 v71, v110, v111
v_xor_b32 v9, 16, v19
ds_write_b128 v9, v[68:71] offset:1024
ds_read_b64_tr_b16 v[128:129], v52 offset:0
ds_read_b64_tr_b16 v[130:131], v52 offset:1024
ds_read_b64_tr_b16 v[192:193], v54 offset:0
ds_read_b64_tr_b16 v[194:195], v54 offset:1024
ds_read_b64_tr_b16 v[132:133], v52 offset:8192
ds_read_b64_tr_b16 v[134:135], v52 offset:9216
ds_read_b64_tr_b16 v[196:197], v54 offset:8192
ds_read_b64_tr_b16 v[198:199], v54 offset:9216
ds_read_b64_tr_b16 v[136:137], v52 offset:16384
ds_read_b64_tr_b16 v[138:139], v52 offset:17408
ds_read_b64_tr_b16 v[200:201], v54 offset:16384
ds_read_b64_tr_b16 v[202:203], v54 offset:17408
ds_read_b64_tr_b16 v[140:141], v52 offset:24576
ds_read_b64_tr_b16 v[142:143], v52 offset:25600
ds_read_b64_tr_b16 v[204:205], v54 offset:24576
ds_read_b64_tr_b16 v[206:207], v54 offset:25600
s_waitcnt vmcnt(8) lgkmcnt(0)
s_barrier
s_add_u32 m0, s62, 0
s_add_u32 s60, s61, 3145728
buffer_load_dwordx4 v48, s[20:23], s60 offen offset:0  lds
s_add_u32 s60, s61, 3177472
buffer_load_dwordx4 v48, s[20:23], s60 offen offset:1024  lds
s_add_u32 s60, s61, 3209216
buffer_load_dwordx4 v49, s[20:23], s60 offen offset:2048  lds
s_add_u32 s60, s61, 3240960
buffer_load_dwordx4 v49, s[20:23], s60 offen offset:3072  lds
s_add_u32 m0, s62, 4096
s_add_u32 s60, s61, 3276800
buffer_load_dwordx4 v48, s[20:23], s60 offen offset:0  lds
s_add_u32 s60, s61, 3308544
buffer_load_dwordx4 v48, s[20:23], s60 offen offset:1024  lds
s_add_u32 s60, s61, 3340288
buffer_load_dwordx4 v49, s[20:23], s60 offen offset:2048  lds
s_add_u32 s60, s61, 3372032
buffer_load_dwordx4 v49, s[20:23], s60 offen offset:3072  lds
v_lshlrev_b32 v96, 16, v72
v_and_b32 v97, 0xffff0000, v72
v_lshlrev_b32 v98, 16, v73
v_and_b32 v99, 0xffff0000, v73
v_lshlrev_b32 v100, 16, v74
v_and_b32 v101, 0xffff0000, v74
v_lshlrev_b32 v102, 16, v75
v_and_b32 v103, 0xffff0000, v75
v_lshlrev_b32 v104, 16, v76
v_and_b32 v105, 0xffff0000, v76
v_lshlrev_b32 v106, 16, v77
v_and_b32 v107, 0xffff0000, v77
v_lshlrev_b32 v108, 16, v78
v_and_b32 v109, 0xffff0000, v78
v_lshlrev_b32 v110, 16, v79
v_and_b32 v111, 0xffff0000, v79
v_add_f32 v112, v96, v97
v_add_f32 v112, v112, v98
v_add_f32 v112, v112, v99
v_add_f32 v112, v112, v100
v_add_f32 v112, v112, v101
v_add_f32 v112, v112, v102
v_add_f32 v112, v112, v103
v_add_f32 v113, v104, v105
v_add_f32 v113, v113, v106
v_add_f32 v113, v113, v107
v_add_f32 v113, v113, v108
v_add_f32 v113, v113, v109
v_add_f32 v113, v113, v110
v_add_f32 v113, v113, v111
v_add_f32_dpp v112, v112, v112 row_ror:8 row_mask:0xf bank_mask:0xf
s_nop 0
v_add_f32_dpp v113, v113, v113 row_ror:8 row_mask:0xf bank_mask:0xf
v_add_f32_dpp v112, v112, v112 row_ror:4 row_mask:0xf bank_mask:0xf
s_nop 0
v_add_f32_dpp v113, v113, v113 row_ror:4 row_mask:0xf bank_mask:0xf
v_add_f32_dpp v112, v112, v112 row_ror:2 row_mask:0xf bank_mask:0xf
s_nop 0
v_add_f32_dpp v113, v113, v113 row_ror:2 row_mask:0xf bank_mask:0xf
v_add_f32_dpp v112, v112, v112 row_ror:1 row_mask:0xf bank_mask:0xf
s_nop 0
v_add_f32_dpp v113, v113, v113 row_ror:1 row_mask:0xf bank_mask:0xf
v_mov_b32 v114, v112
v_mov_b32 v115, v113
s_nop 0
v_permlane16_swap_b32 v112, v114
v_permlane16_swap_b32 v113, v115
v_add_f32 v112, v112, v114
v_add_f32 v113, v113, v115
v_mov_b32 v114, v112
v_mov_b32 v115, v113
s_nop 0
v_permlane32_swap_b32 v112, v114
v_permlane32_swap_b32 v113, v115
v_add_f32 v112, v112, v114
v_add_f32 v113, v113, v115
v_mul_f32 v112, 0x3b000000, v112
v_mul_f32 v113, 0x3b000000, v113
v_sub_f32 v96, v96, v112
v_sub_f32 v97, v97, v112
v_sub_f32 v98, v98, v112
v_sub_f32 v99, v99, v112
v_sub_f32 v100, v100, v112
v_sub_f32 v101, v101, v112
v_sub_f32 v102, v102, v112
v_sub_f32 v103, v103, v112
v_mul_f32 v116, v96, v96
v_fmac_f32 v116, v97, v97
v_fmac_f32 v116, v98, v98
v_fmac_f32 v116, v99, v99
v_fmac_f32 v116, v100, v100
v_fmac_f32 v116, v101, v101
v_fmac_f32 v116, v102, v102
v_fmac_f32 v116, v103, v103
v_sub_f32 v104, v104, v113
v_sub_f32 v105, v105, v113
v_sub_f32 v106, v106, v113
v_sub_f32 v107, v107, v113
v_sub_f32 v108, v108, v113
v_sub_f32 v109, v109, v113
v_sub_f32 v110, v110, v113
v_sub_f32 v111, v111, v113
v_mul_f32 v117, v104, v104
v_fmac_f32 v117, v105, v105
v_fmac_f32 v117, v106, v106
v_fmac_f32 v117, v107, v107
v_fmac_f32 v117, v108, v108
v_fmac_f32 v117, v109, v109
v_fmac_f32 v117, v110, v110
v_fmac_f32 v117, v111, v111
v_add_f32_dpp v116, v116, v116 row_ror:8 row_mask:0xf bank_mask:0xf
s_nop 0
v_add_f32_dpp v117, v117, v117 row_ror:8 row_mask:0xf bank_mask:0xf
v_add_f32_dpp v116, v116, v116 row_ror:4 row_mask:0xf bank_mask:0xf
s_nop 0
v_add_f32_dpp v117, v117, v117 row_ror:4 row_mask:0xf bank_mask:0xf
v_add_f32_dpp v116, v116, v116 row_ror:2 row_mask:0xf bank_mask:0xf
s_nop 0
v_add_f32_dpp v117, v117, v117 row_ror:2 row_mask:0xf bank_mask:0xf
v_add_f32_dpp v116, v116, v116 row_ror:1 row_mask:0xf bank_mask:0xf
s_nop 0
v_add_f32_dpp v117, v117, v117 row_ror:1 row_mask:0xf bank_mask:0xf
v_mov_b32 v114, v116
v_mov_b32 v115, v117
s_nop 0
v_permlane16_swap_b32 v116, v114
v_permlane16_swap_b32 v117, v115
v_add_f32 v116, v116, v114
v_add_f32 v117, v117, v115
v_mov_b32 v114, v116
v_mov_b32 v115, v117
s_nop 0
v_permlane32_swap_b32 v116, v114
v_permlane32_swap_b32 v117, v115
v_add_f32 v116, v116, v114
v_add_f32 v117, v117, v115
v_mov_b32 v118, 0x3727c5ac
v_mul_f32 v116, 0x3b000000, v116
v_add_f32 v116, v116, v118
v_rsq_f32 v116, v116
v_mul_f32 v117, 0x3b000000, v117
v_add_f32 v117, v117, v118
v_rsq_f32 v117, v117
v_mul_f32 v96, v96, v116
v_mul_f32 v97, v97, v116
v_mul_f32 v98, v98, v116
v_mul_f32 v99, v99, v116
v_mul_f32 v100, v100, v116
v_mul_f32 v101, v101, v116
v_mul_f32 v102, v102, v116
v_mul_f32 v103, v103, v116
v_cvt_pk_bf16_f32 v72, v96, v97
v_cvt_pk_bf16_f32 v73, v98, v99
v_cvt_pk_bf16_f32 v74, v100, v101
v_cvt_pk_bf16_f32 v75, v102, v103
v_xor_b32 v9, 32, v19
ds_write_b128 v9, v[72:75] offset:2048
v_mul_f32 v104, v104, v117
v_mul_f32 v105, v105, v117
v_mul_f32 v106, v106, v117
v_mul_f32 v107, v107, v117
v_mul_f32 v108, v108, v117
v_mul_f32 v109, v109, v117
v_mul_f32 v110, v110, v117
v_mul_f32 v111, v111, v117
v_cvt_pk_bf16_f32 v76, v104, v105
v_cvt_pk_bf16_f32 v77, v106, v107
v_cvt_pk_bf16_f32 v78, v108, v109
v_cvt_pk_bf16_f32 v79, v110, v111
v_xor_b32 v9, 48, v19
ds_write_b128 v9, v[76:79] offset:3072
ds_read_b64_tr_b16 v[144:145], v52 offset:32768
ds_read_b64_tr_b16 v[146:147], v52 offset:33792
ds_read_b64_tr_b16 v[208:209], v54 offset:32768
ds_read_b64_tr_b16 v[210:211], v54 offset:33792
ds_read_b64_tr_b16 v[148:149], v52 offset:40960
ds_read_b64_tr_b16 v[150:151], v52 offset:41984
ds_read_b64_tr_b16 v[212:213], v54 offset:40960
ds_read_b64_tr_b16 v[214:215], v54 offset:41984
ds_read_b64_tr_b16 v[152:153], v52 offset:49152
ds_read_b64_tr_b16 v[154:155], v52 offset:50176
ds_read_b64_tr_b16 v[216:217], v54 offset:49152
ds_read_b64_tr_b16 v[218:219], v54 offset:50176
ds_read_b64_tr_b16 v[156:157], v52 offset:57344
ds_read_b64_tr_b16 v[158:159], v52 offset:58368
ds_read_b64_tr_b16 v[220:221], v54 offset:57344
ds_read_b64_tr_b16 v[222:223], v54 offset:58368
s_waitcnt vmcnt(8) lgkmcnt(0)
s_barrier
buffer_load_dword v60, off, s[40:43], 0 offset:136 sc1
s_waitcnt vmcnt(0)
L_gw_7:
v_readfirstlane_b32 s55, v60
s_nop 0
s_cmp_lg_u32 s55, 0
s_cbranch_scc1 L_gk_8
s_add_u32 s54, s54, 1
s_cmp_gt_u32 s54, 400000
s_cbranch_scc1 L_end
buffer_load_dword v60, off, s[40:43], 0 offset:136 sc1
s_waitcnt vmcnt(0)
s_branch L_gw_7
L_gk_8:
s_lshr_b32 s53, s55, 16
s_add_u32 m0, s62, 32768
s_add_u32 s60, s61, 0
buffer_load_dwordx4 v48, s[16:19], s60 offen offset:0  lds
s_add_u32 s60, s61, 31744
buffer_load_dwordx4 v48, s[16:19], s60 offen offset:1024  lds
s_add_u32 s60, s61, 63488
buffer_load_dwordx4 v49, s[16:19], s60 offen offset:2048  lds
s_add_u32 s60, s61, 95232
buffer_load_dwordx4 v49, s[16:19], s60 offen offset:3072  lds
s_add_u32 m0, s62, 36864
s_add_u32 s60, s61, 131072
buffer_load_dwordx4 v48, s[16:19], s60 offen offset:0  lds
s_add_u32 s60, s61, 162816
buffer_load_dwordx4 v48, s[16:19], s60 offen offset:1024  lds
s_add_u32 s60, s61, 194560
buffer_load_dwordx4 v49, s[16:19], s60 offen offset:2048  lds
s_add_u32 s60, s61, 226304
buffer_load_dwordx4 v49, s[16:19], s60 offen offset:3072  lds
v_lshlrev_b32 v96, 16, v80
v_and_b32 v97, 0xffff0000, v80
v_lshlrev_b32 v98, 16, v81
v_and_b32 v99, 0xffff0000, v81
v_lshlrev_b32 v100, 16, v82
v_and_b32 v101, 0xffff0000, v82
v_lshlrev_b32 v102, 16, v83
v_and_b32 v103, 0xffff0000, v83
v_lshlrev_b32 v104, 16, v84
v_and_b32 v105, 0xffff0000, v84
v_lshlrev_b32 v106, 16, v85
v_and_b32 v107, 0xffff0000, v85
v_lshlrev_b32 v108, 16, v86
v_and_b32 v109, 0xffff0000, v86
v_lshlrev_b32 v110, 16, v87
v_and_b32 v111, 0xffff0000, v87
v_add_f32 v112, v96, v97
v_add_f32 v112, v112, v98
v_add_f32 v112, v112, v99
v_add_f32 v112, v112, v100
v_add_f32 v112, v112, v101
v_add_f32 v112, v112, v102
v_add_f32 v112, v112, v103
v_add_f32 v113, v104, v105
v_add_f32 v113, v113, v106
v_add_f32 v113, v113, v107
v_add_f32 v113, v113, v108
v_add_f32 v113, v113, v109
v_add_f32 v113, v113, v110
v_add_f32 v113, v113, v111
v_add_f32_dpp v112, v112, v112 row_ror:8 row_mask:0xf bank_mask:0xf
s_nop 0
v_add_f32_dpp v113, v113, v113 row_ror:8 row_mask:0xf bank_mask:0xf
v_add_f32_dpp v112, v112, v112 row_ror:4 row_mask:0xf bank_mask:0xf
s_nop 0
v_add_f32_dpp v113, v113, v113 row_ror:4 row_mask:0xf bank_mask:0xf
v_add_f32_dpp v112, v112, v112 row_ror:2 row_mask:0xf bank_mask:0xf
s_nop 0
v_add_f32_dpp v113, v113, v113 row_ror:2 row_mask:0xf bank_mask:0xf
v_add_f32_dpp v112, v112, v112 row_ror:1 row_mask:0xf bank_mask:0xf
s_nop 0
v_add_f32_dpp v113, v113, v113 row_ror:1 row_mask:0xf bank_mask:0xf
v_mov_b32 v114, v112
v_mov_b32 v115, v113
s_nop 0
v_permlane16_swap_b32 v112, v114
v_permlane16_swap_b32 v113, v115
v_add_f32 v112, v112, v114
v_add_f32 v113, v113, v115
v_mov_b32 v114, v112
v_mov_b32 v115, v113
s_nop 0
v_permlane32_swap_b32 v112, v114
v_permlane32_swap_b32 v113, v115
v_add_f32 v112, v112, v114
v_add_f32 v113, v113, v115
v_mul_f32 v112, 0x3b000000, v112
v_mul_f32 v113, 0x3b000000, v113
v_sub_f32 v96, v96, v112
v_sub_f32 v97, v97, v112
v_sub_f32 v98, v98, v112
v_sub_f32 v99, v99, v112
v_sub_f32 v100, v100, v112
v_sub_f32 v101, v101, v112
v_sub_f32 v102, v102, v112
v_sub_f32 v103, v103, v112
v_mul_f32 v116, v96, v96
v_fmac_f32 v116, v97, v97
v_fmac_f32 v116, v98, v98
v_fmac_f32 v116, v99, v99
v_fmac_f32 v116, v100, v100
v_fmac_f32 v116, v101, v101
v_fmac_f32 v116, v102, v102
v_fmac_f32 v116, v103, v103
v_sub_f32 v104, v104, v113
v_sub_f32 v105, v105, v113
v_sub_f32 v106, v106, v113
v_sub_f32 v107, v107, v113
v_sub_f32 v108, v108, v113
v_sub_f32 v109, v109, v113
v_sub_f32 v110, v110, v113
v_sub_f32 v111, v111, v113
v_mul_f32 v117, v104, v104
v_fmac_f32 v117, v105, v105
v_fmac_f32 v117, v106, v106
v_fmac_f32 v117, v107, v107
v_fmac_f32 v117, v108, v108
v_fmac_f32 v117, v109, v109
v_fmac_f32 v117, v110, v110
v_fmac_f32 v117, v111, v111
v_add_f32_dpp v116, v116, v116 row_ror:8 row_mask:0xf bank_mask:0xf
s_nop 0
v_add_f32_dpp v117, v117, v117 row_ror:8 row_mask:0xf bank_mask:0xf
v_add_f32_dpp v116, v116, v116 row_ror:4 row_mask:0xf bank_mask:0xf
s_nop 0
v_add_f32_dpp v117, v117, v117 row_ror:4 row_mask:0xf bank_mask:0xf
v_add_f32_dpp v116, v116, v116 row_ror:2 row_mask:0xf bank_mask:0xf
s_nop 0
v_add_f32_dpp v117, v117, v117 row_ror:2 row_mask:0xf bank_mask:0xf
v_add_f32_dpp v116, v116, v116 row_ror:1 row_mask:0xf bank_mask:0xf
s_nop 0
v_add_f32_dpp v117, v117, v117 row_ror:1 row_mask:0xf bank_mask:0xf
v_mov_b32 v114, v116
v_mov_b32 v115, v117
s_nop 0
v_permlane16_swap_b32 v116, v114
v_permlane16_swap_b32 v117, v115
v_add_f32 v116, v116, v114
v_add_f32 v117, v117, v115
v_mov_b32 v114, v116
v_mov_b32 v115, v117
s_nop 0
v_permlane32_swap_b32 v116, v114
v_permlane32_swap_b32 v117, v115
v_add_f32 v116, v116, v114
v_add_f32 v117, v117, v115
v_mov_b32 v118, 0x3727c5ac
v_mul_f32 v116, 0x3b000000, v116
v_add_f32 v116, v116, v118
v_rsq_f32 v116, v116
v_mul_f32 v117, 0x3b000000, v117
v_add_f32 v117, v117, v118
v_rsq_f32 v117, v117
v_mul_f32 v96, v96, v116
v_mul_f32 v97, v97, v116
v_mul_f32 v98, v98, v116
v_mul_f32 v99, v99, v116
v_mul_f32 v100, v100, v116
v_mul_f32 v101, v101, v116
v_mul_f32 v102, v102, v116
v_mul_f32 v103, v103, v116
v_cvt_pk_bf16_f32 v80, v96, v97
v_cvt_pk_bf16_f32 v81, v98, v99
v_cvt_pk_bf16_f32 v82, v100, v101
v_cvt_pk_bf16_f32 v83, v102, v103
v_xor_b32 v9, 64, v19
ds_write_b128 v9, v[80:83] offset:4096
v_mul_f32 v104, v104, v117
v_mul_f32 v105, v105, v117
v_mul_f32 v106, v106, v117
v_mul_f32 v107, v107, v117
v_mul_f32 v108, v108, v117
v_mul_f32 v109, v109, v117
v_mul_f32 v110, v110, v117
v_mul_f32 v111, v111, v117
v_cvt_pk_bf16_f32 v84, v104, v105
v_cvt_pk_bf16_f32 v85, v106, v107
v_cvt_pk_bf16_f32 v86, v108, v109
v_cvt_pk_bf16_f32 v87, v110, v111
v_xor_b32 v9, 80, v19
ds_write_b128 v9, v[84:87] offset:5120
ds_read_b64_tr_b16 v[160:161], v53 offset:0
ds_read_b64_tr_b16 v[162:163], v53 offset:1024
ds_read_b64_tr_b16 v[224:225], v55 offset:0
ds_read_b64_tr_b16 v[226:227], v55 offset:1024
ds_read_b64_tr_b16 v[164:165], v53 offset:8192
ds_read_b64_tr_b16 v[166:167], v53 offset:9216
ds_read_b64_tr_b16 v[228:229], v55 offset:8192
ds_read_b64_tr_b16 v[230:231], v55 offset:9216
ds_read_b64_tr_b16 v[168:169], v53 offset:16384
ds_read_b64_tr_b16 v[170:171], v53 offset:17408
ds_read_b64_tr_b16 v[232:233], v55 offset:16384
ds_read_b64_tr_b16 v[234:235], v55 offset:17408
ds_read_b64_tr_b16 v[172:173], v53 offset:24576
ds_read_b64_tr_b16 v[174:175], v53 offset:25600
ds_read_b64_tr_b16 v[236:237], v55 offset:24576
ds_read_b64_tr_b16 v[238:239], v55 offset:25600
s_waitcnt vmcnt(8) lgkmcnt(0)
s_barrier
s_add_u32 m0, s62, 65536
s_add_u32 s60, s61, 1048576
buffer_load_dwordx4 v48, s[16:19], s60 offen offset:0  lds
s_add_u32 s60, s61, 1080320
buffer_load_dwordx4 v48, s[16:19], s60 offen offset:1024  lds
s_add_u32 s60, s61, 1112064
buffer_load_dwordx4 v49, s[16:19], s60 offen offset:2048  lds
s_add_u32 s60, s61, 1143808
buffer_load_dwordx4 v49, s[16:19], s60 offen offset:3072  lds
s_add_u32 m0, s62, 69632
s_add_u32 s60, s61, 1179648
buffer_load_dwordx4 v48, s[16:19], s60 offen offset:0  lds
s_add_u32 s60, s61, 1211392
buffer_load_dwordx4 v48, s[16:19], s60 offen offset:1024  lds
s_add_u32 s60, s61, 1243136
buffer_load_dwordx4 v49, s[16:19], s60 offen offset:2048  lds
s_add_u32 s60, s61, 1274880
buffer_load_dwordx4 v49, s[16:19], s60 offen offset:3072  lds
v_lshlrev_b32 v96, 16, v88
v_and_b32 v97, 0xffff0000, v88
v_lshlrev_b32 v98, 16, v89
v_and_b32 v99, 0xffff0000, v89
v_lshlrev_b32 v100, 16, v90
v_and_b32 v101, 0xffff0000, v90
v_lshlrev_b32 v102, 16, v91
v_and_b32 v103, 0xffff0000, v91
v_lshlrev_b32 v104, 16, v92
v_and_b32 v105, 0xffff0000, v92
v_lshlrev_b32 v106, 16, v93
v_and_b32 v107, 0xffff0000, v93
v_lshlrev_b32 v108, 16, v94
v_and_b32 v109, 0xffff0000, v94
v_lshlrev_b32 v110, 16, v95
v_and_b32 v111, 0xffff0000, v95
v_add_f32 v112, v96, v97
v_add_f32 v112, v112, v98
v_add_f32 v112, v112, v99
v_add_f32 v112, v112, v100
v_add_f32 v112, v112, v101
v_add_f32 v112, v112, v102
v_add_f32 v112, v112, v103
v_add_f32 v113, v104, v105
v_add_f32 v113, v113, v106
v_add_f32 v113, v113, v107
v_add_f32 v113, v113, v108
v_add_f32 v113, v113, v109
v_add_f32 v113, v113, v110
v_add_f32 v113, v113, v111
v_add_f32_dpp v112, v112, v112 row_ror:8 row_mask:0xf bank_mask:0xf
s_nop 0
v_add_f32_dpp v113, v113, v113 row_ror:8 row_mask:0xf bank_mask:0xf
v_add_f32_dpp v112, v112, v112 row_ror:4 row_mask:0xf bank_mask:0xf
s_nop 0
v_add_f32_dpp v113, v113, v113 row_ror:4 row_mask:0xf bank_mask:0xf
v_add_f32_dpp v112, v112, v112 row_ror:2 row_mask:0xf bank_mask:0xf
s_nop 0
v_add_f32_dpp v113, v113, v113 row_ror:2 row_mask:0xf bank_mask:0xf
v_add_f32_dpp v112, v112, v112 row_ror:1 row_mask:0xf bank_mask:0xf
s_nop 0
v_add_f32_dpp v113, v113, v113 row_ror:1 row_mask:0xf bank_mask:0xf
v_mov_b32 v114, v112
v_mov_b32 v115, v113
s_nop 0
v_permlane16_swap_b32 v112, v114
v_permlane16_swap_b32 v113, v115
v_add_f32 v112, v112, v114
v_add_f32 v113, v113, v115
v_mov_b32 v114, v112
v_mov_b32 v115, v113
s_nop 0
v_permlane32_swap_b32 v112, v114
v_permlane32_swap_b32 v113, v115
v_add_f32 v112, v112, v114
v_add_f32 v113, v113, v115
v_mul_f32 v112, 0x3b000000, v112
v_mul_f32 v113, 0x3b000000, v113
v_sub_f32 v96, v96, v112
v_sub_f32 v97, v97, v112
v_sub_f32 v98, v98, v112
v_sub_f32 v99, v99, v112
v_sub_f32 v100, v100, v112
v_sub_f32 v101, v101, v112
v_sub_f32 v102, v102, v112
v_sub_f32 v103, v103, v112
v_mul_f32 v116, v96, v96
v_fmac_f32 v116, v97, v97
v_fmac_f32 v116, v98, v98
v_fmac_f32 v116, v99, v99
v_fmac_f32 v116, v100, v100
v_fmac_f32 v116, v101, v101
v_fmac_f32 v116, v102, v102
v_fmac_f32 v116, v103, v103
v_sub_f32 v104, v104, v113
v_sub_f32 v105, v105, v113
v_sub_f32 v106, v106, v113
v_sub_f32 v107, v107, v113
v_sub_f32 v108, v108, v113
v_sub_f32 v109, v109, v113
v_sub_f32 v110, v110, v113
v_sub_f32 v111, v111, v113
v_mul_f32 v117, v104, v104
v_fmac_f32 v117, v105, v105
v_fmac_f32 v117, v106, v106
v_fmac_f32 v117, v107, v107
v_fmac_f32 v117, v108, v108
v_fmac_f32 v117, v109, v109
v_fmac_f32 v117, v110, v110
v_fmac_f32 v117, v111, v111
v_add_f32_dpp v116, v116, v116 row_ror:8 row_mask:0xf bank_mask:0xf
s_nop 0
v_add_f32_dpp v117, v117, v117 row_ror:8 row_mask:0xf bank_mask:0xf
v_add_f32_dpp v116, v116, v116 row_ror:4 row_mask:0xf bank_mask:0xf
s_nop 0
v_add_f32_dpp v117, v117, v117 row_ror:4 row_mask:0xf bank_mask:0xf
v_add_f32_dpp v116, v116, v116 row_ror:2 row_mask:0xf bank_mask:0xf
s_nop 0
v_add_f32_dpp v117, v117, v117 row_ror:2 row_mask:0xf bank_mask:0xf
v_add_f32_dpp v116, v116, v116 row_ror:1 row_mask:0xf bank_mask:0xf
s_nop 0
v_add_f32_dpp v117, v117, v117 row_ror:1 row_mask:0xf bank_mask:0xf
v_mov_b32 v114, v116
v_mov_b32 v115, v117
s_nop 0
v_permlane16_swap_b32 v116, v114
v_permlane16_swap_b32 v117, v115
v_add_f32 v116, v116, v114
v_add_f32 v117, v117, v115
v_mov_b32 v114, v116
v_mov_b32 v115, v117
s_nop 0
v_permlane32_swap_b32 v116, v114
v_permlane32_swap_b32 v117, v115
v_add_f32 v116, v116, v114
v_add_f32 v117, v117, v115
v_mov_b32 v118, 0x3727c5ac
v_mul_f32 v116, 0x3b000000, v116
v_add_f32 v116, v116, v118
v_rsq_f32 v116, v116
v_mul_f32 v117, 0x3b000000, v117
v_add_f32 v117, v117, v118
v_rsq_f32 v117, v117
v_mul_f32 v96, v96, v116
v_mul_f32 v97, v97, v116
v_mul_f32 v98, v98, v116
v_mul_f32 v99, v99, v116
v_mul_f32 v100, v100, v116
v_mul_f32 v101, v101, v116
v_mul_f32 v102, v102, v116
v_mul_f32 v103, v103, v116
v_cvt_pk_bf16_f32 v88, v96, v97
v_cvt_pk_bf16_f32 v89, v98, v99
v_cvt_pk_bf16_f32 v90, v100, v101
v_cvt_pk_bf16_f32 v91, v102, v103
v_xor_b32 v9, 96, v19
ds_write_b128 v9, v[88:91] offset:6144
v_mul_f32 v104, v104, v117
v_mul_f32 v105, v105, v117
v_mul_f32 v106, v106, v117
v_mul_f32 v107, v107, v117
v_mul_f32 v108, v108, v117
v_mul_f32 v109, v109, v117
v_mul_f32 v110, v110, v117
v_mul_f32 v111, v111, v117
v_cvt_pk_bf16_f32 v92, v104, v105
v_cvt_pk_bf16_f32 v93, v106, v107
v_cvt_pk_bf16_f32 v94, v108, v109
v_cvt_pk_bf16_f32 v95, v110, v111
v_xor_b32 v9, 112, v19
ds_write_b128 v9, v[92:95] offset:7168
ds_read_b64_tr_b16 v[176:177], v52 offset:0
ds_read_b64_tr_b16 v[178:179], v52 offset:1024
ds_read_b64_tr_b16 v[240:241], v54 offset:0
ds_read_b64_tr_b16 v[242:243], v54 offset:1024
ds_read_b64_tr_b16 v[180:181], v52 offset:8192
ds_read_b64_tr_b16 v[182:183], v52 offset:9216
ds_read_b64_tr_b16 v[244:245], v54 offset:8192
ds_read_b64_tr_b16 v[246:247], v54 offset:9216
ds_read_b64_tr_b16 v[184:185], v52 offset:16384
ds_read_b64_tr_b16 v[186:187], v52 offset:17408
ds_read_b64_tr_b16 v[248:249], v54 offset:16384
ds_read_b64_tr_b16 v[250:251], v54 offset:17408
ds_read_b64_tr_b16 v[188:189], v52 offset:24576
ds_read_b64_tr_b16 v[190:191], v52 offset:25600
ds_read_b64_tr_b16 v[252:253], v54 offset:24576
ds_read_b64_tr_b16 v[254:255], v54 offset:25600
s_waitcnt vmcnt(8) lgkmcnt(0)
s_barrier
s_add_u32 m0, s62, 0
s_add_u32 s60, s61, 2097152
buffer_load_dwordx4 v48, s[16:19], s60 offen offset:0  lds
s_add_u32 s60, s61, 2128896
buffer_load_dwordx4 v48, s[16:19], s60 offen offset:1024  lds
s_add_u32 s60, s61, 2160640
buffer_load_dwordx4 v49, s[16:19], s60 offen offset:2048  lds
s_add_u32 s60, s61, 2192384
buffer_load_dwordx4 v49, s[16:19], s60 offen offset:3072  lds
s_add_u32 m0, s62, 4096
s_add_u32 s60, s61, 2228224
buffer_load_dwordx4 v48, s[16:19], s60 offen offset:0  lds
s_add_u32 s60, s61, 2259968
buffer_load_dwordx4 v48, s[16:19], s60 offen offset:1024  lds
s_add_u32 s60, s61, 2291712
buffer_load_dwordx4 v49, s[16:19], s60 offen offset:2048  lds
s_add_u32 s60, s61, 2323456
buffer_load_dwordx4 v49, s[16:19], s60 offen offset:3072  lds
ds_read_b64_tr_b16 a[128:129], v52 offset:32768
ds_read_b64_tr_b16 a[130:131], v52 offset:33792
ds_read_b64_tr_b16 a[192:193], v54 offset:32768
ds_read_b64_tr_b16 a[194:195], v54 offset:33792
ds_read_b64_tr_b16 a[132:133], v52 offset:40960
ds_read_b64_tr_b16 a[134:135], v52 offset:41984
ds_read_b64_tr_b16 a[196:197], v54 offset:40960
ds_read_b64_tr_b16 a[198:199], v54 offset:41984
ds_read_b64_tr_b16 a[136:137], v52 offset:49152
ds_read_b64_tr_b16 a[138:139], v52 offset:50176
ds_read_b64_tr_b16 a[200:201], v54 offset:49152
ds_read_b64_tr_b16 a[202:203], v54 offset:50176
ds_read_b64_tr_b16 a[140:141], v52 offset:57344
ds_read_b64_tr_b16 a[142:143], v52 offset:58368
ds_read_b64_tr_b16 a[204:205], v54 offset:57344
ds_read_b64_tr_b16 a[206:207], v54 offset:58368
s_waitcnt vmcnt(8) lgkmcnt(0)
s_barrier
s_add_u32 m0, s62, 32768
s_add_u32 s60, s61, 3145728
buffer_load_dwordx4 v48, s[16:19], s60 offen offset:0  lds
s_add_u32 s60, s61, 3177472
buffer_load_dwordx4 v48, s[16:19], s60 offen offset:1024  lds
s_add_u32 s60, s61, 3209216
buffer_load_dwordx4 v49, s[16:19], s60 offen offset:2048  lds
s_add_u32 s60, s61, 3240960
buffer_load_dwordx4 v49, s[16:19], s60 offen offset:3072  lds
s_add_u32 m0, s62, 36864
s_add_u32 s60, s61, 3276800
buffer_load_dwordx4 v48, s[16:19], s60 offen offset:0  lds
s_add_u32 s60, s61, 3308544
buffer_load_dwordx4 v48, s[16:19], s60 offen offset:1024  lds
s_add_u32 s60, s61, 3340288
buffer_load_dwordx4 v49, s[16:19], s60 offen offset:2048  lds
s_add_u32 s60, s61, 3372032
buffer_load_dwordx4 v49, s[16:19], s60 offen offset:3072  lds
buffer_load_dword v60, off, s[40:43], 0 offset:136 sc1
ds_read_b64_tr_b16 a[144:145], v53 offset:0
ds_read_b64_tr_b16 a[146:147], v53 offset:1024
ds_read_b64_tr_b16 a[208:209], v55 offset:0
ds_read_b64_tr_b16 a[210:211], v55 offset:1024
ds_read_b64_tr_b16 a[148:149], v53 offset:8192
ds_read_b64_tr_b16 a[150:151], v53 offset:9216
ds_read_b64_tr_b16 a[212:213], v55 offset:8192
ds_read_b64_tr_b16 a[214:215], v55 offset:9216
ds_read_b64_tr_b16 a[152:153], v53 offset:16384
ds_read_b64_tr_b16 a[154:155], v53 offset:17408
ds_read_b64_tr_b16 a[216:217], v55 offset:16384
ds_read_b64_tr_b16 a[218:219], v55 offset:17408
ds_read_b64_tr_b16 a[156:157], v53 offset:24576
ds_read_b64_tr_b16 a[158:159], v53 offset:25600
ds_read_b64_tr_b16 a[220:221], v55 offset:24576
ds_read_b64_tr_b16 a[222:223], v55 offset:25600
s_waitcnt vmcnt(9) lgkmcnt(0)
s_barrier
s_add_u32 s64, s64, 65536
v_xor_b32 v9, 0, v8
s_add_u32 m0, s67, 98304
s_add_u32 s60, s64, 0
buffer_load_dwordx4 v9, s[44:47], s60 offen offset:0 sc1 lds
v_xor_b32 v9, 16, v8
s_add_u32 s60, s64, 0
buffer_load_dwordx4 v9, s[44:47], s60 offen offset:1024 sc1 lds
v_xor_b32 v9, 32, v8
s_add_u32 s60, s64, 0
buffer_load_dwordx4 v9, s[44:47], s60 offen offset:2048 sc1 lds
v_xor_b32 v9, 48, v8
s_add_u32 s60, s64, 0
buffer_load_dwordx4 v9, s[44:47], s60 offen offset:3072 sc1 lds
v_xor_b32 v9, 64, v8
s_add_u32 m0, s67, 102400
s_add_u32 s60, s64, 4096
buffer_load_dwordx4 v9, s[44:47], s60 offen offset:0 sc1 lds
v_xor_b32 v9, 80, v8
s_add_u32 s60, s64, 4096
buffer_load_dwordx4 v9, s[44:47], s60 offen offset:1024 sc1 lds
v_xor_b32 v9, 96, v8
s_add_u32 s60, s64, 4096
buffer_load_dwordx4 v9, s[44:47], s60 offen offset:2048 sc1 lds
v_xor_b32 v9, 112, v8
s_add_u32 s60, s64, 4096
buffer_load_dwordx4 v9, s[44:47], s60 offen offset:3072 sc1 lds
s_add_u32 s64, s64, 65536
ds_read_b64_tr_b16 a[160:161], v52 offset:0
ds_read_b64_tr_b16 a[162:163], v52 offset:1024
ds_read_b64_tr_b16 a[224:225], v54 offset:0
ds_read_b64_tr_b16 a[226:227], v54 offset:1024
ds_read_b64_tr_b16 a[164:165], v52 offset:8192
ds_read_b64_tr_b16 a[166:167], v52 offset:9216
ds_read_b64_tr_b16 a[228:229], v54 offset:8192
ds_read_b64_tr_b16 a[230:231], v54 offset:9216
ds_read_b64_tr_b16 a[168:169], v52 offset:16384
ds_read_b64_tr_b16 a[170:171], v52 offset:17408
ds_read_b64_tr_b16 a[232:233], v54 offset:16384
ds_read_b64_tr_b16 a[234:235], v54 offset:17408
ds_read_b64_tr_b16 a[172:173], v52 offset:24576
ds_read_b64_tr_b16 a[174:175], v52 offset:25600
ds_read_b64_tr_b16 a[236:237], v54 offset:24576
ds_read_b64_tr_b16 a[238:239], v54 offset:25600
s_waitcnt lgkmcnt(0)
s_waitcnt vmcnt(8)
s_barrier
L_gw_9:
v_readfirstlane_b32 s55, v60
s_nop 0
s_cmp_lg_u32 s55, 0
s_cbranch_scc1 L_gk_10
s_add_u32 s54, s54, 1
s_cmp_gt_u32 s54, 400000
s_cbranch_scc1 L_end
buffer_load_dword v60, off, s[40:43], 0 offset:136 sc1
s_waitcnt vmcnt(0)
s_branch L_gw_9
L_gk_10:
s_lshr_b32 s53, s55, 16
ds_read_b64_tr_b16 a[176:177], v52 offset:32768
ds_read_b64_tr_b16 a[178:179], v52 offset:33792
ds_read_b64_tr_b16 a[240:241], v54 offset:32768
ds_read_b64_tr_b16 a[242:243], v54 offset:33792
ds_read_b64_tr_b16 a[180:181], v52 offset:40960
ds_read_b64_tr_b16 a[182:183], v52 offset:41984
ds_read_b64_tr_b16 a[244:245], v54 offset:40960
ds_read_b64_tr_b16 a[246:247], v54 offset:41984
ds_read_b64_tr_b16 a[184:185], v52 offset:49152
ds_read_b64_tr_b16 a[186:187], v52 offset:50176
ds_read_b64_tr_b16 a[248:249], v54 offset:49152
ds_read_b64_tr_b16 a[250:251], v54 offset:50176
ds_read_b64_tr_b16 a[188:189], v52 offset:57344
ds_read_b64_tr_b16 a[190:191], v52 offset:58368
ds_read_b64_tr_b16 a[252:253], v54 offset:57344
ds_read_b64_tr_b16 a[254:255], v54 offset:58368
s_add_u32 s68, s66, 8192
s_waitcnt lgkmcnt(0)
ds_read_b128 v[28:31], v4 offset:32768
ds_read_b128 v[32:35], v4 offset:49152
ds_read_b128 v[36:39], v5 offset:32768
ds_read_b128 v[40:43], v5 offset:49152
ds_read_b128 v[44:47], v6 offset:32768
ds_read_b128 v[16:19], v6 offset:49152
ds_read_b128 v[56:59], v7 offset:32768
ds_read_b128 v[60:63], v7 offset:49152
s_waitcnt lgkmcnt(6)
v_mfma_f32_16x16x32_bf16 v[80:83], a[128:131], v[28:31], 0
v_mfma_f32_16x16x32_bf16 v[84:87], a[128:131], v[32:35], 0
v_mfma_f32_16x16x32_bf16 v[88:91], a[192:195], v[28:31], 0
v_mfma_f32_16x16x32_bf16 v[92:95], a[192:195], v[32:35], 0
v_mfma_f32_16x16x32_bf16 v[96:99], v[28:31], v[128:131], 0
v_mfma_f32_16x16x32_bf16 v[100:103], v[32:35], v[128:131], 0
v_mfma_f32_16x16x32_bf16 v[104:107], v[28:31], v[192:195], 0
v_mfma_f32_16x16x32_bf16 v[108:111], v[32:35], v[192:195], 0
ds_read_b128 v[28:31], v4 offset:33024
ds_read_b128 v[32:35], v4 offset:49408
s_waitcnt lgkmcnt(6)
v_mfma_f32_16x16x32_bf16 v[80:83], a[132:135], v[36:39], v[80:83]
v_mfma_f32_16x16x32_bf16 v[84:87], a[132:135], v[40:43], v[84:87]
v_mfma_f32_16x16x32_bf16 v[88:91], a[196:199], v[36:39], v[88:91]
v_mfma_f32_16x16x32_bf16 v[92:95], a[196:199], v[40:43], v[92:95]
v_mfma_f32_16x16x32_bf16 v[96:99], v[36:39], v[132:135], v[96:99]
v_mfma_f32_16x16x32_bf16 v[100:103], v[40:43], v[132:135], v[100:103]
v_mfma_f32_16x16x32_bf16 v[104:107], v[36:39], v[196:199], v[104:107]
v_mfma_f32_16x16x32_bf16 v[108:111], v[40:43], v[196:199], v[108:111]
ds_read_b128 v[36:39], v5 offset:33024
ds_read_b128 v[40:43], v5 offset:49408
s_waitcnt lgkmcnt(6)
v_mfma_f32_16x16x32_bf16 v[80:83], a[136:139], v[44:47], v[80:83]
s_add_u32 m0, s62, 65536
s_add_u32 s60, s61, 0
buffer_load_dwordx4 v48, s[12:15], s60 offen offset:0  lds
v_mfma_f32_16x16x32_bf16 v[84:87], a[136:139], v[16:19], v[84:87]
v_mfma_f32_16x16x32_bf16 v[88:91], a[200:203], v[44:47], v[88:91]
v_mfma_f32_16x16x32_bf16 v[92:95], a[200:203], v[16:19], v[92:95]
v_mfma_f32_16x16x32_bf16 v[96:99], v[44:47], v[136:139], v[96:99]
s_add_u32 s60, s61, 31744
buffer_load_dwordx4 v48, s[12:15], s60 offen offset:1024  lds
v_mfma_f32_16x16x32_bf16 v[100:103], v[16:19], v[136:139], v[100:103]
v_mfma_f32_16x16x32_bf16 v[104:107], v[44:47], v[200:203], v[104:107]
v_mfma_f32_16x16x32_bf16 v[108:111], v[16:19], v[200:203], v[108:111]
ds_read_b128 v[44:47], v6 offset:33024
ds_read_b128 v[16:19], v6 offset:49408
s_waitcnt lgkmcnt(6)
v_mfma_f32_16x16x32_bf16 v[80:83], a[140:143], v[56:59], v[80:83]
s_add_u32 s60, s61, 63488
buffer_load_dwordx4 v49, s[12:15], s60 offen offset:2048  lds
v_mfma_f32_16x16x32_bf16 v[84:87], a[140:143], v[60:63], v[84:87]
v_mfma_f32_16x16x32_bf16 v[88:91], a[204:207], v[56:59], v[88:91]
v_mfma_f32_16x16x32_bf16 v[92:95], a[204:207], v[60:63], v[92:95]
v_mfma_f32_16x16x32_bf16 v[96:99], v[56:59], v[140:143], v[96:99]
s_add_u32 s60, s61, 95232
buffer_load_dwordx4 v49, s[12:15], s60 offen offset:3072  lds
v_mfma_f32_16x16x32_bf16 v[100:103], v[60:63], v[140:143], v[100:103]
v_mfma_f32_16x16x32_bf16 v[104:107], v[56:59], v[204:207], v[104:107]
v_mfma_f32_16x16x32_bf16 v[108:111], v[60:63], v[204:207], v[108:111]
ds_read_b128 v[56:59], v7 offset:33024
ds_read_b128 v[60:63], v7 offset:49408
s_waitcnt lgkmcnt(6)
v_mfma_f32_16x16x32_bf16 v[80:83], a[144:147], v[28:31], v[80:83]
s_add_u32 m0, s62, 69632
s_add_u32 s60, s61, 131072
buffer_load_dwordx4 v48, s[12:15], s60 offen offset:0  lds
v_mfma_f32_16x16x32_bf16 v[84:87], a[144:147], v[32:35], v[84:87]
v_mfma_f32_16x16x32_bf16 v[88:91], a[208:211], v[28:31], v[88:91]
v_mfma_f32_16x16x32_bf16 v[92:95], a[208:211], v[32:35], v[92:95]
v_mfma_f32_16x16x32_bf16 v[96:99], v[28:31], v[144:147], v[96:99]
s_add_u32 s60, s61, 162816
buffer_load_dwordx4 v48, s[12:15], s60 offen offset:1024  lds
v_mfma_f32_16x16x32_bf16 v[100:103], v[32:35], v[144:147], v[100:103]
v_mfma_f32_16x16x32_bf16 v[104:107], v[28:31], v[208:211], v[104:107]
v_mfma_f32_16x16x32_bf16 v[108:111], v[32:35], v[208:211], v[108:111]
ds_read_b128 v[28:31], v4 offset:33280
ds_read_b128 v[32:35], v4 offset:49664
s_waitcnt lgkmcnt(6)
v_mfma_f32_16x16x32_bf16 v[80:83], a[148:151], v[36:39], v[80:83]
s_add_u32 s60, s61, 194560
buffer_load_dwordx4 v49, s[12:15], s60 offen offset:2048  lds
v_mfma_f32_16x16x32_bf16 v[84:87], a[148:151], v[40:43], v[84:87]
v_mfma_f32_16x16x32_bf16 v[88:91], a[212:215], v[36:39], v[88:91]
v_mfma_f32_16x16x32_bf16 v[92:95], a[212:215], v[40:43], v[92:95]
v_mfma_f32_16x16x32_bf16 v[96:99], v[36:39], v[148:151], v[96:99]
s_add_u32 s60, s61, 226304
buffer_load_dwordx4 v49, s[12:15], s60 offen offset:3072  lds
v_mfma_f32_16x16x32_bf16 v[100:103], v[40:43], v[148:151], v[100:103]
v_mfma_f32_16x16x32_bf16 v[104:107], v[36:39], v[212:215], v[104:107]
v_mfma_f32_16x16x32_bf16 v[108:111], v[40:43], v[212:215], v[108:111]
ds_read_b128 v[36:39], v5 offset:33280
ds_read_b128 v[40:43], v5 offset:49664
s_waitcnt lgkmcnt(6)
v_mfma_f32_16x16x32_bf16 v[80:83], a[152:155], v[44:47], v[80:83]
v_mfma_f32_16x16x32_bf16 v[84:87], a[152:155], v[16:19], v[84:87]
v_mfma_f32_16x16x32_bf16 v[88:91], a[216:219], v[44:47], v[88:91]
v_mfma_f32_16x16x32_bf16 v[92:95], a[216:219], v[16:19], v[92:95]
v_mfma_f32_16x16x32_bf16 v[96:99], v[44:47], v[152:155], v[96:99]
v_mfma_f32_16x16x32_bf16 v[100:103], v[16:19], v[152:155], v[100:103]
v_mfma_f32_16x16x32_bf16 v[104:107], v[44:47], v[216:219], v[104:107]
v_mfma_f32_16x16x32_bf16 v[108:111], v[16:19], v[216:219], v[108:111]
ds_read_b128 v[44:47], v6 offset:33280
ds_read_b128 v[16:19], v6 offset:49664
s_waitcnt lgkmcnt(6)
v_mfma_f32_16x16x32_bf16 v[80:83], a[156:159], v[56:59], v[80:83]
v_mfma_f32_16x16x32_bf16 v[84:87], a[156:159], v[60:63], v[84:87]
v_mfma_f32_16x16x32_bf16 v[88:91], a[220:223], v[56:59], v[88:91]
v_mfma_f32_16x16x32_bf16 v[92:95], a[220:223], v[60:63], v[92:95]
v_mfma_f32_16x16x32_bf16 v[96:99], v[56:59], v[156:159], v[96:99]
v_mfma_f32_16x16x32_bf16 v[100:103], v[60:63], v[156:159], v[100:103]
v_mfma_f32_16x16x32_bf16 v[104:107], v[56:59], v[220:223], v[104:107]
v_mfma_f32_16x16x32_bf16 v[108:111], v[60:63], v[220:223], v[108:111]
ds_read_b128 v[56:59], v7 offset:33280
ds_read_b128 v[60:63], v7 offset:49664
s_waitcnt lgkmcnt(6)
v_mfma_f32_16x16x32_bf16 v[80:83], a[160:163], v[28:31], v[80:83]
v_mfma_f32_16x16x32_bf16 v[84:87], a[160:163], v[32:35], v[84:87]
v_mfma_f32_16x16x32_bf16 v[88:91], a[224:227], v[28:31], v[88:91]
v_mfma_f32_16x16x32_bf16 v[92:95], a[224:227], v[32:35], v[92:95]
v_mfma_f32_16x16x32_bf16 v[96:99], v[28:31], v[160:163], v[96:99]
v_mfma_f32_16x16x32_bf16 v[100:103], v[32:35], v[160:163], v[100:103]
v_mfma_f32_16x16x32_bf16 v[104:107], v[28:31], v[224:227], v[104:107]
v_mfma_f32_16x16x32_bf16 v[108:111], v[32:35], v[224:227], v[108:111]
ds_read_b128 v[28:31], v4 offset:33536
ds_read_b128 v[32:35], v4 offset:49920
s_waitcnt lgkmcnt(6)
v_mfma_f32_16x16x32_bf16 v[80:83], a[164:167], v[36:39], v[80:83]
v_mfma_f32_16x16x32_bf16 v[84:87], a[164:167], v[40:43], v[84:87]
v_mfma_f32_16x16x32_bf16 v[88:91], a[228:231], v[36:39], v[88:91]
v_mfma_f32_16x16x32_bf16 v[92:95], a[228:231], v[40:43], v[92:95]
v_mfma_f32_16x16x32_bf16 v[96:99], v[36:39], v[164:167], v[96:99]
v_mfma_f32_16x16x32_bf16 v[100:103], v[40:43], v[164:167], v[100:103]
v_mfma_f32_16x16x32_bf16 v[104:107], v[36:39], v[228:231], v[104:107]
v_mfma_f32_16x16x32_bf16 v[108:111], v[40:43], v[228:231], v[108:111]
ds_read_b128 v[36:39], v5 offset:33536
ds_read_b128 v[40:43], v5 offset:49920
s_waitcnt lgkmcnt(6)
v_mfma_f32_16x16x32_bf16 v[80:83], a[168:171], v[44:47], v[80:83]
v_mfma_f32_16x16x32_bf16 v[84:87], a[168:171], v[16:19], v[84:87]
v_mfma_f32_16x16x32_bf16 v[88:91], a[232:235], v[44:47], v[88:91]
v_mfma_f32_16x16x32_bf16 v[92:95], a[232:235], v[16:19], v[92:95]
v_mfma_f32_16x16x32_bf16 v[96:99], v[44:47], v[168:171], v[96:99]
v_mfma_f32_16x16x32_bf16 v[100:103], v[16:19], v[168:171], v[100:103]
v_mfma_f32_16x16x32_bf16 v[104:107], v[44:47], v[232:235], v[104:107]
v_mfma_f32_16x16x32_bf16 v[108:111], v[16:19], v[232:235], v[108:111]
ds_read_b128 v[44:47], v6 offset:33536
ds_read_b128 v[16:19], v6 offset:49920
s_waitcnt lgkmcnt(6)
v_mfma_f32_16x16x32_bf16 v[80:83], a[172:175], v[56:59], v[80:83]
v_mfma_f32_16x16x32_bf16 v[84:87], a[172:175], v[60:63], v[84:87]
v_mfma_f32_16x16x32_bf16 v[88:91], a[236:239], v[56:59], v[88:91]
v_mfma_f32_16x16x32_bf16 v[92:95], a[236:239], v[60:63], v[92:95]
v_mfma_f32_16x16x32_bf16 v[96:99], v[56:59], v[172:175], v[96:99]
v_mfma_f32_16x16x32_bf16 v[100:103], v[60:63], v[172:175], v[100:103]
v_mfma_f32_16x16x32_bf16 v[104:107], v[56:59], v[236:239], v[104:107]
v_mfma_f32_16x16x32_bf16 v[108:111], v[60:63], v[236:239], v[108:111]
ds_read_b128 v[56:59], v7 offset:33536
ds_read_b128 v[60:63], v7 offset:49920
s_waitcnt lgkmcnt(6)
v_mfma_f32_16x16x32_bf16 v[80:83], a[176:179], v[28:31], v[80:83]
v_mfma_f32_16x16x32_bf16 v[84:87], a[176:179], v[32:35], v[84:87]
v_mfma_f32_16x16x32_bf16 v[88:91], a[240:243], v[28:31], v[88:91]
v_mfma_f32_16x16x32_bf16 v[92:95], a[240:243], v[32:35], v[92:95]
v_mfma_f32_16x16x32_bf16 v[96:99], v[28:31], v[176:179], v[96:99]
v_mfma_f32_16x16x32_bf16 v[100:103], v[32:35], v[176:179], v[100:103]
v_mfma_f32_16x16x32_bf16 v[104:107], v[28:31], v[240:243], v[104:107]
v_mfma_f32_16x16x32_bf16 v[108:111], v[32:35], v[240:243], v[108:111]
s_waitcnt vmcnt(8)
s_barrier
ds_read_b128 v[28:31], v4 offset:0
ds_read_b128 v[32:35], v4 offset:16384
s_waitcnt lgkmcnt(6)
v_mfma_f32_16x16x32_bf16 v[80:83], a[180:183], v[36:39], v[80:83]
v_mfma_f32_16x16x32_bf16 v[84:87], a[180:183], v[40:43], v[84:87]
v_mfma_f32_16x16x32_bf16 v[88:91], a[244:247], v[36:39], v[88:91]
v_mfma_f32_16x16x32_bf16 v[92:95], a[244:247], v[40:43], v[92:95]
v_mfma_f32_16x16x32_bf16 v[96:99], v[36:39], v[180:183], v[96:99]
v_mfma_f32_16x16x32_bf16 v[100:103], v[40:43], v[180:183], v[100:103]
v_mfma_f32_16x16x32_bf16 v[104:107], v[36:39], v[244:247], v[104:107]
v_mfma_f32_16x16x32_bf16 v[108:111], v[40:43], v[244:247], v[108:111]
ds_read_b128 v[36:39], v5 offset:0
ds_read_b128 v[40:43], v5 offset:16384
s_waitcnt lgkmcnt(6)
v_mfma_f32_16x16x32_bf16 v[80:83], a[184:187], v[44:47], v[80:83]
v_mfma_f32_16x16x32_bf16 v[84:87], a[184:187], v[16:19], v[84:87]
v_mfma_f32_16x16x32_bf16 v[88:91], a[248:251], v[44:47], v[88:91]
v_mfma_f32_16x16x32_bf16 v[92:95], a[248:251], v[16:19], v[92:95]
v_mfma_f32_16x16x32_bf16 v[96:99], v[44:47], v[184:187], v[96:99]
v_mfma_f32_16x16x32_bf16 v[100:103], v[16:19], v[184:187], v[100:103]
v_mfma_f32_16x16x32_bf16 v[104:107], v[44:47], v[248:251], v[104:107]
v_mfma_f32_16x16x32_bf16 v[108:111], v[16:19], v[248:251], v[108:111]
ds_read_b128 v[44:47], v6 offset:0
ds_read_b128 v[16:19], v6 offset:16384
s_waitcnt lgkmcnt(6)
v_mfma_f32_16x16x32_bf16 v[80:83], a[188:191], v[56:59], v[80:83]
v_mfma_f32_16x16x32_bf16 v[84:87], a[188:191], v[60:63], v[84:87]
v_mfma_f32_16x16x32_bf16 v[88:91], a[252:255], v[56:59], v[88:91]
v_cvt_pk_bf16_f32 v120, v80, v81
v_cvt_pk_bf16_f32 v121, v82, v83
v_mfma_f32_16x16x32_bf16 v[92:95], a[252:255], v[60:63], v[92:95]
v_cvt_pk_bf16_f32 v124, v84, v85
v_cvt_pk_bf16_f32 v125, v86, v87
v_mfma_f32_16x16x32_bf16 v[96:99], v[56:59], v[188:191], v[96:99]
v_cvt_pk_bf16_f32 v122, v88, v89
v_cvt_pk_bf16_f32 v123, v90, v91
v_mfma_f32_16x16x32_bf16 v[100:103], v[60:63], v[188:191], v[100:103]
v_cvt_pk_bf16_f32 v126, v92, v93
v_cvt_pk_bf16_f32 v127, v94, v95
v_mfma_f32_16x16x32_bf16 v[104:107], v[56:59], v[252:255], v[104:107]
v_cvt_pk_bf16_f32 v20, v96, v97
v_cvt_pk_bf16_f32 v21, v98, v99
v_mfma_f32_16x16x32_bf16 v[108:111], v[60:63], v[252:255], v[108:111]
v_cvt_pk_bf16_f32 v22, v100, v101
v_cvt_pk_bf16_f32 v23, v102, v103
ds_read_b128 v[56:59], v7 offset:0
ds_read_b128 v[60:63], v7 offset:16384
s_waitcnt lgkmcnt(6)
v_mfma_f32_16x16x32_bf16 v[80:83], a[128:131], v[28:31], 0
v_cvt_pk_bf16_f32 v24, v104, v105
v_cvt_pk_bf16_f32 v25, v106, v107
v_mfma_f32_16x16x32_bf16 v[84:87], a[128:131], v[32:35], 0
v_cvt_pk_bf16_f32 v26, v108, v109
v_cvt_pk_bf16_f32 v27, v110, v111
v_mfma_f32_16x16x32_bf16 v[88:91], a[192:195], v[28:31], 0
s_add_u32 s55, s69, 8192
buffer_store_dwordx4 v[120:123], v13, s[44:47], s55 offen sc1
v_mfma_f32_16x16x32_bf16 v[92:95], a[192:195], v[32:35], 0
v_mfma_f32_16x16x32_bf16 v[96:99], v[28:31], v[128:131], 0
v_mfma_f32_16x16x32_bf16 v[100:103], v[32:35], v[128:131], 0
v_mfma_f32_16x16x32_bf16 v[104:107], v[28:31], v[192:195], 0
s_add_u32 s55, s69, 12288
buffer_store_dwordx4 v[124:127], v13, s[44:47], s55 offen sc1
v_mfma_f32_16x16x32_bf16 v[108:111], v[32:35], v[192:195], 0
ds_read_b128 v[28:31], v4 offset:256
ds_read_b128 v[32:35], v4 offset:16640
s_waitcnt lgkmcnt(6)
v_mfma_f32_16x16x32_bf16 v[80:83], a[132:135], v[36:39], v[80:83]
v_mfma_f32_16x16x32_bf16 v[84:87], a[132:135], v[40:43], v[84:87]
v_mfma_f32_16x16x32_bf16 v[88:91], a[196:199], v[36:39], v[88:91]
s_add_u32 s55, s69, 16384
buffer_store_dwordx4 v[20:23], v14, s[44:47], s55 offen offset:0 sc1
v_mfma_f32_16x16x32_bf16 v[92:95], a[196:199], v[40:43], v[92:95]
v_mfma_f32_16x16x32_bf16 v[96:99], v[36:39], v[132:135], v[96:99]
v_mfma_f32_16x16x32_bf16 v[100:103], v[40:43], v[132:135], v[100:103]
v_mfma_f32_16x16x32_bf16 v[104:107], v[36:39], v[196:199], v[104:107]
s_add_u32 s55, s69, 16384
buffer_store_dwordx4 v[24:27], v14, s[44:47], s55 offen offset:1024 sc1
v_mfma_f32_16x16x32_bf16 v[108:111], v[40:43], v[196:199], v[108:111]
ds_read_b128 v[36:39], v5 offset:256
ds_read_b128 v[40:43], v5 offset:16640
s_waitcnt lgkmcnt(6)
v_mfma_f32_16x16x32_bf16 v[80:83], a[136:139], v[44:47], v[80:83]
v_mfma_f32_16x16x32_bf16 v[84:87], a[136:139], v[16:19], v[84:87]
v_mfma_f32_16x16x32_bf16 v[88:91], a[200:203], v[44:47], v[88:91]
v_mfma_f32_16x16x32_bf16 v[92:95], a[200:203], v[16:19], v[92:95]
v_mfma_f32_16x16x32_bf16 v[96:99], v[44:47], v[136:139], v[96:99]
v_mfma_f32_16x16x32_bf16 v[100:103], v[16:19], v[136:139], v[100:103]
v_mfma_f32_16x16x32_bf16 v[104:107], v[44:47], v[200:203], v[104:107]
v_mfma_f32_16x16x32_bf16 v[108:111], v[16:19], v[200:203], v[108:111]
ds_read_b128 v[44:47], v6 offset:256
ds_read_b128 v[16:19], v6 offset:16640
s_waitcnt lgkmcnt(6)
v_mfma_f32_16x16x32_bf16 v[80:83], a[140:143], v[56:59], v[80:83]
v_mfma_f32_16x16x32_bf16 v[84:87], a[140:143], v[60:63], v[84:87]
v_mfma_f32_16x16x32_bf16 v[88:91], a[204:207], v[56:59], v[88:91]
v_mfma_f32_16x16x32_bf16 v[92:95], a[204:207], v[60:63], v[92:95]
v_mfma_f32_16x16x32_bf16 v[96:99], v[56:59], v[140:143], v[96:99]
v_mfma_f32_16x16x32_bf16 v[100:103], v[60:63], v[140:143], v[100:103]
v_mfma_f32_16x16x32_bf16 v[104:107], v[56:59], v[204:207], v[104:107]
v_mfma_f32_16x16x32_bf16 v[108:111], v[60:63], v[204:207], v[108:111]
ds_read_b128 v[56:59], v7 offset:256
ds_read_b128 v[60:63], v7 offset:16640
s_waitcnt lgkmcnt(6)
v_mfma_f32_16x16x32_bf16 v[80:83], a[144:147], v[28:31], v[80:83]
v_mfma_f32_16x16x32_bf16 v[84:87], a[144:147], v[32:35], v[84:87]
v_mfma_f32_16x16x32_bf16 v[88:91], a[208:211], v[28:31], v[88:91]
v_mfma_f32_16x16x32_bf16 v[92:95], a[208:211], v[32:35], v[92:95]
v_mfma_f32_16x16x32_bf16 v[96:99], v[28:31], v[144:147], v[96:99]
v_mfma_f32_16x16x32_bf16 v[100:103], v[32:35], v[144:147], v[100:103]
v_mfma_f32_16x16x32_bf16 v[104:107], v[28:31], v[208:211], v[104:107]
v_mfma_f32_16x16x32_bf16 v[108:111], v[32:35], v[208:211], v[108:111]
ds_read_b128 v[28:31], v4 offset:512
ds_read_b128 v[32:35], v4 offset:16896
s_waitcnt lgkmcnt(6)
v_mfma_f32_16x16x32_bf16 v[80:83], a[148:151], v[36:39], v[80:83]
v_mfma_f32_16x16x32_bf16 v[84:87], a[148:151], v[40:43], v[84:87]
v_mfma_f32_16x16x32_bf16 v[88:91], a[212:215], v[36:39], v[88:91]
v_mfma_f32_16x16x32_bf16 v[92:95], a[212:215], v[40:43], v[92:95]
v_mfma_f32_16x16x32_bf16 v[96:99], v[36:39], v[148:151], v[96:99]
v_mfma_f32_16x16x32_bf16 v[100:103], v[40:43], v[148:151], v[100:103]
v_mfma_f32_16x16x32_bf16 v[104:107], v[36:39], v[212:215], v[104:107]
v_mfma_f32_16x16x32_bf16 v[108:111], v[40:43], v[212:215], v[108:111]
ds_read_b128 v[36:39], v5 offset:512
ds_read_b128 v[40:43], v5 offset:16896
s_waitcnt lgkmcnt(6)
v_mfma_f32_16x16x32_bf16 v[80:83], a[152:155], v[44:47], v[80:83]
s_add_u32 m0, s62, 0
s_add_u32 s60, s61, 1048576
buffer_load_dwordx4 v48, s[12:15], s60 offen offset:0  lds
v_mfma_f32_16x16x32_bf16 v[84:87], a[152:155], v[16:19], v[84:87]
v_mfma_f32_16x16x32_bf16 v[88:91], a[216:219], v[44:47], v[88:91]
v_mfma_f32_16x16x32_bf16 v[92:95], a[216:219], v[16:19], v[92:95]
v_mfma_f32_16x16x32_bf16 v[96:99], v[44:47], v[152:155], v[96:99]
s_add_u32 s60, s61, 1080320
buffer_load_dwordx4 v48, s[12:15], s60 offen offset:1024  lds
v_mfma_f32_16x16x32_bf16 v[100:103], v[16:19], v[152:155], v[100:103]
v_mfma_f32_16x16x32_bf16 v[104:107], v[44:47], v[216:219], v[104:107]
v_mfma_f32_16x16x32_bf16 v[108:111], v[16:19], v[216:219], v[108:111]
ds_read_b128 v[44:47], v6 offset:512
ds_read_b128 v[16:19], v6 offset:16896
s_waitcnt lgkmcnt(6)
v_mfma_f32_16x16x32_bf16 v[80:83], a[156:159], v[56:59], v[80:83]
s_add_u32 s60, s61, 1112064
buffer_load_dwordx4 v49, s[12:15], s60 offen offset:2048  lds
v_mfma_f32_16x16x32_bf16 v[84:87], a[156:159], v[60:63], v[84:87]
v_mfma_f32_16x16x32_bf16 v[88:91], a[220:223], v[56:59], v[88:91]
v_mfma_f32_16x16x32_bf16 v[92:95], a[220:223], v[60:63], v[92:95]
v_mfma_f32_16x16x32_bf16 v[96:99], v[56:59], v[156:159], v[96:99]
s_add_u32 s60, s61, 1143808
buffer_load_dwordx4 v49, s[12:15], s60 offen offset:3072  lds
v_mfma_f32_16x16x32_bf16 v[100:103], v[60:63], v[156:159], v[100:103]
v_mfma_f32_16x16x32_bf16 v[104:107], v[56:59], v[220:223], v[104:107]
v_mfma_f32_16x16x32_bf16 v[108:111], v[60:63], v[220:223], v[108:111]
s_waitcnt vmcnt(4)
s_barrier
s_mov_b64 exec, 1
buffer_store_dword v2, off, s[44:47], s66 offset:4 sc1
s_mov_b64 exec, -1
ds_read_b128 v[56:59], v7 offset:512
ds_read_b128 v[60:63], v7 offset:16896
s_waitcnt lgkmcnt(6)
v_mfma_f32_16x16x32_bf16 v[80:83], a[160:163], v[28:31], v[80:83]
s_add_u32 m0, s62, 4096
s_add_u32 s60, s61, 1179648
buffer_load_dwordx4 v48, s[12:15], s60 offen offset:0  lds
v_mfma_f32_16x16x32_bf16 v[84:87], a[160:163], v[32:35], v[84:87]
v_mfma_f32_16x16x32_bf16 v[88:91], a[224:227], v[28:31], v[88:91]
v_mfma_f32_16x16x32_bf16 v[92:95], a[224:227], v[32:35], v[92:95]
v_mfma_f32_16x16x32_bf16 v[96:99], v[28:31], v[160:163], v[96:99]
s_add_u32 s60, s61, 1211392
buffer_load_dwordx4 v48, s[12:15], s60 offen offset:1024  lds
v_mfma_f32_16x16x32_bf16 v[100:103], v[32:35], v[160:163], v[100:103]
v_mfma_f32_16x16x32_bf16 v[104:107], v[28:31], v[224:227], v[104:107]
v_mfma_f32_16x16x32_bf16 v[108:111], v[32:35], v[224:227], v[108:111]
ds_read_b128 v[28:31], v4 offset:768
ds_read_b128 v[32:35], v4 offset:17152
s_waitcnt lgkmcnt(6)
v_mfma_f32_16x16x32_bf16 v[80:83], a[164:167], v[36:39], v[80:83]
s_add_u32 s60, s61, 1243136
buffer_load_dwordx4 v49, s[12:15], s60 offen offset:2048  lds
v_mfma_f32_16x16x32_bf16 v[84:87], a[164:167], v[40:43], v[84:87]
v_mfma_f32_16x16x32_bf16 v[88:91], a[228:231], v[36:39], v[88:91]
v_mfma_f32_16x16x32_bf16 v[92:95], a[228:231], v[40:43], v[92:95]
v_mfma_f32_16x16x32_bf16 v[96:99], v[36:39], v[164:167], v[96:99]
s_add_u32 s60, s61, 1274880
buffer_load_dwordx4 v49, s[12:15], s60 offen offset:3072  lds
v_mfma_f32_16x16x32_bf16 v[100:103], v[40:43], v[164:167], v[100:103]
v_mfma_f32_16x16x32_bf16 v[104:107], v[36:39], v[228:231], v[104:107]
v_mfma_f32_16x16x32_bf16 v[108:111], v[40:43], v[228:231], v[108:111]
ds_read_b128 v[36:39], v5 offset:768
ds_read_b128 v[40:43], v5 offset:17152
s_waitcnt lgkmcnt(6)
v_mfma_f32_16x16x32_bf16 v[80:83], a[168:171], v[44:47], v[80:83]
v_mfma_f32_16x16x32_bf16 v[84:87], a[168:171], v[16:19], v[84:87]
v_mfma_f32_16x16x32_bf16 v[88:91], a[232:235], v[44:47], v[88:91]
v_mfma_f32_16x16x32_bf16 v[92:95], a[232:235], v[16:19], v[92:95]
v_mfma_f32_16x16x32_bf16 v[96:99], v[44:47], v[168:171], v[96:99]
v_mfma_f32_16x16x32_bf16 v[100:103], v[16:19], v[168:171], v[100:103]
v_mfma_f32_16x16x32_bf16 v[104:107], v[44:47], v[232:235], v[104:107]
v_mfma_f32_16x16x32_bf16 v[108:111], v[16:19], v[232:235], v[108:111]
ds_read_b128 v[44:47], v6 offset:768
ds_read_b128 v[16:19], v6 offset:17152
s_waitcnt lgkmcnt(6)
v_mfma_f32_16x16x32_bf16 v[80:83], a[172:175], v[56:59], v[80:83]
v_mfma_f32_16x16x32_bf16 v[84:87], a[172:175], v[60:63], v[84:87]
v_mfma_f32_16x16x32_bf16 v[88:91], a[236:239], v[56:59], v[88:91]
v_mfma_f32_16x16x32_bf16 v[92:95], a[236:239], v[60:63], v[92:95]
v_mfma_f32_16x16x32_bf16 v[96:99], v[56:59], v[172:175], v[96:99]
v_mfma_f32_16x16x32_bf16 v[100:103], v[60:63], v[172:175], v[100:103]
v_mfma_f32_16x16x32_bf16 v[104:107], v[56:59], v[236:239], v[104:107]
v_mfma_f32_16x16x32_bf16 v[108:111], v[60:63], v[236:239], v[108:111]
ds_read_b128 v[56:59], v7 offset:768
ds_read_b128 v[60:63], v7 offset:17152
s_waitcnt lgkmcnt(6)
v_mfma_f32_16x16x32_bf16 v[80:83], a[176:179], v[28:31], v[80:83]
v_mfma_f32_16x16x32_bf16 v[84:87], a[176:179], v[32:35], v[84:87]
v_mfma_f32_16x16x32_bf16 v[88:91], a[240:243], v[28:31], v[88:91]
v_mfma_f32_16x16x32_bf16 v[92:95], a[240:243], v[32:35], v[92:95]
v_mfma_f32_16x16x32_bf16 v[96:99], v[28:31], v[176:179], v[96:99]
v_mfma_f32_16x16x32_bf16 v[100:103], v[32:35], v[176:179], v[100:103]
v_mfma_f32_16x16x32_bf16 v[104:107], v[28:31], v[240:243], v[104:107]
v_mfma_f32_16x16x32_bf16 v[108:111], v[32:35], v[240:243], v[108:111]
ds_read_b128 v[28:31], v4 offset:32768
ds_read_b128 v[32:35], v4 offset:49152
s_waitcnt lgkmcnt(6)
v_mfma_f32_16x16x32_bf16 v[80:83], a[180:183], v[36:39], v[80:83]
v_mfma_f32_16x16x32_bf16 v[84:87], a[180:183], v[40:43], v[84:87]
v_mfma_f32_16x16x32_bf16 v[88:91], a[244:247], v[36:39], v[88:91]
v_mfma_f32_16x16x32_bf16 v[92:95], a[244:247], v[40:43], v[92:95]
v_mfma_f32_16x16x32_bf16 v[96:99], v[36:39], v[180:183], v[96:99]
v_mfma_f32_16x16x32_bf16 v[100:103], v[40:43], v[180:183], v[100:103]
v_mfma_f32_16x16x32_bf16 v[104:107], v[36:39], v[244:247], v[104:107]
v_mfma_f32_16x16x32_bf16 v[108:111], v[40:43], v[244:247], v[108:111]
ds_read_b128 v[36:39], v5 offset:32768
ds_read_b128 v[40:43], v5 offset:49152
s_waitcnt lgkmcnt(6)
v_mfma_f32_16x16x32_bf16 v[80:83], a[184:187], v[44:47], v[80:83]
v_mfma_f32_16x16x32_bf16 v[84:87], a[184:187], v[16:19], v[84:87]
v_mfma_f32_16x16x32_bf16 v[88:91], a[248:251], v[44:47], v[88:91]
v_mfma_f32_16x16x32_bf16 v[92:95], a[248:251], v[16:19], v[92:95]
v_mfma_f32_16x16x32_bf16 v[96:99], v[44:47], v[184:187], v[96:99]
v_mfma_f32_16x16x32_bf16 v[100:103], v[16:19], v[184:187], v[100:103]
v_mfma_f32_16x16x32_bf16 v[104:107], v[44:47], v[248:251], v[104:107]
v_mfma_f32_16x16x32_bf16 v[108:111], v[16:19], v[248:251], v[108:111]
ds_read_b128 v[44:47], v6 offset:32768
ds_read_b128 v[16:19], v6 offset:49152
s_waitcnt lgkmcnt(6)
v_mfma_f32_16x16x32_bf16 v[80:83], a[188:191], v[56:59], v[80:83]
v_mfma_f32_16x16x32_bf16 v[84:87], a[188:191], v[60:63], v[84:87]
v_mfma_f32_16x16x32_bf16 v[88:91], a[252:255], v[56:59], v[88:91]
v_cvt_pk_bf16_f32 v120, v80, v81
v_cvt_pk_bf16_f32 v121, v82, v83
v_mfma_f32_16x16x32_bf16 v[92:95], a[252:255], v[60:63], v[92:95]
v_cvt_pk_bf16_f32 v124, v84, v85
v_cvt_pk_bf16_f32 v125, v86, v87
v_mfma_f32_16x16x32_bf16 v[96:99], v[56:59], v[188:191], v[96:99]
v_cvt_pk_bf16_f32 v122, v88, v89
v_cvt_pk_bf16_f32 v123, v90, v91
v_mfma_f32_16x16x32_bf16 v[100:103], v[60:63], v[188:191], v[100:103]
v_cvt_pk_bf16_f32 v126, v92, v93
v_cvt_pk_bf16_f32 v127, v94, v95
v_mfma_f32_16x16x32_bf16 v[104:107], v[56:59], v[252:255], v[104:107]
v_cvt_pk_bf16_f32 v20, v96, v97
v_cvt_pk_bf16_f32 v21, v98, v99
v_mfma_f32_16x16x32_bf16 v[108:111], v[60:63], v[252:255], v[108:111]
v_cvt_pk_bf16_f32 v22, v100, v101
v_cvt_pk_bf16_f32 v23, v102, v103
s_add_u32 s69, s69, 1572864
v_cvt_pk_bf16_f32 v24, v104, v105
v_cvt_pk_bf16_f32 v25, v106, v107
s_nop 2
v_cvt_pk_bf16_f32 v26, v108, v109
v_cvt_pk_bf16_f32 v27, v110, v111
s_add_u32 s55, s69, 8192
buffer_store_dwordx4 v[120:123], v13, s[44:47], s55 offen sc1
s_add_u32 s55, s69, 12288
buffer_store_dwordx4 v[124:127], v13, s[44:47], s55 offen sc1
s_add_u32 s55, s69, 16384
buffer_store_dwordx4 v[20:23], v14, s[44:47], s55 offen offset:0 sc1
s_add_u32 s55, s69, 16384
buffer_store_dwordx4 v[24:27], v14, s[44:47], s55 offen offset:1024 sc1
s_waitcnt vmcnt(13)
s_barrier
ds_read_b64_tr_b16 a[0:1], v53 offset:0
ds_read_b64_tr_b16 a[2:3], v53 offset:1024
ds_read_b64_tr_b16 a[64:65], v55 offset:0
ds_read_b64_tr_b16 a[66:67], v55 offset:1024
ds_read_b128 v[56:59], v7 offset:32768
ds_read_b128 v[60:63], v7 offset:49152
s_waitcnt lgkmcnt(2)
v_mfma_f32_16x16x32_bf16 v[64:67], a[0:3], v[28:31], 0
ds_read_b64_tr_b16 a[4:5], v53 offset:8192
s_add_u32 m0, s62, 32768
s_add_u32 s60, s61, 2097152
buffer_load_dwordx4 v48, s[12:15], s60 offen offset:0  lds
v_mfma_f32_16x16x32_bf16 v[68:71], a[0:3], v[32:35], 0
ds_read_b64_tr_b16 a[6:7], v53 offset:9216
s_add_u32 s60, s61, 2128896
buffer_load_dwordx4 v48, s[12:15], s60 offen offset:1024  lds
v_mfma_f32_16x16x32_bf16 v[72:75], a[64:67], v[28:31], 0
ds_read_b64_tr_b16 a[68:69], v55 offset:8192
s_add_u32 s60, s61, 2160640
buffer_load_dwordx4 v49, s[12:15], s60 offen offset:2048  lds
v_mfma_f32_16x16x32_bf16 v[76:79], a[64:67], v[32:35], 0
ds_read_b64_tr_b16 a[70:71], v55 offset:9216
s_add_u32 s60, s61, 2192384
buffer_load_dwordx4 v49, s[12:15], s60 offen offset:3072  lds
ds_read_b128 v[28:31], v4 offset:33024
ds_read_b128 v[32:35], v4 offset:49408
s_waitcnt lgkmcnt(2)
v_mfma_f32_16x16x32_bf16 v[64:67], a[4:7], v[36:39], v[64:67]
ds_read_b64_tr_b16 a[8:9], v53 offset:16384
s_add_u32 m0, s62, 36864
s_add_u32 s60, s61, 2228224
buffer_load_dwordx4 v48, s[12:15], s60 offen offset:0  lds
v_mfma_f32_16x16x32_bf16 v[68:71], a[4:7], v[40:43], v[68:71]
ds_read_b64_tr_b16 a[10:11], v53 offset:17408
s_add_u32 s60, s61, 2259968
buffer_load_dwordx4 v48, s[12:15], s60 offen offset:1024  lds
v_mfma_f32_16x16x32_bf16 v[72:75], a[68:71], v[36:39], v[72:75]
ds_read_b64_tr_b16 a[72:73], v55 offset:16384
s_add_u32 s60, s61, 2291712
buffer_load_dwordx4 v49, s[12:15], s60 offen offset:2048  lds
v_mfma_f32_16x16x32_bf16 v[76:79], a[68:71], v[40:43], v[76:79]
ds_read_b64_tr_b16 a[74:75], v55 offset:17408
s_add_u32 s60, s61, 2323456
buffer_load_dwordx4 v49, s[12:15], s60 offen offset:3072  lds
ds_read_b128 v[36:39], v5 offset:33024
ds_read_b128 v[40:43], v5 offset:49408
s_waitcnt lgkmcnt(2)
v_mfma_f32_16x16x32_bf16 v[64:67], a[8:11], v[44:47], v[64:67]
ds_read_b64_tr_b16 a[12:13], v53 offset:24576
v_mfma_f32_16x16x32_bf16 v[68:71], a[8:11], v[16:19], v[68:71]
ds_read_b64_tr_b16 a[14:15], v53 offset:25600
v_mfma_f32_16x16x32_bf16 v[72:75], a[72:75], v[44:47], v[72:75]
ds_read_b64_tr_b16 a[76:77], v55 offset:24576
v_mfma_f32_16x16x32_bf16 v[76:79], a[72:75], v[16:19], v[76:79]
ds_read_b64_tr_b16 a[78:79], v55 offset:25600
ds_read_b128 v[44:47], v6 offset:33024
ds_read_b128 v[16:19], v6 offset:49408
s_waitcnt lgkmcnt(2)
v_mfma_f32_16x16x32_bf16 v[64:67], a[12:15], v[56:59], v[64:67]
v_mfma_f32_16x16x32_bf16 v[68:71], a[12:15], v[60:63], v[68:71]
v_mfma_f32_16x16x32_bf16 v[72:75], a[76:79], v[56:59], v[72:75]
v_mfma_f32_16x16x32_bf16 v[76:79], a[76:79], v[60:63], v[76:79]
s_waitcnt vmcnt(8)
s_barrier
s_mov_b64 exec, 1
buffer_store_dword v2, off, s[44:47], s68 offset:4 sc1
s_mov_b64 exec, -1
ds_read_b64_tr_b16 a[16:17], v52 offset:0
ds_read_b64_tr_b16 a[18:19], v52 offset:1024
ds_read_b64_tr_b16 a[80:81], v54 offset:0
ds_read_b64_tr_b16 a[82:83], v54 offset:1024
ds_read_b128 v[56:59], v7 offset:33024
ds_read_b128 v[60:63], v7 offset:49408
s_waitcnt lgkmcnt(2)
v_mfma_f32_16x16x32_bf16 v[64:67], a[16:19], v[28:31], v[64:67]
ds_read_b64_tr_b16 a[20:21], v52 offset:8192
s_add_u32 m0, s62, 65536
s_add_u32 s60, s61, 3145728
buffer_load_dwordx4 v48, s[12:15], s60 offen offset:0  lds
v_mfma_f32_16x16x32_bf16 v[68:71], a[16:19], v[32:35], v[68:71]
ds_read_b64_tr_b16 a[22:23], v52 offset:9216
s_add_u32 s60, s61, 3177472
buffer_load_dwordx4 v48, s[12:15], s60 offen offset:1024  lds
v_mfma_f32_16x16x32_bf16 v[72:75], a[80:83], v[28:31], v[72:75]
ds_read_b64_tr_b16 a[84:85], v54 offset:8192
s_add_u32 s60, s61, 3209216
buffer_load_dwordx4 v49, s[12:15], s60 offen offset:2048  lds
v_mfma_f32_16x16x32_bf16 v[76:79], a[80:83], v[32:35], v[76:79]
ds_read_b64_tr_b16 a[86:87], v54 offset:9216
s_add_u32 s60, s61, 3240960
buffer_load_dwordx4 v49, s[12:15], s60 offen offset:3072  lds
ds_read_b128 v[28:31], v4 offset:33280
ds_read_b128 v[32:35], v4 offset:49664
s_waitcnt lgkmcnt(2)
v_mfma_f32_16x16x32_bf16 v[64:67], a[20:23], v[36:39], v[64:67]
ds_read_b64_tr_b16 a[24:25], v52 offset:16384
s_add_u32 m0, s62, 69632
s_add_u32 s60, s61, 3276800
buffer_load_dwordx4 v48, s[12:15], s60 offen offset:0  lds
v_mfma_f32_16x16x32_bf16 v[68:71], a[20:23], v[40:43], v[68:71]
ds_read_b64_tr_b16 a[26:27], v52 offset:17408
s_add_u32 s60, s61, 3308544
buffer_load_dwordx4 v48, s[12:15], s60 offen offset:1024  lds
v_mfma_f32_16x16x32_bf16 v[72:75], a[84:87], v[36:39], v[72:75]
ds_read_b64_tr_b16 a[88:89], v54 offset:16384
s_add_u32 s60, s61, 3340288
buffer_load_dwordx4 v49, s[12:15], s60 offen offset:2048  lds
v_mfma_f32_16x16x32_bf16 v[76:79], a[84:87], v[40:43], v[76:79]
ds_read_b64_tr_b16 a[90:91], v54 offset:17408
s_add_u32 s60, s61, 3372032
buffer_load_dwordx4 v49, s[12:15], s60 offen offset:3072  lds
ds_read_b128 v[36:39], v5 offset:33280
ds_read_b128 v[40:43], v5 offset:49664
s_waitcnt lgkmcnt(2)
v_mfma_f32_16x16x32_bf16 v[64:67], a[24:27], v[44:47], v[64:67]
ds_read_b64_tr_b16 a[28:29], v52 offset:24576
v_mfma_f32_16x16x32_bf16 v[68:71], a[24:27], v[16:19], v[68:71]
ds_read_b64_tr_b16 a[30:31], v52 offset:25600
v_mfma_f32_16x16x32_bf16 v[72:75], a[88:91], v[44:47], v[72:75]
ds_read_b64_tr_b16 a[92:93], v54 offset:24576
v_mfma_f32_16x16x32_bf16 v[76:79], a[88:91], v[16:19], v[76:79]
ds_read_b64_tr_b16 a[94:95], v54 offset:25600
ds_read_b128 v[44:47], v6 offset:33280
ds_read_b128 v[16:19], v6 offset:49664
s_waitcnt lgkmcnt(2)
v_mfma_f32_16x16x32_bf16 v[64:67], a[28:31], v[56:59], v[64:67]
v_mfma_f32_16x16x32_bf16 v[68:71], a[28:31], v[60:63], v[68:71]
v_mfma_f32_16x16x32_bf16 v[72:75], a[92:95], v[56:59], v[72:75]
v_mfma_f32_16x16x32_bf16 v[76:79], a[92:95], v[60:63], v[76:79]
s_waitcnt vmcnt(9)
s_barrier
ds_read_b64_tr_b16 a[32:33], v52 offset:32768
ds_read_b64_tr_b16 a[34:35], v52 offset:33792
ds_read_b64_tr_b16 a[96:97], v54 offset:32768
ds_read_b64_tr_b16 a[98:99], v54 offset:33792
ds_read_b128 v[56:59], v7 offset:33280
ds_read_b128 v[60:63], v7 offset:49664
s_waitcnt lgkmcnt(2)
v_mfma_f32_16x16x32_bf16 v[64:67], a[32:35], v[28:31], v[64:67]
ds_read_b64_tr_b16 a[36:37], v52 offset:40960
v_mfma_f32_16x16x32_bf16 v[68:71], a[32:35], v[32:35], v[68:71]
ds_read_b64_tr_b16 a[38:39], v52 offset:41984
v_mfma_f32_16x16x32_bf16 v[72:75], a[96:99], v[28:31], v[72:75]
ds_read_b64_tr_b16 a[100:101], v54 offset:40960
v_mfma_f32_16x16x32_bf16 v[76:79], a[96:99], v[32:35], v[76:79]
ds_read_b64_tr_b16 a[102:103], v54 offset:41984
ds_read_b128 v[28:31], v4 offset:33536
ds_read_b128 v[32:35], v4 offset:49920
s_waitcnt lgkmcnt(2)
v_mfma_f32_16x16x32_bf16 v[64:67], a[36:39], v[36:39], v[64:67]
ds_read_b64_tr_b16 a[40:41], v52 offset:49152
v_mfma_f32_16x16x32_bf16 v[68:71], a[36:39], v[40:43], v[68:71]
ds_read_b64_tr_b16 a[42:43], v52 offset:50176
v_mfma_f32_16x16x32_bf16 v[72:75], a[100:103], v[36:39], v[72:75]
ds_read_b64_tr_b16 a[104:105], v54 offset:49152
v_mfma_f32_16x16x32_bf16 v[76:79], a[100:103], v[40:43], v[76:79]
ds_read_b64_tr_b16 a[106:107], v54 offset:50176
ds_read_b128 v[36:39], v5 offset:33536
ds_read_b128 v[40:43], v5 offset:49920
s_waitcnt lgkmcnt(2)
v_mfma_f32_16x16x32_bf16 v[64:67], a[40:43], v[44:47], v[64:67]
ds_read_b64_tr_b16 a[44:45], v52 offset:57344
v_mfma_f32_16x16x32_bf16 v[68:71], a[40:43], v[16:19], v[68:71]
ds_read_b64_tr_b16 a[46:47], v52 offset:58368
v_mfma_f32_16x16x32_bf16 v[72:75], a[104:107], v[44:47], v[72:75]
ds_read_b64_tr_b16 a[108:109], v54 offset:57344
v_mfma_f32_16x16x32_bf16 v[76:79], a[104:107], v[16:19], v[76:79]
ds_read_b64_tr_b16 a[110:111], v54 offset:58368
ds_read_b128 v[44:47], v6 offset:33536
ds_read_b128 v[16:19], v6 offset:49920
s_waitcnt lgkmcnt(2)
v_mfma_f32_16x16x32_bf16 v[64:67], a[44:47], v[56:59], v[64:67]
v_mfma_f32_16x16x32_bf16 v[68:71], a[44:47], v[60:63], v[68:71]
v_mfma_f32_16x16x32_bf16 v[72:75], a[108:111], v[56:59], v[72:75]
v_mfma_f32_16x16x32_bf16 v[76:79], a[108:111], v[60:63], v[76:79]
s_waitcnt vmcnt(0)
s_barrier
ds_read_b64_tr_b16 a[48:49], v53 offset:0
ds_read_b64_tr_b16 a[50:51], v53 offset:1024
ds_read_b64_tr_b16 a[112:113], v55 offset:0
ds_read_b64_tr_b16 a[114:115], v55 offset:1024
ds_read_b128 v[56:59], v7 offset:33536
ds_read_b128 v[60:63], v7 offset:49920
s_waitcnt lgkmcnt(2)
v_mfma_f32_16x16x32_bf16 v[64:67], a[48:51], v[28:31], v[64:67]
ds_read_b64_tr_b16 a[52:53], v53 offset:8192
v_mfma_f32_16x16x32_bf16 v[68:71], a[48:51], v[32:35], v[68:71]
ds_read_b64_tr_b16 a[54:55], v53 offset:9216
v_mfma_f32_16x16x32_bf16 v[72:75], a[112:115], v[28:31], v[72:75]
ds_read_b64_tr_b16 a[116:117], v55 offset:8192
v_mfma_f32_16x16x32_bf16 v[76:79], a[112:115], v[32:35], v[76:79]
ds_read_b64_tr_b16 a[118:119], v55 offset:9216
ds_read_b128 v[28:31], v4 offset:0
ds_read_b128 v[32:35], v4 offset:16384
s_waitcnt lgkmcnt(2)
v_mfma_f32_16x16x32_bf16 v[64:67], a[52:55], v[36:39], v[64:67]
ds_read_b64_tr_b16 a[56:57], v53 offset:16384
v_mfma_f32_16x16x32_bf16 v[68:71], a[52:55], v[40:43], v[68:71]
ds_read_b64_tr_b16 a[58:59], v53 offset:17408
v_mfma_f32_16x16x32_bf16 v[72:75], a[116:119], v[36:39], v[72:75]
ds_read_b64_tr_b16 a[120:121], v55 offset:16384
v_mfma_f32_16x16x32_bf16 v[76:79], a[116:119], v[40:43], v[76:79]
ds_read_b64_tr_b16 a[122:123], v55 offset:17408
ds_read_b128 v[36:39], v5 offset:0
ds_read_b128 v[40:43], v5 offset:16384
s_waitcnt lgkmcnt(2)
v_mfma_f32_16x16x32_bf16 v[64:67], a[56:59], v[44:47], v[64:67]
ds_read_b64_tr_b16 a[60:61], v53 offset:24576
v_mfma_f32_16x16x32_bf16 v[68:71], a[56:59], v[16:19], v[68:71]
ds_read_b64_tr_b16 a[62:63], v53 offset:25600
v_mfma_f32_16x16x32_bf16 v[72:75], a[120:123], v[44:47], v[72:75]
ds_read_b64_tr_b16 a[124:125], v55 offset:24576
v_mfma_f32_16x16x32_bf16 v[76:79], a[120:123], v[16:19], v[76:79]
ds_read_b64_tr_b16 a[126:127], v55 offset:25600
ds_read_b128 v[44:47], v6 offset:0
ds_read_b128 v[16:19], v6 offset:16384
s_waitcnt lgkmcnt(2)
v_mfma_f32_16x16x32_bf16 v[64:67], a[60:63], v[56:59], v[64:67]
v_mfma_f32_16x16x32_bf16 v[68:71], a[60:63], v[60:63], v[68:71]
v_mfma_f32_16x16x32_bf16 v[72:75], a[124:127], v[56:59], v[72:75]
v_cvt_pk_bf16_f32 v112, v64, v65
v_cvt_pk_bf16_f32 v113, v66, v67
v_mfma_f32_16x16x32_bf16 v[76:79], a[124:127], v[60:63], v[76:79]
v_cvt_pk_bf16_f32 v116, v68, v69
v_cvt_pk_bf16_f32 v117, v70, v71
s_mov_b32 s69, s65
s_waitcnt lgkmcnt(4)
s_barrier
ds_read_b128 v[56:59], v7 offset:0
ds_read_b128 v[60:63], v7 offset:16384
v_mfma_f32_16x16x32_bf16 v[64:67], a[0:3], v[28:31], 0
v_cvt_pk_bf16_f32 v114, v72, v73
v_cvt_pk_bf16_f32 v115, v74, v75
v_mfma_f32_16x16x32_bf16 v[68:71], a[0:3], v[32:35], 0
v_cvt_pk_bf16_f32 v118, v76, v77
v_cvt_pk_bf16_f32 v119, v78, v79
v_mfma_f32_16x16x32_bf16 v[72:75], a[64:67], v[28:31], 0
s_add_u32 s55, s69, 0
buffer_store_dwordx4 v[112:115], v13, s[44:47], s55 offen sc1
v_mfma_f32_16x16x32_bf16 v[76:79], a[64:67], v[32:35], 0
s_add_u32 s55, s69, 4096
buffer_store_dwordx4 v[116:119], v13, s[44:47], s55 offen sc1
ds_read_b128 v[28:31], v4 offset:256
ds_read_b128 v[32:35], v4 offset:16640
v_mfma_f32_16x16x32_bf16 v[64:67], a[4:7], v[36:39], v[64:67]
v_xor_b32 v9, 0, v8
s_add_u32 m0, s67, 131072
s_add_u32 s60, s64, 0
buffer_load_dwordx4 v9, s[44:47], s60 offen offset:0 sc1 lds
v_mfma_f32_16x16x32_bf16 v[68:71], a[4:7], v[40:43], v[68:71]
v_mfma_f32_16x16x32_bf16 v[72:75], a[68:71], v[36:39], v[72:75]
v_xor_b32 v9, 16, v8
s_add_u32 s60, s64, 0
buffer_load_dwordx4 v9, s[44:47], s60 offen offset:1024 sc1 lds
v_mfma_f32_16x16x32_bf16 v[76:79], a[68:71], v[40:43], v[76:79]
ds_read_b128 v[36:39], v5 offset:256
ds_read_b128 v[40:43], v5 offset:16640
s_waitcnt lgkmcnt(6)
v_mfma_f32_16x16x32_bf16 v[64:67], a[8:11], v[44:47], v[64:67]
v_xor_b32 v9, 32, v8
s_add_u32 s60, s64, 0
buffer_load_dwordx4 v9, s[44:47], s60 offen offset:2048 sc1 lds
v_mfma_f32_16x16x32_bf16 v[68:71], a[8:11], v[16:19], v[68:71]
v_mfma_f32_16x16x32_bf16 v[72:75], a[72:75], v[44:47], v[72:75]
v_xor_b32 v9, 48, v8
s_add_u32 s60, s64, 0
buffer_load_dwordx4 v9, s[44:47], s60 offen offset:3072 sc1 lds
v_mfma_f32_16x16x32_bf16 v[76:79], a[72:75], v[16:19], v[76:79]
ds_read_b128 v[44:47], v6 offset:256
ds_read_b128 v[16:19], v6 offset:16640
s_waitcnt lgkmcnt(6)
v_mfma_f32_16x16x32_bf16 v[64:67], a[12:15], v[56:59], v[64:67]
v_xor_b32 v9, 64, v8
s_add_u32 m0, s67, 135168
s_add_u32 s60, s64, 4096
buffer_load_dwordx4 v9, s[44:47], s60 offen offset:0 sc1 lds
v_mfma_f32_16x16x32_bf16 v[68:71], a[12:15], v[60:63], v[68:71]
v_mfma_f32_16x16x32_bf16 v[72:75], a[76:79], v[56:59], v[72:75]
v_xor_b32 v9, 80, v8
s_add_u32 s60, s64, 4096
buffer_load_dwordx4 v9, s[44:47], s60 offen offset:1024 sc1 lds
v_mfma_f32_16x16x32_bf16 v[76:79], a[76:79], v[60:63], v[76:79]
ds_read_b128 v[56:59], v7 offset:256
ds_read_b128 v[60:63], v7 offset:16640
s_waitcnt lgkmcnt(6)
v_mfma_f32_16x16x32_bf16 v[64:67], a[16:19], v[28:31], v[64:67]
v_xor_b32 v9, 96, v8
s_add_u32 s60, s64, 4096
buffer_load_dwordx4 v9, s[44:47], s60 offen offset:2048 sc1 lds
v_mfma_f32_16x16x32_bf16 v[68:71], a[16:19], v[32:35], v[68:71]
v_mfma_f32_16x16x32_bf16 v[72:75], a[80:83], v[28:31], v[72:75]
v_xor_b32 v9, 112, v8
s_add_u32 s60, s64, 4096
buffer_load_dwordx4 v9, s[44:47], s60 offen offset:3072 sc1 lds
v_mfma_f32_16x16x32_bf16 v[76:79], a[80:83], v[32:35], v[76:79]
ds_read_b128 v[28:31], v4 offset:512
ds_read_b128 v[32:35], v4 offset:16896
s_waitcnt lgkmcnt(6)
v_mfma_f32_16x16x32_bf16 v[64:67], a[20:23], v[36:39], v[64:67]
v_mfma_f32_16x16x32_bf16 v[68:71], a[20:23], v[40:43], v[68:71]
v_mfma_f32_16x16x32_bf16 v[72:75], a[84:87], v[36:39], v[72:75]
v_mfma_f32_16x16x32_bf16 v[76:79], a[84:87], v[40:43], v[76:79]
ds_read_b128 v[36:39], v5 offset:512
ds_read_b128 v[40:43], v5 offset:16896
s_waitcnt lgkmcnt(6)
v_mfma_f32_16x16x32_bf16 v[64:67], a[24:27], v[44:47], v[64:67]
v_mfma_f32_16x16x32_bf16 v[68:71], a[24:27], v[16:19], v[68:71]
v_mfma_f32_16x16x32_bf16 v[72:75], a[88:91], v[44:47], v[72:75]
v_mfma_f32_16x16x32_bf16 v[76:79], a[88:91], v[16:19], v[76:79]
ds_read_b128 v[44:47], v6 offset:512
ds_read_b128 v[16:19], v6 offset:16896
s_waitcnt lgkmcnt(6)
v_mfma_f32_16x16x32_bf16 v[64:67], a[28:31], v[56:59], v[64:67]
v_mfma_f32_16x16x32_bf16 v[68:71], a[28:31], v[60:63], v[68:71]
v_mfma_f32_16x16x32_bf16 v[72:75], a[92:95], v[56:59], v[72:75]
v_mfma_f32_16x16x32_bf16 v[76:79], a[92:95], v[60:63], v[76:79]
ds_read_b128 v[56:59], v7 offset:512
ds_read_b128 v[60:63], v7 offset:16896
s_waitcnt lgkmcnt(6)
v_mfma_f32_16x16x32_bf16 v[64:67], a[32:35], v[28:31], v[64:67]
v_mfma_f32_16x16x32_bf16 v[68:71], a[32:35], v[32:35], v[68:71]
v_mfma_f32_16x16x32_bf16 v[72:75], a[96:99], v[28:31], v[72:75]
v_mfma_f32_16x16x32_bf16 v[76:79], a[96:99], v[32:35], v[76:79]
ds_read_b128 v[28:31], v4 offset:768
ds_read_b128 v[32:35], v4 offset:17152
s_waitcnt lgkmcnt(6)
v_mfma_f32_16x16x32_bf16 v[64:67], a[36:39], v[36:39], v[64:67]
v_mfma_f32_16x16x32_bf16 v[68:71], a[36:39], v[40:43], v[68:71]
v_mfma_f32_16x16x32_bf16 v[72:75], a[100:103], v[36:39], v[72:75]
v_mfma_f32_16x16x32_bf16 v[76:79], a[100:103], v[40:43], v[76:79]
ds_read_b128 v[36:39], v5 offset:768
ds_read_b128 v[40:43], v5 offset:17152
s_waitcnt lgkmcnt(6)
v_mfma_f32_16x16x32_bf16 v[64:67], a[40:43], v[44:47], v[64:67]
v_mfma_f32_16x16x32_bf16 v[68:71], a[40:43], v[16:19], v[68:71]
v_mfma_f32_16x16x32_bf16 v[72:75], a[104:107], v[44:47], v[72:75]
v_mfma_f32_16x16x32_bf16 v[76:79], a[104:107], v[16:19], v[76:79]
ds_read_b128 v[44:47], v6 offset:768
ds_read_b128 v[16:19], v6 offset:17152
s_waitcnt lgkmcnt(6)
v_mfma_f32_16x16x32_bf16 v[64:67], a[44:47], v[56:59], v[64:67]
v_mfma_f32_16x16x32_bf16 v[68:71], a[44:47], v[60:63], v[68:71]
v_mfma_f32_16x16x32_bf16 v[72:75], a[108:111], v[56:59], v[72:75]
v_mfma_f32_16x16x32_bf16 v[76:79], a[108:111], v[60:63], v[76:79]
ds_read_b128 v[56:59], v7 offset:768
ds_read_b128 v[60:63], v7 offset:17152
s_waitcnt lgkmcnt(6)
v_mfma_f32_16x16x32_bf16 v[64:67], a[48:51], v[28:31], v[64:67]
v_mfma_f32_16x16x32_bf16 v[68:71], a[48:51], v[32:35], v[68:71]
v_mfma_f32_16x16x32_bf16 v[72:75], a[112:115], v[28:31], v[72:75]
v_mfma_f32_16x16x32_bf16 v[76:79], a[112:115], v[32:35], v[76:79]
s_waitcnt lgkmcnt(4)
v_mfma_f32_16x16x32_bf16 v[64:67], a[52:55], v[36:39], v[64:67]
v_mfma_f32_16x16x32_bf16 v[68:71], a[52:55], v[40:43], v[68:71]
v_mfma_f32_16x16x32_bf16 v[72:75], a[116:119], v[36:39], v[72:75]
v_mfma_f32_16x16x32_bf16 v[76:79], a[116:119], v[40:43], v[76:79]
s_waitcnt lgkmcnt(2)
v_mfma_f32_16x16x32_bf16 v[64:67], a[56:59], v[44:47], v[64:67]
v_mfma_f32_16x16x32_bf16 v[68:71], a[56:59], v[16:19], v[68:71]
v_mfma_f32_16x16x32_bf16 v[72:75], a[120:123], v[44:47], v[72:75]
v_mfma_f32_16x16x32_bf16 v[76:79], a[120:123], v[16:19], v[76:79]
s_waitcnt lgkmcnt(0)
v_mfma_f32_16x16x32_bf16 v[64:67], a[60:63], v[56:59], v[64:67]
v_mfma_f32_16x16x32_bf16 v[68:71], a[60:63], v[60:63], v[68:71]
v_mfma_f32_16x16x32_bf16 v[72:75], a[124:127], v[56:59], v[72:75]
v_cvt_pk_bf16_f32 v112, v64, v65
v_cvt_pk_bf16_f32 v113, v66, v67
v_mfma_f32_16x16x32_bf16 v[76:79], a[124:127], v[60:63], v[76:79]
v_cvt_pk_bf16_f32 v116, v68, v69
v_cvt_pk_bf16_f32 v117, v70, v71
s_nop 0
v_cvt_pk_bf16_f32 v114, v72, v73
v_cvt_pk_bf16_f32 v115, v74, v75
s_nop 2
v_cvt_pk_bf16_f32 v118, v76, v77
v_cvt_pk_bf16_f32 v119, v78, v79
s_waitcnt vmcnt(0)
s_barrier
s_mov_b64 exec, 1
buffer_store_dword v2, off, s[44:47], s66 sc1
s_mov_b64 exec, -1
ds_read_b128 v[32:35], v4 offset:32768
ds_read_b128 v[36:39], v4 offset:49152
ds_read_b128 v[40:43], v5 offset:32768
ds_read_b128 v[44:47], v5 offset:49152
ds_read_b128 v[48:51], v6 offset:32768
ds_read_b128 v[52:55], v6 offset:49152
s_mov_b32 s68, s66
s_mov_b32 s69, s65
s_add_u32 s65, s65, 1572864
s_add_u32 s66, s66, 8192
s_add_u32 s63, s63, 2
s_mov_b32 s68, s66
s_mov_b32 s69, s65
s_add_u32 s65, s65, 1572864
s_add_u32 s66, s66, 8192
s_add_u32 s63, s63, 2
L_a_loop:
s_add_u32 s64, s64, 65536
ds_read_b128 v[56:59], v7 offset:32768
ds_read_b128 v[60:63], v7 offset:49152
s_waitcnt lgkmcnt(6)
v_mfma_f32_16x16x32_bf16 v[64:67], a[0:3], v[32:35], 0
s_add_u32 s55, s69, 8192
buffer_store_dwordx4 v[120:123], v13, s[44:47], s55 offen sc1
v_mfma_f32_16x16x32_bf16 v[68:71], a[0:3], v[36:39], 0
v_mfma_f32_16x16x32_bf16 v[72:75], a[64:67], v[32:35], 0
v_mfma_f32_16x16x32_bf16 v[76:79], a[64:67], v[36:39], 0
v_mfma_f32_16x16x32_bf16 v[80:83], a[128:131], v[32:35], 0
s_add_u32 s55, s69, 12288
buffer_store_dwordx4 v[124:127], v13, s[44:47], s55 offen sc1
v_mfma_f32_16x16x32_bf16 v[84:87], a[128:131], v[36:39], 0
v_mfma_f32_16x16x32_bf16 v[88:91], a[192:195], v[32:35], 0
v_mfma_f32_16x16x32_bf16 v[92:95], a[192:195], v[36:39], 0
v_mfma_f32_16x16x32_bf16 v[96:99], v[32:35], v[128:131], 0
s_add_u32 s55, s69, 16384
buffer_store_dwordx4 v[20:23], v14, s[44:47], s55 offen offset:0 sc1
v_mfma_f32_16x16x32_bf16 v[100:103], v[36:39], v[128:131], 0
v_mfma_f32_16x16x32_bf16 v[104:107], v[32:35], v[192:195], 0
v_mfma_f32_16x16x32_bf16 v[108:111], v[36:39], v[192:195], 0
ds_read_b128 v[32:35], v4 offset:33024
ds_read_b128 v[36:39], v4 offset:49408
s_waitcnt lgkmcnt(6)
v_mfma_f32_16x16x32_bf16 v[64:67], a[4:7], v[40:43], v[64:67]
s_add_u32 s55, s69, 16384
buffer_store_dwordx4 v[24:27], v14, s[44:47], s55 offen offset:1024 sc1
v_mfma_f32_16x16x32_bf16 v[68:71], a[4:7], v[44:47], v[68:71]
v_mfma_f32_16x16x32_bf16 v[72:75], a[68:71], v[40:43], v[72:75]
v_mfma_f32_16x16x32_bf16 v[76:79], a[68:71], v[44:47], v[76:79]
v_mfma_f32_16x16x32_bf16 v[80:83], a[132:135], v[40:43], v[80:83]
s_add_u32 s55, s69, 0
buffer_store_dwordx4 v[112:115], v13, s[44:47], s55 offen sc1
v_mfma_f32_16x16x32_bf16 v[84:87], a[132:135], v[44:47], v[84:87]
v_mfma_f32_16x16x32_bf16 v[88:91], a[196:199], v[40:43], v[88:91]
v_mfma_f32_16x16x32_bf16 v[92:95], a[196:199], v[44:47], v[92:95]
v_mfma_f32_16x16x32_bf16 v[96:99], v[40:43], v[132:135], v[96:99]
s_add_u32 s55, s69, 4096
buffer_store_dwordx4 v[116:119], v13, s[44:47], s55 offen sc1
v_mfma_f32_16x16x32_bf16 v[100:103], v[44:47], v[132:135], v[100:103]
v_mfma_f32_16x16x32_bf16 v[104:107], v[40:43], v[196:199], v[104:107]
v_mfma_f32_16x16x32_bf16 v[108:111], v[44:47], v[196:199], v[108:111]
ds_read_b128 v[40:43], v5 offset:33024
ds_read_b128 v[44:47], v5 offset:49408
s_waitcnt lgkmcnt(6)
v_mfma_f32_16x16x32_bf16 v[64:67], a[8:11], v[48:51], v[64:67]
v_xor_b32 v9, 0, v8
s_add_u32 m0, s67, 98304
s_add_u32 s60, s64, 0
buffer_load_dwordx4 v9, s[44:47], s60 offen offset:0 sc1 lds
v_mfma_f32_16x16x32_bf16 v[68:71], a[8:11], v[52:55], v[68:71]
v_mfma_f32_16x16x32_bf16 v[72:75], a[72:75], v[48:51], v[72:75]
v_mfma_f32_16x16x32_bf16 v[76:79], a[72:75], v[52:55], v[76:79]
v_mfma_f32_16x16x32_bf16 v[80:83], a[136:139], v[48:51], v[80:83]
v_xor_b32 v9, 16, v8
s_add_u32 s60, s64, 0
buffer_load_dwordx4 v9, s[44:47], s60 offen offset:1024 sc1 lds
v_mfma_f32_16x16x32_bf16 v[84:87], a[136:139], v[52:55], v[84:87]
v_mfma_f32_16x16x32_bf16 v[88:91], a[200:203], v[48:51], v[88:91]
v_mfma_f32_16x16x32_bf16 v[92:95], a[200:203], v[52:55], v[92:95]
v_mfma_f32_16x16x32_bf16 v[96:99], v[48:51], v[136:139], v[96:99]
v_xor_b32 v9, 32, v8
s_add_u32 s60, s64, 0
buffer_load_dwordx4 v9, s[44:47], s60 offen offset:2048 sc1 lds
v_mfma_f32_16x16x32_bf16 v[100:103], v[52:55], v[136:139], v[100:103]
v_mfma_f32_16x16x32_bf16 v[104:107], v[48:51], v[200:203], v[104:107]
v_mfma_f32_16x16x32_bf16 v[108:111], v[52:55], v[200:203], v[108:111]
ds_read_b128 v[48:51], v6 offset:33024
ds_read_b128 v[52:55], v6 offset:49408
s_waitcnt lgkmcnt(6)
v_mfma_f32_16x16x32_bf16 v[64:67], a[12:15], v[56:59], v[64:67]
v_xor_b32 v9, 48, v8
s_add_u32 s60, s64, 0
buffer_load_dwordx4 v9, s[44:47], s60 offen offset:3072 sc1 lds
v_mfma_f32_16x16x32_bf16 v[68:71], a[12:15], v[60:63], v[68:71]
v_mfma_f32_16x16x32_bf16 v[72:75], a[76:79], v[56:59], v[72:75]
v_mfma_f32_16x16x32_bf16 v[76:79], a[76:79], v[60:63], v[76:79]
v_mfma_f32_16x16x32_bf16 v[80:83], a[140:143], v[56:59], v[80:83]
v_xor_b32 v9, 64, v8
s_add_u32 m0, s67, 102400
s_add_u32 s60, s64, 4096
buffer_load_dwordx4 v9, s[44:47], s60 offen offset:0 sc1 lds
v_mfma_f32_16x16x32_bf16 v[84:87], a[140:143], v[60:63], v[84:87]
v_mfma_f32_16x16x32_bf16 v[88:91], a[204:207], v[56:59], v[88:91]
v_mfma_f32_16x16x32_bf16 v[92:95], a[204:207], v[60:63], v[92:95]
v_mfma_f32_16x16x32_bf16 v[96:99], v[56:59], v[140:143], v[96:99]
v_xor_b32 v9, 80, v8
s_add_u32 s60, s64, 4096
buffer_load_dwordx4 v9, s[44:47], s60 offen offset:1024 sc1 lds
v_mfma_f32_16x16x32_bf16 v[100:103], v[60:63], v[140:143], v[100:103]
v_mfma_f32_16x16x32_bf16 v[104:107], v[56:59], v[204:207], v[104:107]
v_mfma_f32_16x16x32_bf16 v[108:111], v[60:63], v[204:207], v[108:111]
ds_read_b128 v[56:59], v7 offset:33024
ds_read_b128 v[60:63], v7 offset:49408
s_waitcnt lgkmcnt(6)
v_mfma_f32_16x16x32_bf16 v[64:67], a[16:19], v[32:35], v[64:67]
v_xor_b32 v9, 96, v8
s_add_u32 s60, s64, 4096
buffer_load_dwordx4 v9, s[44:47], s60 offen offset:2048 sc1 lds
v_mfma_f32_16x16x32_bf16 v[68:71], a[16:19], v[36:39], v[68:71]
v_mfma_f32_16x16x32_bf16 v[72:75], a[80:83], v[32:35], v[72:75]
v_mfma_f32_16x16x32_bf16 v[76:79], a[80:83], v[36:39], v[76:79]
v_mfma_f32_16x16x32_bf16 v[80:83], a[144:147], v[32:35], v[80:83]
v_xor_b32 v9, 112, v8
s_add_u32 s60, s64, 4096
buffer_load_dwordx4 v9, s[44:47], s60 offen offset:3072 sc1 lds
v_mfma_f32_16x16x32_bf16 v[84:87], a[144:147], v[36:39], v[84:87]
v_mfma_f32_16x16x32_bf16 v[88:91], a[208:211], v[32:35], v[88:91]
v_mfma_f32_16x16x32_bf16 v[92:95], a[208:211], v[36:39], v[92:95]
v_mfma_f32_16x16x32_bf16 v[96:99], v[32:35], v[144:147], v[96:99]
v_mfma_f32_16x16x32_bf16 v[100:103], v[36:39], v[144:147], v[100:103]
v_mfma_f32_16x16x32_bf16 v[104:107], v[32:35], v[208:211], v[104:107]
v_mfma_f32_16x16x32_bf16 v[108:111], v[36:39], v[208:211], v[108:111]
ds_read_b128 v[32:35], v4 offset:33280
ds_read_b128 v[36:39], v4 offset:49664
s_waitcnt lgkmcnt(6)
v_mfma_f32_16x16x32_bf16 v[64:67], a[20:23], v[40:43], v[64:67]
v_mfma_f32_16x16x32_bf16 v[68:71], a[20:23], v[44:47], v[68:71]
v_mfma_f32_16x16x32_bf16 v[72:75], a[84:87], v[40:43], v[72:75]
v_mfma_f32_16x16x32_bf16 v[76:79], a[84:87], v[44:47], v[76:79]
v_mfma_f32_16x16x32_bf16 v[80:83], a[148:151], v[40:43], v[80:83]
v_mfma_f32_16x16x32_bf16 v[84:87], a[148:151], v[44:47], v[84:87]
v_mfma_f32_16x16x32_bf16 v[88:91], a[212:215], v[40:43], v[88:91]
v_mfma_f32_16x16x32_bf16 v[92:95], a[212:215], v[44:47], v[92:95]
v_mfma_f32_16x16x32_bf16 v[96:99], v[40:43], v[148:151], v[96:99]
v_mfma_f32_16x16x32_bf16 v[100:103], v[44:47], v[148:151], v[100:103]
v_mfma_f32_16x16x32_bf16 v[104:107], v[40:43], v[212:215], v[104:107]
v_mfma_f32_16x16x32_bf16 v[108:111], v[44:47], v[212:215], v[108:111]
s_waitcnt vmcnt(8)
s_barrier
s_mov_b64 exec, 1
buffer_store_dwordx2 v[2:3], off, s[44:47], s68 sc1
s_mov_b64 exec, -1
ds_read_b128 v[40:43], v5 offset:33280
ds_read_b128 v[44:47], v5 offset:49664
s_waitcnt lgkmcnt(6)
v_mfma_f32_16x16x32_bf16 v[64:67], a[24:27], v[48:51], v[64:67]
v_mfma_f32_16x16x32_bf16 v[68:71], a[24:27], v[52:55], v[68:71]
v_mfma_f32_16x16x32_bf16 v[72:75], a[88:91], v[48:51], v[72:75]
v_mfma_f32_16x16x32_bf16 v[76:79], a[88:91], v[52:55], v[76:79]
v_mfma_f32_16x16x32_bf16 v[80:83], a[152:155], v[48:51], v[80:83]
v_mfma_f32_16x16x32_bf16 v[84:87], a[152:155], v[52:55], v[84:87]
v_mfma_f32_16x16x32_bf16 v[88:91], a[216:219], v[48:51], v[88:91]
v_mfma_f32_16x16x32_bf16 v[92:95], a[216:219], v[52:55], v[92:95]
v_mfma_f32_16x16x32_bf16 v[96:99], v[48:51], v[152:155], v[96:99]
v_mfma_f32_16x16x32_bf16 v[100:103], v[52:55], v[152:155], v[100:103]
v_mfma_f32_16x16x32_bf16 v[104:107], v[48:51], v[216:219], v[104:107]
v_mfma_f32_16x16x32_bf16 v[108:111], v[52:55], v[216:219], v[108:111]
ds_read_b128 v[48:51], v6 offset:33280
ds_read_b128 v[52:55], v6 offset:49664
s_waitcnt lgkmcnt(6)
v_mfma_f32_16x16x32_bf16 v[64:67], a[28:31], v[56:59], v[64:67]
v_mfma_f32_16x16x32_bf16 v[68:71], a[28:31], v[60:63], v[68:71]
v_mfma_f32_16x16x32_bf16 v[72:75], a[92:95], v[56:59], v[72:75]
v_mfma_f32_16x16x32_bf16 v[76:79], a[92:95], v[60:63], v[76:79]
v_mfma_f32_16x16x32_bf16 v[80:83], a[156:159], v[56:59], v[80:83]
v_mfma_f32_16x16x32_bf16 v[84:87], a[156:159], v[60:63], v[84:87]
v_mfma_f32_16x16x32_bf16 v[88:91], a[220:223], v[56:59], v[88:91]
v_mfma_f32_16x16x32_bf16 v[92:95], a[220:223], v[60:63], v[92:95]
v_mfma_f32_16x16x32_bf16 v[96:99], v[56:59], v[156:159], v[96:99]
v_mfma_f32_16x16x32_bf16 v[100:103], v[60:63], v[156:159], v[100:103]
v_mfma_f32_16x16x32_bf16 v[104:107], v[56:59], v[220:223], v[104:107]
v_mfma_f32_16x16x32_bf16 v[108:111], v[60:63], v[220:223], v[108:111]
ds_read_b128 v[56:59], v7 offset:33280
ds_read_b128 v[60:63], v7 offset:49664
s_waitcnt lgkmcnt(6)
v_mfma_f32_16x16x32_bf16 v[64:67], a[32:35], v[32:35], v[64:67]
v_mfma_f32_16x16x32_bf16 v[68:71], a[32:35], v[36:39], v[68:71]
v_mfma_f32_16x16x32_bf16 v[72:75], a[96:99], v[32:35], v[72:75]
v_mfma_f32_16x16x32_bf16 v[76:79], a[96:99], v[36:39], v[76:79]
v_mfma_f32_16x16x32_bf16 v[80:83], a[160:163], v[32:35], v[80:83]
v_mfma_f32_16x16x32_bf16 v[84:87], a[160:163], v[36:39], v[84:87]
v_mfma_f32_16x16x32_bf16 v[88:91], a[224:227], v[32:35], v[88:91]
v_mfma_f32_16x16x32_bf16 v[92:95], a[224:227], v[36:39], v[92:95]
v_mfma_f32_16x16x32_bf16 v[96:99], v[32:35], v[160:163], v[96:99]
v_mfma_f32_16x16x32_bf16 v[100:103], v[36:39], v[160:163], v[100:103]
v_mfma_f32_16x16x32_bf16 v[104:107], v[32:35], v[224:227], v[104:107]
v_mfma_f32_16x16x32_bf16 v[108:111], v[36:39], v[224:227], v[108:111]
ds_read_b128 v[32:35], v4 offset:33536
ds_read_b128 v[36:39], v4 offset:49920
s_waitcnt lgkmcnt(6)
v_mfma_f32_16x16x32_bf16 v[64:67], a[36:39], v[40:43], v[64:67]
v_mfma_f32_16x16x32_bf16 v[68:71], a[36:39], v[44:47], v[68:71]
v_mfma_f32_16x16x32_bf16 v[72:75], a[100:103], v[40:43], v[72:75]
v_mfma_f32_16x16x32_bf16 v[76:79], a[100:103], v[44:47], v[76:79]
v_mfma_f32_16x16x32_bf16 v[80:83], a[164:167], v[40:43], v[80:83]
v_mfma_f32_16x16x32_bf16 v[84:87], a[164:167], v[44:47], v[84:87]
v_mfma_f32_16x16x32_bf16 v[88:91], a[228:231], v[40:43], v[88:91]
v_mfma_f32_16x16x32_bf16 v[92:95], a[228:231], v[44:47], v[92:95]
v_mfma_f32_16x16x32_bf16 v[96:99], v[40:43], v[164:167], v[96:99]
v_mfma_f32_16x16x32_bf16 v[100:103], v[44:47], v[164:167], v[100:103]
v_mfma_f32_16x16x32_bf16 v[104:107], v[40:43], v[228:231], v[104:107]
v_mfma_f32_16x16x32_bf16 v[108:111], v[44:47], v[228:231], v[108:111]
ds_read_b128 v[40:43], v5 offset:33536
ds_read_b128 v[44:47], v5 offset:49920
s_waitcnt lgkmcnt(6)
v_mfma_f32_16x16x32_bf16 v[64:67], a[40:43], v[48:51], v[64:67]
v_mfma_f32_16x16x32_bf16 v[68:71], a[40:43], v[52:55], v[68:71]
v_mfma_f32_16x16x32_bf16 v[72:75], a[104:107], v[48:51], v[72:75]
v_mfma_f32_16x16x32_bf16 v[76:79], a[104:107], v[52:55], v[76:79]
v_mfma_f32_16x16x32_bf16 v[80:83], a[168:171], v[48:51], v[80:83]
v_mfma_f32_16x16x32_bf16 v[84:87], a[168:171], v[52:55], v[84:87]
v_mfma_f32_16x16x32_bf16 v[88:91], a[232:235], v[48:51], v[88:91]
v_mfma_f32_16x16x32_bf16 v[92:95], a[232:235], v[52:55], v[92:95]
v_mfma_f32_16x16x32_bf16 v[96:99], v[48:51], v[168:171], v[96:99]
v_mfma_f32_16x16x32_bf16 v[100:103], v[52:55], v[168:171], v[100:103]
v_mfma_f32_16x16x32_bf16 v[104:107], v[48:51], v[232:235], v[104:107]
v_mfma_f32_16x16x32_bf16 v[108:111], v[52:55], v[232:235], v[108:111]
ds_read_b128 v[48:51], v6 offset:33536
ds_read_b128 v[52:55], v6 offset:49920
s_waitcnt lgkmcnt(6)
v_mfma_f32_16x16x32_bf16 v[64:67], a[44:47], v[56:59], v[64:67]
v_mfma_f32_16x16x32_bf16 v[68:71], a[44:47], v[60:63], v[68:71]
v_mfma_f32_16x16x32_bf16 v[72:75], a[108:111], v[56:59], v[72:75]
v_mfma_f32_16x16x32_bf16 v[76:79], a[108:111], v[60:63], v[76:79]
v_mfma_f32_16x16x32_bf16 v[80:83], a[172:175], v[56:59], v[80:83]
v_mfma_f32_16x16x32_bf16 v[84:87], a[172:175], v[60:63], v[84:87]
v_mfma_f32_16x16x32_bf16 v[88:91], a[236:239], v[56:59], v[88:91]
v_mfma_f32_16x16x32_bf16 v[92:95], a[236:239], v[60:63], v[92:95]
v_mfma_f32_16x16x32_bf16 v[96:99], v[56:59], v[172:175], v[96:99]
v_mfma_f32_16x16x32_bf16 v[100:103], v[60:63], v[172:175], v[100:103]
v_mfma_f32_16x16x32_bf16 v[104:107], v[56:59], v[236:239], v[104:107]
v_mfma_f32_16x16x32_bf16 v[108:111], v[60:63], v[236:239], v[108:111]
ds_read_b128 v[56:59], v7 offset:33536
ds_read_b128 v[60:63], v7 offset:49920
s_waitcnt lgkmcnt(6)
v_mfma_f32_16x16x32_bf16 v[64:67], a[48:51], v[32:35], v[64:67]
v_mfma_f32_16x16x32_bf16 v[68:71], a[48:51], v[36:39], v[68:71]
v_mfma_f32_16x16x32_bf16 v[72:75], a[112:115], v[32:35], v[72:75]
v_mfma_f32_16x16x32_bf16 v[76:79], a[112:115], v[36:39], v[76:79]
v_mfma_f32_16x16x32_bf16 v[80:83], a[176:179], v[32:35], v[80:83]
v_mfma_f32_16x16x32_bf16 v[84:87], a[176:179], v[36:39], v[84:87]
v_mfma_f32_16x16x32_bf16 v[88:91], a[240:243], v[32:35], v[88:91]
v_mfma_f32_16x16x32_bf16 v[92:95], a[240:243], v[36:39], v[92:95]
v_mfma_f32_16x16x32_bf16 v[96:99], v[32:35], v[176:179], v[96:99]
v_mfma_f32_16x16x32_bf16 v[100:103], v[36:39], v[176:179], v[100:103]
v_mfma_f32_16x16x32_bf16 v[104:107], v[32:35], v[240:243], v[104:107]
v_mfma_f32_16x16x32_bf16 v[108:111], v[36:39], v[240:243], v[108:111]
s_waitcnt vmcnt(1) lgkmcnt(0)
s_barrier
ds_read_b128 v[32:35], v4 offset:0
ds_read_b128 v[36:39], v4 offset:16384
s_waitcnt lgkmcnt(6)
v_mfma_f32_16x16x32_bf16 v[64:67], a[52:55], v[40:43], v[64:67]
v_mfma_f32_16x16x32_bf16 v[68:71], a[52:55], v[44:47], v[68:71]
v_mfma_f32_16x16x32_bf16 v[72:75], a[116:119], v[40:43], v[72:75]
v_mfma_f32_16x16x32_bf16 v[76:79], a[116:119], v[44:47], v[76:79]
v_mfma_f32_16x16x32_bf16 v[80:83], a[180:183], v[40:43], v[80:83]
v_mfma_f32_16x16x32_bf16 v[84:87], a[180:183], v[44:47], v[84:87]
v_mfma_f32_16x16x32_bf16 v[88:91], a[244:247], v[40:43], v[88:91]
v_mfma_f32_16x16x32_bf16 v[92:95], a[244:247], v[44:47], v[92:95]
v_mfma_f32_16x16x32_bf16 v[96:99], v[40:43], v[180:183], v[96:99]
v_mfma_f32_16x16x32_bf16 v[100:103], v[44:47], v[180:183], v[100:103]
v_mfma_f32_16x16x32_bf16 v[104:107], v[40:43], v[244:247], v[104:107]
v_mfma_f32_16x16x32_bf16 v[108:111], v[44:47], v[244:247], v[108:111]
ds_read_b128 v[40:43], v5 offset:0
ds_read_b128 v[44:47], v5 offset:16384
s_waitcnt lgkmcnt(6)
v_mfma_f32_16x16x32_bf16 v[64:67], a[56:59], v[48:51], v[64:67]
v_mfma_f32_16x16x32_bf16 v[68:71], a[56:59], v[52:55], v[68:71]
v_mfma_f32_16x16x32_bf16 v[72:75], a[120:123], v[48:51], v[72:75]
v_mfma_f32_16x16x32_bf16 v[76:79], a[120:123], v[52:55], v[76:79]
v_mfma_f32_16x16x32_bf16 v[80:83], a[184:187], v[48:51], v[80:83]
v_mfma_f32_16x16x32_bf16 v[84:87], a[184:187], v[52:55], v[84:87]
v_mfma_f32_16x16x32_bf16 v[88:91], a[248:251], v[48:51], v[88:91]
v_mfma_f32_16x16x32_bf16 v[92:95], a[248:251], v[52:55], v[92:95]
v_mfma_f32_16x16x32_bf16 v[96:99], v[48:51], v[184:187], v[96:99]
v_mfma_f32_16x16x32_bf16 v[100:103], v[52:55], v[184:187], v[100:103]
v_mfma_f32_16x16x32_bf16 v[104:107], v[48:51], v[248:251], v[104:107]
v_mfma_f32_16x16x32_bf16 v[108:111], v[52:55], v[248:251], v[108:111]
ds_read_b128 v[48:51], v6 offset:0
ds_read_b128 v[52:55], v6 offset:16384
s_waitcnt lgkmcnt(6)
v_mfma_f32_16x16x32_bf16 v[64:67], a[60:63], v[56:59], v[64:67]
v_mfma_f32_16x16x32_bf16 v[68:71], a[60:63], v[60:63], v[68:71]
v_mfma_f32_16x16x32_bf16 v[72:75], a[124:127], v[56:59], v[72:75]
v_cvt_pk_bf16_f32 v112, v64, v65
v_cvt_pk_bf16_f32 v113, v66, v67
v_mfma_f32_16x16x32_bf16 v[76:79], a[124:127], v[60:63], v[76:79]
v_cvt_pk_bf16_f32 v116, v68, v69
v_cvt_pk_bf16_f32 v117, v70, v71
v_mfma_f32_16x16x32_bf16 v[80:83], a[188:191], v[56:59], v[80:83]
v_cvt_pk_bf16_f32 v114, v72, v73
v_cvt_pk_bf16_f32 v115, v74, v75
v_mfma_f32_16x16x32_bf16 v[84:87], a[188:191], v[60:63], v[84:87]
v_cvt_pk_bf16_f32 v118, v76, v77
v_cvt_pk_bf16_f32 v119, v78, v79
v_mfma_f32_16x16x32_bf16 v[88:91], a[252:255], v[56:59], v[88:91]
v_cvt_pk_bf16_f32 v120, v80, v81
v_cvt_pk_bf16_f32 v121, v82, v83
v_mfma_f32_16x16x32_bf16 v[92:95], a[252:255], v[60:63], v[92:95]
v_cvt_pk_bf16_f32 v124, v84, v85
v_cvt_pk_bf16_f32 v125, v86, v87
v_mfma_f32_16x16x32_bf16 v[96:99], v[56:59], v[188:191], v[96:99]
v_cvt_pk_bf16_f32 v122, v88, v89
v_cvt_pk_bf16_f32 v123, v90, v91
v_mfma_f32_16x16x32_bf16 v[100:103], v[60:63], v[188:191], v[100:103]
v_cvt_pk_bf16_f32 v126, v92, v93
v_cvt_pk_bf16_f32 v127, v94, v95
v_mfma_f32_16x16x32_bf16 v[104:107], v[56:59], v[252:255], v[104:107]
v_cvt_pk_bf16_f32 v20, v96, v97
v_cvt_pk_bf16_f32 v21, v98, v99
v_mfma_f32_16x16x32_bf16 v[108:111], v[60:63], v[252:255], v[108:111]
v_cvt_pk_bf16_f32 v22, v100, v101
v_cvt_pk_bf16_f32 v23, v102, v103
s_mov_b32 s68, s66
s_mov_b32 s69, s65
s_add_u32 s65, s65, 1572864
s_add_u32 s66, s66, 8192
s_add_u32 s63, s63, 2
v_cvt_pk_bf16_f32 v24, v104, v105
v_cvt_pk_bf16_f32 v25, v106, v107
v_cvt_pk_bf16_f32 v26, v108, v109
v_cvt_pk_bf16_f32 v27, v110, v111
s_cmp_ge_u32 s63, 64
s_cbranch_scc1 L_a_done
s_add_u32 s64, s64, 65536
ds_read_b128 v[56:59], v7 offset:0
ds_read_b128 v[60:63], v7 offset:16384
s_waitcnt lgkmcnt(6)
v_mfma_f32_16x16x32_bf16 v[64:67], a[0:3], v[32:35], 0
s_add_u32 s55, s69, 8192
buffer_store_dwordx4 v[120:123], v13, s[44:47], s55 offen sc1
v_mfma_f32_16x16x32_bf16 v[68:71], a[0:3], v[36:39], 0
v_mfma_f32_16x16x32_bf16 v[72:75], a[64:67], v[32:35], 0
v_mfma_f32_16x16x32_bf16 v[76:79], a[64:67], v[36:39], 0
v_mfma_f32_16x16x32_bf16 v[80:83], a[128:131], v[32:35], 0
s_add_u32 s55, s69, 12288
buffer_store_dwordx4 v[124:127], v13, s[44:47], s55 offen sc1
v_mfma_f32_16x16x32_bf16 v[84:87], a[128:131], v[36:39], 0
v_mfma_f32_16x16x32_bf16 v[88:91], a[192:195], v[32:35], 0
v_mfma_f32_16x16x32_bf16 v[92:95], a[192:195], v[36:39], 0
v_mfma_f32_16x16x32_bf16 v[96:99], v[32:35], v[128:131], 0
s_add_u32 s55, s69, 16384
buffer_store_dwordx4 v[20:23], v14, s[44:47], s55 offen offset:0 sc1
v_mfma_f32_16x16x32_bf16 v[100:103], v[36:39], v[128:131], 0
v_mfma_f32_16x16x32_bf16 v[104:107], v[32:35], v[192:195], 0
v_mfma_f32_16x16x32_bf16 v[108:111], v[36:39], v[192:195], 0
ds_read_b128 v[32:35], v4 offset:256
ds_read_b128 v[36:39], v4 offset:16640
s_waitcnt lgkmcnt(6)
v_mfma_f32_16x16x32_bf16 v[64:67], a[4:7], v[40:43], v[64:67]
s_add_u32 s55, s69, 16384
buffer_store_dwordx4 v[24:27], v14, s[44:47], s55 offen offset:1024 sc1
v_mfma_f32_16x16x32_bf16 v[68:71], a[4:7], v[44:47], v[68:71]
v_mfma_f32_16x16x32_bf16 v[72:75], a[68:71], v[40:43], v[72:75]
v_mfma_f32_16x16x32_bf16 v[76:79], a[68:71], v[44:47], v[76:79]
v_mfma_f32_16x16x32_bf16 v[80:83], a[132:135], v[40:43], v[80:83]
s_add_u32 s55, s69, 0
buffer_store_dwordx4 v[112:115], v13, s[44:47], s55 offen sc1
v_mfma_f32_16x16x32_bf16 v[84:87], a[132:135], v[44:47], v[84:87]
v_mfma_f32_16x16x32_bf16 v[88:91], a[196:199], v[40:43], v[88:91]
v_mfma_f32_16x16x32_bf16 v[92:95], a[196:199], v[44:47], v[92:95]
v_mfma_f32_16x16x32_bf16 v[96:99], v[40:43], v[132:135], v[96:99]
s_add_u32 s55, s69, 4096
buffer_store_dwordx4 v[116:119], v13, s[44:47], s55 offen sc1
v_mfma_f32_16x16x32_bf16 v[100:103], v[44:47], v[132:135], v[100:103]
v_mfma_f32_16x16x32_bf16 v[104:107], v[40:43], v[196:199], v[104:107]
v_mfma_f32_16x16x32_bf16 v[108:111], v[44:47], v[196:199], v[108:111]
ds_read_b128 v[40:43], v5 offset:256
ds_read_b128 v[44:47], v5 offset:16640
s_waitcnt lgkmcnt(6)
v_mfma_f32_16x16x32_bf16 v[64:67], a[8:11], v[48:51], v[64:67]
v_xor_b32 v9, 0, v8
s_add_u32 m0, s67, 131072
s_add_u32 s60, s64, 0
buffer_load_dwordx4 v9, s[44:47], s60 offen offset:0 sc1 lds
v_mfma_f32_16x16x32_bf16 v[68:71], a[8:11], v[52:55], v[68:71]
v_mfma_f32_16x16x32_bf16 v[72:75], a[72:75], v[48:51], v[72:75]
v_mfma_f32_16x16x32_bf16 v[76:79], a[72:75], v[52:55], v[76:79]
v_mfma_f32_16x16x32_bf16 v[80:83], a[136:139], v[48:51], v[80:83]
v_xor_b32 v9, 16, v8
s_add_u32 s60, s64, 0
buffer_load_dwordx4 v9, s[44:47], s60 offen offset:1024 sc1 lds
v_mfma_f32_16x16x32_bf16 v[84:87], a[136:139], v[52:55], v[84:87]
v_mfma_f32_16x16x32_bf16 v[88:91], a[200:203], v[48:51], v[88:91]
v_mfma_f32_16x16x32_bf16 v[92:95], a[200:203], v[52:55], v[92:95]
v_mfma_f32_16x16x32_bf16 v[96:99], v[48:51], v[136:139], v[96:99]
v_xor_b32 v9, 32, v8
s_add_u32 s60, s64, 0
buffer_load_dwordx4 v9, s[44:47], s60 offen offset:2048 sc1 lds
v_mfma_f32_16x16x32_bf16 v[100:103], v[52:55], v[136:139], v[100:103]
v_mfma_f32_16x16x32_bf16 v[104:107], v[48:51], v[200:203], v[104:107]
v_mfma_f32_16x16x32_bf16 v[108:111], v[52:55], v[200:203], v[108:111]
ds_read_b128 v[48:51], v6 offset:256
ds_read_b128 v[52:55], v6 offset:16640
s_waitcnt lgkmcnt(6)
v_mfma_f32_16x16x32_bf16 v[64:67], a[12:15], v[56:59], v[64:67]
v_xor_b32 v9, 48, v8
s_add_u32 s60, s64, 0
buffer_load_dwordx4 v9, s[44:47], s60 offen offset:3072 sc1 lds
v_mfma_f32_16x16x32_bf16 v[68:71], a[12:15], v[60:63], v[68:71]
v_mfma_f32_16x16x32_bf16 v[72:75], a[76:79], v[56:59], v[72:75]
v_mfma_f32_16x16x32_bf16 v[76:79], a[76:79], v[60:63], v[76:79]
v_mfma_f32_16x16x32_bf16 v[80:83], a[140:143], v[56:59], v[80:83]
v_xor_b32 v9, 64, v8
s_add_u32 m0, s67, 135168
s_add_u32 s60, s64, 4096
buffer_load_dwordx4 v9, s[44:47], s60 offen offset:0 sc1 lds
v_mfma_f32_16x16x32_bf16 v[84:87], a[140:143], v[60:63], v[84:87]
v_mfma_f32_16x16x32_bf16 v[88:91], a[204:207], v[56:59], v[88:91]
v_mfma_f32_16x16x32_bf16 v[92:95], a[204:207], v[60:63], v[92:95]
v_mfma_f32_16x16x32_bf16 v[96:99], v[56:59], v[140:143], v[96:99]
v_xor_b32 v9, 80, v8
s_add_u32 s60, s64, 4096
buffer_load_dwordx4 v9, s[44:47], s60 offen offset:1024 sc1 lds
v_mfma_f32_16x16x32_bf16 v[100:103], v[60:63], v[140:143], v[100:103]
v_mfma_f32_16x16x32_bf16 v[104:107], v[56:59], v[204:207], v[104:107]
v_mfma_f32_16x16x32_bf16 v[108:111], v[60:63], v[204:207], v[108:111]
ds_read_b128 v[56:59], v7 offset:256
ds_read_b128 v[60:63], v7 offset:16640
s_waitcnt lgkmcnt(6)
v_mfma_f32_16x16x32_bf16 v[64:67], a[16:19], v[32:35], v[64:67]
v_xor_b32 v9, 96, v8
s_add_u32 s60, s64, 4096
buffer_load_dwordx4 v9, s[44:47], s60 offen offset:2048 sc1 lds
v_mfma_f32_16x16x32_bf16 v[68:71], a[16:19], v[36:39], v[68:71]
v_mfma_f32_16x16x32_bf16 v[72:75], a[80:83], v[32:35], v[72:75]
v_mfma_f32_16x16x32_bf16 v[76:79], a[80:83], v[36:39], v[76:79]
v_mfma_f32_16x16x32_bf16 v[80:83], a[144:147], v[32:35], v[80:83]
v_xor_b32 v9, 112, v8
s_add_u32 s60, s64, 4096
buffer_load_dwordx4 v9, s[44:47], s60 offen offset:3072 sc1 lds
v_mfma_f32_16x16x32_bf16 v[84:87], a[144:147], v[36:39], v[84:87]
v_mfma_f32_16x16x32_bf16 v[88:91], a[208:211], v[32:35], v[88:91]
v_mfma_f32_16x16x32_bf16 v[92:95], a[208:211], v[36:39], v[92:95]
v_mfma_f32_16x16x32_bf16 v[96:99], v[32:35], v[144:147], v[96:99]
v_mfma_f32_16x16x32_bf16 v[100:103], v[36:39], v[144:147], v[100:103]
v_mfma_f32_16x16x32_bf16 v[104:107], v[32:35], v[208:211], v[104:107]
v_mfma_f32_16x16x32_bf16 v[108:111], v[36:39], v[208:211], v[108:111]
ds_read_b128 v[32:35], v4 offset:512
ds_read_b128 v[36:39], v4 offset:16896
s_waitcnt lgkmcnt(6)
v_mfma_f32_16x16x32_bf16 v[64:67], a[20:23], v[40:43], v[64:67]
v_mfma_f32_16x16x32_bf16 v[68:71], a[20:23], v[44:47], v[68:71]
v_mfma_f32_16x16x32_bf16 v[72:75], a[84:87], v[40:43], v[72:75]
v_mfma_f32_16x16x32_bf16 v[76:79], a[84:87], v[44:47], v[76:79]
v_mfma_f32_16x16x32_bf16 v[80:83], a[148:151], v[40:43], v[80:83]
v_mfma_f32_16x16x32_bf16 v[84:87], a[148:151], v[44:47], v[84:87]
v_mfma_f32_16x16x32_bf16 v[88:91], a[212:215], v[40:43], v[88:91]
v_mfma_f32_16x16x32_bf16 v[92:95], a[212:215], v[44:47], v[92:95]
v_mfma_f32_16x16x32_bf16 v[96:99], v[40:43], v[148:151], v[96:99]
v_mfma_f32_16x16x32_bf16 v[100:103], v[44:47], v[148:151], v[100:103]
v_mfma_f32_16x16x32_bf16 v[104:107], v[40:43], v[212:215], v[104:107]
v_mfma_f32_16x16x32_bf16 v[108:111], v[44:47], v[212:215], v[108:111]
s_waitcnt vmcnt(8)
s_barrier
s_mov_b64 exec, 1
buffer_store_dwordx2 v[2:3], off, s[44:47], s68 sc1
s_mov_b64 exec, -1
ds_read_b128 v[40:43], v5 offset:512
ds_read_b128 v[44:47], v5 offset:16896
s_waitcnt lgkmcnt(6)
v_mfma_f32_16x16x32_bf16 v[64:67], a[24:27], v[48:51], v[64:67]
v_mfma_f32_16x16x32_bf16 v[68:71], a[24:27], v[52:55], v[68:71]
v_mfma_f32_16x16x32_bf16 v[72:75], a[88:91], v[48:51], v[72:75]
v_mfma_f32_16x16x32_bf16 v[76:79], a[88:91], v[52:55], v[76:79]
v_mfma_f32_16x16x32_bf16 v[80:83], a[152:155], v[48:51], v[80:83]
v_mfma_f32_16x16x32_bf16 v[84:87], a[152:155], v[52:55], v[84:87]
v_mfma_f32_16x16x32_bf16 v[88:91], a[216:219], v[48:51], v[88:91]
v_mfma_f32_16x16x32_bf16 v[92:95], a[216:219], v[52:55], v[92:95]
v_mfma_f32_16x16x32_bf16 v[96:99], v[48:51], v[152:155], v[96:99]
v_mfma_f32_16x16x32_bf16 v[100:103], v[52:55], v[152:155], v[100:103]
v_mfma_f32_16x16x32_bf16 v[104:107], v[48:51], v[216:219], v[104:107]
v_mfma_f32_16x16x32_bf16 v[108:111], v[52:55], v[216:219], v[108:111]
ds_read_b128 v[48:51], v6 offset:512
ds_read_b128 v[52:55], v6 offset:16896
s_waitcnt lgkmcnt(6)
v_mfma_f32_16x16x32_bf16 v[64:67], a[28:31], v[56:59], v[64:67]
v_mfma_f32_16x16x32_bf16 v[68:71], a[28:31], v[60:63], v[68:71]
v_mfma_f32_16x16x32_bf16 v[72:75], a[92:95], v[56:59], v[72:75]
v_mfma_f32_16x16x32_bf16 v[76:79], a[92:95], v[60:63], v[76:79]
v_mfma_f32_16x16x32_bf16 v[80:83], a[156:159], v[56:59], v[80:83]
v_mfma_f32_16x16x32_bf16 v[84:87], a[156:159], v[60:63], v[84:87]
v_mfma_f32_16x16x32_bf16 v[88:91], a[220:223], v[56:59], v[88:91]
v_mfma_f32_16x16x32_bf16 v[92:95], a[220:223], v[60:63], v[92:95]
v_mfma_f32_16x16x32_bf16 v[96:99], v[56:59], v[156:159], v[96:99]
v_mfma_f32_16x16x32_bf16 v[100:103], v[60:63], v[156:159], v[100:103]
v_mfma_f32_16x16x32_bf16 v[104:107], v[56:59], v[220:223], v[104:107]
v_mfma_f32_16x16x32_bf16 v[108:111], v[60:63], v[220:223], v[108:111]
ds_read_b128 v[56:59], v7 offset:512
ds_read_b128 v[60:63], v7 offset:16896
s_waitcnt lgkmcnt(6)
v_mfma_f32_16x16x32_bf16 v[64:67], a[32:35], v[32:35], v[64:67]
v_mfma_f32_16x16x32_bf16 v[68:71], a[32:35], v[36:39], v[68:71]
v_mfma_f32_16x16x32_bf16 v[72:75], a[96:99], v[32:35], v[72:75]
v_mfma_f32_16x16x32_bf16 v[76:79], a[96:99], v[36:39], v[76:79]
v_mfma_f32_16x16x32_bf16 v[80:83], a[160:163], v[32:35], v[80:83]
v_mfma_f32_16x16x32_bf16 v[84:87], a[160:163], v[36:39], v[84:87]
v_mfma_f32_16x16x32_bf16 v[88:91], a[224:227], v[32:35], v[88:91]
v_mfma_f32_16x16x32_bf16 v[92:95], a[224:227], v[36:39], v[92:95]
v_mfma_f32_16x16x32_bf16 v[96:99], v[32:35], v[160:163], v[96:99]
v_mfma_f32_16x16x32_bf16 v[100:103], v[36:39], v[160:163], v[100:103]
v_mfma_f32_16x16x32_bf16 v[104:107], v[32:35], v[224:227], v[104:107]
v_mfma_f32_16x16x32_bf16 v[108:111], v[36:39], v[224:227], v[108:111]
ds_read_b128 v[32:35], v4 offset:768
ds_read_b128 v[36:39], v4 offset:17152
s_waitcnt lgkmcnt(6)
v_mfma_f32_16x16x32_bf16 v[64:67], a[36:39], v[40:43], v[64:67]
v_mfma_f32_16x16x32_bf16 v[68:71], a[36:39], v[44:47], v[68:71]
v_mfma_f32_16x16x32_bf16 v[72:75], a[100:103], v[40:43], v[72:75]
v_mfma_f32_16x16x32_bf16 v[76:79], a[100:103], v[44:47], v[76:79]
v_mfma_f32_16x16x32_bf16 v[80:83], a[164:167], v[40:43], v[80:83]
v_mfma_f32_16x16x32_bf16 v[84:87], a[164:167], v[44:47], v[84:87]
v_mfma_f32_16x16x32_bf16 v[88:91], a[228:231], v[40:43], v[88:91]
v_mfma_f32_16x16x32_bf16 v[92:95], a[228:231], v[44:47], v[92:95]
v_mfma_f32_16x16x32_bf16 v[96:99], v[40:43], v[164:167], v[96:99]
v_mfma_f32_16x16x32_bf16 v[100:103], v[44:47], v[164:167], v[100:103]
v_mfma_f32_16x16x32_bf16 v[104:107], v[40:43], v[228:231], v[104:107]
v_mfma_f32_16x16x32_bf16 v[108:111], v[44:47], v[228:231], v[108:111]
ds_read_b128 v[40:43], v5 offset:768
ds_read_b128 v[44:47], v5 offset:17152
s_waitcnt lgkmcnt(6)
v_mfma_f32_16x16x32_bf16 v[64:67], a[40:43], v[48:51], v[64:67]
v_mfma_f32_16x16x32_bf16 v[68:71], a[40:43], v[52:55], v[68:71]
v_mfma_f32_16x16x32_bf16 v[72:75], a[104:107], v[48:51], v[72:75]
v_mfma_f32_16x16x32_bf16 v[76:79], a[104:107], v[52:55], v[76:79]
v_mfma_f32_16x16x32_bf16 v[80:83], a[168:171], v[48:51], v[80:83]
v_mfma_f32_16x16x32_bf16 v[84:87], a[168:171], v[52:55], v[84:87]
v_mfma_f32_16x16x32_bf16 v[88:91], a[232:235], v[48:51], v[88:91]
v_mfma_f32_16x16x32_bf16 v[92:95], a[232:235], v[52:55], v[92:95]
v_mfma_f32_16x16x32_bf16 v[96:99], v[48:51], v[168:171], v[96:99]
v_mfma_f32_16x16x32_bf16 v[100:103], v[52:55], v[168:171], v[100:103]
v_mfma_f32_16x16x32_bf16 v[104:107], v[48:51], v[232:235], v[104:107]
v_mfma_f32_16x16x32_bf16 v[108:111], v[52:55], v[232:235], v[108:111]
ds_read_b128 v[48:51], v6 offset:768
ds_read_b128 v[52:55], v6 offset:17152
s_waitcnt lgkmcnt(6)
v_mfma_f32_16x16x32_bf16 v[64:67], a[44:47], v[56:59], v[64:67]
v_mfma_f32_16x16x32_bf16 v[68:71], a[44:47], v[60:63], v[68:71]
v_mfma_f32_16x16x32_bf16 v[72:75], a[108:111], v[56:59], v[72:75]
v_mfma_f32_16x16x32_bf16 v[76:79], a[108:111], v[60:63], v[76:79]
v_mfma_f32_16x16x32_bf16 v[80:83], a[172:175], v[56:59], v[80:83]
v_mfma_f32_16x16x32_bf16 v[84:87], a[172:175], v[60:63], v[84:87]
v_mfma_f32_16x16x32_bf16 v[88:91], a[236:239], v[56:59], v[88:91]
v_mfma_f32_16x16x32_bf16 v[92:95], a[236:239], v[60:63], v[92:95]
v_mfma_f32_16x16x32_bf16 v[96:99], v[56:59], v[172:175], v[96:99]
v_mfma_f32_16x16x32_bf16 v[100:103], v[60:63], v[172:175], v[100:103]
v_mfma_f32_16x16x32_bf16 v[104:107], v[56:59], v[236:239], v[104:107]
v_mfma_f32_16x16x32_bf16 v[108:111], v[60:63], v[236:239], v[108:111]
ds_read_b128 v[56:59], v7 offset:768
ds_read_b128 v[60:63], v7 offset:17152
s_waitcnt lgkmcnt(6)
v_mfma_f32_16x16x32_bf16 v[64:67], a[48:51], v[32:35], v[64:67]
v_mfma_f32_16x16x32_bf16 v[68:71], a[48:51], v[36:39], v[68:71]
v_mfma_f32_16x16x32_bf16 v[72:75], a[112:115], v[32:35], v[72:75]
v_mfma_f32_16x16x32_bf16 v[76:79], a[112:115], v[36:39], v[76:79]
v_mfma_f32_16x16x32_bf16 v[80:83], a[176:179], v[32:35], v[80:83]
v_mfma_f32_16x16x32_bf16 v[84:87], a[176:179], v[36:39], v[84:87]
v_mfma_f32_16x16x32_bf16 v[88:91], a[240:243], v[32:35], v[88:91]
v_mfma_f32_16x16x32_bf16 v[92:95], a[240:243], v[36:39], v[92:95]
v_mfma_f32_16x16x32_bf16 v[96:99], v[32:35], v[176:179], v[96:99]
v_mfma_f32_16x16x32_bf16 v[100:103], v[36:39], v[176:179], v[100:103]
v_mfma_f32_16x16x32_bf16 v[104:107], v[32:35], v[240:243], v[104:107]
v_mfma_f32_16x16x32_bf16 v[108:111], v[36:39], v[240:243], v[108:111]
s_waitcnt vmcnt(1) lgkmcnt(0)
s_barrier
ds_read_b128 v[32:35], v4 offset:32768
ds_read_b128 v[36:39], v4 offset:49152
s_waitcnt lgkmcnt(6)
v_mfma_f32_16x16x32_bf16 v[64:67], a[52:55], v[40:43], v[64:67]
v_mfma_f32_16x16x32_bf16 v[68:71], a[52:55], v[44:47], v[68:71]
v_mfma_f32_16x16x32_bf16 v[72:75], a[116:119], v[40:43], v[72:75]
v_mfma_f32_16x16x32_bf16 v[76:79], a[116:119], v[44:47], v[76:79]
v_mfma_f32_16x16x32_bf16 v[80:83], a[180:183], v[40:43], v[80:83]
v_mfma_f32_16x16x32_bf16 v[84:87], a[180:183], v[44:47], v[84:87]
v_mfma_f32_16x16x32_bf16 v[88:91], a[244:247], v[40:43], v[88:91]
v_mfma_f32_16x16x32_bf16 v[92:95], a[244:247], v[44:47], v[92:95]
v_mfma_f32_16x16x32_bf16 v[96:99], v[40:43], v[180:183], v[96:99]
v_mfma_f32_16x16x32_bf16 v[100:103], v[44:47], v[180:183], v[100:103]
v_mfma_f32_16x16x32_bf16 v[104:107], v[40:43], v[244:247], v[104:107]
v_mfma_f32_16x16x32_bf16 v[108:111], v[44:47], v[244:247], v[108:111]
ds_read_b128 v[40:43], v5 offset:32768
ds_read_b128 v[44:47], v5 offset:49152
s_waitcnt lgkmcnt(6)
v_mfma_f32_16x16x32_bf16 v[64:67], a[56:59], v[48:51], v[64:67]
v_mfma_f32_16x16x32_bf16 v[68:71], a[56:59], v[52:55], v[68:71]
v_mfma_f32_16x16x32_bf16 v[72:75], a[120:123], v[48:51], v[72:75]
v_mfma_f32_16x16x32_bf16 v[76:79], a[120:123], v[52:55], v[76:79]
v_mfma_f32_16x16x32_bf16 v[80:83], a[184:187], v[48:51], v[80:83]
v_mfma_f32_16x16x32_bf16 v[84:87], a[184:187], v[52:55], v[84:87]
v_mfma_f32_16x16x32_bf16 v[88:91], a[248:251], v[48:51], v[88:91]
v_mfma_f32_16x16x32_bf16 v[92:95], a[248:251], v[52:55], v[92:95]
v_mfma_f32_16x16x32_bf16 v[96:99], v[48:51], v[184:187], v[96:99]
v_mfma_f32_16x16x32_bf16 v[100:103], v[52:55], v[184:187], v[100:103]
v_mfma_f32_16x16x32_bf16 v[104:107], v[48:51], v[248:251], v[104:107]
v_mfma_f32_16x16x32_bf16 v[108:111], v[52:55], v[248:251], v[108:111]
ds_read_b128 v[48:51], v6 offset:32768
ds_read_b128 v[52:55], v6 offset:49152
s_waitcnt lgkmcnt(6)
v_mfma_f32_16x16x32_bf16 v[64:67], a[60:63], v[56:59], v[64:67]
v_mfma_f32_16x16x32_bf16 v[68:71], a[60:63], v[60:63], v[68:71]
v_mfma_f32_16x16x32_bf16 v[72:75], a[124:127], v[56:59], v[72:75]
v_cvt_pk_bf16_f32 v112, v64, v65
v_cvt_pk_bf16_f32 v113, v66, v67
v_mfma_f32_16x16x32_bf16 v[76:79], a[124:127], v[60:63], v[76:79]
v_cvt_pk_bf16_f32 v116, v68, v69
v_cvt_pk_bf16_f32 v117, v70, v71
v_mfma_f32_16x16x32_bf16 v[80:83], a[188:191], v[56:59], v[80:83]
v_cvt_pk_bf16_f32 v114, v72, v73
v_cvt_pk_bf16_f32 v115, v74, v75
v_mfma_f32_16x16x32_bf16 v[84:87], a[188:191], v[60:63], v[84:87]
v_cvt_pk_bf16_f32 v118, v76, v77
v_cvt_pk_bf16_f32 v119, v78, v79
v_mfma_f32_16x16x32_bf16 v[88:91], a[252:255], v[56:59], v[88:91]
v_cvt_pk_bf16_f32 v120, v80, v81
v_cvt_pk_bf16_f32 v121, v82, v83
v_mfma_f32_16x16x32_bf16 v[92:95], a[252:255], v[60:63], v[92:95]
v_cvt_pk_bf16_f32 v124, v84, v85
v_cvt_pk_bf16_f32 v125, v86, v87
v_mfma_f32_16x16x32_bf16 v[96:99], v[56:59], v[188:191], v[96:99]
v_cvt_pk_bf16_f32 v122, v88, v89
v_cvt_pk_bf16_f32 v123, v90, v91
v_mfma_f32_16x16x32_bf16 v[100:103], v[60:63], v[188:191], v[100:103]
v_cvt_pk_bf16_f32 v126, v92, v93
v_cvt_pk_bf16_f32 v127, v94, v95
v_mfma_f32_16x16x32_bf16 v[104:107], v[56:59], v[252:255], v[104:107]
v_cvt_pk_bf16_f32 v20, v96, v97
v_cvt_pk_bf16_f32 v21, v98, v99
v_mfma_f32_16x16x32_bf16 v[108:111], v[60:63], v[252:255], v[108:111]
v_cvt_pk_bf16_f32 v22, v100, v101
v_cvt_pk_bf16_f32 v23, v102, v103
s_mov_b32 s68, s66
s_mov_b32 s69, s65
s_add_u32 s65, s65, 1572864
s_add_u32 s66, s66, 8192
s_add_u32 s63, s63, 2
v_cvt_pk_bf16_f32 v24, v104, v105
v_cvt_pk_bf16_f32 v25, v106, v107
v_cvt_pk_bf16_f32 v26, v108, v109
v_cvt_pk_bf16_f32 v27, v110, v111
s_cmp_lt_u32 s63, 64
s_cbranch_scc1 L_a_loop
L_a_done:
s_add_u32 s55, s69, 0
buffer_store_dwordx4 v[112:115], v13, s[44:47], s55 offen sc1
s_add_u32 s55, s69, 4096
buffer_store_dwordx4 v[116:119], v13, s[44:47], s55 offen sc1
s_add_u32 s55, s69, 8192
buffer_store_dwordx4 v[120:123], v13, s[44:47], s55 offen sc1
s_add_u32 s55, s69, 12288
buffer_store_dwordx4 v[124:127], v13, s[44:47], s55 offen sc1
s_add_u32 s55, s69, 16384
buffer_store_dwordx4 v[20:23], v14, s[44:47], s55 offen offset:0 sc1
s_add_u32 s55, s69, 16384
buffer_store_dwordx4 v[24:27], v14, s[44:47], s55 offen offset:1024 sc1
s_waitcnt vmcnt(0) lgkmcnt(0)
s_barrier
s_mov_b64 exec, 1
buffer_store_dwordx2 v[2:3], off, s[44:47], s68 sc1
s_mov_b64 exec, -1
s_branch L_b_load
L_chain:
v_and_b32 v51, 15, v0
v_bfe_u32 v50, v0, 4, 1
v_lshlrev_b32 v52, 1, v50
v_xor_b32 v52, v52, v51
v_lshlrev_b32 v52, 4, v52
v_bfe_u32 v50, v0, 4, 2
v_lshl_add_u32 v124, v50, 13, v52
v_bfe_u32 v50, v0, 4, 1
v_lshlrev_b32 v52, 2, v50
v_xor_b32 v52, v52, v51
v_lshlrev_b32 v52, 4, v52
v_bfe_u32 v50, v0, 4, 2
v_lshl_add_u32 v126, v50, 10, v52
v_xor_b32 v125, 128, v126
s_lshl_b32 s80, s50, 8
s_lshl_b32 s55, s48, 18
s_add_u32 s80, s80, s55
s_lshl_b32 s81, s48, 15
s_lshl_b32 s82, s50, 17
s_lshl_b32 s55, s48, 8
s_add_u32 s82, s82, s55
s_or_b32 s55, s48, s52
s_cbranch_scc1 L_ci_11
s_lshl_b32 s55, 1, s50
s_lshl_b32 s56, s49, 5
v_mov_b32 v52, s55
s_cmp_lg_u32 s49, s51
s_cselect_b32 s55, s55, 0
v_mov_b32 v53, s55
v_mov_b32 v54, s56
s_mov_b64 exec, 1
buffer_atomic_or_x2 v[52:53], v54, s[40:43], 0 offen sc0
s_mov_b64 exec, -1
L_ci_11:
s_add_u32 m0, s81, 0
s_add_u32 s60, s80, 0
buffer_load_dwordx4 v124, s[16:19], s60 offen offset:0  lds
v_xor_b32 v127, 64, v124
s_add_u32 s60, s80, 31744
buffer_load_dwordx4 v127, s[16:19], s60 offen offset:1024  lds
s_add_u32 s60, s80, 63488
buffer_load_dwordx4 v124, s[16:19], s60 offen offset:2048  lds
v_xor_b32 v127, 64, v124
s_add_u32 s60, s80, 95232
buffer_load_dwordx4 v127, s[16:19], s60 offen offset:3072  lds
v_xor_b32 v127, 128, v124
s_add_u32 m0, s81, 4096
s_add_u32 s60, s80, 131072
buffer_load_dwordx4 v127, s[16:19], s60 offen offset:0  lds
v_xor_b32 v127, 192, v124
s_add_u32 s60, s80, 162816
buffer_load_dwordx4 v127, s[16:19], s60 offen offset:1024  lds
v_xor_b32 v127, 128, v124
s_add_u32 s60, s80, 194560
buffer_load_dwordx4 v127, s[16:19], s60 offen offset:2048  lds
v_xor_b32 v127, 192, v124
s_add_u32 s60, s80, 226304
buffer_load_dwordx4 v127, s[16:19], s60 offen offset:3072  lds
s_add_u32 m0, s81, 8192
s_add_u32 s60, s80, 1048576
buffer_load_dwordx4 v124, s[16:19], s60 offen offset:0  lds
v_xor_b32 v127, 64, v124
s_add_u32 s60, s80, 1080320
buffer_load_dwordx4 v127, s[16:19], s60 offen offset:1024  lds
s_add_u32 s60, s80, 1112064
buffer_load_dwordx4 v124, s[16:19], s60 offen offset:2048  lds
v_xor_b32 v127, 64, v124
s_add_u32 s60, s80, 1143808
buffer_load_dwordx4 v127, s[16:19], s60 offen offset:3072  lds
v_xor_b32 v127, 128, v124
s_add_u32 m0, s81, 12288
s_add_u32 s60, s80, 1179648
buffer_load_dwordx4 v127, s[16:19], s60 offen offset:0  lds
v_xor_b32 v127, 192, v124
s_add_u32 s60, s80, 1211392
buffer_load_dwordx4 v127, s[16:19], s60 offen offset:1024  lds
v_xor_b32 v127, 128, v124
s_add_u32 s60, s80, 1243136
buffer_load_dwordx4 v127, s[16:19], s60 offen offset:2048  lds
v_xor_b32 v127, 192, v124
s_add_u32 s60, s80, 1274880
buffer_load_dwordx4 v127, s[16:19], s60 offen offset:3072  lds
s_add_u32 m0, s81, 16384
s_add_u32 s60, s80, 2097152
buffer_load_dwordx4 v124, s[16:19], s60 offen offset:0  lds
v_xor_b32 v127, 64, v124
s_add_u32 s60, s80, 2128896
buffer_load_dwordx4 v127, s[16:19], s60 offen offset:1024  lds
s_add_u32 s60, s80, 2160640
buffer_load_dwordx4 v124, s[16:19], s60 offen offset:2048  lds
v_xor_b32 v127, 64, v124
s_add_u32 s60, s80, 2192384
buffer_load_dwordx4 v127, s[16:19], s60 offen offset:3072  lds
v_xor_b32 v127, 128, v124
s_add_u32 m0, s81, 20480
s_add_u32 s60, s80, 2228224
buffer_load_dwordx4 v127, s[16:19], s60 offen offset:0  lds
v_xor_b32 v127, 192, v124
s_add_u32 s60, s80, 2259968
buffer_load_dwordx4 v127, s[16:19], s60 offen offset:1024  lds
v_xor_b32 v127, 128, v124
s_add_u32 s60, s80, 2291712
buffer_load_dwordx4 v127, s[16:19], s60 offen offset:2048  lds
v_xor_b32 v127, 192, v124
s_add_u32 s60, s80, 2323456
buffer_load_dwordx4 v127, s[16:19], s60 offen offset:3072  lds
v_bfe_u32 v21, v0, 1, 1
v_lshlrev_b32 v20, 0, v21
v_bfe_u32 v21, v0, 3, 1
v_lshl_add_u32 v20, v21, 1, v20
v_bfe_u32 v21, v0, 4, 1
v_lshl_add_u32 v20, v21, 2, v20
v_bfe_u32 v21, v0, 2, 1
v_lshl_add_u32 v20, v21, 3, v20
s_lshl_b32 s55, s48, 2
v_xor_b32 v20, s55, v20
v_lshlrev_b32 v20, 4, v20
v_bfe_u32 v21, v0, 0, 1
v_lshl_add_u32 v76, v21, 3, v20
v_bfe_u32 v21, v0, 3, 1
v_lshl_add_u32 v76, v21, 8, v76
v_bfe_u32 v21, v0, 4, 2
v_lshl_add_u32 v76, v21, 10, v76
v_bfe_u32 v21, v0, 2, 1
v_lshl_add_u32 v76, v21, 12, v76
v_add_u32 v77, 0x10000, v76
v_xor_b32 v78, 32, v76
v_xor_b32 v79, 32, v77
v_bfe_u32 v21, v0, 0, 1
v_lshl_add_u32 v80, v21, 3, s81
v_bfe_u32 v21, v0, 1, 1
v_lshl_add_u32 v80, v21, 4, v80
v_bfe_u32 v21, v0, 3, 1
v_lshl_add_u32 v80, v21, 5, v80
v_bfe_u32 v21, v0, 2, 1
v_lshl_add_u32 v80, v21, 6, v80
v_bfe_u32 v21, v0, 4, 1
v_lshl_add_u32 v80, v21, 7, v80
v_bfe_u32 v21, v0, 2, 1
v_lshl_add_u32 v80, v21, 8, v80
v_bfe_u32 v21, v0, 5, 1
v_lshl_add_u32 v80, v21, 10, v80
v_bfe_u32 v21, v0, 4, 1
v_lshl_add_u32 v80, v21, 12, v80
v_add_u32 v2, s81, v1
s_lshl_b32 s55, s48, 11
s_add_u32 s55, s55, 139264
v_add_u32 v3, s55, v1
v_bfe_u32 v23, v0, 1, 1
v_mul_u32_u24 v24, 0xaaaa, v23
v_add_u32 v4, 0x4444, v24
s_mul_i32 s55, s48, 528
s_add_u32 s56, s55, 159744
v_bfe_u32 v21, v0, 4, 2
v_lshl_add_u32 v10, v21, 7, s56
v_bfe_u32 v21, v0, 2, 2
v_lshl_add_u32 v10, v21, 5, v10
v_bfe_u32 v21, v0, 0, 1
v_lshl_add_u32 v10, v21, 4, v10
s_mov_b32 s56, 163520
v_bfe_u32 v21, v0, 2, 2
v_lshl_add_u32 v22, v21, 5, s56
v_bfe_u32 v21, v0, 0, 1
v_lshl_add_u32 v22, v21, 4, v22
v_add_u32 v21, 2112, v10
s_cmp_eq_u32 s48, 3
s_cselect_b64 vcc, -1, 0
v_cndmask_b32 v22, v21, v22, vcc
v_cmp_eq_u32 vcc, 0, v23
s_nop 1
v_cndmask_b32 v11, v22, v10, vcc
s_lshl_b32 s55, s48, 10
s_add_u32 s56, s55, 155648
v_bfe_u32 v21, v0, 0, 4
v_lshl_add_u32 v6, v21, 5, s56
v_bfe_u32 v21, v0, 4, 2
v_lshl_add_u32 v6, v21, 3, v6
v_bfe_u32 v21, v0, 3, 1
v_lshlrev_b32 v22, 4, v21
v_xor_b32 v6, v6, v22
v_add_u32 v5, 4096, v6
s_mov_b32 s56, 155648
v_bfe_u32 v21, v0, 2, 4
v_lshl_add_u32 v8, v21, 5, s56
v_bfe_u32 v21, v0, 0, 2
v_lshl_add_u32 v8, v21, 3, v8
v_bfe_u32 v21, v0, 5, 1
v_lshlrev_b32 v22, 4, v21
v_xor_b32 v8, v8, v22
v_add_u32 v9, 131072, v1
s_lshl_b32 s55, s48, 16
s_lshl_b32 s56, s50, 6
v_bfe_u32 v21, v0, 3, 3
v_lshl_add_u32 v24, v21, 8, s56
v_and_b32 v24, 0x7c0, v24
v_add_u32 v24, s55, v24
v_bfe_u32 v21, v0, 3, 1
v_lshl_add_u32 v12, v21, 13, v24
v_bfe_u32 v21, v0, 4, 2
v_lshl_add_u32 v12, v21, 11, v12
v_bfe_u32 v21, v0, 0, 3
v_lshl_add_u32 v12, v21, 3, v12
s_lshl_b32 s55, s50, 13
s_add_u32 s69, s55, 0x5000000
s_lshl_b32 s55, s48, 11
v_add_u32 v13, s55, v1
s_add_u32 s70, s69, 1024
s_lshl_b32 s55, s50, 8
s_lshl_b32 s56, s48, 6
s_add_u32 s55, s55, s56
v_bfe_u32 v21, v0, 0, 2
v_lshl_add_u32 v24, v21, 2, s55
v_bfe_u32 v21, v0, 4, 2
v_lshl_add_u32 v24, v21, 4, v24
v_bfe_u32 v25, v0, 2, 2
v_mov_b32 v26, 0x40000000
v_cmp_eq_u32 vcc, 0, v25
s_nop 1
v_cndmask_b32 v14, v26, v24, vcc
v_mov_b32 v15, -1
v_bfe_u32 v21, v0, 3, 1
v_lshlrev_b32 v24, 1, v21
v_bfe_u32 v21, v0, 0, 1
v_lshl_add_u32 v24, v21, 0, v24
v_bfe_u32 v21, v0, 1, 1
v_lshl_add_u32 v24, v21, 4, v24
v_bfe_u32 v21, v0, 2, 1
v_lshlrev_b32 v26, 4, v21
v_mov_b32 v27, 0x3f80
v_lshlrev_b32 v27, v26, v27
v_cmp_eq_u32 vcc, 0, v24
s_nop 1
v_cndmask_b32 v16, 0, v27, vcc
v_cmp_eq_u32 vcc, 1, v24
s_nop 1
v_cndmask_b32 v17, 0, v27, vcc
v_cmp_eq_u32 vcc, 2, v24
s_nop 1
v_cndmask_b32 v18, 0, v27, vcc
v_cmp_eq_u32 vcc, 3, v24
s_nop 1
v_cndmask_b32 v19, 0, v27, vcc
v_and_b32 v20, 3, v0
v_mov_b32 v27, 0x3f803f80
v_cmp_eq_u32 vcc, 2, v20
s_nop 1
v_cndmask_b32 v16, v16, v27, vcc
v_cndmask_b32 v17, v17, v27, vcc
v_cndmask_b32 v18, v18, v27, vcc
v_cndmask_b32 v19, v19, v27, vcc
s_lshl_b32 s55, s48, 10
s_add_u32 s55, s55, 155648
v_add_u32 v20, s55, v1
v_pk_mov_b32 v[24:25], 0, 0
v_pk_mov_b32 v[26:27], 0, 0
ds_write_b128 v20, v[24:27]
s_mov_b32 s78, 0xcccccccc
s_mov_b32 s79, 0xcccccccc
s_mov_b32 s71, 0xbe0293ee
s_mul_i32 s55, s50, 24576
s_lshl_b32 s56, s48, 11
s_add_u32 s55, s55, s56
s_add_u32 s62, s55, 0x384000
s_add_u32 s63, s55, 0x382000
s_add_u32 s72, s56, 0x50c9000
s_mov_b32 s74, 0x50c9000
s_add_u32 s76, s56, 131072
s_add_u32 s73, s56, 0x50cb000
s_mov_b32 s75, 0x50cb000
s_add_u32 s77, s56, 139264
s_lshl_b32 s55, s50, 12
s_lshl_b32 s56, s48, 10
s_add_u32 s55, s55, s56
s_add_u32 s64, s55, 0x3320000
s_lshl_b32 s55, s50, 7
s_add_u32 s66, s55, 0x5042000
s_sub_u32 s65, 0x5085000, s55
s_cmp_lg_u32 s48, 0
s_cselect_b32 s65, 0x40000000, s65
s_mov_b32 s61, 2
s_lshl_b32 s55, s48, 8
v_bfe_u32 v21, v0, 1, 1
v_lshlrev_b32 v82, 7, v21
v_bfe_u32 v21, v0, 4, 1
v_lshl_add_u32 v82, v21, 4, v82
v_bfe_u32 v21, v0, 0, 1
v_lshl_add_u32 v82, v21, 3, v82
v_bfe_u32 v21, v0, 5, 1
v_lshl_add_u32 v82, v21, 2, v82
v_bfe_u32 v21, v0, 2, 2
v_mul_u32_u24 v21, 393216, v21
v_add_u32 v82, v21, v82
s_and_b32 s55, s50, 30
s_mul_i32 s55, s55, 12288
s_and_b32 s56, s50, 1
s_lshl_b32 s56, s56, 8
s_add_u32 s55, s55, s56
s_lshl_b32 s56, s48, 5
s_add_u32 s55, s55, s56
s_add_u32 s67, s55, 0x5c02a00
s_add_u32 s68, s67, 12288
v_mul_u32_u24 v24, 0x0202, v23
v_lshl_add_u32 v24, v24, 16, v24
v_add_u32 v83, 0x05040100, v24
v_bfe_u32 v21, v0, 0, 1
v_lshlrev_b32 v57, 12, v21
s_cmp_eq_u32 s48, 1
s_cbranch_scc1 L_c_w1
s_cmp_eq_u32 s48, 2
s_cbranch_scc1 L_c_w2
s_cmp_eq_u32 s48, 3
s_cbranch_scc1 L_c_w3
s_waitcnt vmcnt(16) lgkmcnt(0)
s_or_b32 s55, s48, s52
s_cbranch_scc1 L_cc_rd_12
s_mov_b32 s57, s49
s_mov_b32 s58, s50
L_cc_lp_13:
v_readfirstlane_b32 s55, v52
s_nop 0
s_lshr_b32 s56, s55, s58
s_and_b32 s56, s56, 1
s_cbranch_scc0 L_cc_ok_14
s_ff0_i32_b32 s58, s55
s_cmp_lg_u32 s55, -1
s_cbranch_scc1 L_cc_nf_15
s_add_u32 s57, s57, 1
s_and_b32 s57, s57, 7
s_mov_b32 s58, 0
L_cc_nf_15:
s_add_u32 s54, s54, 1
s_cmp_gt_u32 s54, 400000
s_cbranch_scc1 L_end
s_lshl_b32 s55, 1, s58
s_lshl_b32 s56, s57, 5
v_mov_b32 v52, s55
s_cmp_lg_u32 s57, s51
s_cselect_b32 s55, s55, 0
v_mov_b32 v53, s55
v_mov_b32 v54, s56
s_mov_b64 exec, 1
buffer_atomic_or_x2 v[52:53], v54, s[40:43], 0 offen sc0
s_mov_b64 exec, -1
s_waitcnt vmcnt(0)
s_branch L_cc_lp_13
L_cc_ok_14:
s_lshl_b32 s57, s57, 8
s_or_b32 s57, s57, s58
v_mov_b32 v52, s57
v_mov_b32 v53, 162816
ds_write_b32 v53, v52
s_waitcnt lgkmcnt(0)
L_cc_rd_12:
s_barrier
s_add_u32 m0, s81, 24576
s_add_u32 s60, s80, 3145728
buffer_load_dwordx4 v124, s[16:19], s60 offen offset:0  lds
v_xor_b32 v127, 64, v124
s_add_u32 s60, s80, 3177472
buffer_load_dwordx4 v127, s[16:19], s60 offen offset:1024  lds
s_add_u32 s60, s80, 3209216
buffer_load_dwordx4 v124, s[16:19], s60 offen offset:2048  lds
v_xor_b32 v127, 64, v124
s_add_u32 s60, s80, 3240960
buffer_load_dwordx4 v127, s[16:19], s60 offen offset:3072  lds
v_xor_b32 v127, 128, v124
s_add_u32 m0, s81, 28672
s_add_u32 s60, s80, 3276800
buffer_load_dwordx4 v127, s[16:19], s60 offen offset:0  lds
v_xor_b32 v127, 192, v124
s_add_u32 s60, s80, 3308544
buffer_load_dwordx4 v127, s[16:19], s60 offen offset:1024  lds
v_xor_b32 v127, 128, v124
s_add_u32 s60, s80, 3340288
buffer_load_dwordx4 v127, s[16:19], s60 offen offset:2048  lds
v_xor_b32 v127, 192, v124
s_add_u32 s60, s80, 3372032
buffer_load_dwordx4 v127, s[16:19], s60 offen offset:3072  lds
s_cmp_lg_u32 s52, 0
s_cbranch_scc1 L_cc_done_16
v_mov_b32 v53, 162816
ds_read_b32 v52, v53
s_mov_b32 s52, 1
s_lshl_b32 s56, s49, 8
s_or_b32 s56, s56, s50
s_waitcnt lgkmcnt(0)
v_readfirstlane_b32 s55, v52
s_nop 0
s_cmp_eq_u32 s55, s56
s_cbranch_scc1 L_cc_done_16
s_lshr_b32 s49, s55, 8
s_and_b32 s50, s55, 31
s_waitcnt vmcnt(0)
s_barrier
s_branch L_dispatch
L_cc_done_16:
ds_read_b64_tr_b16 a[0:1], v76 offset:0
ds_read_b64_tr_b16 a[2:3], v76 offset:512
ds_read_b64_tr_b16 a[4:5], v76 offset:32768
ds_read_b64_tr_b16 a[6:7], v76 offset:33280
ds_read_b64_tr_b16 a[64:65], v78 offset:0
ds_read_b64_tr_b16 a[66:67], v78 offset:512
ds_read_b64_tr_b16 a[68:69], v78 offset:32768
ds_read_b64_tr_b16 a[70:71], v78 offset:33280
ds_read_b64_tr_b16 a[8:9], v77 offset:0
ds_read_b64_tr_b16 a[10:11], v77 offset:512
ds_read_b64_tr_b16 a[12:13], v77 offset:32768
ds_read_b64_tr_b16 a[14:15], v77 offset:33280
ds_read_b64_tr_b16 a[72:73], v79 offset:0
ds_read_b64_tr_b16 a[74:75], v79 offset:512
ds_read_b64_tr_b16 a[76:77], v79 offset:32768
ds_read_b64_tr_b16 a[78:79], v79 offset:33280
s_waitcnt vmcnt(16) lgkmcnt(0)
s_barrier
s_add_u32 m0, s81, 0
s_add_u32 s60, s80, 0
buffer_load_dwordx4 v124, s[20:23], s60 offen offset:0  lds
v_xor_b32 v127, 64, v124
s_add_u32 s60, s80, 31744
buffer_load_dwordx4 v127, s[20:23], s60 offen offset:1024  lds
s_add_u32 s60, s80, 63488
buffer_load_dwordx4 v124, s[20:23], s60 offen offset:2048  lds
v_xor_b32 v127, 64, v124
s_add_u32 s60, s80, 95232
buffer_load_dwordx4 v127, s[20:23], s60 offen offset:3072  lds
v_xor_b32 v127, 128, v124
s_add_u32 m0, s81, 4096
s_add_u32 s60, s80, 131072
buffer_load_dwordx4 v127, s[20:23], s60 offen offset:0  lds
v_xor_b32 v127, 192, v124
s_add_u32 s60, s80, 162816
buffer_load_dwordx4 v127, s[20:23], s60 offen offset:1024  lds
v_xor_b32 v127, 128, v124
s_add_u32 s60, s80, 194560
buffer_load_dwordx4 v127, s[20:23], s60 offen offset:2048  lds
v_xor_b32 v127, 192, v124
s_add_u32 s60, s80, 226304
buffer_load_dwordx4 v127, s[20:23], s60 offen offset:3072  lds
ds_read_b64_tr_b16 a[16:17], v76 offset:8192
ds_read_b64_tr_b16 a[18:19], v76 offset:8704
ds_read_b64_tr_b16 a[20:21], v76 offset:40960
ds_read_b64_tr_b16 a[22:23], v76 offset:41472
ds_read_b64_tr_b16 a[80:81], v78 offset:8192
ds_read_b64_tr_b16 a[82:83], v78 offset:8704
ds_read_b64_tr_b16 a[84:85], v78 offset:40960
ds_read_b64_tr_b16 a[86:87], v78 offset:41472
ds_read_b64_tr_b16 a[24:25], v77 offset:8192
ds_read_b64_tr_b16 a[26:27], v77 offset:8704
ds_read_b64_tr_b16 a[28:29], v77 offset:40960
ds_read_b64_tr_b16 a[30:31], v77 offset:41472
ds_read_b64_tr_b16 a[88:89], v79 offset:8192
ds_read_b64_tr_b16 a[90:91], v79 offset:8704
ds_read_b64_tr_b16 a[92:93], v79 offset:40960
ds_read_b64_tr_b16 a[94:95], v79 offset:41472
s_waitcnt vmcnt(16) lgkmcnt(0)
s_barrier
s_add_u32 m0, s81, 8192
s_add_u32 s60, s80, 1048576
buffer_load_dwordx4 v124, s[20:23], s60 offen offset:0  lds
v_xor_b32 v127, 64, v124
s_add_u32 s60, s80, 1080320
buffer_load_dwordx4 v127, s[20:23], s60 offen offset:1024  lds
s_add_u32 s60, s80, 1112064
buffer_load_dwordx4 v124, s[20:23], s60 offen offset:2048  lds
v_xor_b32 v127, 64, v124
s_add_u32 s60, s80, 1143808
buffer_load_dwordx4 v127, s[20:23], s60 offen offset:3072  lds
v_xor_b32 v127, 128, v124
s_add_u32 m0, s81, 12288
s_add_u32 s60, s80, 1179648
buffer_load_dwordx4 v127, s[20:23], s60 offen offset:0  lds
v_xor_b32 v127, 192, v124
s_add_u32 s60, s80, 1211392
buffer_load_dwordx4 v127, s[20:23], s60 offen offset:1024  lds
v_xor_b32 v127, 128, v124
s_add_u32 s60, s80, 1243136
buffer_load_dwordx4 v127, s[20:23], s60 offen offset:2048  lds
v_xor_b32 v127, 192, v124
s_add_u32 s60, s80, 1274880
buffer_load_dwordx4 v127, s[20:23], s60 offen offset:3072  lds
ds_read_b64_tr_b16 a[32:33], v76 offset:16384
ds_read_b64_tr_b16 a[34:35], v76 offset:16896
ds_read_b64_tr_b16 a[36:37], v76 offset:49152
ds_read_b64_tr_b16 a[38:39], v76 offset:49664
ds_read_b64_tr_b16 a[96:97], v78 offset:16384
ds_read_b64_tr_b16 a[98:99], v78 offset:16896
ds_read_b64_tr_b16 a[100:101], v78 offset:49152
ds_read_b64_tr_b16 a[102:103], v78 offset:49664
ds_read_b64_tr_b16 a[40:41], v77 offset:16384
ds_read_b64_tr_b16 a[42:43], v77 offset:16896
ds_read_b64_tr_b16 a[44:45], v77 offset:49152
ds_read_b64_tr_b16 a[46:47], v77 offset:49664
ds_read_b64_tr_b16 a[104:105], v79 offset:16384
ds_read_b64_tr_b16 a[106:107], v79 offset:16896
ds_read_b64_tr_b16 a[108:109], v79 offset:49152
ds_read_b64_tr_b16 a[110:111], v79 offset:49664
s_waitcnt vmcnt(16) lgkmcnt(0)
s_barrier
s_add_u32 m0, s81, 16384
s_add_u32 s60, s80, 2097152
buffer_load_dwordx4 v124, s[20:23], s60 offen offset:0  lds
v_xor_b32 v127, 64, v124
s_add_u32 s60, s80, 2128896
buffer_load_dwordx4 v127, s[20:23], s60 offen offset:1024  lds
s_add_u32 s60, s80, 2160640
buffer_load_dwordx4 v124, s[20:23], s60 offen offset:2048  lds
v_xor_b32 v127, 64, v124
s_add_u32 s60, s80, 2192384
buffer_load_dwordx4 v127, s[20:23], s60 offen offset:3072  lds
v_xor_b32 v127, 128, v124
s_add_u32 m0, s81, 20480
s_add_u32 s60, s80, 2228224
buffer_load_dwordx4 v127, s[20:23], s60 offen offset:0  lds
v_xor_b32 v127, 192, v124
s_add_u32 s60, s80, 2259968
buffer_load_dwordx4 v127, s[20:23], s60 offen offset:1024  lds
v_xor_b32 v127, 128, v124
s_add_u32 s60, s80, 2291712
buffer_load_dwordx4 v127, s[20:23], s60 offen offset:2048  lds
v_xor_b32 v127, 192, v124
s_add_u32 s60, s80, 2323456
buffer_load_dwordx4 v127, s[20:23], s60 offen offset:3072  lds
ds_read_b64_tr_b16 a[48:49], v76 offset:24576
ds_read_b64_tr_b16 a[50:51], v76 offset:25088
ds_read_b64_tr_b16 a[52:53], v76 offset:57344
ds_read_b64_tr_b16 a[54:55], v76 offset:57856
ds_read_b64_tr_b16 a[112:113], v78 offset:24576
ds_read_b64_tr_b16 a[114:115], v78 offset:25088
ds_read_b64_tr_b16 a[116:117], v78 offset:57344
ds_read_b64_tr_b16 a[118:119], v78 offset:57856
ds_read_b64_tr_b16 a[56:57], v77 offset:24576
ds_read_b64_tr_b16 a[58:59], v77 offset:25088
ds_read_b64_tr_b16 a[60:61], v77 offset:57344
ds_read_b64_tr_b16 a[62:63], v77 offset:57856
ds_read_b64_tr_b16 a[120:121], v79 offset:24576
ds_read_b64_tr_b16 a[122:123], v79 offset:25088
ds_read_b64_tr_b16 a[124:125], v79 offset:57344
ds_read_b64_tr_b16 a[126:127], v79 offset:57856
s_waitcnt vmcnt(16) lgkmcnt(0)
s_barrier
s_add_u32 m0, s81, 24576
s_add_u32 s60, s80, 3145728
buffer_load_dwordx4 v124, s[20:23], s60 offen offset:0  lds
v_xor_b32 v127, 64, v124
s_add_u32 s60, s80, 3177472
buffer_load_dwordx4 v127, s[20:23], s60 offen offset:1024  lds
s_add_u32 s60, s80, 3209216
buffer_load_dwordx4 v124, s[20:23], s60 offen offset:2048  lds
v_xor_b32 v127, 64, v124
s_add_u32 s60, s80, 3240960
buffer_load_dwordx4 v127, s[20:23], s60 offen offset:3072  lds
v_xor_b32 v127, 128, v124
s_add_u32 m0, s81, 28672
s_add_u32 s60, s80, 3276800
buffer_load_dwordx4 v127, s[20:23], s60 offen offset:0  lds
v_xor_b32 v127, 192, v124
s_add_u32 s60, s80, 3308544
buffer_load_dwordx4 v127, s[20:23], s60 offen offset:1024  lds
v_xor_b32 v127, 128, v124
s_add_u32 s60, s80, 3340288
buffer_load_dwordx4 v127, s[20:23], s60 offen offset:2048  lds
v_xor_b32 v127, 192, v124
s_add_u32 s60, s80, 3372032
buffer_load_dwordx4 v127, s[20:23], s60 offen offset:3072  lds
ds_read_b64_tr_b16 a[128:129], v76 offset:0
ds_read_b64_tr_b16 a[130:131], v76 offset:512
ds_read_b64_tr_b16 a[132:133], v76 offset:32768
ds_read_b64_tr_b16 a[134:135], v76 offset:33280
ds_read_b64_tr_b16 a[192:193], v78 offset:0
ds_read_b64_tr_b16 a[194:195], v78 offset:512
ds_read_b64_tr_b16 a[196:197], v78 offset:32768
ds_read_b64_tr_b16 a[198:199], v78 offset:33280
ds_read_b64_tr_b16 a[136:137], v77 offset:0
ds_read_b64_tr_b16 a[138:139], v77 offset:512
ds_read_b64_tr_b16 a[140:141], v77 offset:32768
ds_read_b64_tr_b16 a[142:143], v77 offset:33280
ds_read_b64_tr_b16 a[200:201], v79 offset:0
ds_read_b64_tr_b16 a[202:203], v79 offset:512
ds_read_b64_tr_b16 a[204:205], v79 offset:32768
ds_read_b64_tr_b16 a[206:207], v79 offset:33280
s_waitcnt vmcnt(16) lgkmcnt(0)
s_barrier
s_add_u32 m0, s81, 0
s_add_u32 s60, s80, 0
buffer_load_dwordx4 v124, s[12:15], s60 offen offset:0  lds
v_xor_b32 v127, 64, v124
s_add_u32 s60, s80, 31744
buffer_load_dwordx4 v127, s[12:15], s60 offen offset:1024  lds
s_add_u32 s60, s80, 63488
buffer_load_dwordx4 v124, s[12:15], s60 offen offset:2048  lds
v_xor_b32 v127, 64, v124
s_add_u32 s60, s80, 95232
buffer_load_dwordx4 v127, s[12:15], s60 offen offset:3072  lds
v_xor_b32 v127, 128, v124
s_add_u32 m0, s81, 4096
s_add_u32 s60, s80, 131072
buffer_load_dwordx4 v127, s[12:15], s60 offen offset:0  lds
v_xor_b32 v127, 192, v124
s_add_u32 s60, s80, 162816
buffer_load_dwordx4 v127, s[12:15], s60 offen offset:1024  lds
v_xor_b32 v127, 128, v124
s_add_u32 s60, s80, 194560
buffer_load_dwordx4 v127, s[12:15], s60 offen offset:2048  lds
v_xor_b32 v127, 192, v124
s_add_u32 s60, s80, 226304
buffer_load_dwordx4 v127, s[12:15], s60 offen offset:3072  lds
ds_read_b64_tr_b16 a[144:145], v76 offset:8192
ds_read_b64_tr_b16 a[146:147], v76 offset:8704
ds_read_b64_tr_b16 a[148:149], v76 offset:40960
ds_read_b64_tr_b16 a[150:151], v76 offset:41472
ds_read_b64_tr_b16 a[208:209], v78 offset:8192
ds_read_b64_tr_b16 a[210:211], v78 offset:8704
ds_read_b64_tr_b16 a[212:213], v78 offset:40960
ds_read_b64_tr_b16 a[214:215], v78 offset:41472
ds_read_b64_tr_b16 a[152:153], v77 offset:8192
ds_read_b64_tr_b16 a[154:155], v77 offset:8704
ds_read_b64_tr_b16 a[156:157], v77 offset:40960
ds_read_b64_tr_b16 a[158:159], v77 offset:41472
ds_read_b64_tr_b16 a[216:217], v79 offset:8192
ds_read_b64_tr_b16 a[218:219], v79 offset:8704
ds_read_b64_tr_b16 a[220:221], v79 offset:40960
ds_read_b64_tr_b16 a[222:223], v79 offset:41472
s_waitcnt vmcnt(16) lgkmcnt(0)
s_barrier
s_add_u32 m0, s81, 8192
s_add_u32 s60, s80, 1048576
buffer_load_dwordx4 v124, s[12:15], s60 offen offset:0  lds
v_xor_b32 v127, 64, v124
s_add_u32 s60, s80, 1080320
buffer_load_dwordx4 v127, s[12:15], s60 offen offset:1024  lds
s_add_u32 s60, s80, 1112064
buffer_load_dwordx4 v124, s[12:15], s60 offen offset:2048  lds
v_xor_b32 v127, 64, v124
s_add_u32 s60, s80, 1143808
buffer_load_dwordx4 v127, s[12:15], s60 offen offset:3072  lds
v_xor_b32 v127, 128, v124
s_add_u32 m0, s81, 12288
s_add_u32 s60, s80, 1179648
buffer_load_dwordx4 v127, s[12:15], s60 offen offset:0  lds
v_xor_b32 v127, 192, v124
s_add_u32 s60, s80, 1211392
buffer_load_dwordx4 v127, s[12:15], s60 offen offset:1024  lds
v_xor_b32 v127, 128, v124
s_add_u32 s60, s80, 1243136
buffer_load_dwordx4 v127, s[12:15], s60 offen offset:2048  lds
v_xor_b32 v127, 192, v124
s_add_u32 s60, s80, 1274880
buffer_load_dwordx4 v127, s[12:15], s60 offen offset:3072  lds
buffer_load_dword v56, off, s[40:43], 0 offset:136 sc1
ds_read_b64_tr_b16 a[160:161], v76 offset:16384
ds_read_b64_tr_b16 a[162:163], v76 offset:16896
ds_read_b64_tr_b16 a[164:165], v76 offset:49152
ds_read_b64_tr_b16 a[166:167], v76 offset:49664
ds_read_b64_tr_b16 a[224:225], v78 offset:16384
ds_read_b64_tr_b16 a[226:227], v78 offset:16896
ds_read_b64_tr_b16 a[228:229], v78 offset:49152
ds_read_b64_tr_b16 a[230:231], v78 offset:49664
ds_read_b64_tr_b16 a[168:169], v77 offset:16384
ds_read_b64_tr_b16 a[170:171], v77 offset:16896
ds_read_b64_tr_b16 a[172:173], v77 offset:49152
ds_read_b64_tr_b16 a[174:175], v77 offset:49664
ds_read_b64_tr_b16 a[232:233], v79 offset:16384
ds_read_b64_tr_b16 a[234:235], v79 offset:16896
ds_read_b64_tr_b16 a[236:237], v79 offset:49152
ds_read_b64_tr_b16 a[238:239], v79 offset:49664
s_waitcnt vmcnt(17) lgkmcnt(0)
s_barrier
s_add_u32 m0, s81, 16384
s_add_u32 s60, s80, 2097152
buffer_load_dwordx4 v124, s[12:15], s60 offen offset:0  lds
v_xor_b32 v127, 64, v124
s_add_u32 s60, s80, 2128896
buffer_load_dwordx4 v127, s[12:15], s60 offen offset:1024  lds
s_add_u32 s60, s80, 2160640
buffer_load_dwordx4 v124, s[12:15], s60 offen offset:2048  lds
v_xor_b32 v127, 64, v124
s_add_u32 s60, s80, 2192384
buffer_load_dwordx4 v127, s[12:15], s60 offen offset:3072  lds
v_xor_b32 v127, 128, v124
s_add_u32 m0, s81, 20480
s_add_u32 s60, s80, 2228224
buffer_load_dwordx4 v127, s[12:15], s60 offen offset:0  lds
v_xor_b32 v127, 192, v124
s_add_u32 s60, s80, 2259968
buffer_load_dwordx4 v127, s[12:15], s60 offen offset:1024  lds
v_xor_b32 v127, 128, v124
s_add_u32 s60, s80, 2291712
buffer_load_dwordx4 v127, s[12:15], s60 offen offset:2048  lds
v_xor_b32 v127, 192, v124
s_add_u32 s60, s80, 2323456
buffer_load_dwordx4 v127, s[12:15], s60 offen offset:3072  lds
ds_read_b64_tr_b16 a[176:177], v76 offset:24576
ds_read_b64_tr_b16 a[178:179], v76 offset:25088
ds_read_b64_tr_b16 a[180:181], v76 offset:57344
ds_read_b64_tr_b16 a[182:183], v76 offset:57856
ds_read_b64_tr_b16 a[240:241], v78 offset:24576
ds_read_b64_tr_b16 a[242:243], v78 offset:25088
ds_read_b64_tr_b16 a[244:245], v78 offset:57344
ds_read_b64_tr_b16 a[246:247], v78 offset:57856
ds_read_b64_tr_b16 a[184:185], v77 offset:24576
ds_read_b64_tr_b16 a[186:187], v77 offset:25088
ds_read_b64_tr_b16 a[188:189], v77 offset:57344
ds_read_b64_tr_b16 a[190:191], v77 offset:57856
ds_read_b64_tr_b16 a[248:249], v79 offset:24576
ds_read_b64_tr_b16 a[250:251], v79 offset:25088
ds_read_b64_tr_b16 a[252:253], v79 offset:57344
ds_read_b64_tr_b16 a[254:255], v79 offset:57856
s_waitcnt vmcnt(17) lgkmcnt(0)
s_barrier
s_add_u32 m0, s81, 24576
s_add_u32 s60, s80, 3145728
buffer_load_dwordx4 v124, s[12:15], s60 offen offset:0  lds
v_xor_b32 v127, 64, v124
s_add_u32 s60, s80, 3177472
buffer_load_dwordx4 v127, s[12:15], s60 offen offset:1024  lds
s_add_u32 s60, s80, 3209216
buffer_load_dwordx4 v124, s[12:15], s60 offen offset:2048  lds
v_xor_b32 v127, 64, v124
s_add_u32 s60, s80, 3240960
buffer_load_dwordx4 v127, s[12:15], s60 offen offset:3072  lds
v_xor_b32 v127, 128, v124
s_add_u32 m0, s81, 28672
s_add_u32 s60, s80, 3276800
buffer_load_dwordx4 v127, s[12:15], s60 offen offset:0  lds
v_xor_b32 v127, 192, v124
s_add_u32 s60, s80, 3308544
buffer_load_dwordx4 v127, s[12:15], s60 offen offset:1024  lds
v_xor_b32 v127, 128, v124
s_add_u32 s60, s80, 3340288
buffer_load_dwordx4 v127, s[12:15], s60 offen offset:2048  lds
v_xor_b32 v127, 192, v124
s_add_u32 s60, s80, 3372032
buffer_load_dwordx4 v127, s[12:15], s60 offen offset:3072  lds
ds_read_b64_tr_b16 v[84:85], v76 offset:0
ds_read_b64_tr_b16 v[86:87], v76 offset:512
ds_read_b64_tr_b16 v[88:89], v76 offset:32768
ds_read_b64_tr_b16 v[90:91], v76 offset:33280
ds_read_b64_tr_b16 v[92:93], v78 offset:0
ds_read_b64_tr_b16 v[94:95], v78 offset:512
ds_read_b64_tr_b16 v[96:97], v78 offset:32768
ds_read_b64_tr_b16 v[98:99], v78 offset:33280
ds_read_b64_tr_b16 v[100:101], v77 offset:0
ds_read_b64_tr_b16 v[102:103], v77 offset:512
ds_read_b64_tr_b16 v[104:105], v77 offset:32768
ds_read_b64_tr_b16 v[106:107], v77 offset:33280
ds_read_b64_tr_b16 v[108:109], v79 offset:0
ds_read_b64_tr_b16 v[110:111], v79 offset:512
ds_read_b64_tr_b16 v[112:113], v79 offset:32768
ds_read_b64_tr_b16 v[114:115], v79 offset:33280
s_waitcnt vmcnt(16) lgkmcnt(0)
s_barrier
s_add_u32 m0, s81, 0
s_add_u32 s60, s82, 0
buffer_load_dwordx4 v126, s[24:27], s60 offen offset:0  lds
s_add_u32 s60, s82, 3072
buffer_load_dwordx4 v126, s[24:27], s60 offen offset:1024  lds
s_add_u32 s60, s82, 6144
buffer_load_dwordx4 v126, s[24:27], s60 offen offset:2048  lds
s_add_u32 s60, s82, 9216
buffer_load_dwordx4 v126, s[24:27], s60 offen offset:3072  lds
s_add_u32 m0, s81, 4096
s_add_u32 s60, s82, 16384
buffer_load_dwordx4 v125, s[24:27], s60 offen offset:0  lds
s_add_u32 s60, s82, 19456
buffer_load_dwordx4 v125, s[24:27], s60 offen offset:1024  lds
s_add_u32 s60, s82, 22528
buffer_load_dwordx4 v125, s[24:27], s60 offen offset:2048  lds
s_add_u32 s60, s82, 25600
buffer_load_dwordx4 v125, s[24:27], s60 offen offset:3072  lds
L_gw_17:
v_readfirstlane_b32 s55, v56
s_nop 0
s_cmp_lg_u32 s55, 0
s_cbranch_scc1 L_gk_18
s_add_u32 s54, s54, 1
s_cmp_gt_u32 s54, 400000
s_cbranch_scc1 L_end
buffer_load_dword v56, off, s[40:43], 0 offset:136 sc1
s_waitcnt vmcnt(0)
s_branch L_gw_17
L_gk_18:
s_lshr_b32 s53, s55, 16
ds_read_b64_tr_b16 v[116:117], v76 offset:8192
ds_read_b64_tr_b16 v[118:119], v76 offset:8704
ds_read_b64_tr_b16 v[120:121], v76 offset:40960
ds_read_b64_tr_b16 v[122:123], v76 offset:41472
ds_read_b64_tr_b16 v[168:169], v78 offset:8192
ds_read_b64_tr_b16 v[170:171], v78 offset:8704
ds_read_b64_tr_b16 v[172:173], v78 offset:40960
ds_read_b64_tr_b16 v[174:175], v78 offset:41472
ds_read_b64_tr_b16 v[128:129], v77 offset:8192
ds_read_b64_tr_b16 v[130:131], v77 offset:8704
ds_read_b64_tr_b16 v[132:133], v77 offset:40960
ds_read_b64_tr_b16 v[134:135], v77 offset:41472
ds_read_b64_tr_b16 v[176:177], v79 offset:8192
ds_read_b64_tr_b16 v[178:179], v79 offset:8704
ds_read_b64_tr_b16 v[180:181], v79 offset:40960
ds_read_b64_tr_b16 v[182:183], v79 offset:41472
s_waitcnt vmcnt(16) lgkmcnt(0)
s_barrier
s_add_u32 m0, s81, 8192
s_add_u32 s60, s82, 32768
buffer_load_dwordx4 v126, s[24:27], s60 offen offset:0  lds
s_add_u32 s60, s82, 35840
buffer_load_dwordx4 v126, s[24:27], s60 offen offset:1024  lds
s_add_u32 s60, s82, 38912
buffer_load_dwordx4 v126, s[24:27], s60 offen offset:2048  lds
s_add_u32 s60, s82, 41984
buffer_load_dwordx4 v126, s[24:27], s60 offen offset:3072  lds
s_add_u32 m0, s81, 12288
s_add_u32 s60, s82, 49152
buffer_load_dwordx4 v125, s[24:27], s60 offen offset:0  lds
s_add_u32 s60, s82, 52224
buffer_load_dwordx4 v125, s[24:27], s60 offen offset:1024  lds
s_add_u32 s60, s82, 55296
buffer_load_dwordx4 v125, s[24:27], s60 offen offset:2048  lds
s_add_u32 s60, s82, 58368
buffer_load_dwordx4 v125, s[24:27], s60 offen offset:3072  lds
ds_read_b64_tr_b16 v[136:137], v76 offset:16384
ds_read_b64_tr_b16 v[138:139], v76 offset:16896
ds_read_b64_tr_b16 v[140:141], v76 offset:49152
ds_read_b64_tr_b16 v[142:143], v76 offset:49664
ds_read_b64_tr_b16 v[184:185], v78 offset:16384
ds_read_b64_tr_b16 v[186:187], v78 offset:16896
ds_read_b64_tr_b16 v[188:189], v78 offset:49152
ds_read_b64_tr_b16 v[190:191], v78 offset:49664
ds_read_b64_tr_b16 v[144:145], v77 offset:16384
ds_read_b64_tr_b16 v[146:147], v77 offset:16896
ds_read_b64_tr_b16 v[148:149], v77 offset:49152
ds_read_b64_tr_b16 v[150:151], v77 offset:49664
ds_read_b64_tr_b16 v[192:193], v79 offset:16384
ds_read_b64_tr_b16 v[194:195], v79 offset:16896
ds_read_b64_tr_b16 v[196:197], v79 offset:49152
ds_read_b64_tr_b16 v[198:199], v79 offset:49664
s_waitcnt vmcnt(16) lgkmcnt(0)
s_barrier
s_add_u32 m0, s81, 16384
s_add_u32 s60, s82, 65536
buffer_load_dwordx4 v126, s[24:27], s60 offen offset:0  lds
s_add_u32 s60, s82, 68608
buffer_load_dwordx4 v126, s[24:27], s60 offen offset:1024  lds
s_add_u32 s60, s82, 71680
buffer_load_dwordx4 v126, s[24:27], s60 offen offset:2048  lds
s_add_u32 s60, s82, 74752
buffer_load_dwordx4 v126, s[24:27], s60 offen offset:3072  lds
s_add_u32 m0, s81, 20480
s_add_u32 s60, s82, 81920
buffer_load_dwordx4 v125, s[24:27], s60 offen offset:0  lds
s_add_u32 s60, s82, 84992
buffer_load_dwordx4 v125, s[24:27], s60 offen offset:1024  lds
s_add_u32 s60, s82, 88064
buffer_load_dwordx4 v125, s[24:27], s60 offen offset:2048  lds
s_add_u32 s60, s82, 91136
buffer_load_dwordx4 v125, s[24:27], s60 offen offset:3072  lds
ds_read_b64_tr_b16 v[152:153], v76 offset:24576
ds_read_b64_tr_b16 v[154:155], v76 offset:25088
ds_read_b64_tr_b16 v[156:157], v76 offset:57344
ds_read_b64_tr_b16 v[158:159], v76 offset:57856
ds_read_b64_tr_b16 v[200:201], v78 offset:24576
ds_read_b64_tr_b16 v[202:203], v78 offset:25088
ds_read_b64_tr_b16 v[204:205], v78 offset:57344
ds_read_b64_tr_b16 v[206:207], v78 offset:57856
ds_read_b64_tr_b16 v[160:161], v77 offset:24576
ds_read_b64_tr_b16 v[162:163], v77 offset:25088
ds_read_b64_tr_b16 v[164:165], v77 offset:57344
ds_read_b64_tr_b16 v[166:167], v77 offset:57856
ds_read_b64_tr_b16 v[208:209], v79 offset:24576
ds_read_b64_tr_b16 v[210:211], v79 offset:25088
ds_read_b64_tr_b16 v[212:213], v79 offset:57344
ds_read_b64_tr_b16 v[214:215], v79 offset:57856
s_waitcnt vmcnt(16) lgkmcnt(0)
s_barrier
s_add_u32 m0, s81, 24576
s_add_u32 s60, s82, 98304
buffer_load_dwordx4 v126, s[24:27], s60 offen offset:0  lds
s_add_u32 s60, s82, 101376
buffer_load_dwordx4 v126, s[24:27], s60 offen offset:1024  lds
s_add_u32 s60, s82, 104448
buffer_load_dwordx4 v126, s[24:27], s60 offen offset:2048  lds
s_add_u32 s60, s82, 107520
buffer_load_dwordx4 v126, s[24:27], s60 offen offset:3072  lds
s_add_u32 m0, s81, 28672
s_add_u32 s60, s82, 114688
buffer_load_dwordx4 v125, s[24:27], s60 offen offset:0  lds
s_add_u32 s60, s82, 117760
buffer_load_dwordx4 v125, s[24:27], s60 offen offset:1024  lds
s_add_u32 s60, s82, 120832
buffer_load_dwordx4 v125, s[24:27], s60 offen offset:2048  lds
s_add_u32 s60, s82, 123904
buffer_load_dwordx4 v125, s[24:27], s60 offen offset:3072  lds
ds_read_b64_tr_b16 v[20:21], v80 offset:0
ds_read_b64_tr_b16 v[22:23], v80 offset:512
ds_read_b64_tr_b16 v[24:25], v80 offset:2048
ds_read_b64_tr_b16 v[26:27], v80 offset:2560
v_xor_b32 v81, 64, v80
ds_read_b64_tr_b16 v[28:29], v81 offset:0
ds_read_b64_tr_b16 v[30:31], v81 offset:512
ds_read_b64_tr_b16 v[32:33], v81 offset:2048
ds_read_b64_tr_b16 v[34:35], v81 offset:2560
v_xor_b32 v81, 128, v80
ds_read_b64_tr_b16 v[36:37], v81 offset:0
ds_read_b64_tr_b16 v[38:39], v81 offset:512
ds_read_b64_tr_b16 v[40:41], v81 offset:2048
ds_read_b64_tr_b16 v[42:43], v81 offset:2560
v_xor_b32 v81, 192, v80
ds_read_b64_tr_b16 v[44:45], v81 offset:0
ds_read_b64_tr_b16 v[46:47], v81 offset:512
ds_read_b64_tr_b16 v[48:49], v81 offset:2048
ds_read_b64_tr_b16 v[50:51], v81 offset:2560
s_waitcnt lgkmcnt(0)
ds_write_b128 v2, v[20:23] offset:0
ds_write_b128 v2, v[24:27] offset:1024
ds_write_b128 v2, v[28:31] offset:2048
ds_write_b128 v2, v[32:35] offset:3072
ds_write_b128 v2, v[36:39] offset:4096
ds_write_b128 v2, v[40:43] offset:5120
ds_write_b128 v2, v[44:47] offset:6144
ds_write_b128 v2, v[48:51] offset:7168
s_waitcnt vmcnt(16) lgkmcnt(0)
s_barrier
ds_read_b64_tr_b16 v[20:21], v80 offset:8192
ds_read_b64_tr_b16 v[22:23], v80 offset:8704
ds_read_b64_tr_b16 v[24:25], v80 offset:10240
ds_read_b64_tr_b16 v[26:27], v80 offset:10752
v_xor_b32 v81, 64, v80
ds_read_b64_tr_b16 v[224:225], v81 offset:8192
ds_read_b64_tr_b16 v[226:227], v81 offset:8704
ds_read_b64_tr_b16 v[228:229], v81 offset:10240
ds_read_b64_tr_b16 v[230:231], v81 offset:10752
v_xor_b32 v81, 128, v80
ds_read_b64_tr_b16 v[248:249], v81 offset:8192
ds_read_b64_tr_b16 v[250:251], v81 offset:8704
ds_read_b64_tr_b16 v[252:253], v81 offset:10240
ds_read_b64_tr_b16 v[254:255], v81 offset:10752
v_xor_b32 v81, 192, v80
ds_read_b64_tr_b16 v[28:29], v81 offset:8192
ds_read_b64_tr_b16 v[30:31], v81 offset:8704
ds_read_b64_tr_b16 v[32:33], v81 offset:10240
ds_read_b64_tr_b16 v[34:35], v81 offset:10752
s_waitcnt lgkmcnt(0)
ds_write_b128 v2, v[20:23] offset:8192
ds_write_b128 v2, v[24:27] offset:9216
ds_write_b128 v2, v[28:31] offset:10240
ds_write_b128 v2, v[32:35] offset:11264
ds_write_b128 v2, v[84:87] offset:12288
ds_write_b128 v2, v[88:91] offset:13312
ds_write_b128 v2, v[92:95] offset:14336
ds_write_b128 v2, v[96:99] offset:15360
s_waitcnt vmcnt(8) lgkmcnt(0)
s_barrier
ds_read_b64_tr_b16 v[20:21], v80 offset:16384
ds_read_b64_tr_b16 v[22:23], v80 offset:16896
ds_read_b64_tr_b16 v[24:25], v80 offset:18432
ds_read_b64_tr_b16 v[26:27], v80 offset:18944
v_xor_b32 v81, 64, v80
ds_read_b64_tr_b16 v[232:233], v81 offset:16384
ds_read_b64_tr_b16 v[234:235], v81 offset:16896
ds_read_b64_tr_b16 v[236:237], v81 offset:18432
ds_read_b64_tr_b16 v[238:239], v81 offset:18944
v_xor_b32 v81, 128, v80
ds_read_b64_tr_b16 v[28:29], v81 offset:16384
ds_read_b64_tr_b16 v[30:31], v81 offset:16896
ds_read_b64_tr_b16 v[32:33], v81 offset:18432
ds_read_b64_tr_b16 v[34:35], v81 offset:18944
v_xor_b32 v81, 192, v80
ds_read_b64_tr_b16 v[36:37], v81 offset:16384
ds_read_b64_tr_b16 v[38:39], v81 offset:16896
ds_read_b64_tr_b16 v[40:41], v81 offset:18432
ds_read_b64_tr_b16 v[42:43], v81 offset:18944
s_waitcnt lgkmcnt(0)
ds_write_b128 v2, v[20:23] offset:16384
ds_write_b128 v2, v[24:27] offset:17408
ds_write_b128 v2, v[28:31] offset:18432
ds_write_b128 v2, v[32:35] offset:19456
ds_write_b128 v2, v[36:39] offset:20480
ds_write_b128 v2, v[40:43] offset:21504
ds_write_b128 v2, v[100:103] offset:22528
ds_write_b128 v2, v[104:107] offset:23552
s_waitcnt vmcnt(0) lgkmcnt(0)
s_barrier
buffer_load_dword v56, v57, s[44:47], s66 offen offset:4 sc1
buffer_load_dword v60, v82, s[44:47], s67 offen sc1
buffer_load_dword v61, v82, s[44:47], s68 offen sc1
ds_read_b64_tr_b16 v[216:217], v80 offset:24576
ds_read_b64_tr_b16 v[218:219], v80 offset:25088
ds_read_b64_tr_b16 v[220:221], v80 offset:26624
ds_read_b64_tr_b16 v[222:223], v80 offset:27136
v_xor_b32 v81, 64, v80
ds_read_b64_tr_b16 v[240:241], v81 offset:24576
ds_read_b64_tr_b16 v[242:243], v81 offset:25088
ds_read_b64_tr_b16 v[244:245], v81 offset:26624
ds_read_b64_tr_b16 v[246:247], v81 offset:27136
v_xor_b32 v81, 128, v80
ds_read_b64_tr_b16 v[20:21], v81 offset:24576
ds_read_b64_tr_b16 v[22:23], v81 offset:25088
ds_read_b64_tr_b16 v[24:25], v81 offset:26624
ds_read_b64_tr_b16 v[26:27], v81 offset:27136
v_xor_b32 v81, 192, v80
ds_read_b64_tr_b16 v[28:29], v81 offset:24576
ds_read_b64_tr_b16 v[30:31], v81 offset:25088
ds_read_b64_tr_b16 v[32:33], v81 offset:26624
ds_read_b64_tr_b16 v[34:35], v81 offset:27136
s_waitcnt lgkmcnt(0)
ds_write_b128 v2, v[20:23] offset:24576
ds_write_b128 v2, v[24:27] offset:25600
ds_write_b128 v2, v[28:31] offset:26624
ds_write_b128 v2, v[32:35] offset:27648
ds_write_b128 v2, v[108:111] offset:28672
ds_write_b128 v2, v[112:115] offset:29696
ds_write_b128 v2, v[116:119] offset:30720
ds_write_b128 v2, v[120:123] offset:31744
s_waitcnt lgkmcnt(0)
s_branch L_c_wd
L_c_w1:
s_waitcnt vmcnt(16) lgkmcnt(0)
s_barrier
s_add_u32 m0, s81, 24576
s_add_u32 s60, s80, 3145728
buffer_load_dwordx4 v124, s[16:19], s60 offen offset:0  lds
v_xor_b32 v127, 64, v124
s_add_u32 s60, s80, 3177472
buffer_load_dwordx4 v127, s[16:19], s60 offen offset:1024  lds
s_add_u32 s60, s80, 3209216
buffer_load_dwordx4 v124, s[16:19], s60 offen offset:2048  lds
v_xor_b32 v127, 64, v124
s_add_u32 s60, s80, 3240960
buffer_load_dwordx4 v127, s[16:19], s60 offen offset:3072  lds
v_xor_b32 v127, 128, v124
s_add_u32 m0, s81, 28672
s_add_u32 s60, s80, 3276800
buffer_load_dwordx4 v127, s[16:19], s60 offen offset:0  lds
v_xor_b32 v127, 192, v124
s_add_u32 s60, s80, 3308544
buffer_load_dwordx4 v127, s[16:19], s60 offen offset:1024  lds
v_xor_b32 v127, 128, v124
s_add_u32 s60, s80, 3340288
buffer_load_dwordx4 v127, s[16:19], s60 offen offset:2048  lds
v_xor_b32 v127, 192, v124
s_add_u32 s60, s80, 3372032
buffer_load_dwordx4 v127, s[16:19], s60 offen offset:3072  lds
s_cmp_lg_u32 s52, 0
s_cbranch_scc1 L_cc_done_19
v_mov_b32 v53, 162816
ds_read_b32 v52, v53
s_mov_b32 s52, 1
s_lshl_b32 s56, s49, 8
s_or_b32 s56, s56, s50
s_waitcnt lgkmcnt(0)
v_readfirstlane_b32 s55, v52
s_nop 0
s_cmp_eq_u32 s55, s56
s_cbranch_scc1 L_cc_done_19
s_lshr_b32 s49, s55, 8
s_and_b32 s50, s55, 31
s_waitcnt vmcnt(0)
s_barrier
s_branch L_dispatch
L_cc_done_19:
ds_read_b64_tr_b16 a[16:17], v76 offset:0
ds_read_b64_tr_b16 a[18:19], v76 offset:512
ds_read_b64_tr_b16 a[20:21], v76 offset:32768
ds_read_b64_tr_b16 a[22:23], v76 offset:33280
ds_read_b64_tr_b16 a[80:81], v78 offset:0
ds_read_b64_tr_b16 a[82:83], v78 offset:512
ds_read_b64_tr_b16 a[84:85], v78 offset:32768
ds_read_b64_tr_b16 a[86:87], v78 offset:33280
ds_read_b64_tr_b16 a[24:25], v77 offset:0
ds_read_b64_tr_b16 a[26:27], v77 offset:512
ds_read_b64_tr_b16 a[28:29], v77 offset:32768
ds_read_b64_tr_b16 a[30:31], v77 offset:33280
ds_read_b64_tr_b16 a[88:89], v79 offset:0
ds_read_b64_tr_b16 a[90:91], v79 offset:512
ds_read_b64_tr_b16 a[92:93], v79 offset:32768
ds_read_b64_tr_b16 a[94:95], v79 offset:33280
s_waitcnt vmcnt(16) lgkmcnt(0)
s_barrier
s_add_u32 m0, s81, 0
s_add_u32 s60, s80, 0
buffer_load_dwordx4 v124, s[20:23], s60 offen offset:0  lds
v_xor_b32 v127, 64, v124
s_add_u32 s60, s80, 31744
buffer_load_dwordx4 v127, s[20:23], s60 offen offset:1024  lds
s_add_u32 s60, s80, 63488
buffer_load_dwordx4 v124, s[20:23], s60 offen offset:2048  lds
v_xor_b32 v127, 64, v124
s_add_u32 s60, s80, 95232
buffer_load_dwordx4 v127, s[20:23], s60 offen offset:3072  lds
v_xor_b32 v127, 128, v124
s_add_u32 m0, s81, 4096
s_add_u32 s60, s80, 131072
buffer_load_dwordx4 v127, s[20:23], s60 offen offset:0  lds
v_xor_b32 v127, 192, v124
s_add_u32 s60, s80, 162816
buffer_load_dwordx4 v127, s[20:23], s60 offen offset:1024  lds
v_xor_b32 v127, 128, v124
s_add_u32 s60, s80, 194560
buffer_load_dwordx4 v127, s[20:23], s60 offen offset:2048  lds
v_xor_b32 v127, 192, v124
s_add_u32 s60, s80, 226304
buffer_load_dwordx4 v127, s[20:23], s60 offen offset:3072  lds
ds_read_b64_tr_b16 a[0:1], v76 offset:8192
ds_read_b64_tr_b16 a[2:3], v76 offset:8704
ds_read_b64_tr_b16 a[4:5], v76 offset:40960
ds_read_b64_tr_b16 a[6:7], v76 offset:41472
ds_read_b64_tr_b16 a[64:65], v78 offset:8192
ds_read_b64_tr_b16 a[66:67], v78 offset:8704
ds_read_b64_tr_b16 a[68:69], v78 offset:40960
ds_read_b64_tr_b16 a[70:71], v78 offset:41472
ds_read_b64_tr_b16 a[8:9], v77 offset:8192
ds_read_b64_tr_b16 a[10:11], v77 offset:8704
ds_read_b64_tr_b16 a[12:13], v77 offset:40960
ds_read_b64_tr_b16 a[14:15], v77 offset:41472
ds_read_b64_tr_b16 a[72:73], v79 offset:8192
ds_read_b64_tr_b16 a[74:75], v79 offset:8704
ds_read_b64_tr_b16 a[76:77], v79 offset:40960
ds_read_b64_tr_b16 a[78:79], v79 offset:41472
s_waitcnt vmcnt(16) lgkmcnt(0)
s_barrier
s_add_u32 m0, s81, 8192
s_add_u32 s60, s80, 1048576
buffer_load_dwordx4 v124, s[20:23], s60 offen offset:0  lds
v_xor_b32 v127, 64, v124
s_add_u32 s60, s80, 1080320
buffer_load_dwordx4 v127, s[20:23], s60 offen offset:1024  lds
s_add_u32 s60, s80, 1112064
buffer_load_dwordx4 v124, s[20:23], s60 offen offset:2048  lds
v_xor_b32 v127, 64, v124
s_add_u32 s60, s80, 1143808
buffer_load_dwordx4 v127, s[20:23], s60 offen offset:3072  lds
v_xor_b32 v127, 128, v124
s_add_u32 m0, s81, 12288
s_add_u32 s60, s80, 1179648
buffer_load_dwordx4 v127, s[20:23], s60 offen offset:0  lds
v_xor_b32 v127, 192, v124
s_add_u32 s60, s80, 1211392
buffer_load_dwordx4 v127, s[20:23], s60 offen offset:1024  lds
v_xor_b32 v127, 128, v124
s_add_u32 s60, s80, 1243136
buffer_load_dwordx4 v127, s[20:23], s60 offen offset:2048  lds
v_xor_b32 v127, 192, v124
s_add_u32 s60, s80, 1274880
buffer_load_dwordx4 v127, s[20:23], s60 offen offset:3072  lds
ds_read_b64_tr_b16 a[48:49], v76 offset:16384
ds_read_b64_tr_b16 a[50:51], v76 offset:16896
ds_read_b64_tr_b16 a[52:53], v76 offset:49152
ds_read_b64_tr_b16 a[54:55], v76 offset:49664
ds_read_b64_tr_b16 a[112:113], v78 offset:16384
ds_read_b64_tr_b16 a[114:115], v78 offset:16896
ds_read_b64_tr_b16 a[116:117], v78 offset:49152
ds_read_b64_tr_b16 a[118:119], v78 offset:49664
ds_read_b64_tr_b16 a[56:57], v77 offset:16384
ds_read_b64_tr_b16 a[58:59], v77 offset:16896
ds_read_b64_tr_b16 a[60:61], v77 offset:49152
ds_read_b64_tr_b16 a[62:63], v77 offset:49664
ds_read_b64_tr_b16 a[120:121], v79 offset:16384
ds_read_b64_tr_b16 a[122:123], v79 offset:16896
ds_read_b64_tr_b16 a[124:125], v79 offset:49152
ds_read_b64_tr_b16 a[126:127], v79 offset:49664
s_waitcnt vmcnt(16) lgkmcnt(0)
s_barrier
s_add_u32 m0, s81, 16384
s_add_u32 s60, s80, 2097152
buffer_load_dwordx4 v124, s[20:23], s60 offen offset:0  lds
v_xor_b32 v127, 64, v124
s_add_u32 s60, s80, 2128896
buffer_load_dwordx4 v127, s[20:23], s60 offen offset:1024  lds
s_add_u32 s60, s80, 2160640
buffer_load_dwordx4 v124, s[20:23], s60 offen offset:2048  lds
v_xor_b32 v127, 64, v124
s_add_u32 s60, s80, 2192384
buffer_load_dwordx4 v127, s[20:23], s60 offen offset:3072  lds
v_xor_b32 v127, 128, v124
s_add_u32 m0, s81, 20480
s_add_u32 s60, s80, 2228224
buffer_load_dwordx4 v127, s[20:23], s60 offen offset:0  lds
v_xor_b32 v127, 192, v124
s_add_u32 s60, s80, 2259968
buffer_load_dwordx4 v127, s[20:23], s60 offen offset:1024  lds
v_xor_b32 v127, 128, v124
s_add_u32 s60, s80, 2291712
buffer_load_dwordx4 v127, s[20:23], s60 offen offset:2048  lds
v_xor_b32 v127, 192, v124
s_add_u32 s60, s80, 2323456
buffer_load_dwordx4 v127, s[20:23], s60 offen offset:3072  lds
ds_read_b64_tr_b16 a[32:33], v76 offset:24576
ds_read_b64_tr_b16 a[34:35], v76 offset:25088
ds_read_b64_tr_b16 a[36:37], v76 offset:57344
ds_read_b64_tr_b16 a[38:39], v76 offset:57856
ds_read_b64_tr_b16 a[96:97], v78 offset:24576
ds_read_b64_tr_b16 a[98:99], v78 offset:25088
ds_read_b64_tr_b16 a[100:101], v78 offset:57344
ds_read_b64_tr_b16 a[102:103], v78 offset:57856
ds_read_b64_tr_b16 a[40:41], v77 offset:24576
ds_read_b64_tr_b16 a[42:43], v77 offset:25088
ds_read_b64_tr_b16 a[44:45], v77 offset:57344
ds_read_b64_tr_b16 a[46:47], v77 offset:57856
ds_read_b64_tr_b16 a[104:105], v79 offset:24576
ds_read_b64_tr_b16 a[106:107], v79 offset:25088
ds_read_b64_tr_b16 a[108:109], v79 offset:57344
ds_read_b64_tr_b16 a[110:111], v79 offset:57856
s_waitcnt vmcnt(16) lgkmcnt(0)
s_barrier
s_add_u32 m0, s81, 24576
s_add_u32 s60, s80, 3145728
buffer_load_dwordx4 v124, s[20:23], s60 offen offset:0  lds
v_xor_b32 v127, 64, v124
s_add_u32 s60, s80, 3177472
buffer_load_dwordx4 v127, s[20:23], s60 offen offset:1024  lds
s_add_u32 s60, s80, 3209216
buffer_load_dwordx4 v124, s[20:23], s60 offen offset:2048  lds
v_xor_b32 v127, 64, v124
s_add_u32 s60, s80, 3240960
buffer_load_dwordx4 v127, s[20:23], s60 offen offset:3072  lds
v_xor_b32 v127, 128, v124
s_add_u32 m0, s81, 28672
s_add_u32 s60, s80, 3276800
buffer_load_dwordx4 v127, s[20:23], s60 offen offset:0  lds
v_xor_b32 v127, 192, v124
s_add_u32 s60, s80, 3308544
buffer_load_dwordx4 v127, s[20:23], s60 offen offset:1024  lds
v_xor_b32 v127, 128, v124
s_add_u32 s60, s80, 3340288
buffer_load_dwordx4 v127, s[20:23], s60 offen offset:2048  lds
v_xor_b32 v127, 192, v124
s_add_u32 s60, s80, 3372032
buffer_load_dwordx4 v127, s[20:23], s60 offen offset:3072  lds
ds_read_b64_tr_b16 a[144:145], v76 offset:0
ds_read_b64_tr_b16 a[146:147], v76 offset:512
ds_read_b64_tr_b16 a[148:149], v76 offset:32768
ds_read_b64_tr_b16 a[150:151], v76 offset:33280
ds_read_b64_tr_b16 a[208:209], v78 offset:0
ds_read_b64_tr_b16 a[210:211], v78 offset:512
ds_read_b64_tr_b16 a[212:213], v78 offset:32768
ds_read_b64_tr_b16 a[214:215], v78 offset:33280
ds_read_b64_tr_b16 a[152:153], v77 offset:0
ds_read_b64_tr_b16 a[154:155], v77 offset:512
ds_read_b64_tr_b16 a[156:157], v77 offset:32768
ds_read_b64_tr_b16 a[158:159], v77 offset:33280
ds_read_b64_tr_b16 a[216:217], v79 offset:0
ds_read_b64_tr_b16 a[218:219], v79 offset:512
ds_read_b64_tr_b16 a[220:221], v79 offset:32768
ds_read_b64_tr_b16 a[222:223], v79 offset:33280
s_waitcnt vmcnt(16) lgkmcnt(0)
s_barrier
s_add_u32 m0, s81, 0
s_add_u32 s60, s80, 0
buffer_load_dwordx4 v124, s[12:15], s60 offen offset:0  lds
v_xor_b32 v127, 64, v124
s_add_u32 s60, s80, 31744
buffer_load_dwordx4 v127, s[12:15], s60 offen offset:1024  lds
s_add_u32 s60, s80, 63488
buffer_load_dwordx4 v124, s[12:15], s60 offen offset:2048  lds
v_xor_b32 v127, 64, v124
s_add_u32 s60, s80, 95232
buffer_load_dwordx4 v127, s[12:15], s60 offen offset:3072  lds
v_xor_b32 v127, 128, v124
s_add_u32 m0, s81, 4096
s_add_u32 s60, s80, 131072
buffer_load_dwordx4 v127, s[12:15], s60 offen offset:0  lds
v_xor_b32 v127, 192, v124
s_add_u32 s60, s80, 162816
buffer_load_dwordx4 v127, s[12:15], s60 offen offset:1024  lds
v_xor_b32 v127, 128, v124
s_add_u32 s60, s80, 194560
buffer_load_dwordx4 v127, s[12:15], s60 offen offset:2048  lds
v_xor_b32 v127, 192, v124
s_add_u32 s60, s80, 226304
buffer_load_dwordx4 v127, s[12:15], s60 offen offset:3072  lds
ds_read_b64_tr_b16 a[128:129], v76 offset:8192
ds_read_b64_tr_b16 a[130:131], v76 offset:8704
ds_read_b64_tr_b16 a[132:133], v76 offset:40960
ds_read_b64_tr_b16 a[134:135], v76 offset:41472
ds_read_b64_tr_b16 a[192:193], v78 offset:8192
ds_read_b64_tr_b16 a[194:195], v78 offset:8704
ds_read_b64_tr_b16 a[196:197], v78 offset:40960
ds_read_b64_tr_b16 a[198:199], v78 offset:41472
ds_read_b64_tr_b16 a[136:137], v77 offset:8192
ds_read_b64_tr_b16 a[138:139], v77 offset:8704
ds_read_b64_tr_b16 a[140:141], v77 offset:40960
ds_read_b64_tr_b16 a[142:143], v77 offset:41472
ds_read_b64_tr_b16 a[200:201], v79 offset:8192
ds_read_b64_tr_b16 a[202:203], v79 offset:8704
ds_read_b64_tr_b16 a[204:205], v79 offset:40960
ds_read_b64_tr_b16 a[206:207], v79 offset:41472
s_waitcnt vmcnt(16) lgkmcnt(0)
s_barrier
s_add_u32 m0, s81, 8192
s_add_u32 s60, s80, 1048576
buffer_load_dwordx4 v124, s[12:15], s60 offen offset:0  lds
v_xor_b32 v127, 64, v124
s_add_u32 s60, s80, 1080320
buffer_load_dwordx4 v127, s[12:15], s60 offen offset:1024  lds
s_add_u32 s60, s80, 1112064
buffer_load_dwordx4 v124, s[12:15], s60 offen offset:2048  lds
v_xor_b32 v127, 64, v124
s_add_u32 s60, s80, 1143808
buffer_load_dwordx4 v127, s[12:15], s60 offen offset:3072  lds
v_xor_b32 v127, 128, v124
s_add_u32 m0, s81, 12288
s_add_u32 s60, s80, 1179648
buffer_load_dwordx4 v127, s[12:15], s60 offen offset:0  lds
v_xor_b32 v127, 192, v124
s_add_u32 s60, s80, 1211392
buffer_load_dwordx4 v127, s[12:15], s60 offen offset:1024  lds
v_xor_b32 v127, 128, v124
s_add_u32 s60, s80, 1243136
buffer_load_dwordx4 v127, s[12:15], s60 offen offset:2048  lds
v_xor_b32 v127, 192, v124
s_add_u32 s60, s80, 1274880
buffer_load_dwordx4 v127, s[12:15], s60 offen offset:3072  lds
buffer_load_dword v56, off, s[40:43], 0 offset:136 sc1
ds_read_b64_tr_b16 a[176:177], v76 offset:16384
ds_read_b64_tr_b16 a[178:179], v76 offset:16896
ds_read_b64_tr_b16 a[180:181], v76 offset:49152
ds_read_b64_tr_b16 a[182:183], v76 offset:49664
ds_read_b64_tr_b16 a[240:241], v78 offset:16384
ds_read_b64_tr_b16 a[242:243], v78 offset:16896
ds_read_b64_tr_b16 a[244:245], v78 offset:49152
ds_read_b64_tr_b16 a[246:247], v78 offset:49664
ds_read_b64_tr_b16 a[184:185], v77 offset:16384
ds_read_b64_tr_b16 a[186:187], v77 offset:16896
ds_read_b64_tr_b16 a[188:189], v77 offset:49152
ds_read_b64_tr_b16 a[190:191], v77 offset:49664
ds_read_b64_tr_b16 a[248:249], v79 offset:16384
ds_read_b64_tr_b16 a[250:251], v79 offset:16896
ds_read_b64_tr_b16 a[252:253], v79 offset:49152
ds_read_b64_tr_b16 a[254:255], v79 offset:49664
s_waitcnt vmcnt(17) lgkmcnt(0)
s_barrier
s_add_u32 m0, s81, 16384
s_add_u32 s60, s80, 2097152
buffer_load_dwordx4 v124, s[12:15], s60 offen offset:0  lds
v_xor_b32 v127, 64, v124
s_add_u32 s60, s80, 2128896
buffer_load_dwordx4 v127, s[12:15], s60 offen offset:1024  lds
s_add_u32 s60, s80, 2160640
buffer_load_dwordx4 v124, s[12:15], s60 offen offset:2048  lds
v_xor_b32 v127, 64, v124
s_add_u32 s60, s80, 2192384
buffer_load_dwordx4 v127, s[12:15], s60 offen offset:3072  lds
v_xor_b32 v127, 128, v124
s_add_u32 m0, s81, 20480
s_add_u32 s60, s80, 2228224
buffer_load_dwordx4 v127, s[12:15], s60 offen offset:0  lds
v_xor_b32 v127, 192, v124
s_add_u32 s60, s80, 2259968
buffer_load_dwordx4 v127, s[12:15], s60 offen offset:1024  lds
v_xor_b32 v127, 128, v124
s_add_u32 s60, s80, 2291712
buffer_load_dwordx4 v127, s[12:15], s60 offen offset:2048  lds
v_xor_b32 v127, 192, v124
s_add_u32 s60, s80, 2323456
buffer_load_dwordx4 v127, s[12:15], s60 offen offset:3072  lds
ds_read_b64_tr_b16 a[160:161], v76 offset:24576
ds_read_b64_tr_b16 a[162:163], v76 offset:25088
ds_read_b64_tr_b16 a[164:165], v76 offset:57344
ds_read_b64_tr_b16 a[166:167], v76 offset:57856
ds_read_b64_tr_b16 a[224:225], v78 offset:24576
ds_read_b64_tr_b16 a[226:227], v78 offset:25088
ds_read_b64_tr_b16 a[228:229], v78 offset:57344
ds_read_b64_tr_b16 a[230:231], v78 offset:57856
ds_read_b64_tr_b16 a[168:169], v77 offset:24576
ds_read_b64_tr_b16 a[170:171], v77 offset:25088
ds_read_b64_tr_b16 a[172:173], v77 offset:57344
ds_read_b64_tr_b16 a[174:175], v77 offset:57856
ds_read_b64_tr_b16 a[232:233], v79 offset:24576
ds_read_b64_tr_b16 a[234:235], v79 offset:25088
ds_read_b64_tr_b16 a[236:237], v79 offset:57344
ds_read_b64_tr_b16 a[238:239], v79 offset:57856
s_waitcnt vmcnt(17) lgkmcnt(0)
s_barrier
s_add_u32 m0, s81, 24576
s_add_u32 s60, s80, 3145728
buffer_load_dwordx4 v124, s[12:15], s60 offen offset:0  lds
v_xor_b32 v127, 64, v124
s_add_u32 s60, s80, 3177472
buffer_load_dwordx4 v127, s[12:15], s60 offen offset:1024  lds
s_add_u32 s60, s80, 3209216
buffer_load_dwordx4 v124, s[12:15], s60 offen offset:2048  lds
v_xor_b32 v127, 64, v124
s_add_u32 s60, s80, 3240960
buffer_load_dwordx4 v127, s[12:15], s60 offen offset:3072  lds
v_xor_b32 v127, 128, v124
s_add_u32 m0, s81, 28672
s_add_u32 s60, s80, 3276800
buffer_load_dwordx4 v127, s[12:15], s60 offen offset:0  lds
v_xor_b32 v127, 192, v124
s_add_u32 s60, s80, 3308544
buffer_load_dwordx4 v127, s[12:15], s60 offen offset:1024  lds
v_xor_b32 v127, 128, v124
s_add_u32 s60, s80, 3340288
buffer_load_dwordx4 v127, s[12:15], s60 offen offset:2048  lds
v_xor_b32 v127, 192, v124
s_add_u32 s60, s80, 3372032
buffer_load_dwordx4 v127, s[12:15], s60 offen offset:3072  lds
ds_read_b64_tr_b16 v[116:117], v76 offset:0
ds_read_b64_tr_b16 v[118:119], v76 offset:512
ds_read_b64_tr_b16 v[120:121], v76 offset:32768
ds_read_b64_tr_b16 v[122:123], v76 offset:33280
ds_read_b64_tr_b16 v[168:169], v78 offset:0
ds_read_b64_tr_b16 v[170:171], v78 offset:512
ds_read_b64_tr_b16 v[172:173], v78 offset:32768
ds_read_b64_tr_b16 v[174:175], v78 offset:33280
ds_read_b64_tr_b16 v[128:129], v77 offset:0
ds_read_b64_tr_b16 v[130:131], v77 offset:512
ds_read_b64_tr_b16 v[132:133], v77 offset:32768
ds_read_b64_tr_b16 v[134:135], v77 offset:33280
ds_read_b64_tr_b16 v[176:177], v79 offset:0
ds_read_b64_tr_b16 v[178:179], v79 offset:512
ds_read_b64_tr_b16 v[180:181], v79 offset:32768
ds_read_b64_tr_b16 v[182:183], v79 offset:33280
s_waitcnt vmcnt(16) lgkmcnt(0)
s_barrier
s_add_u32 m0, s81, 0
s_add_u32 s60, s82, 32768
buffer_load_dwordx4 v126, s[24:27], s60 offen offset:0  lds
s_add_u32 s60, s82, 35840
buffer_load_dwordx4 v126, s[24:27], s60 offen offset:1024  lds
s_add_u32 s60, s82, 38912
buffer_load_dwordx4 v126, s[24:27], s60 offen offset:2048  lds
s_add_u32 s60, s82, 41984
buffer_load_dwordx4 v126, s[24:27], s60 offen offset:3072  lds
s_add_u32 m0, s81, 4096
s_add_u32 s60, s82, 49152
buffer_load_dwordx4 v125, s[24:27], s60 offen offset:0  lds
s_add_u32 s60, s82, 52224
buffer_load_dwordx4 v125, s[24:27], s60 offen offset:1024  lds
s_add_u32 s60, s82, 55296
buffer_load_dwordx4 v125, s[24:27], s60 offen offset:2048  lds
s_add_u32 s60, s82, 58368
buffer_load_dwordx4 v125, s[24:27], s60 offen offset:3072  lds
L_gw_20:
v_readfirstlane_b32 s55, v56
s_nop 0
s_cmp_lg_u32 s55, 0
s_cbranch_scc1 L_gk_21
s_add_u32 s54, s54, 1
s_cmp_gt_u32 s54, 400000
s_cbranch_scc1 L_end
buffer_load_dword v56, off, s[40:43], 0 offset:136 sc1
s_waitcnt vmcnt(0)
s_branch L_gw_20
L_gk_21:
s_lshr_b32 s53, s55, 16
ds_read_b64_tr_b16 v[84:85], v76 offset:8192
ds_read_b64_tr_b16 v[86:87], v76 offset:8704
ds_read_b64_tr_b16 v[88:89], v76 offset:40960
ds_read_b64_tr_b16 v[90:91], v76 offset:41472
ds_read_b64_tr_b16 v[92:93], v78 offset:8192
ds_read_b64_tr_b16 v[94:95], v78 offset:8704
ds_read_b64_tr_b16 v[96:97], v78 offset:40960
ds_read_b64_tr_b16 v[98:99], v78 offset:41472
ds_read_b64_tr_b16 v[100:101], v77 offset:8192
ds_read_b64_tr_b16 v[102:103], v77 offset:8704
ds_read_b64_tr_b16 v[104:105], v77 offset:40960
ds_read_b64_tr_b16 v[106:107], v77 offset:41472
ds_read_b64_tr_b16 v[108:109], v79 offset:8192
ds_read_b64_tr_b16 v[110:111], v79 offset:8704
ds_read_b64_tr_b16 v[112:113], v79 offset:40960
ds_read_b64_tr_b16 v[114:115], v79 offset:41472
s_waitcnt vmcnt(16) lgkmcnt(0)
s_barrier
s_add_u32 m0, s81, 8192
s_add_u32 s60, s82, 65536
buffer_load_dwordx4 v126, s[24:27], s60 offen offset:0  lds
s_add_u32 s60, s82, 68608
buffer_load_dwordx4 v126, s[24:27], s60 offen offset:1024  lds
s_add_u32 s60, s82, 71680
buffer_load_dwordx4 v126, s[24:27], s60 offen offset:2048  lds
s_add_u32 s60, s82, 74752
buffer_load_dwordx4 v126, s[24:27], s60 offen offset:3072  lds
s_add_u32 m0, s81, 12288
s_add_u32 s60, s82, 81920
buffer_load_dwordx4 v125, s[24:27], s60 offen offset:0  lds
s_add_u32 s60, s82, 84992
buffer_load_dwordx4 v125, s[24:27], s60 offen offset:1024  lds
s_add_u32 s60, s82, 88064
buffer_load_dwordx4 v125, s[24:27], s60 offen offset:2048  lds
s_add_u32 s60, s82, 91136
buffer_load_dwordx4 v125, s[24:27], s60 offen offset:3072  lds
ds_read_b64_tr_b16 v[152:153], v76 offset:16384
ds_read_b64_tr_b16 v[154:155], v76 offset:16896
ds_read_b64_tr_b16 v[156:157], v76 offset:49152
ds_read_b64_tr_b16 v[158:159], v76 offset:49664
ds_read_b64_tr_b16 v[200:201], v78 offset:16384
ds_read_b64_tr_b16 v[202:203], v78 offset:16896
ds_read_b64_tr_b16 v[204:205], v78 offset:49152
ds_read_b64_tr_b16 v[206:207], v78 offset:49664
ds_read_b64_tr_b16 v[160:161], v77 offset:16384
ds_read_b64_tr_b16 v[162:163], v77 offset:16896
ds_read_b64_tr_b16 v[164:165], v77 offset:49152
ds_read_b64_tr_b16 v[166:167], v77 offset:49664
ds_read_b64_tr_b16 v[208:209], v79 offset:16384
ds_read_b64_tr_b16 v[210:211], v79 offset:16896
ds_read_b64_tr_b16 v[212:213], v79 offset:49152
ds_read_b64_tr_b16 v[214:215], v79 offset:49664
s_waitcnt vmcnt(16) lgkmcnt(0)
s_barrier
s_add_u32 m0, s81, 16384
s_add_u32 s60, s82, 98304
buffer_load_dwordx4 v126, s[24:27], s60 offen offset:0  lds
s_add_u32 s60, s82, 101376
buffer_load_dwordx4 v126, s[24:27], s60 offen offset:1024  lds
s_add_u32 s60, s82, 104448
buffer_load_dwordx4 v126, s[24:27], s60 offen offset:2048  lds
s_add_u32 s60, s82, 107520
buffer_load_dwordx4 v126, s[24:27], s60 offen offset:3072  lds
s_add_u32 m0, s81, 20480
s_add_u32 s60, s82, 114688
buffer_load_dwordx4 v125, s[24:27], s60 offen offset:0  lds
s_add_u32 s60, s82, 117760
buffer_load_dwordx4 v125, s[24:27], s60 offen offset:1024  lds
s_add_u32 s60, s82, 120832
buffer_load_dwordx4 v125, s[24:27], s60 offen offset:2048  lds
s_add_u32 s60, s82, 123904
buffer_load_dwordx4 v125, s[24:27], s60 offen offset:3072  lds
ds_read_b64_tr_b16 v[136:137], v76 offset:24576
ds_read_b64_tr_b16 v[138:139], v76 offset:25088
ds_read_b64_tr_b16 v[140:141], v76 offset:57344
ds_read_b64_tr_b16 v[142:143], v76 offset:57856
ds_read_b64_tr_b16 v[184:185], v78 offset:24576
ds_read_b64_tr_b16 v[186:187], v78 offset:25088
ds_read_b64_tr_b16 v[188:189], v78 offset:57344
ds_read_b64_tr_b16 v[190:191], v78 offset:57856
ds_read_b64_tr_b16 v[144:145], v77 offset:24576
ds_read_b64_tr_b16 v[146:147], v77 offset:25088
ds_read_b64_tr_b16 v[148:149], v77 offset:57344
ds_read_b64_tr_b16 v[150:151], v77 offset:57856
ds_read_b64_tr_b16 v[192:193], v79 offset:24576
ds_read_b64_tr_b16 v[194:195], v79 offset:25088
ds_read_b64_tr_b16 v[196:197], v79 offset:57344
ds_read_b64_tr_b16 v[198:199], v79 offset:57856
s_waitcnt vmcnt(16) lgkmcnt(0)
s_barrier
s_add_u32 m0, s81, 24576
s_add_u32 s60, s82, 0
buffer_load_dwordx4 v126, s[24:27], s60 offen offset:0  lds
s_add_u32 s60, s82, 3072
buffer_load_dwordx4 v126, s[24:27], s60 offen offset:1024  lds
s_add_u32 s60, s82, 6144
buffer_load_dwordx4 v126, s[24:27], s60 offen offset:2048  lds
s_add_u32 s60, s82, 9216
buffer_load_dwordx4 v126, s[24:27], s60 offen offset:3072  lds
s_add_u32 m0, s81, 28672
s_add_u32 s60, s82, 16384
buffer_load_dwordx4 v125, s[24:27], s60 offen offset:0  lds
s_add_u32 s60, s82, 19456
buffer_load_dwordx4 v125, s[24:27], s60 offen offset:1024  lds
s_add_u32 s60, s82, 22528
buffer_load_dwordx4 v125, s[24:27], s60 offen offset:2048  lds
s_add_u32 s60, s82, 25600
buffer_load_dwordx4 v125, s[24:27], s60 offen offset:3072  lds
ds_read_b64_tr_b16 v[20:21], v80 offset:0
ds_read_b64_tr_b16 v[22:23], v80 offset:512
ds_read_b64_tr_b16 v[24:25], v80 offset:2048
ds_read_b64_tr_b16 v[26:27], v80 offset:2560
v_xor_b32 v81, 64, v80
ds_read_b64_tr_b16 v[28:29], v81 offset:0
ds_read_b64_tr_b16 v[30:31], v81 offset:512
ds_read_b64_tr_b16 v[32:33], v81 offset:2048
ds_read_b64_tr_b16 v[34:35], v81 offset:2560
v_xor_b32 v81, 128, v80
ds_read_b64_tr_b16 v[36:37], v81 offset:0
ds_read_b64_tr_b16 v[38:39], v81 offset:512
ds_read_b64_tr_b16 v[40:41], v81 offset:2048
ds_read_b64_tr_b16 v[42:43], v81 offset:2560
v_xor_b32 v81, 192, v80
ds_read_b64_tr_b16 v[44:45], v81 offset:0
ds_read_b64_tr_b16 v[46:47], v81 offset:512
ds_read_b64_tr_b16 v[48:49], v81 offset:2048
ds_read_b64_tr_b16 v[50:51], v81 offset:2560
s_waitcnt lgkmcnt(0)
ds_write_b128 v2, v[20:23] offset:0
ds_write_b128 v2, v[24:27] offset:1024
ds_write_b128 v2, v[28:31] offset:2048
ds_write_b128 v2, v[32:35] offset:3072
ds_write_b128 v2, v[36:39] offset:4096
ds_write_b128 v2, v[40:43] offset:5120
ds_write_b128 v2, v[44:47] offset:6144
ds_write_b128 v2, v[48:51] offset:7168
s_waitcnt vmcnt(16) lgkmcnt(0)
s_barrier
ds_read_b64_tr_b16 v[20:21], v80 offset:8192
ds_read_b64_tr_b16 v[22:23], v80 offset:8704
ds_read_b64_tr_b16 v[24:25], v80 offset:10240
ds_read_b64_tr_b16 v[26:27], v80 offset:10752
v_xor_b32 v81, 64, v80
ds_read_b64_tr_b16 v[224:225], v81 offset:8192
ds_read_b64_tr_b16 v[226:227], v81 offset:8704
ds_read_b64_tr_b16 v[228:229], v81 offset:10240
ds_read_b64_tr_b16 v[230:231], v81 offset:10752
v_xor_b32 v81, 128, v80
ds_read_b64_tr_b16 v[248:249], v81 offset:8192
ds_read_b64_tr_b16 v[250:251], v81 offset:8704
ds_read_b64_tr_b16 v[252:253], v81 offset:10240
ds_read_b64_tr_b16 v[254:255], v81 offset:10752
v_xor_b32 v81, 192, v80
ds_read_b64_tr_b16 v[28:29], v81 offset:8192
ds_read_b64_tr_b16 v[30:31], v81 offset:8704
ds_read_b64_tr_b16 v[32:33], v81 offset:10240
ds_read_b64_tr_b16 v[34:35], v81 offset:10752
s_waitcnt lgkmcnt(0)
ds_write_b128 v2, v[20:23] offset:8192
ds_write_b128 v2, v[24:27] offset:9216
ds_write_b128 v2, v[28:31] offset:10240
ds_write_b128 v2, v[32:35] offset:11264
ds_write_b128 v2, v[84:87] offset:12288
ds_write_b128 v2, v[88:91] offset:13312
ds_write_b128 v2, v[92:95] offset:14336
ds_write_b128 v2, v[96:99] offset:15360
s_waitcnt vmcnt(8) lgkmcnt(0)
s_barrier
ds_read_b64_tr_b16 v[20:21], v80 offset:16384
ds_read_b64_tr_b16 v[22:23], v80 offset:16896
ds_read_b64_tr_b16 v[24:25], v80 offset:18432
ds_read_b64_tr_b16 v[26:27], v80 offset:18944
v_xor_b32 v81, 64, v80
ds_read_b64_tr_b16 v[232:233], v81 offset:16384
ds_read_b64_tr_b16 v[234:235], v81 offset:16896
ds_read_b64_tr_b16 v[236:237], v81 offset:18432
ds_read_b64_tr_b16 v[238:239], v81 offset:18944
v_xor_b32 v81, 128, v80
ds_read_b64_tr_b16 v[28:29], v81 offset:16384
ds_read_b64_tr_b16 v[30:31], v81 offset:16896
ds_read_b64_tr_b16 v[32:33], v81 offset:18432
ds_read_b64_tr_b16 v[34:35], v81 offset:18944
v_xor_b32 v81, 192, v80
ds_read_b64_tr_b16 v[36:37], v81 offset:16384
ds_read_b64_tr_b16 v[38:39], v81 offset:16896
ds_read_b64_tr_b16 v[40:41], v81 offset:18432
ds_read_b64_tr_b16 v[42:43], v81 offset:18944
s_waitcnt lgkmcnt(0)
ds_write_b128 v2, v[20:23] offset:16384
ds_write_b128 v2, v[24:27] offset:17408
ds_write_b128 v2, v[28:31] offset:18432
ds_write_b128 v2, v[32:35] offset:19456
ds_write_b128 v2, v[36:39] offset:20480
ds_write_b128 v2, v[40:43] offset:21504
ds_write_b128 v2, v[100:103] offset:22528
ds_write_b128 v2, v[104:107] offset:23552
s_waitcnt vmcnt(0) lgkmcnt(0)
s_barrier
buffer_load_dword v56, v57, s[44:47], s66 offen offset:4 sc1
buffer_load_dword v60, v82, s[44:47], s67 offen sc1
buffer_load_dword v61, v82, s[44:47], s68 offen sc1
ds_read_b64_tr_b16 v[216:217], v80 offset:24576
ds_read_b64_tr_b16 v[218:219], v80 offset:25088
ds_read_b64_tr_b16 v[220:221], v80 offset:26624
ds_read_b64_tr_b16 v[222:223], v80 offset:27136
v_xor_b32 v81, 64, v80
ds_read_b64_tr_b16 v[240:241], v81 offset:24576
ds_read_b64_tr_b16 v[242:243], v81 offset:25088
ds_read_b64_tr_b16 v[244:245], v81 offset:26624
ds_read_b64_tr_b16 v[246:247], v81 offset:27136
v_xor_b32 v81, 128, v80
ds_read_b64_tr_b16 v[20:21], v81 offset:24576
ds_read_b64_tr_b16 v[22:23], v81 offset:25088
ds_read_b64_tr_b16 v[24:25], v81 offset:26624
ds_read_b64_tr_b16 v[26:27], v81 offset:27136
v_xor_b32 v81, 192, v80
ds_read_b64_tr_b16 v[28:29], v81 offset:24576
ds_read_b64_tr_b16 v[30:31], v81 offset:25088
ds_read_b64_tr_b16 v[32:33], v81 offset:26624
ds_read_b64_tr_b16 v[34:35], v81 offset:27136
s_waitcnt lgkmcnt(0)
ds_write_b128 v2, v[20:23] offset:24576
ds_write_b128 v2, v[24:27] offset:25600
ds_write_b128 v2, v[28:31] offset:26624
ds_write_b128 v2, v[32:35] offset:27648
ds_write_b128 v2, v[108:111] offset:28672
ds_write_b128 v2, v[112:115] offset:29696
ds_write_b128 v2, v[116:119] offset:30720
ds_write_b128 v2, v[120:123] offset:31744
s_waitcnt lgkmcnt(0)
s_branch L_c_wd
L_c_w2:
s_waitcnt vmcnt(16) lgkmcnt(0)
s_barrier
s_add_u32 m0, s81, 24576
s_add_u32 s60, s80, 3145728
buffer_load_dwordx4 v124, s[16:19], s60 offen offset:0  lds
v_xor_b32 v127, 64, v124
s_add_u32 s60, s80, 3177472
buffer_load_dwordx4 v127, s[16:19], s60 offen offset:1024  lds
s_add_u32 s60, s80, 3209216
buffer_load_dwordx4 v124, s[16:19], s60 offen offset:2048  lds
v_xor_b32 v127, 64, v124
s_add_u32 s60, s80, 3240960
buffer_load_dwordx4 v127, s[16:19], s60 offen offset:3072  lds
v_xor_b32 v127, 128, v124
s_add_u32 m0, s81, 28672
s_add_u32 s60, s80, 3276800
buffer_load_dwordx4 v127, s[16:19], s60 offen offset:0  lds
v_xor_b32 v127, 192, v124
s_add_u32 s60, s80, 3308544
buffer_load_dwordx4 v127, s[16:19], s60 offen offset:1024  lds
v_xor_b32 v127, 128, v124
s_add_u32 s60, s80, 3340288
buffer_load_dwordx4 v127, s[16:19], s60 offen offset:2048  lds
v_xor_b32 v127, 192, v124
s_add_u32 s60, s80, 3372032
buffer_load_dwordx4 v127, s[16:19], s60 offen offset:3072  lds
s_cmp_lg_u32 s52, 0
s_cbranch_scc1 L_cc_done_22
v_mov_b32 v53, 162816
ds_read_b32 v52, v53
s_mov_b32 s52, 1
s_lshl_b32 s56, s49, 8
s_or_b32 s56, s56, s50
s_waitcnt lgkmcnt(0)
v_readfirstlane_b32 s55, v52
s_nop 0
s_cmp_eq_u32 s55, s56
s_cbranch_scc1 L_cc_done_22
s_lshr_b32 s49, s55, 8
s_and_b32 s50, s55, 31
s_waitcnt vmcnt(0)
s_barrier
s_branch L_dispatch
L_cc_done_22:
ds_read_b64_tr_b16 a[32:33], v76 offset:0
ds_read_b64_tr_b16 a[34:35], v76 offset:512
ds_read_b64_tr_b16 a[36:37], v76 offset:32768
ds_read_b64_tr_b16 a[38:39], v76 offset:33280
ds_read_b64_tr_b16 a[96:97], v78 offset:0
ds_read_b64_tr_b16 a[98:99], v78 offset:512
ds_read_b64_tr_b16 a[100:101], v78 offset:32768
ds_read_b64_tr_b16 a[102:103], v78 offset:33280
ds_read_b64_tr_b16 a[40:41], v77 offset:0
ds_read_b64_tr_b16 a[42:43], v77 offset:512
ds_read_b64_tr_b16 a[44:45], v77 offset:32768
ds_read_b64_tr_b16 a[46:47], v77 offset:33280
ds_read_b64_tr_b16 a[104:105], v79 offset:0
ds_read_b64_tr_b16 a[106:107], v79 offset:512
ds_read_b64_tr_b16 a[108:109], v79 offset:32768
ds_read_b64_tr_b16 a[110:111], v79 offset:33280
s_waitcnt vmcnt(16) lgkmcnt(0)
s_barrier
s_add_u32 m0, s81, 0
s_add_u32 s60, s80, 0
buffer_load_dwordx4 v124, s[20:23], s60 offen offset:0  lds
v_xor_b32 v127, 64, v124
s_add_u32 s60, s80, 31744
buffer_load_dwordx4 v127, s[20:23], s60 offen offset:1024  lds
s_add_u32 s60, s80, 63488
buffer_load_dwordx4 v124, s[20:23], s60 offen offset:2048  lds
v_xor_b32 v127, 64, v124
s_add_u32 s60, s80, 95232
buffer_load_dwordx4 v127, s[20:23], s60 offen offset:3072  lds
v_xor_b32 v127, 128, v124
s_add_u32 m0, s81, 4096
s_add_u32 s60, s80, 131072
buffer_load_dwordx4 v127, s[20:23], s60 offen offset:0  lds
v_xor_b32 v127, 192, v124
s_add_u32 s60, s80, 162816
buffer_load_dwordx4 v127, s[20:23], s60 offen offset:1024  lds
v_xor_b32 v127, 128, v124
s_add_u32 s60, s80, 194560
buffer_load_dwordx4 v127, s[20:23], s60 offen offset:2048  lds
v_xor_b32 v127, 192, v124
s_add_u32 s60, s80, 226304
buffer_load_dwordx4 v127, s[20:23], s60 offen offset:3072  lds
ds_read_b64_tr_b16 a[48:49], v76 offset:8192
ds_read_b64_tr_b16 a[50:51], v76 offset:8704
ds_read_b64_tr_b16 a[52:53], v76 offset:40960
ds_read_b64_tr_b16 a[54:55], v76 offset:41472
ds_read_b64_tr_b16 a[112:113], v78 offset:8192
ds_read_b64_tr_b16 a[114:115], v78 offset:8704
ds_read_b64_tr_b16 a[116:117], v78 offset:40960
ds_read_b64_tr_b16 a[118:119], v78 offset:41472
ds_read_b64_tr_b16 a[56:57], v77 offset:8192
ds_read_b64_tr_b16 a[58:59], v77 offset:8704
ds_read_b64_tr_b16 a[60:61], v77 offset:40960
ds_read_b64_tr_b16 a[62:63], v77 offset:41472
ds_read_b64_tr_b16 a[120:121], v79 offset:8192
ds_read_b64_tr_b16 a[122:123], v79 offset:8704
ds_read_b64_tr_b16 a[124:125], v79 offset:40960
ds_read_b64_tr_b16 a[126:127], v79 offset:41472
s_waitcnt vmcnt(16) lgkmcnt(0)
s_barrier
s_add_u32 m0, s81, 8192
s_add_u32 s60, s80, 1048576
buffer_load_dwordx4 v124, s[20:23], s60 offen offset:0  lds
v_xor_b32 v127, 64, v124
s_add_u32 s60, s80, 1080320
buffer_load_dwordx4 v127, s[20:23], s60 offen offset:1024  lds
s_add_u32 s60, s80, 1112064
buffer_load_dwordx4 v124, s[20:23], s60 offen offset:2048  lds
v_xor_b32 v127, 64, v124
s_add_u32 s60, s80, 1143808
buffer_load_dwordx4 v127, s[20:23], s60 offen offset:3072  lds
v_xor_b32 v127, 128, v124
s_add_u32 m0, s81, 12288
s_add_u32 s60, s80, 1179648
buffer_load_dwordx4 v127, s[20:23], s60 offen offset:0  lds
v_xor_b32 v127, 192, v124
s_add_u32 s60, s80, 1211392
buffer_load_dwordx4 v127, s[20:23], s60 offen offset:1024  lds
v_xor_b32 v127, 128, v124
s_add_u32 s60, s80, 1243136
buffer_load_dwordx4 v127, s[20:23], s60 offen offset:2048  lds
v_xor_b32 v127, 192, v124
s_add_u32 s60, s80, 1274880
buffer_load_dwordx4 v127, s[20:23], s60 offen offset:3072  lds
ds_read_b64_tr_b16 a[0:1], v76 offset:16384
ds_read_b64_tr_b16 a[2:3], v76 offset:16896
ds_read_b64_tr_b16 a[4:5], v76 offset:49152
ds_read_b64_tr_b16 a[6:7], v76 offset:49664
ds_read_b64_tr_b16 a[64:65], v78 offset:16384
ds_read_b64_tr_b16 a[66:67], v78 offset:16896
ds_read_b64_tr_b16 a[68:69], v78 offset:49152
ds_read_b64_tr_b16 a[70:71], v78 offset:49664
ds_read_b64_tr_b16 a[8:9], v77 offset:16384
ds_read_b64_tr_b16 a[10:11], v77 offset:16896
ds_read_b64_tr_b16 a[12:13], v77 offset:49152
ds_read_b64_tr_b16 a[14:15], v77 offset:49664
ds_read_b64_tr_b16 a[72:73], v79 offset:16384
ds_read_b64_tr_b16 a[74:75], v79 offset:16896
ds_read_b64_tr_b16 a[76:77], v79 offset:49152
ds_read_b64_tr_b16 a[78:79], v79 offset:49664
s_waitcnt vmcnt(16) lgkmcnt(0)
s_barrier
s_add_u32 m0, s81, 16384
s_add_u32 s60, s80, 2097152
buffer_load_dwordx4 v124, s[20:23], s60 offen offset:0  lds
v_xor_b32 v127, 64, v124
s_add_u32 s60, s80, 2128896
buffer_load_dwordx4 v127, s[20:23], s60 offen offset:1024  lds
s_add_u32 s60, s80, 2160640
buffer_load_dwordx4 v124, s[20:23], s60 offen offset:2048  lds
v_xor_b32 v127, 64, v124
s_add_u32 s60, s80, 2192384
buffer_load_dwordx4 v127, s[20:23], s60 offen offset:3072  lds
v_xor_b32 v127, 128, v124
s_add_u32 m0, s81, 20480
s_add_u32 s60, s80, 2228224
buffer_load_dwordx4 v127, s[20:23], s60 offen offset:0  lds
v_xor_b32 v127, 192, v124
s_add_u32 s60, s80, 2259968
buffer_load_dwordx4 v127, s[20:23], s60 offen offset:1024  lds
v_xor_b32 v127, 128, v124
s_add_u32 s60, s80, 2291712
buffer_load_dwordx4 v127, s[20:23], s60 offen offset:2048  lds
v_xor_b32 v127, 192, v124
s_add_u32 s60, s80, 2323456
buffer_load_dwordx4 v127, s[20:23], s60 offen offset:3072  lds
ds_read_b64_tr_b16 a[16:17], v76 offset:24576
ds_read_b64_tr_b16 a[18:19], v76 offset:25088
ds_read_b64_tr_b16 a[20:21], v76 offset:57344
ds_read_b64_tr_b16 a[22:23], v76 offset:57856
ds_read_b64_tr_b16 a[80:81], v78 offset:24576
ds_read_b64_tr_b16 a[82:83], v78 offset:25088
ds_read_b64_tr_b16 a[84:85], v78 offset:57344
ds_read_b64_tr_b16 a[86:87], v78 offset:57856
ds_read_b64_tr_b16 a[24:25], v77 offset:24576
ds_read_b64_tr_b16 a[26:27], v77 offset:25088
ds_read_b64_tr_b16 a[28:29], v77 offset:57344
ds_read_b64_tr_b16 a[30:31], v77 offset:57856
ds_read_b64_tr_b16 a[88:89], v79 offset:24576
ds_read_b64_tr_b16 a[90:91], v79 offset:25088
ds_read_b64_tr_b16 a[92:93], v79 offset:57344
ds_read_b64_tr_b16 a[94:95], v79 offset:57856
s_waitcnt vmcnt(16) lgkmcnt(0)
s_barrier
s_add_u32 m0, s81, 24576
s_add_u32 s60, s80, 3145728
buffer_load_dwordx4 v124, s[20:23], s60 offen offset:0  lds
v_xor_b32 v127, 64, v124
s_add_u32 s60, s80, 3177472
buffer_load_dwordx4 v127, s[20:23], s60 offen offset:1024  lds
s_add_u32 s60, s80, 3209216
buffer_load_dwordx4 v124, s[20:23], s60 offen offset:2048  lds
v_xor_b32 v127, 64, v124
s_add_u32 s60, s80, 3240960
buffer_load_dwordx4 v127, s[20:23], s60 offen offset:3072  lds
v_xor_b32 v127, 128, v124
s_add_u32 m0, s81, 28672
s_add_u32 s60, s80, 3276800
buffer_load_dwordx4 v127, s[20:23], s60 offen offset:0  lds
v_xor_b32 v127, 192, v124
s_add_u32 s60, s80, 3308544
buffer_load_dwordx4 v127, s[20:23], s60 offen offset:1024  lds
v_xor_b32 v127, 128, v124
s_add_u32 s60, s80, 3340288
buffer_load_dwordx4 v127, s[20:23], s60 offen offset:2048  lds
v_xor_b32 v127, 192, v124
s_add_u32 s60, s80, 3372032
buffer_load_dwordx4 v127, s[20:23], s60 offen offset:3072  lds
ds_read_b64_tr_b16 a[160:161], v76 offset:0
ds_read_b64_tr_b16 a[162:163], v76 offset:512
ds_read_b64_tr_b16 a[164:165], v76 offset:32768
ds_read_b64_tr_b16 a[166:167], v76 offset:33280
ds_read_b64_tr_b16 a[224:225], v78 offset:0
ds_read_b64_tr_b16 a[226:227], v78 offset:512
ds_read_b64_tr_b16 a[228:229], v78 offset:32768
ds_read_b64_tr_b16 a[230:231], v78 offset:33280
ds_read_b64_tr_b16 a[168:169], v77 offset:0
ds_read_b64_tr_b16 a[170:171], v77 offset:512
ds_read_b64_tr_b16 a[172:173], v77 offset:32768
ds_read_b64_tr_b16 a[174:175], v77 offset:33280
ds_read_b64_tr_b16 a[232:233], v79 offset:0
ds_read_b64_tr_b16 a[234:235], v79 offset:512
ds_read_b64_tr_b16 a[236:237], v79 offset:32768
ds_read_b64_tr_b16 a[238:239], v79 offset:33280
s_waitcnt vmcnt(16) lgkmcnt(0)
s_barrier
s_add_u32 m0, s81, 0
s_add_u32 s60, s80, 0
buffer_load_dwordx4 v124, s[12:15], s60 offen offset:0  lds
v_xor_b32 v127, 64, v124
s_add_u32 s60, s80, 31744
buffer_load_dwordx4 v127, s[12:15], s60 offen offset:1024  lds
s_add_u32 s60, s80, 63488
buffer_load_dwordx4 v124, s[12:15], s60 offen offset:2048  lds
v_xor_b32 v127, 64, v124
s_add_u32 s60, s80, 95232
buffer_load_dwordx4 v127, s[12:15], s60 offen offset:3072  lds
v_xor_b32 v127, 128, v124
s_add_u32 m0, s81, 4096
s_add_u32 s60, s80, 131072
buffer_load_dwordx4 v127, s[12:15], s60 offen offset:0  lds
v_xor_b32 v127, 192, v124
s_add_u32 s60, s80, 162816
buffer_load_dwordx4 v127, s[12:15], s60 offen offset:1024  lds
v_xor_b32 v127, 128, v124
s_add_u32 s60, s80, 194560
buffer_load_dwordx4 v127, s[12:15], s60 offen offset:2048  lds
v_xor_b32 v127, 192, v124
s_add_u32 s60, s80, 226304
buffer_load_dwordx4 v127, s[12:15], s60 offen offset:3072  lds
ds_read_b64_tr_b16 a[176:177], v76 offset:8192
ds_read_b64_tr_b16 a[178:179], v76 offset:8704
ds_read_b64_tr_b16 a[180:181], v76 offset:40960
ds_read_b64_tr_b16 a[182:183], v76 offset:41472
ds_read_b64_tr_b16 a[240:241], v78 offset:8192
ds_read_b64_tr_b16 a[242:243], v78 offset:8704
ds_read_b64_tr_b16 a[244:245], v78 offset:40960
ds_read_b64_tr_b16 a[246:247], v78 offset:41472
ds_read_b64_tr_b16 a[184:185], v77 offset:8192
ds_read_b64_tr_b16 a[186:187], v77 offset:8704
ds_read_b64_tr_b16 a[188:189], v77 offset:40960
ds_read_b64_tr_b16 a[190:191], v77 offset:41472
ds_read_b64_tr_b16 a[248:249], v79 offset:8192
ds_read_b64_tr_b16 a[250:251], v79 offset:8704
ds_read_b64_tr_b16 a[252:253], v79 offset:40960
ds_read_b64_tr_b16 a[254:255], v79 offset:41472
s_waitcnt vmcnt(16) lgkmcnt(0)
s_barrier
s_add_u32 m0, s81, 8192
s_add_u32 s60, s80, 1048576
buffer_load_dwordx4 v124, s[12:15], s60 offen offset:0  lds
v_xor_b32 v127, 64, v124
s_add_u32 s60, s80, 1080320
buffer_load_dwordx4 v127, s[12:15], s60 offen offset:1024  lds
s_add_u32 s60, s80, 1112064
buffer_load_dwordx4 v124, s[12:15], s60 offen offset:2048  lds
v_xor_b32 v127, 64, v124
s_add_u32 s60, s80, 1143808
buffer_load_dwordx4 v127, s[12:15], s60 offen offset:3072  lds
v_xor_b32 v127, 128, v124
s_add_u32 m0, s81, 12288
s_add_u32 s60, s80, 1179648
buffer_load_dwordx4 v127, s[12:15], s60 offen offset:0  lds
v_xor_b32 v127, 192, v124
s_add_u32 s60, s80, 1211392
buffer_load_dwordx4 v127, s[12:15], s60 offen offset:1024  lds
v_xor_b32 v127, 128, v124
s_add_u32 s60, s80, 1243136
buffer_load_dwordx4 v127, s[12:15], s60 offen offset:2048  lds
v_xor_b32 v127, 192, v124
s_add_u32 s60, s80, 1274880
buffer_load_dwordx4 v127, s[12:15], s60 offen offset:3072  lds
buffer_load_dword v56, off, s[40:43], 0 offset:136 sc1
ds_read_b64_tr_b16 a[128:129], v76 offset:16384
ds_read_b64_tr_b16 a[130:131], v76 offset:16896
ds_read_b64_tr_b16 a[132:133], v76 offset:49152
ds_read_b64_tr_b16 a[134:135], v76 offset:49664
ds_read_b64_tr_b16 a[192:193], v78 offset:16384
ds_read_b64_tr_b16 a[194:195], v78 offset:16896
ds_read_b64_tr_b16 a[196:197], v78 offset:49152
ds_read_b64_tr_b16 a[198:199], v78 offset:49664
ds_read_b64_tr_b16 a[136:137], v77 offset:16384
ds_read_b64_tr_b16 a[138:139], v77 offset:16896
ds_read_b64_tr_b16 a[140:141], v77 offset:49152
ds_read_b64_tr_b16 a[142:143], v77 offset:49664
ds_read_b64_tr_b16 a[200:201], v79 offset:16384
ds_read_b64_tr_b16 a[202:203], v79 offset:16896
ds_read_b64_tr_b16 a[204:205], v79 offset:49152
ds_read_b64_tr_b16 a[206:207], v79 offset:49664
s_waitcnt vmcnt(17) lgkmcnt(0)
s_barrier
s_add_u32 m0, s81, 16384
s_add_u32 s60, s80, 2097152
buffer_load_dwordx4 v124, s[12:15], s60 offen offset:0  lds
v_xor_b32 v127, 64, v124
s_add_u32 s60, s80, 2128896
buffer_load_dwordx4 v127, s[12:15], s60 offen offset:1024  lds
s_add_u32 s60, s80, 2160640
buffer_load_dwordx4 v124, s[12:15], s60 offen offset:2048  lds
v_xor_b32 v127, 64, v124
s_add_u32 s60, s80, 2192384
buffer_load_dwordx4 v127, s[12:15], s60 offen offset:3072  lds
v_xor_b32 v127, 128, v124
s_add_u32 m0, s81, 20480
s_add_u32 s60, s80, 2228224
buffer_load_dwordx4 v127, s[12:15], s60 offen offset:0  lds
v_xor_b32 v127, 192, v124
s_add_u32 s60, s80, 2259968
buffer_load_dwordx4 v127, s[12:15], s60 offen offset:1024  lds
v_xor_b32 v127, 128, v124
s_add_u32 s60, s80, 2291712
buffer_load_dwordx4 v127, s[12:15], s60 offen offset:2048  lds
v_xor_b32 v127, 192, v124
s_add_u32 s60, s80, 2323456
buffer_load_dwordx4 v127, s[12:15], s60 offen offset:3072  lds
ds_read_b64_tr_b16 a[144:145], v76 offset:24576
ds_read_b64_tr_b16 a[146:147], v76 offset:25088
ds_read_b64_tr_b16 a[148:149], v76 offset:57344
ds_read_b64_tr_b16 a[150:151], v76 offset:57856
ds_read_b64_tr_b16 a[208:209], v78 offset:24576
ds_read_b64_tr_b16 a[210:211], v78 offset:25088
ds_read_b64_tr_b16 a[212:213], v78 offset:57344
ds_read_b64_tr_b16 a[214:215], v78 offset:57856
ds_read_b64_tr_b16 a[152:153], v77 offset:24576
ds_read_b64_tr_b16 a[154:155], v77 offset:25088
ds_read_b64_tr_b16 a[156:157], v77 offset:57344
ds_read_b64_tr_b16 a[158:159], v77 offset:57856
ds_read_b64_tr_b16 a[216:217], v79 offset:24576
ds_read_b64_tr_b16 a[218:219], v79 offset:25088
ds_read_b64_tr_b16 a[220:221], v79 offset:57344
ds_read_b64_tr_b16 a[222:223], v79 offset:57856
s_waitcnt vmcnt(17) lgkmcnt(0)
s_barrier
s_add_u32 m0, s81, 24576
s_add_u32 s60, s80, 3145728
buffer_load_dwordx4 v124, s[12:15], s60 offen offset:0  lds
v_xor_b32 v127, 64, v124
s_add_u32 s60, s80, 3177472
buffer_load_dwordx4 v127, s[12:15], s60 offen offset:1024  lds
s_add_u32 s60, s80, 3209216
buffer_load_dwordx4 v124, s[12:15], s60 offen offset:2048  lds
v_xor_b32 v127, 64, v124
s_add_u32 s60, s80, 3240960
buffer_load_dwordx4 v127, s[12:15], s60 offen offset:3072  lds
v_xor_b32 v127, 128, v124
s_add_u32 m0, s81, 28672
s_add_u32 s60, s80, 3276800
buffer_load_dwordx4 v127, s[12:15], s60 offen offset:0  lds
v_xor_b32 v127, 192, v124
s_add_u32 s60, s80, 3308544
buffer_load_dwordx4 v127, s[12:15], s60 offen offset:1024  lds
v_xor_b32 v127, 128, v124
s_add_u32 s60, s80, 3340288
buffer_load_dwordx4 v127, s[12:15], s60 offen offset:2048  lds
v_xor_b32 v127, 192, v124
s_add_u32 s60, s80, 3372032
buffer_load_dwordx4 v127, s[12:15], s60 offen offset:3072  lds
ds_read_b64_tr_b16 v[136:137], v76 offset:0
ds_read_b64_tr_b16 v[138:139], v76 offset:512
ds_read_b64_tr_b16 v[140:141], v76 offset:32768
ds_read_b64_tr_b16 v[142:143], v76 offset:33280
ds_read_b64_tr_b16 v[184:185], v78 offset:0
ds_read_b64_tr_b16 v[186:187], v78 offset:512
ds_read_b64_tr_b16 v[188:189], v78 offset:32768
ds_read_b64_tr_b16 v[190:191], v78 offset:33280
ds_read_b64_tr_b16 v[144:145], v77 offset:0
ds_read_b64_tr_b16 v[146:147], v77 offset:512
ds_read_b64_tr_b16 v[148:149], v77 offset:32768
ds_read_b64_tr_b16 v[150:151], v77 offset:33280
ds_read_b64_tr_b16 v[192:193], v79 offset:0
ds_read_b64_tr_b16 v[194:195], v79 offset:512
ds_read_b64_tr_b16 v[196:197], v79 offset:32768
ds_read_b64_tr_b16 v[198:199], v79 offset:33280
s_waitcnt vmcnt(16) lgkmcnt(0)
s_barrier
s_add_u32 m0, s81, 0
s_add_u32 s60, s82, 65536
buffer_load_dwordx4 v126, s[24:27], s60 offen offset:0  lds
s_add_u32 s60, s82, 68608
buffer_load_dwordx4 v126, s[24:27], s60 offen offset:1024  lds
s_add_u32 s60, s82, 71680
buffer_load_dwordx4 v126, s[24:27], s60 offen offset:2048  lds
s_add_u32 s60, s82, 74752
buffer_load_dwordx4 v126, s[24:27], s60 offen offset:3072  lds
s_add_u32 m0, s81, 4096
s_add_u32 s60, s82, 81920
buffer_load_dwordx4 v125, s[24:27], s60 offen offset:0  lds
s_add_u32 s60, s82, 84992
buffer_load_dwordx4 v125, s[24:27], s60 offen offset:1024  lds
s_add_u32 s60, s82, 88064
buffer_load_dwordx4 v125, s[24:27], s60 offen offset:2048  lds
s_add_u32 s60, s82, 91136
buffer_load_dwordx4 v125, s[24:27], s60 offen offset:3072  lds
L_gw_23:
v_readfirstlane_b32 s55, v56
s_nop 0
s_cmp_lg_u32 s55, 0
s_cbranch_scc1 L_gk_24
s_add_u32 s54, s54, 1
s_cmp_gt_u32 s54, 400000
s_cbranch_scc1 L_end
buffer_load_dword v56, off, s[40:43], 0 offset:136 sc1
s_waitcnt vmcnt(0)
s_branch L_gw_23
L_gk_24:
s_lshr_b32 s53, s55, 16
ds_read_b64_tr_b16 v[152:153], v76 offset:8192
ds_read_b64_tr_b16 v[154:155], v76 offset:8704
ds_read_b64_tr_b16 v[156:157], v76 offset:40960
ds_read_b64_tr_b16 v[158:159], v76 offset:41472
ds_read_b64_tr_b16 v[200:201], v78 offset:8192
ds_read_b64_tr_b16 v[202:203], v78 offset:8704
ds_read_b64_tr_b16 v[204:205], v78 offset:40960
ds_read_b64_tr_b16 v[206:207], v78 offset:41472
ds_read_b64_tr_b16 v[160:161], v77 offset:8192
ds_read_b64_tr_b16 v[162:163], v77 offset:8704
ds_read_b64_tr_b16 v[164:165], v77 offset:40960
ds_read_b64_tr_b16 v[166:167], v77 offset:41472
ds_read_b64_tr_b16 v[208:209], v79 offset:8192
ds_read_b64_tr_b16 v[210:211], v79 offset:8704
ds_read_b64_tr_b16 v[212:213], v79 offset:40960
ds_read_b64_tr_b16 v[214:215], v79 offset:41472
s_waitcnt vmcnt(16) lgkmcnt(0)
s_barrier
s_add_u32 m0, s81, 8192
s_add_u32 s60, s82, 98304
buffer_load_dwordx4 v126, s[24:27], s60 offen offset:0  lds
s_add_u32 s60, s82, 101376
buffer_load_dwordx4 v126, s[24:27], s60 offen offset:1024  lds
s_add_u32 s60, s82, 104448
buffer_load_dwordx4 v126, s[24:27], s60 offen offset:2048  lds
s_add_u32 s60, s82, 107520
buffer_load_dwordx4 v126, s[24:27], s60 offen offset:3072  lds
s_add_u32 m0, s81, 12288
s_add_u32 s60, s82, 114688
buffer_load_dwordx4 v125, s[24:27], s60 offen offset:0  lds
s_add_u32 s60, s82, 117760
buffer_load_dwordx4 v125, s[24:27], s60 offen offset:1024  lds
s_add_u32 s60, s82, 120832
buffer_load_dwordx4 v125, s[24:27], s60 offen offset:2048  lds
s_add_u32 s60, s82, 123904
buffer_load_dwordx4 v125, s[24:27], s60 offen offset:3072  lds
ds_read_b64_tr_b16 v[84:85], v76 offset:16384
ds_read_b64_tr_b16 v[86:87], v76 offset:16896
ds_read_b64_tr_b16 v[88:89], v76 offset:49152
ds_read_b64_tr_b16 v[90:91], v76 offset:49664
ds_read_b64_tr_b16 v[92:93], v78 offset:16384
ds_read_b64_tr_b16 v[94:95], v78 offset:16896
ds_read_b64_tr_b16 v[96:97], v78 offset:49152
ds_read_b64_tr_b16 v[98:99], v78 offset:49664
ds_read_b64_tr_b16 v[100:101], v77 offset:16384
ds_read_b64_tr_b16 v[102:103], v77 offset:16896
ds_read_b64_tr_b16 v[104:105], v77 offset:49152
ds_read_b64_tr_b16 v[106:107], v77 offset:49664
ds_read_b64_tr_b16 v[108:109], v79 offset:16384
ds_read_b64_tr_b16 v[110:111], v79 offset:16896
ds_read_b64_tr_b16 v[112:113], v79 offset:49152
ds_read_b64_tr_b16 v[114:115], v79 offset:49664
s_waitcnt vmcnt(16) lgkmcnt(0)
s_barrier
s_add_u32 m0, s81, 16384
s_add_u32 s60, s82, 0
buffer_load_dwordx4 v126, s[24:27], s60 offen offset:0  lds
s_add_u32 s60, s82, 3072
buffer_load_dwordx4 v126, s[24:27], s60 offen offset:1024  lds
s_add_u32 s60, s82, 6144
buffer_load_dwordx4 v126, s[24:27], s60 offen offset:2048  lds
s_add_u32 s60, s82, 9216
buffer_load_dwordx4 v126, s[24:27], s60 offen offset:3072  lds
s_add_u32 m0, s81, 20480
s_add_u32 s60, s82, 16384
buffer_load_dwordx4 v125, s[24:27], s60 offen offset:0  lds
s_add_u32 s60, s82, 19456
buffer_load_dwordx4 v125, s[24:27], s60 offen offset:1024  lds
s_add_u32 s60, s82, 22528
buffer_load_dwordx4 v125, s[24:27], s60 offen offset:2048  lds
s_add_u32 s60, s82, 25600
buffer_load_dwordx4 v125, s[24:27], s60 offen offset:3072  lds
ds_read_b64_tr_b16 v[116:117], v76 offset:24576
ds_read_b64_tr_b16 v[118:119], v76 offset:25088
ds_read_b64_tr_b16 v[120:121], v76 offset:57344
ds_read_b64_tr_b16 v[122:123], v76 offset:57856
ds_read_b64_tr_b16 v[168:169], v78 offset:24576
ds_read_b64_tr_b16 v[170:171], v78 offset:25088
ds_read_b64_tr_b16 v[172:173], v78 offset:57344
ds_read_b64_tr_b16 v[174:175], v78 offset:57856
ds_read_b64_tr_b16 v[128:129], v77 offset:24576
ds_read_b64_tr_b16 v[130:131], v77 offset:25088
ds_read_b64_tr_b16 v[132:133], v77 offset:57344
ds_read_b64_tr_b16 v[134:135], v77 offset:57856
ds_read_b64_tr_b16 v[176:177], v79 offset:24576
ds_read_b64_tr_b16 v[178:179], v79 offset:25088
ds_read_b64_tr_b16 v[180:181], v79 offset:57344
ds_read_b64_tr_b16 v[182:183], v79 offset:57856
s_waitcnt vmcnt(16) lgkmcnt(0)
s_barrier
s_add_u32 m0, s81, 24576
s_add_u32 s60, s82, 32768
buffer_load_dwordx4 v126, s[24:27], s60 offen offset:0  lds
s_add_u32 s60, s82, 35840
buffer_load_dwordx4 v126, s[24:27], s60 offen offset:1024  lds
s_add_u32 s60, s82, 38912
buffer_load_dwordx4 v126, s[24:27], s60 offen offset:2048  lds
s_add_u32 s60, s82, 41984
buffer_load_dwordx4 v126, s[24:27], s60 offen offset:3072  lds
s_add_u32 m0, s81, 28672
s_add_u32 s60, s82, 49152
buffer_load_dwordx4 v125, s[24:27], s60 offen offset:0  lds
s_add_u32 s60, s82, 52224
buffer_load_dwordx4 v125, s[24:27], s60 offen offset:1024  lds
s_add_u32 s60, s82, 55296
buffer_load_dwordx4 v125, s[24:27], s60 offen offset:2048  lds
s_add_u32 s60, s82, 58368
buffer_load_dwordx4 v125, s[24:27], s60 offen offset:3072  lds
ds_read_b64_tr_b16 v[20:21], v80 offset:0
ds_read_b64_tr_b16 v[22:23], v80 offset:512
ds_read_b64_tr_b16 v[24:25], v80 offset:2048
ds_read_b64_tr_b16 v[26:27], v80 offset:2560
v_xor_b32 v81, 64, v80
ds_read_b64_tr_b16 v[28:29], v81 offset:0
ds_read_b64_tr_b16 v[30:31], v81 offset:512
ds_read_b64_tr_b16 v[32:33], v81 offset:2048
ds_read_b64_tr_b16 v[34:35], v81 offset:2560
v_xor_b32 v81, 128, v80
ds_read_b64_tr_b16 v[36:37], v81 offset:0
ds_read_b64_tr_b16 v[38:39], v81 offset:512
ds_read_b64_tr_b16 v[40:41], v81 offset:2048
ds_read_b64_tr_b16 v[42:43], v81 offset:2560
v_xor_b32 v81, 192, v80
ds_read_b64_tr_b16 v[44:45], v81 offset:0
ds_read_b64_tr_b16 v[46:47], v81 offset:512
ds_read_b64_tr_b16 v[48:49], v81 offset:2048
ds_read_b64_tr_b16 v[50:51], v81 offset:2560
s_waitcnt lgkmcnt(0)
ds_write_b128 v2, v[20:23] offset:0
ds_write_b128 v2, v[24:27] offset:1024
ds_write_b128 v2, v[28:31] offset:2048
ds_write_b128 v2, v[32:35] offset:3072
ds_write_b128 v2, v[36:39] offset:4096
ds_write_b128 v2, v[40:43] offset:5120
ds_write_b128 v2, v[44:47] offset:6144
ds_write_b128 v2, v[48:51] offset:7168
s_waitcnt vmcnt(16) lgkmcnt(0)
s_barrier
ds_read_b64_tr_b16 v[20:21], v80 offset:8192
ds_read_b64_tr_b16 v[22:23], v80 offset:8704
ds_read_b64_tr_b16 v[24:25], v80 offset:10240
ds_read_b64_tr_b16 v[26:27], v80 offset:10752
v_xor_b32 v81, 64, v80
ds_read_b64_tr_b16 v[224:225], v81 offset:8192
ds_read_b64_tr_b16 v[226:227], v81 offset:8704
ds_read_b64_tr_b16 v[228:229], v81 offset:10240
ds_read_b64_tr_b16 v[230:231], v81 offset:10752
v_xor_b32 v81, 128, v80
ds_read_b64_tr_b16 v[248:249], v81 offset:8192
ds_read_b64_tr_b16 v[250:251], v81 offset:8704
ds_read_b64_tr_b16 v[252:253], v81 offset:10240
ds_read_b64_tr_b16 v[254:255], v81 offset:10752
v_xor_b32 v81, 192, v80
ds_read_b64_tr_b16 v[28:29], v81 offset:8192
ds_read_b64_tr_b16 v[30:31], v81 offset:8704
ds_read_b64_tr_b16 v[32:33], v81 offset:10240
ds_read_b64_tr_b16 v[34:35], v81 offset:10752
s_waitcnt lgkmcnt(0)
ds_write_b128 v2, v[20:23] offset:8192
ds_write_b128 v2, v[24:27] offset:9216
ds_write_b128 v2, v[28:31] offset:10240
ds_write_b128 v2, v[32:35] offset:11264
ds_write_b128 v2, v[84:87] offset:12288
ds_write_b128 v2, v[88:91] offset:13312
ds_write_b128 v2, v[92:95] offset:14336
ds_write_b128 v2, v[96:99] offset:15360
s_waitcnt vmcnt(8) lgkmcnt(0)
s_barrier
ds_read_b64_tr_b16 v[20:21], v80 offset:16384
ds_read_b64_tr_b16 v[22:23], v80 offset:16896
ds_read_b64_tr_b16 v[24:25], v80 offset:18432
ds_read_b64_tr_b16 v[26:27], v80 offset:18944
v_xor_b32 v81, 64, v80
ds_read_b64_tr_b16 v[232:233], v81 offset:16384
ds_read_b64_tr_b16 v[234:235], v81 offset:16896
ds_read_b64_tr_b16 v[236:237], v81 offset:18432
ds_read_b64_tr_b16 v[238:239], v81 offset:18944
v_xor_b32 v81, 128, v80
ds_read_b64_tr_b16 v[28:29], v81 offset:16384
ds_read_b64_tr_b16 v[30:31], v81 offset:16896
ds_read_b64_tr_b16 v[32:33], v81 offset:18432
ds_read_b64_tr_b16 v[34:35], v81 offset:18944
v_xor_b32 v81, 192, v80
ds_read_b64_tr_b16 v[36:37], v81 offset:16384
ds_read_b64_tr_b16 v[38:39], v81 offset:16896
ds_read_b64_tr_b16 v[40:41], v81 offset:18432
ds_read_b64_tr_b16 v[42:43], v81 offset:18944
s_waitcnt lgkmcnt(0)
ds_write_b128 v2, v[20:23] offset:16384
ds_write_b128 v2, v[24:27] offset:17408
ds_write_b128 v2, v[28:31] offset:18432
ds_write_b128 v2, v[32:35] offset:19456
ds_write_b128 v2, v[36:39] offset:20480
ds_write_b128 v2, v[40:43] offset:21504
ds_write_b128 v2, v[100:103] offset:22528
ds_write_b128 v2, v[104:107] offset:23552
s_waitcnt vmcnt(0) lgkmcnt(0)
s_barrier
buffer_load_dword v56, v57, s[44:47], s66 offen offset:4 sc1
buffer_load_dword v60, v82, s[44:47], s67 offen sc1
buffer_load_dword v61, v82, s[44:47], s68 offen sc1
ds_read_b64_tr_b16 v[216:217], v80 offset:24576
ds_read_b64_tr_b16 v[218:219], v80 offset:25088
ds_read_b64_tr_b16 v[220:221], v80 offset:26624
ds_read_b64_tr_b16 v[222:223], v80 offset:27136
v_xor_b32 v81, 64, v80
ds_read_b64_tr_b16 v[240:241], v81 offset:24576
ds_read_b64_tr_b16 v[242:243], v81 offset:25088
ds_read_b64_tr_b16 v[244:245], v81 offset:26624
ds_read_b64_tr_b16 v[246:247], v81 offset:27136
v_xor_b32 v81, 128, v80
ds_read_b64_tr_b16 v[20:21], v81 offset:24576
ds_read_b64_tr_b16 v[22:23], v81 offset:25088
ds_read_b64_tr_b16 v[24:25], v81 offset:26624
ds_read_b64_tr_b16 v[26:27], v81 offset:27136
v_xor_b32 v81, 192, v80
ds_read_b64_tr_b16 v[28:29], v81 offset:24576
ds_read_b64_tr_b16 v[30:31], v81 offset:25088
ds_read_b64_tr_b16 v[32:33], v81 offset:26624
ds_read_b64_tr_b16 v[34:35], v81 offset:27136
s_waitcnt lgkmcnt(0)
ds_write_b128 v2, v[20:23] offset:24576
ds_write_b128 v2, v[24:27] offset:25600
ds_write_b128 v2, v[28:31] offset:26624
ds_write_b128 v2, v[32:35] offset:27648
ds_write_b128 v2, v[108:111] offset:28672
ds_write_b128 v2, v[112:115] offset:29696
ds_write_b128 v2, v[116:119] offset:30720
ds_write_b128 v2, v[120:123] offset:31744
s_waitcnt lgkmcnt(0)
s_branch L_c_wd
L_c_w3:
s_waitcnt vmcnt(16) lgkmcnt(0)
s_barrier
s_add_u32 m0, s81, 24576
s_add_u32 s60, s80, 3145728
buffer_load_dwordx4 v124, s[16:19], s60 offen offset:0  lds
v_xor_b32 v127, 64, v124
s_add_u32 s60, s80, 3177472
buffer_load_dwordx4 v127, s[16:19], s60 offen offset:1024  lds
s_add_u32 s60, s80, 3209216
buffer_load_dwordx4 v124, s[16:19], s60 offen offset:2048  lds
v_xor_b32 v127, 64, v124
s_add_u32 s60, s80, 3240960
buffer_load_dwordx4 v127, s[16:19], s60 offen offset:3072  lds
v_xor_b32 v127, 128, v124
s_add_u32 m0, s81, 28672
s_add_u32 s60, s80, 3276800
buffer_load_dwordx4 v127, s[16:19], s60 offen offset:0  lds
v_xor_b32 v127, 192, v124
s_add_u32 s60, s80, 3308544
buffer_load_dwordx4 v127, s[16:19], s60 offen offset:1024  lds
v_xor_b32 v127, 128, v124
s_add_u32 s60, s80, 3340288
buffer_load_dwordx4 v127, s[16:19], s60 offen offset:2048  lds
v_xor_b32 v127, 192, v124
s_add_u32 s60, s80, 3372032
buffer_load_dwordx4 v127, s[16:19], s60 offen offset:3072  lds
s_cmp_lg_u32 s52, 0
s_cbranch_scc1 L_cc_done_25
v_mov_b32 v53, 162816
ds_read_b32 v52, v53
s_mov_b32 s52, 1
s_lshl_b32 s56, s49, 8
s_or_b32 s56, s56, s50
s_waitcnt lgkmcnt(0)
v_readfirstlane_b32 s55, v52
s_nop 0
s_cmp_eq_u32 s55, s56
s_cbranch_scc1 L_cc_done_25
s_lshr_b32 s49, s55, 8
s_and_b32 s50, s55, 31
s_waitcnt vmcnt(0)
s_barrier
s_branch L_dispatch
L_cc_done_25:
ds_read_b64_tr_b16 a[48:49], v76 offset:0
ds_read_b64_tr_b16 a[50:51], v76 offset:512
ds_read_b64_tr_b16 a[52:53], v76 offset:32768
ds_read_b64_tr_b16 a[54:55], v76 offset:33280
ds_read_b64_tr_b16 a[112:113], v78 offset:0
ds_read_b64_tr_b16 a[114:115], v78 offset:512
ds_read_b64_tr_b16 a[116:117], v78 offset:32768
ds_read_b64_tr_b16 a[118:119], v78 offset:33280
ds_read_b64_tr_b16 a[56:57], v77 offset:0
ds_read_b64_tr_b16 a[58:59], v77 offset:512
ds_read_b64_tr_b16 a[60:61], v77 offset:32768
ds_read_b64_tr_b16 a[62:63], v77 offset:33280
ds_read_b64_tr_b16 a[120:121], v79 offset:0
ds_read_b64_tr_b16 a[122:123], v79 offset:512
ds_read_b64_tr_b16 a[124:125], v79 offset:32768
ds_read_b64_tr_b16 a[126:127], v79 offset:33280
s_waitcnt vmcnt(16) lgkmcnt(0)
s_barrier
s_add_u32 m0, s81, 0
s_add_u32 s60, s80, 0
buffer_load_dwordx4 v124, s[20:23], s60 offen offset:0  lds
v_xor_b32 v127, 64, v124
s_add_u32 s60, s80, 31744
buffer_load_dwordx4 v127, s[20:23], s60 offen offset:1024  lds
s_add_u32 s60, s80, 63488
buffer_load_dwordx4 v124, s[20:23], s60 offen offset:2048  lds
v_xor_b32 v127, 64, v124
s_add_u32 s60, s80, 95232
buffer_load_dwordx4 v127, s[20:23], s60 offen offset:3072  lds
v_xor_b32 v127, 128, v124
s_add_u32 m0, s81, 4096
s_add_u32 s60, s80, 131072
buffer_load_dwordx4 v127, s[20:23], s60 offen offset:0  lds
v_xor_b32 v127, 192, v124
s_add_u32 s60, s80, 162816
buffer_load_dwordx4 v127, s[20:23], s60 offen offset:1024  lds
v_xor_b32 v127, 128, v124
s_add_u32 s60, s80, 194560
buffer_load_dwordx4 v127, s[20:23], s60 offen offset:2048  lds
v_xor_b32 v127, 192, v124
s_add_u32 s60, s80, 226304
buffer_load_dwordx4 v127, s[20:23], s60 offen offset:3072  lds
ds_read_b64_tr_b16 a[32:33], v76 offset:8192
ds_read_b64_tr_b16 a[34:35], v76 offset:8704
ds_read_b64_tr_b16 a[36:37], v76 offset:40960
ds_read_b64_tr_b16 a[38:39], v76 offset:41472
ds_read_b64_tr_b16 a[96:97], v78 offset:8192
ds_read_b64_tr_b16 a[98:99], v78 offset:8704
ds_read_b64_tr_b16 a[100:101], v78 offset:40960
ds_read_b64_tr_b16 a[102:103], v78 offset:41472
ds_read_b64_tr_b16 a[40:41], v77 offset:8192
ds_read_b64_tr_b16 a[42:43], v77 offset:8704
ds_read_b64_tr_b16 a[44:45], v77 offset:40960
ds_read_b64_tr_b16 a[46:47], v77 offset:41472
ds_read_b64_tr_b16 a[104:105], v79 offset:8192
ds_read_b64_tr_b16 a[106:107], v79 offset:8704
ds_read_b64_tr_b16 a[108:109], v79 offset:40960
ds_read_b64_tr_b16 a[110:111], v79 offset:41472
s_waitcnt vmcnt(16) lgkmcnt(0)
s_barrier
s_add_u32 m0, s81, 8192
s_add_u32 s60, s80, 1048576
buffer_load_dwordx4 v124, s[20:23], s60 offen offset:0  lds
v_xor_b32 v127, 64, v124
s_add_u32 s60, s80, 1080320
buffer_load_dwordx4 v127, s[20:23], s60 offen offset:1024  lds
s_add_u32 s60, s80, 1112064
buffer_load_dwordx4 v124, s[20:23], s60 offen offset:2048  lds
v_xor_b32 v127, 64, v124
s_add_u32 s60, s80, 1143808
buffer_load_dwordx4 v127, s[20:23], s60 offen offset:3072  lds
v_xor_b32 v127, 128, v124
s_add_u32 m0, s81, 12288
s_add_u32 s60, s80, 1179648
buffer_load_dwordx4 v127, s[20:23], s60 offen offset:0  lds
v_xor_b32 v127, 192, v124
s_add_u32 s60, s80, 1211392
buffer_load_dwordx4 v127, s[20:23], s60 offen offset:1024  lds
v_xor_b32 v127, 128, v124
s_add_u32 s60, s80, 1243136
buffer_load_dwordx4 v127, s[20:23], s60 offen offset:2048  lds
v_xor_b32 v127, 192, v124
s_add_u32 s60, s80, 1274880
buffer_load_dwordx4 v127, s[20:23], s60 offen offset:3072  lds
ds_read_b64_tr_b16 a[16:17], v76 offset:16384
ds_read_b64_tr_b16 a[18:19], v76 offset:16896
ds_read_b64_tr_b16 a[20:21], v76 offset:49152
ds_read_b64_tr_b16 a[22:23], v76 offset:49664
ds_read_b64_tr_b16 a[80:81], v78 offset:16384
ds_read_b64_tr_b16 a[82:83], v78 offset:16896
ds_read_b64_tr_b16 a[84:85], v78 offset:49152
ds_read_b64_tr_b16 a[86:87], v78 offset:49664
ds_read_b64_tr_b16 a[24:25], v77 offset:16384
ds_read_b64_tr_b16 a[26:27], v77 offset:16896
ds_read_b64_tr_b16 a[28:29], v77 offset:49152
ds_read_b64_tr_b16 a[30:31], v77 offset:49664
ds_read_b64_tr_b16 a[88:89], v79 offset:16384
ds_read_b64_tr_b16 a[90:91], v79 offset:16896
ds_read_b64_tr_b16 a[92:93], v79 offset:49152
ds_read_b64_tr_b16 a[94:95], v79 offset:49664
s_waitcnt vmcnt(16) lgkmcnt(0)
s_barrier
s_add_u32 m0, s81, 16384
s_add_u32 s60, s80, 2097152
buffer_load_dwordx4 v124, s[20:23], s60 offen offset:0  lds
v_xor_b32 v127, 64, v124
s_add_u32 s60, s80, 2128896
buffer_load_dwordx4 v127, s[20:23], s60 offen offset:1024  lds
s_add_u32 s60, s80, 2160640
buffer_load_dwordx4 v124, s[20:23], s60 offen offset:2048  lds
v_xor_b32 v127, 64, v124
s_add_u32 s60, s80, 2192384
buffer_load_dwordx4 v127, s[20:23], s60 offen offset:3072  lds
v_xor_b32 v127, 128, v124
s_add_u32 m0, s81, 20480
s_add_u32 s60, s80, 2228224
buffer_load_dwordx4 v127, s[20:23], s60 offen offset:0  lds
v_xor_b32 v127, 192, v124
s_add_u32 s60, s80, 2259968
buffer_load_dwordx4 v127, s[20:23], s60 offen offset:1024  lds
v_xor_b32 v127, 128, v124
s_add_u32 s60, s80, 2291712
buffer_load_dwordx4 v127, s[20:23], s60 offen offset:2048  lds
v_xor_b32 v127, 192, v124
s_add_u32 s60, s80, 2323456
buffer_load_dwordx4 v127, s[20:23], s60 offen offset:3072  lds
ds_read_b64_tr_b16 a[0:1], v76 offset:24576
ds_read_b64_tr_b16 a[2:3], v76 offset:25088
ds_read_b64_tr_b16 a[4:5], v76 offset:57344
ds_read_b64_tr_b16 a[6:7], v76 offset:57856
ds_read_b64_tr_b16 a[64:65], v78 offset:24576
ds_read_b64_tr_b16 a[66:67], v78 offset:25088
ds_read_b64_tr_b16 a[68:69], v78 offset:57344
ds_read_b64_tr_b16 a[70:71], v78 offset:57856
ds_read_b64_tr_b16 a[8:9], v77 offset:24576
ds_read_b64_tr_b16 a[10:11], v77 offset:25088
ds_read_b64_tr_b16 a[12:13], v77 offset:57344
ds_read_b64_tr_b16 a[14:15], v77 offset:57856
ds_read_b64_tr_b16 a[72:73], v79 offset:24576
ds_read_b64_tr_b16 a[74:75], v79 offset:25088
ds_read_b64_tr_b16 a[76:77], v79 offset:57344
ds_read_b64_tr_b16 a[78:79], v79 offset:57856
s_waitcnt vmcnt(16) lgkmcnt(0)
s_barrier
s_add_u32 m0, s81, 24576
s_add_u32 s60, s80, 3145728
buffer_load_dwordx4 v124, s[20:23], s60 offen offset:0  lds
v_xor_b32 v127, 64, v124
s_add_u32 s60, s80, 3177472
buffer_load_dwordx4 v127, s[20:23], s60 offen offset:1024  lds
s_add_u32 s60, s80, 3209216
buffer_load_dwordx4 v124, s[20:23], s60 offen offset:2048  lds
v_xor_b32 v127, 64, v124
s_add_u32 s60, s80, 3240960
buffer_load_dwordx4 v127, s[20:23], s60 offen offset:3072  lds
v_xor_b32 v127, 128, v124
s_add_u32 m0, s81, 28672
s_add_u32 s60, s80, 3276800
buffer_load_dwordx4 v127, s[20:23], s60 offen offset:0  lds
v_xor_b32 v127, 192, v124
s_add_u32 s60, s80, 3308544
buffer_load_dwordx4 v127, s[20:23], s60 offen offset:1024  lds
v_xor_b32 v127, 128, v124
s_add_u32 s60, s80, 3340288
buffer_load_dwordx4 v127, s[20:23], s60 offen offset:2048  lds
v_xor_b32 v127, 192, v124
s_add_u32 s60, s80, 3372032
buffer_load_dwordx4 v127, s[20:23], s60 offen offset:3072  lds
ds_read_b64_tr_b16 a[176:177], v76 offset:0
ds_read_b64_tr_b16 a[178:179], v76 offset:512
ds_read_b64_tr_b16 a[180:181], v76 offset:32768
ds_read_b64_tr_b16 a[182:183], v76 offset:33280
ds_read_b64_tr_b16 a[240:241], v78 offset:0
ds_read_b64_tr_b16 a[242:243], v78 offset:512
ds_read_b64_tr_b16 a[244:245], v78 offset:32768
ds_read_b64_tr_b16 a[246:247], v78 offset:33280
ds_read_b64_tr_b16 a[184:185], v77 offset:0
ds_read_b64_tr_b16 a[186:187], v77 offset:512
ds_read_b64_tr_b16 a[188:189], v77 offset:32768
ds_read_b64_tr_b16 a[190:191], v77 offset:33280
ds_read_b64_tr_b16 a[248:249], v79 offset:0
ds_read_b64_tr_b16 a[250:251], v79 offset:512
ds_read_b64_tr_b16 a[252:253], v79 offset:32768
ds_read_b64_tr_b16 a[254:255], v79 offset:33280
s_waitcnt vmcnt(16) lgkmcnt(0)
s_barrier
s_add_u32 m0, s81, 0
s_add_u32 s60, s80, 0
buffer_load_dwordx4 v124, s[12:15], s60 offen offset:0  lds
v_xor_b32 v127, 64, v124
s_add_u32 s60, s80, 31744
buffer_load_dwordx4 v127, s[12:15], s60 offen offset:1024  lds
s_add_u32 s60, s80, 63488
buffer_load_dwordx4 v124, s[12:15], s60 offen offset:2048  lds
v_xor_b32 v127, 64, v124
s_add_u32 s60, s80, 95232
buffer_load_dwordx4 v127, s[12:15], s60 offen offset:3072  lds
v_xor_b32 v127, 128, v124
s_add_u32 m0, s81, 4096
s_add_u32 s60, s80, 131072
buffer_load_dwordx4 v127, s[12:15], s60 offen offset:0  lds
v_xor_b32 v127, 192, v124
s_add_u32 s60, s80, 162816
buffer_load_dwordx4 v127, s[12:15], s60 offen offset:1024  lds
v_xor_b32 v127, 128, v124
s_add_u32 s60, s80, 194560
buffer_load_dwordx4 v127, s[12:15], s60 offen offset:2048  lds
v_xor_b32 v127, 192, v124
s_add_u32 s60, s80, 226304
buffer_load_dwordx4 v127, s[12:15], s60 offen offset:3072  lds
ds_read_b64_tr_b16 a[160:161], v76 offset:8192
ds_read_b64_tr_b16 a[162:163], v76 offset:8704
ds_read_b64_tr_b16 a[164:165], v76 offset:40960
ds_read_b64_tr_b16 a[166:167], v76 offset:41472
ds_read_b64_tr_b16 a[224:225], v78 offset:8192
ds_read_b64_tr_b16 a[226:227], v78 offset:8704
ds_read_b64_tr_b16 a[228:229], v78 offset:40960
ds_read_b64_tr_b16 a[230:231], v78 offset:41472
ds_read_b64_tr_b16 a[168:169], v77 offset:8192
ds_read_b64_tr_b16 a[170:171], v77 offset:8704
ds_read_b64_tr_b16 a[172:173], v77 offset:40960
ds_read_b64_tr_b16 a[174:175], v77 offset:41472
ds_read_b64_tr_b16 a[232:233], v79 offset:8192
ds_read_b64_tr_b16 a[234:235], v79 offset:8704
ds_read_b64_tr_b16 a[236:237], v79 offset:40960
ds_read_b64_tr_b16 a[238:239], v79 offset:41472
s_waitcnt vmcnt(16) lgkmcnt(0)
s_barrier
s_add_u32 m0, s81, 8192
s_add_u32 s60, s80, 1048576
buffer_load_dwordx4 v124, s[12:15], s60 offen offset:0  lds
v_xor_b32 v127, 64, v124
s_add_u32 s60, s80, 1080320
buffer_load_dwordx4 v127, s[12:15], s60 offen offset:1024  lds
s_add_u32 s60, s80, 1112064
buffer_load_dwordx4 v124, s[12:15], s60 offen offset:2048  lds
v_xor_b32 v127, 64, v124
s_add_u32 s60, s80, 1143808
buffer_load_dwordx4 v127, s[12:15], s60 offen offset:3072  lds
v_xor_b32 v127, 128, v124
s_add_u32 m0, s81, 12288
s_add_u32 s60, s80, 1179648
buffer_load_dwordx4 v127, s[12:15], s60 offen offset:0  lds
v_xor_b32 v127, 192, v124
s_add_u32 s60, s80, 1211392
buffer_load_dwordx4 v127, s[12:15], s60 offen offset:1024  lds
v_xor_b32 v127, 128, v124
s_add_u32 s60, s80, 1243136
buffer_load_dwordx4 v127, s[12:15], s60 offen offset:2048  lds
v_xor_b32 v127, 192, v124
s_add_u32 s60, s80, 1274880
buffer_load_dwordx4 v127, s[12:15], s60 offen offset:3072  lds
buffer_load_dword v56, off, s[40:43], 0 offset:136 sc1
ds_read_b64_tr_b16 a[144:145], v76 offset:16384
ds_read_b64_tr_b16 a[146:147], v76 offset:16896
ds_read_b64_tr_b16 a[148:149], v76 offset:49152
ds_read_b64_tr_b16 a[150:151], v76 offset:49664
ds_read_b64_tr_b16 a[208:209], v78 offset:16384
ds_read_b64_tr_b16 a[210:211], v78 offset:16896
ds_read_b64_tr_b16 a[212:213], v78 offset:49152
ds_read_b64_tr_b16 a[214:215], v78 offset:49664
ds_read_b64_tr_b16 a[152:153], v77 offset:16384
ds_read_b64_tr_b16 a[154:155], v77 offset:16896
ds_read_b64_tr_b16 a[156:157], v77 offset:49152
ds_read_b64_tr_b16 a[158:159], v77 offset:49664
ds_read_b64_tr_b16 a[216:217], v79 offset:16384
ds_read_b64_tr_b16 a[218:219], v79 offset:16896
ds_read_b64_tr_b16 a[220:221], v79 offset:49152
ds_read_b64_tr_b16 a[222:223], v79 offset:49664
s_waitcnt vmcnt(17) lgkmcnt(0)
s_barrier
s_add_u32 m0, s81, 16384
s_add_u32 s60, s80, 2097152
buffer_load_dwordx4 v124, s[12:15], s60 offen offset:0  lds
v_xor_b32 v127, 64, v124
s_add_u32 s60, s80, 2128896
buffer_load_dwordx4 v127, s[12:15], s60 offen offset:1024  lds
s_add_u32 s60, s80, 2160640
buffer_load_dwordx4 v124, s[12:15], s60 offen offset:2048  lds
v_xor_b32 v127, 64, v124
s_add_u32 s60, s80, 2192384
buffer_load_dwordx4 v127, s[12:15], s60 offen offset:3072  lds
v_xor_b32 v127, 128, v124
s_add_u32 m0, s81, 20480
s_add_u32 s60, s80, 2228224
buffer_load_dwordx4 v127, s[12:15], s60 offen offset:0  lds
v_xor_b32 v127, 192, v124
s_add_u32 s60, s80, 2259968
buffer_load_dwordx4 v127, s[12:15], s60 offen offset:1024  lds
v_xor_b32 v127, 128, v124
s_add_u32 s60, s80, 2291712
buffer_load_dwordx4 v127, s[12:15], s60 offen offset:2048  lds
v_xor_b32 v127, 192, v124
s_add_u32 s60, s80, 2323456
buffer_load_dwordx4 v127, s[12:15], s60 offen offset:3072  lds
ds_read_b64_tr_b16 a[128:129], v76 offset:24576
ds_read_b64_tr_b16 a[130:131], v76 offset:25088
ds_read_b64_tr_b16 a[132:133], v76 offset:57344
ds_read_b64_tr_b16 a[134:135], v76 offset:57856
ds_read_b64_tr_b16 a[192:193], v78 offset:24576
ds_read_b64_tr_b16 a[194:195], v78 offset:25088
ds_read_b64_tr_b16 a[196:197], v78 offset:57344
ds_read_b64_tr_b16 a[198:199], v78 offset:57856
ds_read_b64_tr_b16 a[136:137], v77 offset:24576
ds_read_b64_tr_b16 a[138:139], v77 offset:25088
ds_read_b64_tr_b16 a[140:141], v77 offset:57344
ds_read_b64_tr_b16 a[142:143], v77 offset:57856
ds_read_b64_tr_b16 a[200:201], v79 offset:24576
ds_read_b64_tr_b16 a[202:203], v79 offset:25088
ds_read_b64_tr_b16 a[204:205], v79 offset:57344
ds_read_b64_tr_b16 a[206:207], v79 offset:57856
s_waitcnt vmcnt(17) lgkmcnt(0)
s_barrier
s_add_u32 m0, s81, 24576
s_add_u32 s60, s80, 3145728
buffer_load_dwordx4 v124, s[12:15], s60 offen offset:0  lds
v_xor_b32 v127, 64, v124
s_add_u32 s60, s80, 3177472
buffer_load_dwordx4 v127, s[12:15], s60 offen offset:1024  lds
s_add_u32 s60, s80, 3209216
buffer_load_dwordx4 v124, s[12:15], s60 offen offset:2048  lds
v_xor_b32 v127, 64, v124
s_add_u32 s60, s80, 3240960
buffer_load_dwordx4 v127, s[12:15], s60 offen offset:3072  lds
v_xor_b32 v127, 128, v124
s_add_u32 m0, s81, 28672
s_add_u32 s60, s80, 3276800
buffer_load_dwordx4 v127, s[12:15], s60 offen offset:0  lds
v_xor_b32 v127, 192, v124
s_add_u32 s60, s80, 3308544
buffer_load_dwordx4 v127, s[12:15], s60 offen offset:1024  lds
v_xor_b32 v127, 128, v124
s_add_u32 s60, s80, 3340288
buffer_load_dwordx4 v127, s[12:15], s60 offen offset:2048  lds
v_xor_b32 v127, 192, v124
s_add_u32 s60, s80, 3372032
buffer_load_dwordx4 v127, s[12:15], s60 offen offset:3072  lds
ds_read_b64_tr_b16 v[152:153], v76 offset:0
ds_read_b64_tr_b16 v[154:155], v76 offset:512
ds_read_b64_tr_b16 v[156:157], v76 offset:32768
ds_read_b64_tr_b16 v[158:159], v76 offset:33280
ds_read_b64_tr_b16 v[200:201], v78 offset:0
ds_read_b64_tr_b16 v[202:203], v78 offset:512
ds_read_b64_tr_b16 v[204:205], v78 offset:32768
ds_read_b64_tr_b16 v[206:207], v78 offset:33280
ds_read_b64_tr_b16 v[160:161], v77 offset:0
ds_read_b64_tr_b16 v[162:163], v77 offset:512
ds_read_b64_tr_b16 v[164:165], v77 offset:32768
ds_read_b64_tr_b16 v[166:167], v77 offset:33280
ds_read_b64_tr_b16 v[208:209], v79 offset:0
ds_read_b64_tr_b16 v[210:211], v79 offset:512
ds_read_b64_tr_b16 v[212:213], v79 offset:32768
ds_read_b64_tr_b16 v[214:215], v79 offset:33280
s_waitcnt vmcnt(16) lgkmcnt(0)
s_barrier
s_add_u32 m0, s81, 0
s_add_u32 s60, s82, 98304
buffer_load_dwordx4 v126, s[24:27], s60 offen offset:0  lds
s_add_u32 s60, s82, 101376
buffer_load_dwordx4 v126, s[24:27], s60 offen offset:1024  lds
s_add_u32 s60, s82, 104448
buffer_load_dwordx4 v126, s[24:27], s60 offen offset:2048  lds
s_add_u32 s60, s82, 107520
buffer_load_dwordx4 v126, s[24:27], s60 offen offset:3072  lds
s_add_u32 m0, s81, 4096
s_add_u32 s60, s82, 114688
buffer_load_dwordx4 v125, s[24:27], s60 offen offset:0  lds
s_add_u32 s60, s82, 117760
buffer_load_dwordx4 v125, s[24:27], s60 offen offset:1024  lds
s_add_u32 s60, s82, 120832
buffer_load_dwordx4 v125, s[24:27], s60 offen offset:2048  lds
s_add_u32 s60, s82, 123904
buffer_load_dwordx4 v125, s[24:27], s60 offen offset:3072  lds
L_gw_26:
v_readfirstlane_b32 s55, v56
s_nop 0
s_cmp_lg_u32 s55, 0
s_cbranch_scc1 L_gk_27
s_add_u32 s54, s54, 1
s_cmp_gt_u32 s54, 400000
s_cbranch_scc1 L_end
buffer_load_dword v56, off, s[40:43], 0 offset:136 sc1
s_waitcnt vmcnt(0)
s_branch L_gw_26
L_gk_27:
s_lshr_b32 s53, s55, 16
ds_read_b64_tr_b16 v[136:137], v76 offset:8192
ds_read_b64_tr_b16 v[138:139], v76 offset:8704
ds_read_b64_tr_b16 v[140:141], v76 offset:40960
ds_read_b64_tr_b16 v[142:143], v76 offset:41472
ds_read_b64_tr_b16 v[184:185], v78 offset:8192
ds_read_b64_tr_b16 v[186:187], v78 offset:8704
ds_read_b64_tr_b16 v[188:189], v78 offset:40960
ds_read_b64_tr_b16 v[190:191], v78 offset:41472
ds_read_b64_tr_b16 v[144:145], v77 offset:8192
ds_read_b64_tr_b16 v[146:147], v77 offset:8704
ds_read_b64_tr_b16 v[148:149], v77 offset:40960
ds_read_b64_tr_b16 v[150:151], v77 offset:41472
ds_read_b64_tr_b16 v[192:193], v79 offset:8192
ds_read_b64_tr_b16 v[194:195], v79 offset:8704
ds_read_b64_tr_b16 v[196:197], v79 offset:40960
ds_read_b64_tr_b16 v[198:199], v79 offset:41472
s_waitcnt vmcnt(16) lgkmcnt(0)
s_barrier
s_add_u32 m0, s81, 8192
s_add_u32 s60, s82, 0
buffer_load_dwordx4 v126, s[24:27], s60 offen offset:0  lds
s_add_u32 s60, s82, 3072
buffer_load_dwordx4 v126, s[24:27], s60 offen offset:1024  lds
s_add_u32 s60, s82, 6144
buffer_load_dwordx4 v126, s[24:27], s60 offen offset:2048  lds
s_add_u32 s60, s82, 9216
buffer_load_dwordx4 v126, s[24:27], s60 offen offset:3072  lds
s_add_u32 m0, s81, 12288
s_add_u32 s60, s82, 16384
buffer_load_dwordx4 v125, s[24:27], s60 offen offset:0  lds
s_add_u32 s60, s82, 19456
buffer_load_dwordx4 v125, s[24:27], s60 offen offset:1024  lds
s_add_u32 s60, s82, 22528
buffer_load_dwordx4 v125, s[24:27], s60 offen offset:2048  lds
s_add_u32 s60, s82, 25600
buffer_load_dwordx4 v125, s[24:27], s60 offen offset:3072  lds
ds_read_b64_tr_b16 v[116:117], v76 offset:16384
ds_read_b64_tr_b16 v[118:119], v76 offset:16896
ds_read_b64_tr_b16 v[120:121], v76 offset:49152
ds_read_b64_tr_b16 v[122:123], v76 offset:49664
ds_read_b64_tr_b16 v[168:169], v78 offset:16384
ds_read_b64_tr_b16 v[170:171], v78 offset:16896
ds_read_b64_tr_b16 v[172:173], v78 offset:49152
ds_read_b64_tr_b16 v[174:175], v78 offset:49664
ds_read_b64_tr_b16 v[128:129], v77 offset:16384
ds_read_b64_tr_b16 v[130:131], v77 offset:16896
ds_read_b64_tr_b16 v[132:133], v77 offset:49152
ds_read_b64_tr_b16 v[134:135], v77 offset:49664
ds_read_b64_tr_b16 v[176:177], v79 offset:16384
ds_read_b64_tr_b16 v[178:179], v79 offset:16896
ds_read_b64_tr_b16 v[180:181], v79 offset:49152
ds_read_b64_tr_b16 v[182:183], v79 offset:49664
s_waitcnt vmcnt(16) lgkmcnt(0)
s_barrier
s_add_u32 m0, s81, 16384
s_add_u32 s60, s82, 32768
buffer_load_dwordx4 v126, s[24:27], s60 offen offset:0  lds
s_add_u32 s60, s82, 35840
buffer_load_dwordx4 v126, s[24:27], s60 offen offset:1024  lds
s_add_u32 s60, s82, 38912
buffer_load_dwordx4 v126, s[24:27], s60 offen offset:2048  lds
s_add_u32 s60, s82, 41984
buffer_load_dwordx4 v126, s[24:27], s60 offen offset:3072  lds
s_add_u32 m0, s81, 20480
s_add_u32 s60, s82, 49152
buffer_load_dwordx4 v125, s[24:27], s60 offen offset:0  lds
s_add_u32 s60, s82, 52224
buffer_load_dwordx4 v125, s[24:27], s60 offen offset:1024  lds
s_add_u32 s60, s82, 55296
buffer_load_dwordx4 v125, s[24:27], s60 offen offset:2048  lds
s_add_u32 s60, s82, 58368
buffer_load_dwordx4 v125, s[24:27], s60 offen offset:3072  lds
ds_read_b64_tr_b16 v[84:85], v76 offset:24576
ds_read_b64_tr_b16 v[86:87], v76 offset:25088
ds_read_b64_tr_b16 v[88:89], v76 offset:57344
ds_read_b64_tr_b16 v[90:91], v76 offset:57856
ds_read_b64_tr_b16 v[92:93], v78 offset:24576
ds_read_b64_tr_b16 v[94:95], v78 offset:25088
ds_read_b64_tr_b16 v[96:97], v78 offset:57344
ds_read_b64_tr_b16 v[98:99], v78 offset:57856
ds_read_b64_tr_b16 v[100:101], v77 offset:24576
ds_read_b64_tr_b16 v[102:103], v77 offset:25088
ds_read_b64_tr_b16 v[104:105], v77 offset:57344
ds_read_b64_tr_b16 v[106:107], v77 offset:57856
ds_read_b64_tr_b16 v[108:109], v79 offset:24576
ds_read_b64_tr_b16 v[110:111], v79 offset:25088
ds_read_b64_tr_b16 v[112:113], v79 offset:57344
ds_read_b64_tr_b16 v[114:115], v79 offset:57856
s_waitcnt vmcnt(16) lgkmcnt(0)
s_barrier
s_add_u32 m0, s81, 24576
s_add_u32 s60, s82, 65536
buffer_load_dwordx4 v126, s[24:27], s60 offen offset:0  lds
s_add_u32 s60, s82, 68608
buffer_load_dwordx4 v126, s[24:27], s60 offen offset:1024  lds
s_add_u32 s60, s82, 71680
buffer_load_dwordx4 v126, s[24:27], s60 offen offset:2048  lds
s_add_u32 s60, s82, 74752
buffer_load_dwordx4 v126, s[24:27], s60 offen offset:3072  lds
s_add_u32 m0, s81, 28672
s_add_u32 s60, s82, 81920
buffer_load_dwordx4 v125, s[24:27], s60 offen offset:0  lds
s_add_u32 s60, s82, 84992
buffer_load_dwordx4 v125, s[24:27], s60 offen offset:1024  lds
s_add_u32 s60, s82, 88064
buffer_load_dwordx4 v125, s[24:27], s60 offen offset:2048  lds
s_add_u32 s60, s82, 91136
buffer_load_dwordx4 v125, s[24:27], s60 offen offset:3072  lds
ds_read_b64_tr_b16 v[20:21], v80 offset:0
ds_read_b64_tr_b16 v[22:23], v80 offset:512
ds_read_b64_tr_b16 v[24:25], v80 offset:2048
ds_read_b64_tr_b16 v[26:27], v80 offset:2560
v_xor_b32 v81, 64, v80
ds_read_b64_tr_b16 v[28:29], v81 offset:0
ds_read_b64_tr_b16 v[30:31], v81 offset:512
ds_read_b64_tr_b16 v[32:33], v81 offset:2048
ds_read_b64_tr_b16 v[34:35], v81 offset:2560
v_xor_b32 v81, 128, v80
ds_read_b64_tr_b16 v[36:37], v81 offset:0
ds_read_b64_tr_b16 v[38:39], v81 offset:512
ds_read_b64_tr_b16 v[40:41], v81 offset:2048
ds_read_b64_tr_b16 v[42:43], v81 offset:2560
v_xor_b32 v81, 192, v80
ds_read_b64_tr_b16 v[44:45], v81 offset:0
ds_read_b64_tr_b16 v[46:47], v81 offset:512
ds_read_b64_tr_b16 v[48:49], v81 offset:2048
ds_read_b64_tr_b16 v[50:51], v81 offset:2560
s_waitcnt lgkmcnt(0)
ds_write_b128 v2, v[20:23] offset:0
ds_write_b128 v2, v[24:27] offset:1024
ds_write_b128 v2, v[28:31] offset:2048
ds_write_b128 v2, v[32:35] offset:3072
ds_write_b128 v2, v[36:39] offset:4096
ds_write_b128 v2, v[40:43] offset:5120
ds_write_b128 v2, v[44:47] offset:6144
ds_write_b128 v2, v[48:51] offset:7168
s_waitcnt vmcnt(16) lgkmcnt(0)
s_barrier
ds_read_b64_tr_b16 v[20:21], v80 offset:8192
ds_read_b64_tr_b16 v[22:23], v80 offset:8704
ds_read_b64_tr_b16 v[24:25], v80 offset:10240
ds_read_b64_tr_b16 v[26:27], v80 offset:10752
v_xor_b32 v81, 64, v80
ds_read_b64_tr_b16 v[224:225], v81 offset:8192
ds_read_b64_tr_b16 v[226:227], v81 offset:8704
ds_read_b64_tr_b16 v[228:229], v81 offset:10240
ds_read_b64_tr_b16 v[230:231], v81 offset:10752
v_xor_b32 v81, 128, v80
ds_read_b64_tr_b16 v[248:249], v81 offset:8192
ds_read_b64_tr_b16 v[250:251], v81 offset:8704
ds_read_b64_tr_b16 v[252:253], v81 offset:10240
ds_read_b64_tr_b16 v[254:255], v81 offset:10752
v_xor_b32 v81, 192, v80
ds_read_b64_tr_b16 v[28:29], v81 offset:8192
ds_read_b64_tr_b16 v[30:31], v81 offset:8704
ds_read_b64_tr_b16 v[32:33], v81 offset:10240
ds_read_b64_tr_b16 v[34:35], v81 offset:10752
s_waitcnt lgkmcnt(0)
ds_write_b128 v2, v[20:23] offset:8192
ds_write_b128 v2, v[24:27] offset:9216
ds_write_b128 v2, v[28:31] offset:10240
ds_write_b128 v2, v[32:35] offset:11264
ds_write_b128 v2, v[84:87] offset:12288
ds_write_b128 v2, v[88:91] offset:13312
ds_write_b128 v2, v[92:95] offset:14336
ds_write_b128 v2, v[96:99] offset:15360
s_waitcnt vmcnt(8) lgkmcnt(0)
s_barrier
ds_read_b64_tr_b16 v[20:21], v80 offset:16384
ds_read_b64_tr_b16 v[22:23], v80 offset:16896
ds_read_b64_tr_b16 v[24:25], v80 offset:18432
ds_read_b64_tr_b16 v[26:27], v80 offset:18944
v_xor_b32 v81, 64, v80
ds_read_b64_tr_b16 v[232:233], v81 offset:16384
ds_read_b64_tr_b16 v[234:235], v81 offset:16896
ds_read_b64_tr_b16 v[236:237], v81 offset:18432
ds_read_b64_tr_b16 v[238:239], v81 offset:18944
v_xor_b32 v81, 128, v80
ds_read_b64_tr_b16 v[28:29], v81 offset:16384
ds_read_b64_tr_b16 v[30:31], v81 offset:16896
ds_read_b64_tr_b16 v[32:33], v81 offset:18432
ds_read_b64_tr_b16 v[34:35], v81 offset:18944
v_xor_b32 v81, 192, v80
ds_read_b64_tr_b16 v[36:37], v81 offset:16384
ds_read_b64_tr_b16 v[38:39], v81 offset:16896
ds_read_b64_tr_b16 v[40:41], v81 offset:18432
ds_read_b64_tr_b16 v[42:43], v81 offset:18944
s_waitcnt lgkmcnt(0)
ds_write_b128 v2, v[20:23] offset:16384
ds_write_b128 v2, v[24:27] offset:17408
ds_write_b128 v2, v[28:31] offset:18432
ds_write_b128 v2, v[32:35] offset:19456
ds_write_b128 v2, v[36:39] offset:20480
ds_write_b128 v2, v[40:43] offset:21504
ds_write_b128 v2, v[100:103] offset:22528
ds_write_b128 v2, v[104:107] offset:23552
s_waitcnt vmcnt(0) lgkmcnt(0)
s_barrier
buffer_load_dword v56, v57, s[44:47], s66 offen offset:4 sc1
buffer_load_dword v60, v82, s[44:47], s67 offen sc1
buffer_load_dword v61, v82, s[44:47], s68 offen sc1
ds_read_b64_tr_b16 v[216:217], v80 offset:24576
ds_read_b64_tr_b16 v[218:219], v80 offset:25088
ds_read_b64_tr_b16 v[220:221], v80 offset:26624
ds_read_b64_tr_b16 v[222:223], v80 offset:27136
v_xor_b32 v81, 64, v80
ds_read_b64_tr_b16 v[240:241], v81 offset:24576
ds_read_b64_tr_b16 v[242:243], v81 offset:25088
ds_read_b64_tr_b16 v[244:245], v81 offset:26624
ds_read_b64_tr_b16 v[246:247], v81 offset:27136
v_xor_b32 v81, 128, v80
ds_read_b64_tr_b16 v[20:21], v81 offset:24576
ds_read_b64_tr_b16 v[22:23], v81 offset:25088
ds_read_b64_tr_b16 v[24:25], v81 offset:26624
ds_read_b64_tr_b16 v[26:27], v81 offset:27136
v_xor_b32 v81, 192, v80
ds_read_b64_tr_b16 v[28:29], v81 offset:24576
ds_read_b64_tr_b16 v[30:31], v81 offset:25088
ds_read_b64_tr_b16 v[32:33], v81 offset:26624
ds_read_b64_tr_b16 v[34:35], v81 offset:27136
s_waitcnt lgkmcnt(0)
ds_write_b128 v2, v[20:23] offset:24576
ds_write_b128 v2, v[24:27] offset:25600
ds_write_b128 v2, v[28:31] offset:26624
ds_write_b128 v2, v[32:35] offset:27648
ds_write_b128 v2, v[108:111] offset:28672
ds_write_b128 v2, v[112:115] offset:29696
ds_write_b128 v2, v[116:119] offset:30720
ds_write_b128 v2, v[120:123] offset:31744
s_waitcnt lgkmcnt(0)
L_c_wd:
s_mov_b32 s80, 0x5004000
s_mov_b32 s81, 0x5008000
s_mov_b32 s82, 0x500c000
L_c_xp_28:
s_waitcnt vmcnt(0)
v_max_u32 v64, v60, v61
v_cmp_eq_u32 vcc, -1, v64
s_cbranch_vccz L_c_xk_29
s_add_u32 s54, s54, 1
s_cmp_gt_u32 s54, 400000
s_cbranch_scc1 L_end
buffer_load_dword v60, v82, s[44:47], s67 offen sc1
buffer_load_dword v61, v82, s[44:47], s68 offen sc1
buffer_load_dword v56, v57, s[44:47], s66 offen offset:4 sc1
s_branch L_c_xp_28
L_c_xk_29:
v_add_f32_dpp v60, v60, v60 row_ror:4 row_mask:0xf bank_mask:0xf
v_add_f32_dpp v61, v61, v61 row_ror:4 row_mask:0xf bank_mask:0xf
s_nop 0
v_add_f32_dpp v60, v60, v60 row_ror:8 row_mask:0xf bank_mask:0xf
v_add_f32_dpp v61, v61, v61 row_ror:8 row_mask:0xf bank_mask:0xf
v_cvt_pk_bf16_f32 v60, v60, v61
v_min_u32 v60, -2, v60
s_cmp_lg_u32 s53, 0
s_cbranch_scc1 L_c_in_i
buffer_store_dword v60, v14, s[44:47], s74 offen
L_c_f01_30:
v_cmp_eq_u32 vcc, 0, v56
s_cbranch_vccz L_c_f01k_31
s_add_u32 s54, s54, 1
s_cmp_gt_u32 s54, 400000
s_cbranch_scc1 L_end
buffer_load_dword v56, v57, s[44:47], s66 offen offset:4 sc1
s_waitcnt vmcnt(0)
s_branch L_c_f01_30
L_c_f01k_31:
s_mov_b32 m0, s76
s_add_u32 s66, s66, 8192
buffer_load_dwordx4 v1, s[44:47], s63 offen offset:0 sc1 lds
buffer_load_dwordx4 v1, s[44:47], s63 offen offset:1024 sc1 lds
s_mov_b32 m0, s77
s_add_u32 s63, s63, 786432
buffer_load_dwordx4 v1, s[44:47], s62 offen offset:0 sc1 lds
buffer_load_dwordx4 v1, s[44:47], s62 offen offset:1024 sc1 lds
s_add_u32 s62, s62, 786432
s_mov_b32 s67, 0x5000000
v_xor_b32 v66, 2048, v3
v_xor_b32 v74, 4096, v3
v_xor_b32 v82, 6144, v3
v_pk_mov_b32 v[28:29], 0, 0
v_pk_mov_b32 v[30:31], 0, 0
v_pk_mov_b32 v[32:33], 0, 0
v_pk_mov_b32 v[34:35], 0, 0
v_pk_mov_b32 v[36:37], 0, 0
v_pk_mov_b32 v[38:39], 0, 0
v_pk_mov_b32 v[40:41], 0, 0
v_pk_mov_b32 v[42:43], 0, 0
v_pk_mov_b32 v[44:45], 0, 0
v_pk_mov_b32 v[46:47], 0, 0
v_pk_mov_b32 v[48:49], 0, 0
v_pk_mov_b32 v[50:51], 0, 0
s_waitcnt vmcnt(4)
buffer_load_dwordx4 v[52:55], v1, s[44:47], s72 offen offset:0 sc1
buffer_load_dwordx4 v[56:59], v1, s[44:47], s72 offen offset:1024 sc1
buffer_store_dword v15, v14, s[44:47], s75 offen
s_waitcnt vmcnt(3)
ds_read_b128 v[20:23], v3 offset:0
ds_read_b128 v[24:27], v3 offset:1024
s_branch L_c_top_p
L_c_in_i:
buffer_store_dword v60, v14, s[44:47], s74 offen sc1
L_c_f01_32:
v_cmp_eq_u32 vcc, 0, v56
s_cbranch_vccz L_c_f01k_33
s_add_u32 s54, s54, 1
s_cmp_gt_u32 s54, 400000
s_cbranch_scc1 L_end
buffer_load_dword v56, v57, s[44:47], s66 offen offset:4 sc1
s_waitcnt vmcnt(0)
s_branch L_c_f01_32
L_c_f01k_33:
s_mov_b32 m0, s76
s_add_u32 s66, s66, 8192
buffer_load_dwordx4 v1, s[44:47], s63 offen offset:0 sc1 lds
buffer_load_dwordx4 v1, s[44:47], s63 offen offset:1024 sc1 lds
s_mov_b32 m0, s77
s_add_u32 s63, s63, 786432
buffer_load_dwordx4 v1, s[44:47], s62 offen offset:0 sc1 lds
buffer_load_dwordx4 v1, s[44:47], s62 offen offset:1024 sc1 lds
s_add_u32 s62, s62, 786432
s_mov_b32 s67, 0x5000000
v_xor_b32 v66, 2048, v3
v_xor_b32 v74, 4096, v3
v_xor_b32 v82, 6144, v3
v_pk_mov_b32 v[28:29], 0, 0
v_pk_mov_b32 v[30:31], 0, 0
v_pk_mov_b32 v[32:33], 0, 0
v_pk_mov_b32 v[34:35], 0, 0
v_pk_mov_b32 v[36:37], 0, 0
v_pk_mov_b32 v[38:39], 0, 0
v_pk_mov_b32 v[40:41], 0, 0
v_pk_mov_b32 v[42:43], 0, 0
v_pk_mov_b32 v[44:45], 0, 0
v_pk_mov_b32 v[46:47], 0, 0
v_pk_mov_b32 v[48:49], 0, 0
v_pk_mov_b32 v[50:51], 0, 0
s_waitcnt vmcnt(4)
buffer_load_dwordx4 v[52:55], v1, s[44:47], s72 offen offset:0 sc1
buffer_load_dwordx4 v[56:59], v1, s[44:47], s72 offen offset:1024 sc1
buffer_store_dword v15, v14, s[44:47], s75 offen sc1
s_waitcnt vmcnt(3)
ds_read_b128 v[20:23], v3 offset:0
ds_read_b128 v[24:27], v3 offset:1024
s_branch L_c_top_i
.p2align 6
s_endpgm
L_c_top_p:
s_waitcnt vmcnt(2) lgkmcnt(0)
ds_write_b128 v3, v[52:55] offset:8192
s_waitcnt vmcnt(1)
v_max3_u32 v64, v52, v53, v54
v_max3_u32 v65, v55, v56, v57
v_max3_u32 v64, v64, v58, v59
v_max_u32 v64, v64, v65
v_cmp_eq_u32 vcc, -1, v64
ds_write_b128 v3, v[56:59] offset:9216
s_cbranch_vccnz L_c_gr_34
L_c_gb_35:
L_c_body_p:
v_smfmac_f32_16x16x64_bf16 v[28:31], v[52:55], v[84:91], v4
s_mov_b32 m0, s77
v_smfmac_f32_16x16x64_bf16 v[32:35], v[52:55], v[92:99], v4
s_add_u32 s61, s61, 1
v_smfmac_f32_16x16x64_bf16 v[28:31], v[56:59], v[100:107], v4
s_cmp_lt_u32 s61, 62
v_smfmac_f32_16x16x64_bf16 v[32:35], v[56:59], v[108:115], v4
s_cselect_b32 s68, 4096, 0
s_waitcnt lgkmcnt(0)
s_barrier
v_smfmac_f32_16x16x64_bf16 v[36:39], v[52:55], a[0:7], v4
ds_read_b128 v[60:63], v66 offset:8192
buffer_store_dwordx4 v[124:127], v1, s[44:47], s64 offen sc1
v_smfmac_f32_16x16x64_bf16 v[40:43], v[52:55], a[64:71], v4
ds_read_b128 v[64:67], v66 offset:9216
v_smfmac_f32_16x16x64_bf16 v[36:39], v[56:59], a[8:15], v4
ds_read_b128 v[68:71], v74 offset:8192
buffer_store_dword v15, v14, s[44:47], s65 offen sc1
v_smfmac_f32_16x16x64_bf16 v[40:43], v[56:59], a[72:79], v4
ds_read_b128 v[72:75], v74 offset:9216
v_smfmac_f32_16x16x64_bf16 v[44:47], v[52:55], a[128:135], v4
ds_read_b128 v[76:79], v82 offset:8192
buffer_load_dwordx4 v1, s[44:47], s62 offen offset:0 sc1 lds
v_smfmac_f32_16x16x64_bf16 v[48:51], v[52:55], a[192:199], v4
ds_read_b128 v[80:83], v82 offset:9216
v_smfmac_f32_16x16x64_bf16 v[44:47], v[56:59], a[136:143], v4
s_waitcnt lgkmcnt(4)
v_smfmac_f32_16x16x64_bf16 v[28:31], v[60:63], v[116:123], v4
ds_read_b128 v[84:87], v9 offset:0
v_smfmac_f32_16x16x64_bf16 v[28:31], v[64:67], v[128:135], v4
ds_read_b128 v[88:91], v9 offset:4096
s_waitcnt lgkmcnt(4)
v_smfmac_f32_16x16x64_bf16 v[28:31], v[68:71], v[136:143], v4
ds_read_b128 v[92:95], v9 offset:1024
buffer_load_dwordx4 v1, s[44:47], s62 offen offset:1024 sc1 lds
v_smfmac_f32_16x16x64_bf16 v[28:31], v[72:75], v[144:151], v4
ds_read_b128 v[96:99], v9 offset:5120
s_waitcnt lgkmcnt(4)
v_smfmac_f32_16x16x64_bf16 v[28:31], v[76:79], v[152:159], v4
ds_read_b128 v[100:103], v9 offset:2048
v_smfmac_f32_16x16x64_bf16 v[28:31], v[80:83], v[160:167], v4
ds_read_b128 v[104:107], v9 offset:6144
s_add_u32 s62, s62, 786432
v_smfmac_f32_16x16x64_bf16 v[32:35], v[60:63], v[168:175], v4
ds_read_b128 v[108:111], v9 offset:3072
s_mov_b32 m0, s76
v_smfmac_f32_16x16x64_bf16 v[32:35], v[64:67], v[176:183], v4
ds_read_b128 v[112:115], v9 offset:7168
v_add_f32 v28, v28, v30
v_smfmac_f32_16x16x64_bf16 v[32:35], v[68:71], v[184:191], v4
s_add_u32 s65, s65, 4096
s_add_u32 s64, s64, 131072
v_add_f32 v29, v29, v31
v_smfmac_f32_16x16x64_bf16 v[32:35], v[72:75], v[192:199], v4
v_cvt_pk_bf16_f32 v28, v28, v29
v_smfmac_f32_16x16x64_bf16 v[32:35], v[76:79], v[200:207], v4
ds_write2_b32 v5, v28, v28 offset0:0 offset1:1
v_smfmac_f32_16x16x64_bf16 v[32:35], v[80:83], v[208:215], v4
v_smfmac_f32_16x16x64_bf16 v[48:51], v[56:59], a[200:207], v4
v_smfmac_f32_16x16x64_bf16 v[36:39], v[60:63], a[16:23], v4
v_add_f32 v32, v32, v34
v_add_f32 v33, v33, v35
v_smfmac_f32_16x16x64_bf16 v[36:39], v[64:67], a[24:31], v4
v_cvt_pk_bf16_f32 v29, v32, v33
v_smfmac_f32_16x16x64_bf16 v[36:39], v[68:71], a[32:39], v4
ds_write2_b32 v5, v29, v29 offset0:128 offset1:129
v_smfmac_f32_16x16x64_bf16 v[36:39], v[72:75], a[40:47], v4
v_smfmac_f32_16x16x64_bf16 v[36:39], v[76:79], a[48:55], v4
v_smfmac_f32_16x16x64_bf16 v[36:39], v[80:83], a[56:63], v4
v_smfmac_f32_16x16x64_bf16 v[40:43], v[60:63], a[80:87], v4
s_waitcnt lgkmcnt(0)
s_barrier
v_smfmac_f32_16x16x64_bf16 v[40:43], v[64:67], a[88:95], v4
ds_read_b64_tr_b16 v[116:117], v8 offset:4096
ds_read_b64_tr_b16 v[118:119], v8 offset:4608
v_smfmac_f32_16x16x64_bf16 v[40:43], v[68:71], a[96:103], v4
ds_read_b64_tr_b16 v[120:121], v8 offset:5120
ds_read_b64_tr_b16 v[122:123], v8 offset:5632
v_smfmac_f32_16x16x64_bf16 v[40:43], v[72:75], a[104:111], v4
ds_read_b64_tr_b16 v[52:53], v8 offset:6144
v_add_f32 v36, v36, v38
v_smfmac_f32_16x16x64_bf16 v[40:43], v[76:79], a[112:119], v4
ds_read_b64_tr_b16 v[54:55], v8 offset:6656
v_add_f32 v37, v37, v39
v_smfmac_f32_16x16x64_bf16 v[40:43], v[80:83], a[120:127], v4
ds_read_b64_tr_b16 v[56:57], v8 offset:7168
s_waitcnt lgkmcnt(5)
v_mfma_f32_16x16x32_bf16 v[28:31], v[84:87], v[116:119], 0
ds_read_b64_tr_b16 v[58:59], v8 offset:7680
v_cvt_pk_bf16_f32 v125, v36, v37
v_mfma_f32_16x16x32_bf16 v[32:35], v[88:91], v[116:119], 0
s_waitcnt lgkmcnt(4)
v_add_f32 v40, v40, v42
v_add_f32 v41, v41, v43
v_mfma_f32_16x16x32_bf16 v[28:31], v[92:95], v[120:123], v[28:31]
ds_write_b32 v6, v125 offset:0
v_cvt_pk_bf16_f32 v127, v40, v41
v_mfma_f32_16x16x32_bf16 v[32:35], v[96:99], v[120:123], v[32:35]
ds_write_b32 v6, v127 offset:512
s_waitcnt lgkmcnt(4)
v_mfma_f32_16x16x32_bf16 v[28:31], v[100:103], v[52:55], v[28:31]
buffer_load_dwordx4 v1, s[44:47], s63 offen offset:0 sc1 lds
v_mfma_f32_16x16x32_bf16 v[32:35], v[104:107], v[52:55], v[32:35]
s_waitcnt lgkmcnt(2)
buffer_load_dword v0, off, s[44:47], s66 offset:4 sc1
v_mfma_f32_16x16x32_bf16 v[28:31], v[108:111], v[56:59], v[28:31]
buffer_load_dwordx4 v1, s[44:47], s63 offen offset:1024 sc1 lds
v_mfma_f32_16x16x32_bf16 v[32:35], v[112:115], v[56:59], v[32:35]
s_add_u32 s63, s63, 786432
s_add_u32 s66, s66, s68
s_waitcnt lgkmcnt(0)
s_barrier
v_smfmac_f32_16x16x64_bf16 v[44:47], v[60:63], a[144:151], v4
ds_read_b64_tr_b16 v[84:85], v8 offset:0
ds_read_b64_tr_b16 v[86:87], v8 offset:512
v_smfmac_f32_16x16x64_bf16 v[44:47], v[64:67], a[152:159], v4
ds_read_b64_tr_b16 v[88:89], v8 offset:1024
ds_read_b64_tr_b16 v[90:91], v8 offset:1536
v_smfmac_f32_16x16x64_bf16 v[44:47], v[68:71], a[160:167], v4
ds_read_b64_tr_b16 v[92:93], v8 offset:2048
ds_read_b64_tr_b16 v[94:95], v8 offset:2560
v_smfmac_f32_16x16x64_bf16 v[44:47], v[72:75], a[168:175], v4
ds_read_b64_tr_b16 v[96:97], v8 offset:3072
v_cndmask_b32 v28, v28, v32, s[78:79]
v_smfmac_f32_16x16x64_bf16 v[44:47], v[76:79], a[176:183], v4
ds_read_b64_tr_b16 v[98:99], v8 offset:3584
v_cndmask_b32 v29, v29, v33, s[78:79]
v_smfmac_f32_16x16x64_bf16 v[44:47], v[80:83], a[184:191], v4
s_waitcnt lgkmcnt(4)
v_cndmask_b32 v30, v30, v34, s[78:79]
v_mfma_f32_16x16x32_bf16 v[36:39], v[84:87], v[116:119], 0
ds_read_b128 v[100:103], v2 offset:0
v_cndmask_b32 v31, v31, v35, s[78:79]
v_mfma_f32_16x16x32_bf16 v[36:39], v[88:91], v[120:123], v[36:39]
s_waitcnt lgkmcnt(1)
v_max3_f32 v42, v28, v29, v30
v_max_f32 v42, v42, v31
v_mfma_f32_16x16x32_bf16 v[36:39], v[92:95], v[52:55], v[36:39]
ds_read_b128 v[104:107], v2 offset:1024
v_add_f32 v44, v44, v46
v_mfma_f32_16x16x32_bf16 v[36:39], v[96:99], v[56:59], v[36:39]
v_max_f32_dpp v42, v42, v42 quad_perm:[2,3,0,1] row_mask:0xf bank_mask:0xf
v_add_f32 v45, v45, v47
v_smfmac_f32_16x16x64_bf16 v[48:51], v[60:63], a[208:215], v4
ds_read_b128 v[108:111], v2 offset:2048
v_cvt_pk_bf16_f32 v124, v44, v45
s_nop 0
v_max3_f32 v42, v42, v36, v37
v_mov_b32 v43, v42
v_smfmac_f32_16x16x64_bf16 v[48:51], v[64:67], a[216:223], v4
ds_read_b128 v[112:115], v2 offset:3072
v_permlane16_swap_b32 v42, v43
v_max_f32 v42, v42, v43
v_mov_b32 v43, v42
v_smfmac_f32_16x16x64_bf16 v[48:51], v[68:71], a[224:231], v4
ds_read_b128 v[84:87], v2 offset:4096
v_permlane32_swap_b32 v42, v43
v_max_f32 v42, v42, v43
v_mul_f32 v42, s71, v42
v_fmamk_f32 v28, v28, 0x3e0293ee, v42
v_fmamk_f32 v29, v29, 0x3e0293ee, v42
v_smfmac_f32_16x16x64_bf16 v[48:51], v[72:75], a[232:239], v4
ds_read_b128 v[88:91], v2 offset:5120
v_exp_f32 v28, v28
v_exp_f32 v29, v29
v_fmamk_f32 v30, v30, 0x3e0293ee, v42
v_fmamk_f32 v31, v31, 0x3e0293ee, v42
v_smfmac_f32_16x16x64_bf16 v[48:51], v[76:79], a[240:247], v4
ds_read_b128 v[92:95], v2 offset:6144
v_exp_f32 v30, v30
v_exp_f32 v31, v31
v_cvt_pk_bf16_f32 v32, v28, v29
v_cvt_pk_bf16_f32 v33, v30, v31
v_smfmac_f32_16x16x64_bf16 v[48:51], v[80:83], a[248:255], v4
ds_read_b128 v[96:99], v2 offset:7168
v_mov_b32_dpp v34, v32 quad_perm:[2,3,0,1] row_mask:0xf bank_mask:0xf
v_mov_b32_dpp v35, v33 quad_perm:[2,3,0,1] row_mask:0xf bank_mask:0xf
v_cndmask_b32 v36, v36, v37, s[78:79]
v_fmamk_f32 v36, v36, 0x3e0293ee, v42
v_mfma_f32_16x16x32_bf16 v[28:31], v[20:23], v[32:35], 0
ds_read_b128 v[116:119], v2 offset:8192
v_exp_f32 v36, v36
v_mfma_f32_16x16x32_bf16 v[40:43], v[16:19], v[32:35], 0
ds_read_b128 v[120:123], v2 offset:9216
v_mov_b32_dpp v37, v36 quad_perm:[2,3,0,1] row_mask:0xf bank_mask:0xf
v_cvt_pk_bf16_f32 v38, v36, v37
v_mfma_f32_16x16x32_bf16 v[20:23], v[24:27], v[32:35], 0
v_add_f32 v48, v48, v50
v_add_f32 v49, v49, v51
v_mfma_f32_16x16x16_bf16 v[40:43], v[16:17], v[38:39], v[40:43]
ds_read_b128 v[52:55], v2 offset:16384
v_cvt_pk_bf16_f32 v126, v48, v49
v_mfma_f32_16x16x16_bf16 v[28:31], v[124:125], v[38:39], v[28:31]
ds_read_b128 v[56:59], v2 offset:17408
v_mfma_f32_16x16x16_bf16 v[20:23], v[126:127], v[38:39], v[20:23]
v_rcp_f32 v42, v42
v_mfma_i32_16x16x4_4b_i8 v[60:75], v39, v4, 0
s_nop 0
v_mul_f32_dpp v28, v28, v42 quad_perm:[0,1,0,1] row_mask:0xf bank_mask:0xf
v_mul_f32_dpp v29, v29, v42 quad_perm:[0,1,0,1] row_mask:0xf bank_mask:0xf
v_mul_f32_dpp v30, v30, v42 quad_perm:[0,1,0,1] row_mask:0xf bank_mask:0xf
v_mul_f32_dpp v31, v31, v42 quad_perm:[0,1,0,1] row_mask:0xf bank_mask:0xf
v_cvt_pk_bf16_f32 v36, v28, v29
v_cvt_pk_bf16_f32 v37, v30, v31
v_mul_f32_dpp v20, v20, v42 quad_perm:[0,1,0,1] row_mask:0xf bank_mask:0xf
v_mul_f32_dpp v21, v21, v42 quad_perm:[0,1,0,1] row_mask:0xf bank_mask:0xf
v_mul_f32_dpp v22, v22, v42 quad_perm:[0,1,0,1] row_mask:0xf bank_mask:0xf
v_mul_f32_dpp v23, v23, v42 quad_perm:[0,1,0,1] row_mask:0xf bank_mask:0xf
v_cvt_pk_bf16_f32 v38, v20, v21
v_cvt_pk_bf16_f32 v39, v22, v23
ds_write_b128 v11, v[36:39]
s_waitcnt vmcnt(7)
s_waitcnt lgkmcnt(5)
v_smfmac_f32_16x16x64_bf16 v[60:63], v[36:39], v[100:107], v4
v_smfmac_f32_16x16x64_bf16 v[64:67], v[36:39], v[108:115], v4
v_smfmac_f32_16x16x64_bf16 v[68:71], v[36:39], v[84:91], v4
s_waitcnt lgkmcnt(0)
s_barrier
ds_read_b128 v[40:43], v10 offset:528
ds_read_b128 v[44:47], v10 offset:1056
ds_read_b128 v[48:51], v10 offset:1584
v_smfmac_f32_16x16x64_bf16 v[72:75], v[36:39], v[92:99], v4
ds_read_b128 v[20:23], v2 offset:18432
ds_read_b128 v[24:27], v2 offset:19456
s_waitcnt lgkmcnt(4)
v_smfmac_f32_16x16x64_bf16 v[60:63], v[40:43], v[116:123], v4
ds_read_b128 v[28:31], v2 offset:24576
s_waitcnt lgkmcnt(4)
v_smfmac_f32_16x16x64_bf16 v[60:63], v[44:47], v[52:59], v4
ds_read_b128 v[32:35], v2 offset:25600
s_waitcnt lgkmcnt(4)
v_smfmac_f32_16x16x64_bf16 v[60:63], v[48:51], v[216:223], v4
ds_read_b128 v[76:79], v2 offset:10240
v_smfmac_f32_16x16x64_bf16 v[64:67], v[40:43], v[224:231], v4
ds_read_b128 v[80:83], v2 offset:11264
v_smfmac_f32_16x16x64_bf16 v[64:67], v[44:47], v[232:239], v4
ds_read_b128 v[100:103], v2 offset:20480
v_cvt_pk_bf16_f32 v60, v60, v61
v_cvt_pk_bf16_f32 v61, v62, v63
v_or_b32 v60, 1, v60
v_smfmac_f32_16x16x64_bf16 v[64:67], v[48:51], v[240:247], v4
ds_read_b128 v[104:107], v2 offset:21504
buffer_store_dwordx2 v[60:61], v12, s[44:47], s67 offen
v_smfmac_f32_16x16x64_bf16 v[68:71], v[40:43], v[248:255], v4
ds_read_b128 v[108:111], v2 offset:26624
s_waitcnt lgkmcnt(5)
v_smfmac_f32_16x16x64_bf16 v[68:71], v[44:47], v[20:27], v4
ds_read_b128 v[112:115], v2 offset:27648
v_cvt_pk_bf16_f32 v64, v64, v65
v_cvt_pk_bf16_f32 v65, v66, v67
v_or_b32 v64, 1, v64
v_smfmac_f32_16x16x64_bf16 v[68:71], v[48:51], v[28:35], v4
buffer_store_dwordx2 v[64:65], v12, s[44:47], s80 offen
s_waitcnt lgkmcnt(2)
v_smfmac_f32_16x16x64_bf16 v[72:75], v[40:43], v[76:83], v4
v_smfmac_f32_16x16x64_bf16 v[72:75], v[44:47], v[100:107], v4
s_waitcnt lgkmcnt(0)
v_cvt_pk_bf16_f32 v68, v68, v69
v_cvt_pk_bf16_f32 v69, v70, v71
v_or_b32 v68, 1, v68
v_smfmac_f32_16x16x64_bf16 v[72:75], v[48:51], v[108:115], v4
buffer_store_dwordx2 v[68:69], v12, s[44:47], s81 offen
s_nop 6
v_cvt_pk_bf16_f32 v72, v72, v73
v_cvt_pk_bf16_f32 v73, v74, v75
v_or_b32 v72, 1, v72
buffer_store_dwordx2 v[72:73], v12, s[44:47], s82 offen
ds_read_b128 v[84:87], v2 offset:12288
ds_read_b128 v[88:91], v2 offset:13312
ds_read_b128 v[92:95], v2 offset:14336
ds_read_b128 v[96:99], v2 offset:15360
ds_read_b128 v[100:103], v2 offset:22528
ds_read_b128 v[104:107], v2 offset:23552
ds_read_b128 v[108:111], v2 offset:28672
ds_read_b128 v[112:115], v2 offset:29696
ds_read_b128 v[116:119], v2 offset:30720
ds_read_b128 v[120:123], v2 offset:31744
v_xor_b32 v66, 2048, v3
v_xor_b32 v74, 4096, v3
v_xor_b32 v82, 6144, v3
s_waitcnt vmcnt(4)
ds_read_b128 v[20:23], v3 offset:0
ds_read_b128 v[24:27], v3 offset:1024
s_waitcnt vmcnt(0)
buffer_load_dwordx4 v[52:55], v13, s[44:47], s69 offen sc1
buffer_load_dwordx4 v[56:59], v13, s[44:47], s70 offen sc1
v_cmp_eq_u32 vcc, 0, v0
s_cbranch_vccnz L_c_fs_36
L_c_fb_37:
s_waitcnt vmcnt(1)
v_mfma_f32_16x16x32_bf16 v[60:63], v[16:19], v[52:55], 0
s_waitcnt vmcnt(0)
v_mfma_f32_16x16x32_bf16 v[60:63], v[16:19], v[56:59], v[60:63]
v_bitop3_b32 v64, v52, v54, v56 bitop3:0x80
v_bitop3_b32 v64, v64, v58, 1 bitop3:0x80
v_cmp_eq_u32 vcc, 0, v64
s_cbranch_vccnz L_c_rr_38
L_c_rb_39:
s_nop 3
v_add_f32_dpp v60, v60, v60 row_ror:4 row_mask:0xf bank_mask:0xf
v_add_f32_dpp v61, v61, v61 row_ror:4 row_mask:0xf bank_mask:0xf
s_nop 0
v_add_f32_dpp v60, v60, v60 row_ror:8 row_mask:0xf bank_mask:0xf
v_add_f32_dpp v61, v61, v61 row_ror:8 row_mask:0xf bank_mask:0xf
v_cvt_pk_bf16_f32 v60, v60, v61
v_min_u32 v60, -2, v60
buffer_store_dword v60, v14, s[44:47], s75 offen
s_waitcnt vmcnt(0)
buffer_load_dwordx4 v[52:55], v1, s[44:47], s73 offen offset:0 sc1
buffer_load_dwordx4 v[56:59], v1, s[44:47], s73 offen offset:1024 sc1
buffer_store_dword v15, v14, s[44:47], s74 offen
v_pk_mov_b32 v[28:29], 0, 0
v_pk_mov_b32 v[30:31], 0, 0
v_pk_mov_b32 v[32:33], 0, 0
v_pk_mov_b32 v[34:35], 0, 0
v_pk_mov_b32 v[36:37], 0, 0
v_pk_mov_b32 v[38:39], 0, 0
v_pk_mov_b32 v[40:41], 0, 0
v_pk_mov_b32 v[42:43], 0, 0
v_pk_mov_b32 v[44:45], 0, 0
v_pk_mov_b32 v[46:47], 0, 0
v_pk_mov_b32 v[48:49], 0, 0
v_pk_mov_b32 v[50:51], 0, 0
s_cmp_eq_u32 s61, 63
s_cbranch_scc1 L_c_final
s_waitcnt vmcnt(2) lgkmcnt(0)
ds_write_b128 v3, v[52:55] offset:8192
s_waitcnt vmcnt(1)
v_max3_u32 v64, v52, v53, v54
v_max3_u32 v65, v55, v56, v57
v_max3_u32 v64, v64, v58, v59
v_max_u32 v64, v64, v65
v_cmp_eq_u32 vcc, -1, v64
ds_write_b128 v3, v[56:59] offset:9216
s_cbranch_vccnz L_c_gr_40
L_c_gb_41:
v_smfmac_f32_16x16x64_bf16 v[28:31], v[52:55], v[84:91], v4
s_mov_b32 m0, s77
v_smfmac_f32_16x16x64_bf16 v[32:35], v[52:55], v[92:99], v4
s_add_u32 s61, s61, 1
v_smfmac_f32_16x16x64_bf16 v[28:31], v[56:59], v[100:107], v4
s_cmp_lt_u32 s61, 62
v_smfmac_f32_16x16x64_bf16 v[32:35], v[56:59], v[108:115], v4
s_cselect_b32 s68, 4096, 0
s_waitcnt lgkmcnt(0)
s_barrier
v_smfmac_f32_16x16x64_bf16 v[36:39], v[52:55], a[0:7], v4
ds_read_b128 v[60:63], v66 offset:8192
buffer_store_dwordx4 v[124:127], v1, s[44:47], s64 offen sc1
v_smfmac_f32_16x16x64_bf16 v[40:43], v[52:55], a[64:71], v4
ds_read_b128 v[64:67], v66 offset:9216
v_smfmac_f32_16x16x64_bf16 v[36:39], v[56:59], a[8:15], v4
ds_read_b128 v[68:71], v74 offset:8192
buffer_store_dword v15, v14, s[44:47], s65 offen sc1
v_smfmac_f32_16x16x64_bf16 v[40:43], v[56:59], a[72:79], v4
ds_read_b128 v[72:75], v74 offset:9216
v_smfmac_f32_16x16x64_bf16 v[44:47], v[52:55], a[128:135], v4
ds_read_b128 v[76:79], v82 offset:8192
buffer_load_dwordx4 v1, s[44:47], s62 offen offset:0 sc1 lds
v_smfmac_f32_16x16x64_bf16 v[48:51], v[52:55], a[192:199], v4
ds_read_b128 v[80:83], v82 offset:9216
v_smfmac_f32_16x16x64_bf16 v[44:47], v[56:59], a[136:143], v4
s_waitcnt lgkmcnt(4)
v_smfmac_f32_16x16x64_bf16 v[28:31], v[60:63], v[116:123], v4
ds_read_b128 v[84:87], v9 offset:0
v_smfmac_f32_16x16x64_bf16 v[28:31], v[64:67], v[128:135], v4
ds_read_b128 v[88:91], v9 offset:4096
s_waitcnt lgkmcnt(4)
v_smfmac_f32_16x16x64_bf16 v[28:31], v[68:71], v[136:143], v4
ds_read_b128 v[92:95], v9 offset:1024
buffer_load_dwordx4 v1, s[44:47], s62 offen offset:1024 sc1 lds
v_smfmac_f32_16x16x64_bf16 v[28:31], v[72:75], v[144:151], v4
ds_read_b128 v[96:99], v9 offset:5120
s_waitcnt lgkmcnt(4)
v_smfmac_f32_16x16x64_bf16 v[28:31], v[76:79], v[152:159], v4
ds_read_b128 v[100:103], v9 offset:2048
v_smfmac_f32_16x16x64_bf16 v[28:31], v[80:83], v[160:167], v4
ds_read_b128 v[104:107], v9 offset:6144
s_add_u32 s62, s62, 786432
v_smfmac_f32_16x16x64_bf16 v[32:35], v[60:63], v[168:175], v4
ds_read_b128 v[108:111], v9 offset:3072
s_mov_b32 m0, s76
v_smfmac_f32_16x16x64_bf16 v[32:35], v[64:67], v[176:183], v4
ds_read_b128 v[112:115], v9 offset:7168
v_add_f32 v28, v28, v30
v_smfmac_f32_16x16x64_bf16 v[32:35], v[68:71], v[184:191], v4
s_add_u32 s65, s65, 4096
s_add_u32 s64, s64, 131072
v_add_f32 v29, v29, v31
v_smfmac_f32_16x16x64_bf16 v[32:35], v[72:75], v[192:199], v4
v_cvt_pk_bf16_f32 v28, v28, v29
v_smfmac_f32_16x16x64_bf16 v[32:35], v[76:79], v[200:207], v4
ds_write2_b32 v5, v28, v28 offset0:0 offset1:1
v_smfmac_f32_16x16x64_bf16 v[32:35], v[80:83], v[208:215], v4
v_smfmac_f32_16x16x64_bf16 v[48:51], v[56:59], a[200:207], v4
v_smfmac_f32_16x16x64_bf16 v[36:39], v[60:63], a[16:23], v4
v_add_f32 v32, v32, v34
v_add_f32 v33, v33, v35
v_smfmac_f32_16x16x64_bf16 v[36:39], v[64:67], a[24:31], v4
v_cvt_pk_bf16_f32 v29, v32, v33
v_smfmac_f32_16x16x64_bf16 v[36:39], v[68:71], a[32:39], v4
ds_write2_b32 v5, v29, v29 offset0:128 offset1:129
v_smfmac_f32_16x16x64_bf16 v[36:39], v[72:75], a[40:47], v4
v_smfmac_f32_16x16x64_bf16 v[36:39], v[76:79], a[48:55], v4
v_smfmac_f32_16x16x64_bf16 v[36:39], v[80:83], a[56:63], v4
v_smfmac_f32_16x16x64_bf16 v[40:43], v[60:63], a[80:87], v4
s_waitcnt lgkmcnt(0)
s_barrier
v_smfmac_f32_16x16x64_bf16 v[40:43], v[64:67], a[88:95], v4
ds_read_b64_tr_b16 v[116:117], v8 offset:4096
ds_read_b64_tr_b16 v[118:119], v8 offset:4608
v_smfmac_f32_16x16x64_bf16 v[40:43], v[68:71], a[96:103], v4
ds_read_b64_tr_b16 v[120:121], v8 offset:5120
ds_read_b64_tr_b16 v[122:123], v8 offset:5632
v_smfmac_f32_16x16x64_bf16 v[40:43], v[72:75], a[104:111], v4
ds_read_b64_tr_b16 v[52:53], v8 offset:6144
v_add_f32 v36, v36, v38
v_smfmac_f32_16x16x64_bf16 v[40:43], v[76:79], a[112:119], v4
ds_read_b64_tr_b16 v[54:55], v8 offset:6656
v_add_f32 v37, v37, v39
v_smfmac_f32_16x16x64_bf16 v[40:43], v[80:83], a[120:127], v4
ds_read_b64_tr_b16 v[56:57], v8 offset:7168
s_waitcnt lgkmcnt(5)
v_mfma_f32_16x16x32_bf16 v[28:31], v[84:87], v[116:119], 0
ds_read_b64_tr_b16 v[58:59], v8 offset:7680
v_cvt_pk_bf16_f32 v125, v36, v37
v_mfma_f32_16x16x32_bf16 v[32:35], v[88:91], v[116:119], 0
s_waitcnt lgkmcnt(4)
v_add_f32 v40, v40, v42
v_add_f32 v41, v41, v43
v_mfma_f32_16x16x32_bf16 v[28:31], v[92:95], v[120:123], v[28:31]
ds_write_b32 v6, v125 offset:0
v_cvt_pk_bf16_f32 v127, v40, v41
v_mfma_f32_16x16x32_bf16 v[32:35], v[96:99], v[120:123], v[32:35]
ds_write_b32 v6, v127 offset:512
s_waitcnt lgkmcnt(4)
v_mfma_f32_16x16x32_bf16 v[28:31], v[100:103], v[52:55], v[28:31]
buffer_load_dwordx4 v1, s[44:47], s63 offen offset:0 sc1 lds
v_mfma_f32_16x16x32_bf16 v[32:35], v[104:107], v[52:55], v[32:35]
s_waitcnt lgkmcnt(2)
buffer_load_dword v0, off, s[44:47], s66 offset:4 sc1
v_mfma_f32_16x16x32_bf16 v[28:31], v[108:111], v[56:59], v[28:31]
buffer_load_dwordx4 v1, s[44:47], s63 offen offset:1024 sc1 lds
v_mfma_f32_16x16x32_bf16 v[32:35], v[112:115], v[56:59], v[32:35]
s_add_u32 s63, s63, 786432
s_add_u32 s66, s66, s68
s_waitcnt lgkmcnt(0)
s_barrier
v_smfmac_f32_16x16x64_bf16 v[44:47], v[60:63], a[144:151], v4
ds_read_b64_tr_b16 v[84:85], v8 offset:0
ds_read_b64_tr_b16 v[86:87], v8 offset:512
v_smfmac_f32_16x16x64_bf16 v[44:47], v[64:67], a[152:159], v4
ds_read_b64_tr_b16 v[88:89], v8 offset:1024
ds_read_b64_tr_b16 v[90:91], v8 offset:1536
v_smfmac_f32_16x16x64_bf16 v[44:47], v[68:71], a[160:167], v4
ds_read_b64_tr_b16 v[92:93], v8 offset:2048
ds_read_b64_tr_b16 v[94:95], v8 offset:2560
v_smfmac_f32_16x16x64_bf16 v[44:47], v[72:75], a[168:175], v4
ds_read_b64_tr_b16 v[96:97], v8 offset:3072
v_cndmask_b32 v28, v28, v32, s[78:79]
v_smfmac_f32_16x16x64_bf16 v[44:47], v[76:79], a[176:183], v4
ds_read_b64_tr_b16 v[98:99], v8 offset:3584
v_cndmask_b32 v29, v29, v33, s[78:79]
v_smfmac_f32_16x16x64_bf16 v[44:47], v[80:83], a[184:191], v4
s_waitcnt lgkmcnt(4)
v_cndmask_b32 v30, v30, v34, s[78:79]
v_mfma_f32_16x16x32_bf16 v[36:39], v[84:87], v[116:119], 0
ds_read_b128 v[100:103], v2 offset:0
v_cndmask_b32 v31, v31, v35, s[78:79]
v_mfma_f32_16x16x32_bf16 v[36:39], v[88:91], v[120:123], v[36:39]
s_waitcnt lgkmcnt(1)
v_max3_f32 v42, v28, v29, v30
v_max_f32 v42, v42, v31
v_mfma_f32_16x16x32_bf16 v[36:39], v[92:95], v[52:55], v[36:39]
ds_read_b128 v[104:107], v2 offset:1024
v_add_f32 v44, v44, v46
v_mfma_f32_16x16x32_bf16 v[36:39], v[96:99], v[56:59], v[36:39]
v_max_f32_dpp v42, v42, v42 quad_perm:[2,3,0,1] row_mask:0xf bank_mask:0xf
v_add_f32 v45, v45, v47
v_smfmac_f32_16x16x64_bf16 v[48:51], v[60:63], a[208:215], v4
ds_read_b128 v[108:111], v2 offset:2048
v_cvt_pk_bf16_f32 v124, v44, v45
s_nop 0
v_max3_f32 v42, v42, v36, v37
v_mov_b32 v43, v42
v_smfmac_f32_16x16x64_bf16 v[48:51], v[64:67], a[216:223], v4
ds_read_b128 v[112:115], v2 offset:3072
v_permlane16_swap_b32 v42, v43
v_max_f32 v42, v42, v43
v_mov_b32 v43, v42
v_smfmac_f32_16x16x64_bf16 v[48:51], v[68:71], a[224:231], v4
ds_read_b128 v[84:87], v2 offset:4096
v_permlane32_swap_b32 v42, v43
v_max_f32 v42, v42, v43
v_mul_f32 v42, s71, v42
v_fmamk_f32 v28, v28, 0x3e0293ee, v42
v_fmamk_f32 v29, v29, 0x3e0293ee, v42
v_smfmac_f32_16x16x64_bf16 v[48:51], v[72:75], a[232:239], v4
ds_read_b128 v[88:91], v2 offset:5120
v_exp_f32 v28, v28
v_exp_f32 v29, v29
v_fmamk_f32 v30, v30, 0x3e0293ee, v42
v_fmamk_f32 v31, v31, 0x3e0293ee, v42
v_smfmac_f32_16x16x64_bf16 v[48:51], v[76:79], a[240:247], v4
ds_read_b128 v[92:95], v2 offset:6144
v_exp_f32 v30, v30
v_exp_f32 v31, v31
v_cvt_pk_bf16_f32 v32, v28, v29
v_cvt_pk_bf16_f32 v33, v30, v31
v_smfmac_f32_16x16x64_bf16 v[48:51], v[80:83], a[248:255], v4
ds_read_b128 v[96:99], v2 offset:7168
v_mov_b32_dpp v34, v32 quad_perm:[2,3,0,1] row_mask:0xf bank_mask:0xf
v_mov_b32_dpp v35, v33 quad_perm:[2,3,0,1] row_mask:0xf bank_mask:0xf
v_cndmask_b32 v36, v36, v37, s[78:79]
v_fmamk_f32 v36, v36, 0x3e0293ee, v42
v_mfma_f32_16x16x32_bf16 v[28:31], v[20:23], v[32:35], 0
ds_read_b128 v[116:119], v2 offset:8192
v_exp_f32 v36, v36
v_mfma_f32_16x16x32_bf16 v[40:43], v[16:19], v[32:35], 0
ds_read_b128 v[120:123], v2 offset:9216
v_mov_b32_dpp v37, v36 quad_perm:[2,3,0,1] row_mask:0xf bank_mask:0xf
v_cvt_pk_bf16_f32 v38, v36, v37
v_mfma_f32_16x16x32_bf16 v[20:23], v[24:27], v[32:35], 0
v_add_f32 v48, v48, v50
v_add_f32 v49, v49, v51
v_mfma_f32_16x16x16_bf16 v[40:43], v[16:17], v[38:39], v[40:43]
ds_read_b128 v[52:55], v2 offset:16384
v_cvt_pk_bf16_f32 v126, v48, v49
v_mfma_f32_16x16x16_bf16 v[28:31], v[124:125], v[38:39], v[28:31]
ds_read_b128 v[56:59], v2 offset:17408
v_mfma_f32_16x16x16_bf16 v[20:23], v[126:127], v[38:39], v[20:23]
v_rcp_f32 v42, v42
v_mfma_i32_16x16x4_4b_i8 v[60:75], v39, v4, 0
s_nop 0
v_mul_f32_dpp v28, v28, v42 quad_perm:[0,1,0,1] row_mask:0xf bank_mask:0xf
v_mul_f32_dpp v29, v29, v42 quad_perm:[0,1,0,1] row_mask:0xf bank_mask:0xf
v_mul_f32_dpp v30, v30, v42 quad_perm:[0,1,0,1] row_mask:0xf bank_mask:0xf
v_mul_f32_dpp v31, v31, v42 quad_perm:[0,1,0,1] row_mask:0xf bank_mask:0xf
v_cvt_pk_bf16_f32 v36, v28, v29
v_cvt_pk_bf16_f32 v37, v30, v31
v_mul_f32_dpp v20, v20, v42 quad_perm:[0,1,0,1] row_mask:0xf bank_mask:0xf
v_mul_f32_dpp v21, v21, v42 quad_perm:[0,1,0,1] row_mask:0xf bank_mask:0xf
v_mul_f32_dpp v22, v22, v42 quad_perm:[0,1,0,1] row_mask:0xf bank_mask:0xf
v_mul_f32_dpp v23, v23, v42 quad_perm:[0,1,0,1] row_mask:0xf bank_mask:0xf
v_cvt_pk_bf16_f32 v38, v20, v21
v_cvt_pk_bf16_f32 v39, v22, v23
ds_write_b128 v11, v[36:39]
s_waitcnt vmcnt(7)
s_waitcnt lgkmcnt(5)
v_smfmac_f32_16x16x64_bf16 v[60:63], v[36:39], v[100:107], v4
v_smfmac_f32_16x16x64_bf16 v[64:67], v[36:39], v[108:115], v4
v_smfmac_f32_16x16x64_bf16 v[68:71], v[36:39], v[84:91], v4
s_waitcnt lgkmcnt(0)
s_barrier
ds_read_b128 v[40:43], v10 offset:528
ds_read_b128 v[44:47], v10 offset:1056
ds_read_b128 v[48:51], v10 offset:1584
v_smfmac_f32_16x16x64_bf16 v[72:75], v[36:39], v[92:99], v4
ds_read_b128 v[20:23], v2 offset:18432
ds_read_b128 v[24:27], v2 offset:19456
s_waitcnt lgkmcnt(4)
v_smfmac_f32_16x16x64_bf16 v[60:63], v[40:43], v[116:123], v4
ds_read_b128 v[28:31], v2 offset:24576
s_waitcnt lgkmcnt(4)
v_smfmac_f32_16x16x64_bf16 v[60:63], v[44:47], v[52:59], v4
ds_read_b128 v[32:35], v2 offset:25600
s_waitcnt lgkmcnt(4)
v_smfmac_f32_16x16x64_bf16 v[60:63], v[48:51], v[216:223], v4
ds_read_b128 v[76:79], v2 offset:10240
v_smfmac_f32_16x16x64_bf16 v[64:67], v[40:43], v[224:231], v4
ds_read_b128 v[80:83], v2 offset:11264
v_smfmac_f32_16x16x64_bf16 v[64:67], v[44:47], v[232:239], v4
ds_read_b128 v[100:103], v2 offset:20480
v_cvt_pk_bf16_f32 v60, v60, v61
v_cvt_pk_bf16_f32 v61, v62, v63
v_and_b32 v60, -2, v60
v_smfmac_f32_16x16x64_bf16 v[64:67], v[48:51], v[240:247], v4
ds_read_b128 v[104:107], v2 offset:21504
buffer_store_dwordx2 v[60:61], v12, s[44:47], s67 offen
v_smfmac_f32_16x16x64_bf16 v[68:71], v[40:43], v[248:255], v4
ds_read_b128 v[108:111], v2 offset:26624
s_waitcnt lgkmcnt(5)
v_smfmac_f32_16x16x64_bf16 v[68:71], v[44:47], v[20:27], v4
ds_read_b128 v[112:115], v2 offset:27648
v_cvt_pk_bf16_f32 v64, v64, v65
v_cvt_pk_bf16_f32 v65, v66, v67
v_and_b32 v64, -2, v64
v_smfmac_f32_16x16x64_bf16 v[68:71], v[48:51], v[28:35], v4
buffer_store_dwordx2 v[64:65], v12, s[44:47], s80 offen
s_waitcnt lgkmcnt(2)
v_smfmac_f32_16x16x64_bf16 v[72:75], v[40:43], v[76:83], v4
v_smfmac_f32_16x16x64_bf16 v[72:75], v[44:47], v[100:107], v4
s_waitcnt lgkmcnt(0)
v_cvt_pk_bf16_f32 v68, v68, v69
v_cvt_pk_bf16_f32 v69, v70, v71
v_and_b32 v68, -2, v68
v_smfmac_f32_16x16x64_bf16 v[72:75], v[48:51], v[108:115], v4
buffer_store_dwordx2 v[68:69], v12, s[44:47], s81 offen
s_nop 6
v_cvt_pk_bf16_f32 v72, v72, v73
v_cvt_pk_bf16_f32 v73, v74, v75
v_and_b32 v72, -2, v72
buffer_store_dwordx2 v[72:73], v12, s[44:47], s82 offen
ds_read_b128 v[84:87], v2 offset:12288
ds_read_b128 v[88:91], v2 offset:13312
ds_read_b128 v[92:95], v2 offset:14336
ds_read_b128 v[96:99], v2 offset:15360
ds_read_b128 v[100:103], v2 offset:22528
ds_read_b128 v[104:107], v2 offset:23552
ds_read_b128 v[108:111], v2 offset:28672
ds_read_b128 v[112:115], v2 offset:29696
ds_read_b128 v[116:119], v2 offset:30720
ds_read_b128 v[120:123], v2 offset:31744
v_xor_b32 v66, 2048, v3
v_xor_b32 v74, 4096, v3
v_xor_b32 v82, 6144, v3
s_waitcnt vmcnt(4)
ds_read_b128 v[20:23], v3 offset:0
ds_read_b128 v[24:27], v3 offset:1024
s_waitcnt vmcnt(0)
buffer_load_dwordx4 v[52:55], v13, s[44:47], s69 offen sc1
buffer_load_dwordx4 v[56:59], v13, s[44:47], s70 offen sc1
v_cmp_eq_u32 vcc, 0, v0
s_cbranch_vccnz L_c_fs_42
L_c_fb_43:
s_waitcnt vmcnt(1)
v_mfma_f32_16x16x32_bf16 v[60:63], v[16:19], v[52:55], 0
s_waitcnt vmcnt(0)
v_mfma_f32_16x16x32_bf16 v[60:63], v[16:19], v[56:59], v[60:63]
v_bitop3_b32 v64, v52, v54, v56 bitop3:0xfe
v_bitop3_b32 v64, v64, v58, 1 bitop3:0xa8
v_cmp_ne_u32 vcc, 0, v64
s_cbranch_vccnz L_c_rr_44
L_c_rb_45:
s_nop 3
v_add_f32_dpp v60, v60, v60 row_ror:4 row_mask:0xf bank_mask:0xf
v_add_f32_dpp v61, v61, v61 row_ror:4 row_mask:0xf bank_mask:0xf
s_nop 0
v_add_f32_dpp v60, v60, v60 row_ror:8 row_mask:0xf bank_mask:0xf
v_add_f32_dpp v61, v61, v61 row_ror:8 row_mask:0xf bank_mask:0xf
v_cvt_pk_bf16_f32 v60, v60, v61
v_min_u32 v60, -2, v60
buffer_store_dword v60, v14, s[44:47], s74 offen
s_waitcnt vmcnt(0)
buffer_load_dwordx4 v[52:55], v1, s[44:47], s72 offen offset:0 sc1
buffer_load_dwordx4 v[56:59], v1, s[44:47], s72 offen offset:1024 sc1
buffer_store_dword v15, v14, s[44:47], s75 offen
v_pk_mov_b32 v[28:29], 0, 0
v_pk_mov_b32 v[30:31], 0, 0
v_pk_mov_b32 v[32:33], 0, 0
v_pk_mov_b32 v[34:35], 0, 0
v_pk_mov_b32 v[36:37], 0, 0
v_pk_mov_b32 v[38:39], 0, 0
v_pk_mov_b32 v[40:41], 0, 0
v_pk_mov_b32 v[42:43], 0, 0
v_pk_mov_b32 v[44:45], 0, 0
v_pk_mov_b32 v[46:47], 0, 0
v_pk_mov_b32 v[48:49], 0, 0
v_pk_mov_b32 v[50:51], 0, 0
s_branch L_c_top_p
L_c_gr_34:
L_c_gl_46:
s_mov_b64 exec, vcc
buffer_load_dwordx4 v[52:55], v1, s[44:47], s72 offen offset:0 sc1
buffer_load_dwordx4 v[56:59], v1, s[44:47], s72 offen offset:1024 sc1
s_mov_b64 exec, -1
s_add_u32 s54, s54, 1
s_cmp_gt_u32 s54, 400000
s_cbranch_scc1 L_end
s_waitcnt vmcnt(1) lgkmcnt(0)
ds_write_b128 v3, v[52:55] offset:8192
s_waitcnt vmcnt(0)
v_max3_u32 v64, v52, v53, v54
v_max3_u32 v65, v55, v56, v57
v_max3_u32 v64, v64, v58, v59
v_max_u32 v64, v64, v65
v_cmp_eq_u32 vcc, -1, v64
ds_write_b128 v3, v[56:59] offset:9216
s_cbranch_vccnz L_c_gl_46
s_branch L_c_gb_35
L_c_fs_36:
s_sub_u32 s56, s66, s68
L_wf_47:
s_add_u32 s54, s54, 1
s_cmp_gt_u32 s54, 400000
s_cbranch_scc1 L_end
buffer_load_dword v0, off, s[44:47], s56 offset:4 sc1
s_waitcnt vmcnt(0)
v_cmp_eq_u32 vcc, 0, v0
s_cbranch_vccnz L_wf_47
s_branch L_c_fb_37
L_c_rr_38:
L_c_rl_48:
s_mov_b64 exec, vcc
buffer_load_dwordx4 v[52:55], v13, s[44:47], s69 offen sc1
buffer_load_dwordx4 v[56:59], v13, s[44:47], s70 offen sc1
s_mov_b64 exec, -1
s_add_u32 s54, s54, 1
s_cmp_gt_u32 s54, 400000
s_cbranch_scc1 L_end
s_waitcnt vmcnt(1)
v_mfma_f32_16x16x32_bf16 v[60:63], v[16:19], v[52:55], 0
s_waitcnt vmcnt(0)
v_mfma_f32_16x16x32_bf16 v[60:63], v[16:19], v[56:59], v[60:63]
v_bitop3_b32 v64, v52, v54, v56 bitop3:0x80
v_bitop3_b32 v64, v64, v58, 1 bitop3:0x80
v_cmp_eq_u32 vcc, 0, v64
s_cbranch_vccnz L_c_rl_48
s_branch L_c_rb_39
L_c_gr_40:
L_c_gl_49:
s_mov_b64 exec, vcc
buffer_load_dwordx4 v[52:55], v1, s[44:47], s73 offen offset:0 sc1
buffer_load_dwordx4 v[56:59], v1, s[44:47], s73 offen offset:1024 sc1
s_mov_b64 exec, -1
s_add_u32 s54, s54, 1
s_cmp_gt_u32 s54, 400000
s_cbranch_scc1 L_end
s_waitcnt vmcnt(1) lgkmcnt(0)
ds_write_b128 v3, v[52:55] offset:8192
s_waitcnt vmcnt(0)
v_max3_u32 v64, v52, v53, v54
v_max3_u32 v65, v55, v56, v57
v_max3_u32 v64, v64, v58, v59
v_max_u32 v64, v64, v65
v_cmp_eq_u32 vcc, -1, v64
ds_write_b128 v3, v[56:59] offset:9216
s_cbranch_vccnz L_c_gl_49
s_branch L_c_gb_41
L_c_fs_42:
s_sub_u32 s56, s66, s68
L_wf_50:
s_add_u32 s54, s54, 1
s_cmp_gt_u32 s54, 400000
s_cbranch_scc1 L_end
buffer_load_dword v0, off, s[44:47], s56 offset:4 sc1
s_waitcnt vmcnt(0)
v_cmp_eq_u32 vcc, 0, v0
s_cbranch_vccnz L_wf_50
s_branch L_c_fb_43
L_c_rr_44:
L_c_rl_51:
s_mov_b64 exec, vcc
buffer_load_dwordx4 v[52:55], v13, s[44:47], s69 offen sc1
buffer_load_dwordx4 v[56:59], v13, s[44:47], s70 offen sc1
s_mov_b64 exec, -1
s_add_u32 s54, s54, 1
s_cmp_gt_u32 s54, 400000
s_cbranch_scc1 L_end
s_waitcnt vmcnt(1)
v_mfma_f32_16x16x32_bf16 v[60:63], v[16:19], v[52:55], 0
s_waitcnt vmcnt(0)
v_mfma_f32_16x16x32_bf16 v[60:63], v[16:19], v[56:59], v[60:63]
v_bitop3_b32 v64, v52, v54, v56 bitop3:0xfe
v_bitop3_b32 v64, v64, v58, 1 bitop3:0xa8
v_cmp_ne_u32 vcc, 0, v64
s_cbranch_vccnz L_c_rl_51
s_branch L_c_rb_45
L_c_top_i:
s_waitcnt vmcnt(2) lgkmcnt(0)
ds_write_b128 v3, v[52:55] offset:8192
s_waitcnt vmcnt(1)
v_max3_u32 v64, v52, v53, v54
v_max3_u32 v65, v55, v56, v57
v_max3_u32 v64, v64, v58, v59
v_max_u32 v64, v64, v65
v_cmp_eq_u32 vcc, -1, v64
ds_write_b128 v3, v[56:59] offset:9216
s_cbranch_vccnz L_c_gr_52
L_c_gb_53:
L_c_body_i:
v_smfmac_f32_16x16x64_bf16 v[28:31], v[52:55], v[84:91], v4
s_mov_b32 m0, s77
v_smfmac_f32_16x16x64_bf16 v[32:35], v[52:55], v[92:99], v4
s_add_u32 s61, s61, 1
v_smfmac_f32_16x16x64_bf16 v[28:31], v[56:59], v[100:107], v4
s_cmp_lt_u32 s61, 62
v_smfmac_f32_16x16x64_bf16 v[32:35], v[56:59], v[108:115], v4
s_cselect_b32 s68, 4096, 0
s_waitcnt lgkmcnt(0)
s_barrier
v_smfmac_f32_16x16x64_bf16 v[36:39], v[52:55], a[0:7], v4
ds_read_b128 v[60:63], v66 offset:8192
buffer_store_dwordx4 v[124:127], v1, s[44:47], s64 offen sc1
v_smfmac_f32_16x16x64_bf16 v[40:43], v[52:55], a[64:71], v4
ds_read_b128 v[64:67], v66 offset:9216
v_smfmac_f32_16x16x64_bf16 v[36:39], v[56:59], a[8:15], v4
ds_read_b128 v[68:71], v74 offset:8192
buffer_store_dword v15, v14, s[44:47], s65 offen sc1
v_smfmac_f32_16x16x64_bf16 v[40:43], v[56:59], a[72:79], v4
ds_read_b128 v[72:75], v74 offset:9216
v_smfmac_f32_16x16x64_bf16 v[44:47], v[52:55], a[128:135], v4
ds_read_b128 v[76:79], v82 offset:8192
buffer_load_dwordx4 v1, s[44:47], s62 offen offset:0 sc1 lds
v_smfmac_f32_16x16x64_bf16 v[48:51], v[52:55], a[192:199], v4
ds_read_b128 v[80:83], v82 offset:9216
v_smfmac_f32_16x16x64_bf16 v[44:47], v[56:59], a[136:143], v4
s_waitcnt lgkmcnt(4)
v_smfmac_f32_16x16x64_bf16 v[28:31], v[60:63], v[116:123], v4
ds_read_b128 v[84:87], v9 offset:0
v_smfmac_f32_16x16x64_bf16 v[28:31], v[64:67], v[128:135], v4
ds_read_b128 v[88:91], v9 offset:4096
s_waitcnt lgkmcnt(4)
v_smfmac_f32_16x16x64_bf16 v[28:31], v[68:71], v[136:143], v4
ds_read_b128 v[92:95], v9 offset:1024
buffer_load_dwordx4 v1, s[44:47], s62 offen offset:1024 sc1 lds
v_smfmac_f32_16x16x64_bf16 v[28:31], v[72:75], v[144:151], v4
ds_read_b128 v[96:99], v9 offset:5120
s_waitcnt lgkmcnt(4)
v_smfmac_f32_16x16x64_bf16 v[28:31], v[76:79], v[152:159], v4
ds_read_b128 v[100:103], v9 offset:2048
v_smfmac_f32_16x16x64_bf16 v[28:31], v[80:83], v[160:167], v4
ds_read_b128 v[104:107], v9 offset:6144
s_add_u32 s62, s62, 786432
v_smfmac_f32_16x16x64_bf16 v[32:35], v[60:63], v[168:175], v4
ds_read_b128 v[108:111], v9 offset:3072
s_mov_b32 m0, s76
v_smfmac_f32_16x16x64_bf16 v[32:35], v[64:67], v[176:183], v4
ds_read_b128 v[112:115], v9 offset:7168
v_add_f32 v28, v28, v30
v_smfmac_f32_16x16x64_bf16 v[32:35], v[68:71], v[184:191], v4
s_add_u32 s65, s65, 4096
s_add_u32 s64, s64, 131072
v_add_f32 v29, v29, v31
v_smfmac_f32_16x16x64_bf16 v[32:35], v[72:75], v[192:199], v4
v_cvt_pk_bf16_f32 v28, v28, v29
v_smfmac_f32_16x16x64_bf16 v[32:35], v[76:79], v[200:207], v4
ds_write2_b32 v5, v28, v28 offset0:0 offset1:1
v_smfmac_f32_16x16x64_bf16 v[32:35], v[80:83], v[208:215], v4
v_smfmac_f32_16x16x64_bf16 v[48:51], v[56:59], a[200:207], v4
v_smfmac_f32_16x16x64_bf16 v[36:39], v[60:63], a[16:23], v4
v_add_f32 v32, v32, v34
v_add_f32 v33, v33, v35
v_smfmac_f32_16x16x64_bf16 v[36:39], v[64:67], a[24:31], v4
v_cvt_pk_bf16_f32 v29, v32, v33
v_smfmac_f32_16x16x64_bf16 v[36:39], v[68:71], a[32:39], v4
ds_write2_b32 v5, v29, v29 offset0:128 offset1:129
v_smfmac_f32_16x16x64_bf16 v[36:39], v[72:75], a[40:47], v4
v_smfmac_f32_16x16x64_bf16 v[36:39], v[76:79], a[48:55], v4
v_smfmac_f32_16x16x64_bf16 v[36:39], v[80:83], a[56:63], v4
v_smfmac_f32_16x16x64_bf16 v[40:43], v[60:63], a[80:87], v4
s_waitcnt lgkmcnt(0)
s_barrier
v_smfmac_f32_16x16x64_bf16 v[40:43], v[64:67], a[88:95], v4
ds_read_b64_tr_b16 v[116:117], v8 offset:4096
ds_read_b64_tr_b16 v[118:119], v8 offset:4608
v_smfmac_f32_16x16x64_bf16 v[40:43], v[68:71], a[96:103], v4
ds_read_b64_tr_b16 v[120:121], v8 offset:5120
ds_read_b64_tr_b16 v[122:123], v8 offset:5632
v_smfmac_f32_16x16x64_bf16 v[40:43], v[72:75], a[104:111], v4
ds_read_b64_tr_b16 v[52:53], v8 offset:6144
v_add_f32 v36, v36, v38
v_smfmac_f32_16x16x64_bf16 v[40:43], v[76:79], a[112:119], v4
ds_read_b64_tr_b16 v[54:55], v8 offset:6656
v_add_f32 v37, v37, v39
v_smfmac_f32_16x16x64_bf16 v[40:43], v[80:83], a[120:127], v4
ds_read_b64_tr_b16 v[56:57], v8 offset:7168
s_waitcnt lgkmcnt(5)
v_mfma_f32_16x16x32_bf16 v[28:31], v[84:87], v[116:119], 0
ds_read_b64_tr_b16 v[58:59], v8 offset:7680
v_cvt_pk_bf16_f32 v125, v36, v37
v_mfma_f32_16x16x32_bf16 v[32:35], v[88:91], v[116:119], 0
s_waitcnt lgkmcnt(4)
v_add_f32 v40, v40, v42
v_add_f32 v41, v41, v43
v_mfma_f32_16x16x32_bf16 v[28:31], v[92:95], v[120:123], v[28:31]
ds_write_b32 v6, v125 offset:0
v_cvt_pk_bf16_f32 v127, v40, v41
v_mfma_f32_16x16x32_bf16 v[32:35], v[96:99], v[120:123], v[32:35]
ds_write_b32 v6, v127 offset:512
s_waitcnt lgkmcnt(4)
v_mfma_f32_16x16x32_bf16 v[28:31], v[100:103], v[52:55], v[28:31]
buffer_load_dwordx4 v1, s[44:47], s63 offen offset:0 sc1 lds
v_mfma_f32_16x16x32_bf16 v[32:35], v[104:107], v[52:55], v[32:35]
s_waitcnt lgkmcnt(2)
buffer_load_dword v0, off, s[44:47], s66 offset:4 sc1
v_mfma_f32_16x16x32_bf16 v[28:31], v[108:111], v[56:59], v[28:31]
buffer_load_dwordx4 v1, s[44:47], s63 offen offset:1024 sc1 lds
v_mfma_f32_16x16x32_bf16 v[32:35], v[112:115], v[56:59], v[32:35]
s_add_u32 s63, s63, 786432
s_add_u32 s66, s66, s68
s_waitcnt lgkmcnt(0)
s_barrier
v_smfmac_f32_16x16x64_bf16 v[44:47], v[60:63], a[144:151], v4
ds_read_b64_tr_b16 v[84:85], v8 offset:0
ds_read_b64_tr_b16 v[86:87], v8 offset:512
v_smfmac_f32_16x16x64_bf16 v[44:47], v[64:67], a[152:159], v4
ds_read_b64_tr_b16 v[88:89], v8 offset:1024
ds_read_b64_tr_b16 v[90:91], v8 offset:1536
v_smfmac_f32_16x16x64_bf16 v[44:47], v[68:71], a[160:167], v4
ds_read_b64_tr_b16 v[92:93], v8 offset:2048
ds_read_b64_tr_b16 v[94:95], v8 offset:2560
v_smfmac_f32_16x16x64_bf16 v[44:47], v[72:75], a[168:175], v4
ds_read_b64_tr_b16 v[96:97], v8 offset:3072
v_cndmask_b32 v28, v28, v32, s[78:79]
v_smfmac_f32_16x16x64_bf16 v[44:47], v[76:79], a[176:183], v4
ds_read_b64_tr_b16 v[98:99], v8 offset:3584
v_cndmask_b32 v29, v29, v33, s[78:79]
v_smfmac_f32_16x16x64_bf16 v[44:47], v[80:83], a[184:191], v4
s_waitcnt lgkmcnt(4)
v_cndmask_b32 v30, v30, v34, s[78:79]
v_mfma_f32_16x16x32_bf16 v[36:39], v[84:87], v[116:119], 0
ds_read_b128 v[100:103], v2 offset:0
v_cndmask_b32 v31, v31, v35, s[78:79]
v_mfma_f32_16x16x32_bf16 v[36:39], v[88:91], v[120:123], v[36:39]
s_waitcnt lgkmcnt(1)
v_max3_f32 v42, v28, v29, v30
v_max_f32 v42, v42, v31
v_mfma_f32_16x16x32_bf16 v[36:39], v[92:95], v[52:55], v[36:39]
ds_read_b128 v[104:107], v2 offset:1024
v_add_f32 v44, v44, v46
v_mfma_f32_16x16x32_bf16 v[36:39], v[96:99], v[56:59], v[36:39]
v_max_f32_dpp v42, v42, v42 quad_perm:[2,3,0,1] row_mask:0xf bank_mask:0xf
v_add_f32 v45, v45, v47
v_smfmac_f32_16x16x64_bf16 v[48:51], v[60:63], a[208:215], v4
ds_read_b128 v[108:111], v2 offset:2048
v_cvt_pk_bf16_f32 v124, v44, v45
s_nop 0
v_max3_f32 v42, v42, v36, v37
v_mov_b32 v43, v42
v_smfmac_f32_16x16x64_bf16 v[48:51], v[64:67], a[216:223], v4
ds_read_b128 v[112:115], v2 offset:3072
v_permlane16_swap_b32 v42, v43
v_max_f32 v42, v42, v43
v_mov_b32 v43, v42
v_smfmac_f32_16x16x64_bf16 v[48:51], v[68:71], a[224:231], v4
ds_read_b128 v[84:87], v2 offset:4096
v_permlane32_swap_b32 v42, v43
v_max_f32 v42, v42, v43
v_mul_f32 v42, s71, v42
v_fmamk_f32 v28, v28, 0x3e0293ee, v42
v_fmamk_f32 v29, v29, 0x3e0293ee, v42
v_smfmac_f32_16x16x64_bf16 v[48:51], v[72:75], a[232:239], v4
ds_read_b128 v[88:91], v2 offset:5120
v_exp_f32 v28, v28
v_exp_f32 v29, v29
v_fmamk_f32 v30, v30, 0x3e0293ee, v42
v_fmamk_f32 v31, v31, 0x3e0293ee, v42
v_smfmac_f32_16x16x64_bf16 v[48:51], v[76:79], a[240:247], v4
ds_read_b128 v[92:95], v2 offset:6144
v_exp_f32 v30, v30
v_exp_f32 v31, v31
v_cvt_pk_bf16_f32 v32, v28, v29
v_cvt_pk_bf16_f32 v33, v30, v31
v_smfmac_f32_16x16x64_bf16 v[48:51], v[80:83], a[248:255], v4
ds_read_b128 v[96:99], v2 offset:7168
v_mov_b32_dpp v34, v32 quad_perm:[2,3,0,1] row_mask:0xf bank_mask:0xf
v_mov_b32_dpp v35, v33 quad_perm:[2,3,0,1] row_mask:0xf bank_mask:0xf
v_cndmask_b32 v36, v36, v37, s[78:79]
v_fmamk_f32 v36, v36, 0x3e0293ee, v42
v_mfma_f32_16x16x32_bf16 v[28:31], v[20:23], v[32:35], 0
ds_read_b128 v[116:119], v2 offset:8192
v_exp_f32 v36, v36
v_mfma_f32_16x16x32_bf16 v[40:43], v[16:19], v[32:35], 0
ds_read_b128 v[120:123], v2 offset:9216
v_mov_b32_dpp v37, v36 quad_perm:[2,3,0,1] row_mask:0xf bank_mask:0xf
v_cvt_pk_bf16_f32 v38, v36, v37
v_mfma_f32_16x16x32_bf16 v[20:23], v[24:27], v[32:35], 0
v_add_f32 v48, v48, v50
v_add_f32 v49, v49, v51
v_mfma_f32_16x16x16_bf16 v[40:43], v[16:17], v[38:39], v[40:43]
ds_read_b128 v[52:55], v2 offset:16384
v_cvt_pk_bf16_f32 v126, v48, v49
v_mfma_f32_16x16x16_bf16 v[28:31], v[124:125], v[38:39], v[28:31]
ds_read_b128 v[56:59], v2 offset:17408
v_mfma_f32_16x16x16_bf16 v[20:23], v[126:127], v[38:39], v[20:23]
v_rcp_f32 v42, v42
v_mfma_i32_16x16x4_4b_i8 v[60:75], v39, v4, 0
s_nop 0
v_mul_f32_dpp v28, v28, v42 quad_perm:[0,1,0,1] row_mask:0xf bank_mask:0xf
v_mul_f32_dpp v29, v29, v42 quad_perm:[0,1,0,1] row_mask:0xf bank_mask:0xf
v_mul_f32_dpp v30, v30, v42 quad_perm:[0,1,0,1] row_mask:0xf bank_mask:0xf
v_mul_f32_dpp v31, v31, v42 quad_perm:[0,1,0,1] row_mask:0xf bank_mask:0xf
v_cvt_pk_bf16_f32 v36, v28, v29
v_cvt_pk_bf16_f32 v37, v30, v31
v_mul_f32_dpp v20, v20, v42 quad_perm:[0,1,0,1] row_mask:0xf bank_mask:0xf
v_mul_f32_dpp v21, v21, v42 quad_perm:[0,1,0,1] row_mask:0xf bank_mask:0xf
v_mul_f32_dpp v22, v22, v42 quad_perm:[0,1,0,1] row_mask:0xf bank_mask:0xf
v_mul_f32_dpp v23, v23, v42 quad_perm:[0,1,0,1] row_mask:0xf bank_mask:0xf
v_cvt_pk_bf16_f32 v38, v20, v21
v_cvt_pk_bf16_f32 v39, v22, v23
ds_write_b128 v11, v[36:39]
s_waitcnt vmcnt(7)
s_waitcnt lgkmcnt(5)
v_smfmac_f32_16x16x64_bf16 v[60:63], v[36:39], v[100:107], v4
v_smfmac_f32_16x16x64_bf16 v[64:67], v[36:39], v[108:115], v4
v_smfmac_f32_16x16x64_bf16 v[68:71], v[36:39], v[84:91], v4
s_waitcnt lgkmcnt(0)
s_barrier
ds_read_b128 v[40:43], v10 offset:528
ds_read_b128 v[44:47], v10 offset:1056
ds_read_b128 v[48:51], v10 offset:1584
v_smfmac_f32_16x16x64_bf16 v[72:75], v[36:39], v[92:99], v4
ds_read_b128 v[20:23], v2 offset:18432
ds_read_b128 v[24:27], v2 offset:19456
s_waitcnt lgkmcnt(4)
v_smfmac_f32_16x16x64_bf16 v[60:63], v[40:43], v[116:123], v4
ds_read_b128 v[28:31], v2 offset:24576
s_waitcnt lgkmcnt(4)
v_smfmac_f32_16x16x64_bf16 v[60:63], v[44:47], v[52:59], v4
ds_read_b128 v[32:35], v2 offset:25600
s_waitcnt lgkmcnt(4)
v_smfmac_f32_16x16x64_bf16 v[60:63], v[48:51], v[216:223], v4
ds_read_b128 v[76:79], v2 offset:10240
v_smfmac_f32_16x16x64_bf16 v[64:67], v[40:43], v[224:231], v4
ds_read_b128 v[80:83], v2 offset:11264
v_smfmac_f32_16x16x64_bf16 v[64:67], v[44:47], v[232:239], v4
ds_read_b128 v[100:103], v2 offset:20480
v_cvt_pk_bf16_f32 v60, v60, v61
v_cvt_pk_bf16_f32 v61, v62, v63
v_or_b32 v60, 1, v60
v_smfmac_f32_16x16x64_bf16 v[64:67], v[48:51], v[240:247], v4
ds_read_b128 v[104:107], v2 offset:21504
buffer_store_dwordx2 v[60:61], v12, s[44:47], s67 offen sc1
v_smfmac_f32_16x16x64_bf16 v[68:71], v[40:43], v[248:255], v4
ds_read_b128 v[108:111], v2 offset:26624
s_waitcnt lgkmcnt(5)
v_smfmac_f32_16x16x64_bf16 v[68:71], v[44:47], v[20:27], v4
ds_read_b128 v[112:115], v2 offset:27648
v_cvt_pk_bf16_f32 v64, v64, v65
v_cvt_pk_bf16_f32 v65, v66, v67
v_or_b32 v64, 1, v64
v_smfmac_f32_16x16x64_bf16 v[68:71], v[48:51], v[28:35], v4
buffer_store_dwordx2 v[64:65], v12, s[44:47], s80 offen sc1
s_waitcnt lgkmcnt(2)
v_smfmac_f32_16x16x64_bf16 v[72:75], v[40:43], v[76:83], v4
v_smfmac_f32_16x16x64_bf16 v[72:75], v[44:47], v[100:107], v4
s_waitcnt lgkmcnt(0)
v_cvt_pk_bf16_f32 v68, v68, v69
v_cvt_pk_bf16_f32 v69, v70, v71
v_or_b32 v68, 1, v68
v_smfmac_f32_16x16x64_bf16 v[72:75], v[48:51], v[108:115], v4
buffer_store_dwordx2 v[68:69], v12, s[44:47], s81 offen sc1
s_nop 6
v_cvt_pk_bf16_f32 v72, v72, v73
v_cvt_pk_bf16_f32 v73, v74, v75
v_or_b32 v72, 1, v72
buffer_store_dwordx2 v[72:73], v12, s[44:47], s82 offen sc1
ds_read_b128 v[84:87], v2 offset:12288
ds_read_b128 v[88:91], v2 offset:13312
ds_read_b128 v[92:95], v2 offset:14336
ds_read_b128 v[96:99], v2 offset:15360
ds_read_b128 v[100:103], v2 offset:22528
ds_read_b128 v[104:107], v2 offset:23552
ds_read_b128 v[108:111], v2 offset:28672
ds_read_b128 v[112:115], v2 offset:29696
ds_read_b128 v[116:119], v2 offset:30720
ds_read_b128 v[120:123], v2 offset:31744
v_xor_b32 v66, 2048, v3
v_xor_b32 v74, 4096, v3
v_xor_b32 v82, 6144, v3
s_waitcnt vmcnt(4)
ds_read_b128 v[20:23], v3 offset:0
ds_read_b128 v[24:27], v3 offset:1024
s_waitcnt vmcnt(0)
buffer_load_dwordx4 v[52:55], v13, s[44:47], s69 offen sc1
buffer_load_dwordx4 v[56:59], v13, s[44:47], s70 offen sc1
v_cmp_eq_u32 vcc, 0, v0
s_cbranch_vccnz L_c_fs_54
L_c_fb_55:
s_waitcnt vmcnt(1)
v_mfma_f32_16x16x32_bf16 v[60:63], v[16:19], v[52:55], 0
s_waitcnt vmcnt(0)
v_mfma_f32_16x16x32_bf16 v[60:63], v[16:19], v[56:59], v[60:63]
v_bitop3_b32 v64, v52, v54, v56 bitop3:0x80
v_bitop3_b32 v64, v64, v58, 1 bitop3:0x80
v_cmp_eq_u32 vcc, 0, v64
s_cbranch_vccnz L_c_rr_56
L_c_rb_57:
s_nop 3
v_add_f32_dpp v60, v60, v60 row_ror:4 row_mask:0xf bank_mask:0xf
v_add_f32_dpp v61, v61, v61 row_ror:4 row_mask:0xf bank_mask:0xf
s_nop 0
v_add_f32_dpp v60, v60, v60 row_ror:8 row_mask:0xf bank_mask:0xf
v_add_f32_dpp v61, v61, v61 row_ror:8 row_mask:0xf bank_mask:0xf
v_cvt_pk_bf16_f32 v60, v60, v61
v_min_u32 v60, -2, v60
buffer_store_dword v60, v14, s[44:47], s75 offen sc1
s_waitcnt vmcnt(0)
buffer_load_dwordx4 v[52:55], v1, s[44:47], s73 offen offset:0 sc1
buffer_load_dwordx4 v[56:59], v1, s[44:47], s73 offen offset:1024 sc1
buffer_store_dword v15, v14, s[44:47], s74 offen sc1
v_pk_mov_b32 v[28:29], 0, 0
v_pk_mov_b32 v[30:31], 0, 0
v_pk_mov_b32 v[32:33], 0, 0
v_pk_mov_b32 v[34:35], 0, 0
v_pk_mov_b32 v[36:37], 0, 0
v_pk_mov_b32 v[38:39], 0, 0
v_pk_mov_b32 v[40:41], 0, 0
v_pk_mov_b32 v[42:43], 0, 0
v_pk_mov_b32 v[44:45], 0, 0
v_pk_mov_b32 v[46:47], 0, 0
v_pk_mov_b32 v[48:49], 0, 0
v_pk_mov_b32 v[50:51], 0, 0
s_cmp_eq_u32 s61, 63
s_cbranch_scc1 L_c_final
s_waitcnt vmcnt(2) lgkmcnt(0)
ds_write_b128 v3, v[52:55] offset:8192
s_waitcnt vmcnt(1)
v_max3_u32 v64, v52, v53, v54
v_max3_u32 v65, v55, v56, v57
v_max3_u32 v64, v64, v58, v59
v_max_u32 v64, v64, v65
v_cmp_eq_u32 vcc, -1, v64
ds_write_b128 v3, v[56:59] offset:9216
s_cbranch_vccnz L_c_gr_58
L_c_gb_59:
v_smfmac_f32_16x16x64_bf16 v[28:31], v[52:55], v[84:91], v4
s_mov_b32 m0, s77
v_smfmac_f32_16x16x64_bf16 v[32:35], v[52:55], v[92:99], v4
s_add_u32 s61, s61, 1
v_smfmac_f32_16x16x64_bf16 v[28:31], v[56:59], v[100:107], v4
s_cmp_lt_u32 s61, 62
v_smfmac_f32_16x16x64_bf16 v[32:35], v[56:59], v[108:115], v4
s_cselect_b32 s68, 4096, 0
s_waitcnt lgkmcnt(0)
s_barrier
v_smfmac_f32_16x16x64_bf16 v[36:39], v[52:55], a[0:7], v4
ds_read_b128 v[60:63], v66 offset:8192
buffer_store_dwordx4 v[124:127], v1, s[44:47], s64 offen sc1
v_smfmac_f32_16x16x64_bf16 v[40:43], v[52:55], a[64:71], v4
ds_read_b128 v[64:67], v66 offset:9216
v_smfmac_f32_16x16x64_bf16 v[36:39], v[56:59], a[8:15], v4
ds_read_b128 v[68:71], v74 offset:8192
buffer_store_dword v15, v14, s[44:47], s65 offen sc1
v_smfmac_f32_16x16x64_bf16 v[40:43], v[56:59], a[72:79], v4
ds_read_b128 v[72:75], v74 offset:9216
v_smfmac_f32_16x16x64_bf16 v[44:47], v[52:55], a[128:135], v4
ds_read_b128 v[76:79], v82 offset:8192
buffer_load_dwordx4 v1, s[44:47], s62 offen offset:0 sc1 lds
v_smfmac_f32_16x16x64_bf16 v[48:51], v[52:55], a[192:199], v4
ds_read_b128 v[80:83], v82 offset:9216
v_smfmac_f32_16x16x64_bf16 v[44:47], v[56:59], a[136:143], v4
s_waitcnt lgkmcnt(4)
v_smfmac_f32_16x16x64_bf16 v[28:31], v[60:63], v[116:123], v4
ds_read_b128 v[84:87], v9 offset:0
v_smfmac_f32_16x16x64_bf16 v[28:31], v[64:67], v[128:135], v4
ds_read_b128 v[88:91], v9 offset:4096
s_waitcnt lgkmcnt(4)
v_smfmac_f32_16x16x64_bf16 v[28:31], v[68:71], v[136:143], v4
ds_read_b128 v[92:95], v9 offset:1024
buffer_load_dwordx4 v1, s[44:47], s62 offen offset:1024 sc1 lds
v_smfmac_f32_16x16x64_bf16 v[28:31], v[72:75], v[144:151], v4
ds_read_b128 v[96:99], v9 offset:5120
s_waitcnt lgkmcnt(4)
v_smfmac_f32_16x16x64_bf16 v[28:31], v[76:79], v[152:159], v4
ds_read_b128 v[100:103], v9 offset:2048
v_smfmac_f32_16x16x64_bf16 v[28:31], v[80:83], v[160:167], v4
ds_read_b128 v[104:107], v9 offset:6144
s_add_u32 s62, s62, 786432
v_smfmac_f32_16x16x64_bf16 v[32:35], v[60:63], v[168:175], v4
ds_read_b128 v[108:111], v9 offset:3072
s_mov_b32 m0, s76
v_smfmac_f32_16x16x64_bf16 v[32:35], v[64:67], v[176:183], v4
ds_read_b128 v[112:115], v9 offset:7168
v_add_f32 v28, v28, v30
v_smfmac_f32_16x16x64_bf16 v[32:35], v[68:71], v[184:191], v4
s_add_u32 s65, s65, 4096
s_add_u32 s64, s64, 131072
v_add_f32 v29, v29, v31
v_smfmac_f32_16x16x64_bf16 v[32:35], v[72:75], v[192:199], v4
v_cvt_pk_bf16_f32 v28, v28, v29
v_smfmac_f32_16x16x64_bf16 v[32:35], v[76:79], v[200:207], v4
ds_write2_b32 v5, v28, v28 offset0:0 offset1:1
v_smfmac_f32_16x16x64_bf16 v[32:35], v[80:83], v[208:215], v4
v_smfmac_f32_16x16x64_bf16 v[48:51], v[56:59], a[200:207], v4
v_smfmac_f32_16x16x64_bf16 v[36:39], v[60:63], a[16:23], v4
v_add_f32 v32, v32, v34
v_add_f32 v33, v33, v35
v_smfmac_f32_16x16x64_bf16 v[36:39], v[64:67], a[24:31], v4
v_cvt_pk_bf16_f32 v29, v32, v33
v_smfmac_f32_16x16x64_bf16 v[36:39], v[68:71], a[32:39], v4
ds_write2_b32 v5, v29, v29 offset0:128 offset1:129
v_smfmac_f32_16x16x64_bf16 v[36:39], v[72:75], a[40:47], v4
v_smfmac_f32_16x16x64_bf16 v[36:39], v[76:79], a[48:55], v4
v_smfmac_f32_16x16x64_bf16 v[36:39], v[80:83], a[56:63], v4
v_smfmac_f32_16x16x64_bf16 v[40:43], v[60:63], a[80:87], v4
s_waitcnt lgkmcnt(0)
s_barrier
v_smfmac_f32_16x16x64_bf16 v[40:43], v[64:67], a[88:95], v4
ds_read_b64_tr_b16 v[116:117], v8 offset:4096
ds_read_b64_tr_b16 v[118:119], v8 offset:4608
v_smfmac_f32_16x16x64_bf16 v[40:43], v[68:71], a[96:103], v4
ds_read_b64_tr_b16 v[120:121], v8 offset:5120
ds_read_b64_tr_b16 v[122:123], v8 offset:5632
v_smfmac_f32_16x16x64_bf16 v[40:43], v[72:75], a[104:111], v4
ds_read_b64_tr_b16 v[52:53], v8 offset:6144
v_add_f32 v36, v36, v38
v_smfmac_f32_16x16x64_bf16 v[40:43], v[76:79], a[112:119], v4
ds_read_b64_tr_b16 v[54:55], v8 offset:6656
v_add_f32 v37, v37, v39
v_smfmac_f32_16x16x64_bf16 v[40:43], v[80:83], a[120:127], v4
ds_read_b64_tr_b16 v[56:57], v8 offset:7168
s_waitcnt lgkmcnt(5)
v_mfma_f32_16x16x32_bf16 v[28:31], v[84:87], v[116:119], 0
ds_read_b64_tr_b16 v[58:59], v8 offset:7680
v_cvt_pk_bf16_f32 v125, v36, v37
v_mfma_f32_16x16x32_bf16 v[32:35], v[88:91], v[116:119], 0
s_waitcnt lgkmcnt(4)
v_add_f32 v40, v40, v42
v_add_f32 v41, v41, v43
v_mfma_f32_16x16x32_bf16 v[28:31], v[92:95], v[120:123], v[28:31]
ds_write_b32 v6, v125 offset:0
v_cvt_pk_bf16_f32 v127, v40, v41
v_mfma_f32_16x16x32_bf16 v[32:35], v[96:99], v[120:123], v[32:35]
ds_write_b32 v6, v127 offset:512
s_waitcnt lgkmcnt(4)
v_mfma_f32_16x16x32_bf16 v[28:31], v[100:103], v[52:55], v[28:31]
buffer_load_dwordx4 v1, s[44:47], s63 offen offset:0 sc1 lds
v_mfma_f32_16x16x32_bf16 v[32:35], v[104:107], v[52:55], v[32:35]
s_waitcnt lgkmcnt(2)
buffer_load_dword v0, off, s[44:47], s66 offset:4 sc1
v_mfma_f32_16x16x32_bf16 v[28:31], v[108:111], v[56:59], v[28:31]
buffer_load_dwordx4 v1, s[44:47], s63 offen offset:1024 sc1 lds
v_mfma_f32_16x16x32_bf16 v[32:35], v[112:115], v[56:59], v[32:35]
s_add_u32 s63, s63, 786432
s_add_u32 s66, s66, s68
s_waitcnt lgkmcnt(0)
s_barrier
v_smfmac_f32_16x16x64_bf16 v[44:47], v[60:63], a[144:151], v4
ds_read_b64_tr_b16 v[84:85], v8 offset:0
ds_read_b64_tr_b16 v[86:87], v8 offset:512
v_smfmac_f32_16x16x64_bf16 v[44:47], v[64:67], a[152:159], v4
ds_read_b64_tr_b16 v[88:89], v8 offset:1024
ds_read_b64_tr_b16 v[90:91], v8 offset:1536
v_smfmac_f32_16x16x64_bf16 v[44:47], v[68:71], a[160:167], v4
ds_read_b64_tr_b16 v[92:93], v8 offset:2048
ds_read_b64_tr_b16 v[94:95], v8 offset:2560
v_smfmac_f32_16x16x64_bf16 v[44:47], v[72:75], a[168:175], v4
ds_read_b64_tr_b16 v[96:97], v8 offset:3072
v_cndmask_b32 v28, v28, v32, s[78:79]
v_smfmac_f32_16x16x64_bf16 v[44:47], v[76:79], a[176:183], v4
ds_read_b64_tr_b16 v[98:99], v8 offset:3584
v_cndmask_b32 v29, v29, v33, s[78:79]
v_smfmac_f32_16x16x64_bf16 v[44:47], v[80:83], a[184:191], v4
s_waitcnt lgkmcnt(4)
v_cndmask_b32 v30, v30, v34, s[78:79]
v_mfma_f32_16x16x32_bf16 v[36:39], v[84:87], v[116:119], 0
ds_read_b128 v[100:103], v2 offset:0
v_cndmask_b32 v31, v31, v35, s[78:79]
v_mfma_f32_16x16x32_bf16 v[36:39], v[88:91], v[120:123], v[36:39]
s_waitcnt lgkmcnt(1)
v_max3_f32 v42, v28, v29, v30
v_max_f32 v42, v42, v31
v_mfma_f32_16x16x32_bf16 v[36:39], v[92:95], v[52:55], v[36:39]
ds_read_b128 v[104:107], v2 offset:1024
v_add_f32 v44, v44, v46
v_mfma_f32_16x16x32_bf16 v[36:39], v[96:99], v[56:59], v[36:39]
v_max_f32_dpp v42, v42, v42 quad_perm:[2,3,0,1] row_mask:0xf bank_mask:0xf
v_add_f32 v45, v45, v47
v_smfmac_f32_16x16x64_bf16 v[48:51], v[60:63], a[208:215], v4
ds_read_b128 v[108:111], v2 offset:2048
v_cvt_pk_bf16_f32 v124, v44, v45
s_nop 0
v_max3_f32 v42, v42, v36, v37
v_mov_b32 v43, v42
v_smfmac_f32_16x16x64_bf16 v[48:51], v[64:67], a[216:223], v4
ds_read_b128 v[112:115], v2 offset:3072
v_permlane16_swap_b32 v42, v43
v_max_f32 v42, v42, v43
v_mov_b32 v43, v42
v_smfmac_f32_16x16x64_bf16 v[48:51], v[68:71], a[224:231], v4
ds_read_b128 v[84:87], v2 offset:4096
v_permlane32_swap_b32 v42, v43
v_max_f32 v42, v42, v43
v_mul_f32 v42, s71, v42
v_fmamk_f32 v28, v28, 0x3e0293ee, v42
v_fmamk_f32 v29, v29, 0x3e0293ee, v42
v_smfmac_f32_16x16x64_bf16 v[48:51], v[72:75], a[232:239], v4
ds_read_b128 v[88:91], v2 offset:5120
v_exp_f32 v28, v28
v_exp_f32 v29, v29
v_fmamk_f32 v30, v30, 0x3e0293ee, v42
v_fmamk_f32 v31, v31, 0x3e0293ee, v42
v_smfmac_f32_16x16x64_bf16 v[48:51], v[76:79], a[240:247], v4
ds_read_b128 v[92:95], v2 offset:6144
v_exp_f32 v30, v30
v_exp_f32 v31, v31
v_cvt_pk_bf16_f32 v32, v28, v29
v_cvt_pk_bf16_f32 v33, v30, v31
v_smfmac_f32_16x16x64_bf16 v[48:51], v[80:83], a[248:255], v4
ds_read_b128 v[96:99], v2 offset:7168
v_mov_b32_dpp v34, v32 quad_perm:[2,3,0,1] row_mask:0xf bank_mask:0xf
v_mov_b32_dpp v35, v33 quad_perm:[2,3,0,1] row_mask:0xf bank_mask:0xf
v_cndmask_b32 v36, v36, v37, s[78:79]
v_fmamk_f32 v36, v36, 0x3e0293ee, v42
v_mfma_f32_16x16x32_bf16 v[28:31], v[20:23], v[32:35], 0
ds_read_b128 v[116:119], v2 offset:8192
v_exp_f32 v36, v36
v_mfma_f32_16x16x32_bf16 v[40:43], v[16:19], v[32:35], 0
ds_read_b128 v[120:123], v2 offset:9216
v_mov_b32_dpp v37, v36 quad_perm:[2,3,0,1] row_mask:0xf bank_mask:0xf
v_cvt_pk_bf16_f32 v38, v36, v37
v_mfma_f32_16x16x32_bf16 v[20:23], v[24:27], v[32:35], 0
v_add_f32 v48, v48, v50
v_add_f32 v49, v49, v51
v_mfma_f32_16x16x16_bf16 v[40:43], v[16:17], v[38:39], v[40:43]
ds_read_b128 v[52:55], v2 offset:16384
v_cvt_pk_bf16_f32 v126, v48, v49
v_mfma_f32_16x16x16_bf16 v[28:31], v[124:125], v[38:39], v[28:31]
ds_read_b128 v[56:59], v2 offset:17408
v_mfma_f32_16x16x16_bf16 v[20:23], v[126:127], v[38:39], v[20:23]
v_rcp_f32 v42, v42
v_mfma_i32_16x16x4_4b_i8 v[60:75], v39, v4, 0
s_nop 0
v_mul_f32_dpp v28, v28, v42 quad_perm:[0,1,0,1] row_mask:0xf bank_mask:0xf
v_mul_f32_dpp v29, v29, v42 quad_perm:[0,1,0,1] row_mask:0xf bank_mask:0xf
v_mul_f32_dpp v30, v30, v42 quad_perm:[0,1,0,1] row_mask:0xf bank_mask:0xf
v_mul_f32_dpp v31, v31, v42 quad_perm:[0,1,0,1] row_mask:0xf bank_mask:0xf
v_cvt_pk_bf16_f32 v36, v28, v29
v_cvt_pk_bf16_f32 v37, v30, v31
v_mul_f32_dpp v20, v20, v42 quad_perm:[0,1,0,1] row_mask:0xf bank_mask:0xf
v_mul_f32_dpp v21, v21, v42 quad_perm:[0,1,0,1] row_mask:0xf bank_mask:0xf
v_mul_f32_dpp v22, v22, v42 quad_perm:[0,1,0,1] row_mask:0xf bank_mask:0xf
v_mul_f32_dpp v23, v23, v42 quad_perm:[0,1,0,1] row_mask:0xf bank_mask:0xf
v_cvt_pk_bf16_f32 v38, v20, v21
v_cvt_pk_bf16_f32 v39, v22, v23
ds_write_b128 v11, v[36:39]
s_waitcnt vmcnt(7)
s_waitcnt lgkmcnt(5)
v_smfmac_f32_16x16x64_bf16 v[60:63], v[36:39], v[100:107], v4
v_smfmac_f32_16x16x64_bf16 v[64:67], v[36:39], v[108:115], v4
v_smfmac_f32_16x16x64_bf16 v[68:71], v[36:39], v[84:91], v4
s_waitcnt lgkmcnt(0)
s_barrier
ds_read_b128 v[40:43], v10 offset:528
ds_read_b128 v[44:47], v10 offset:1056
ds_read_b128 v[48:51], v10 offset:1584
v_smfmac_f32_16x16x64_bf16 v[72:75], v[36:39], v[92:99], v4
ds_read_b128 v[20:23], v2 offset:18432
ds_read_b128 v[24:27], v2 offset:19456
s_waitcnt lgkmcnt(4)
v_smfmac_f32_16x16x64_bf16 v[60:63], v[40:43], v[116:123], v4
ds_read_b128 v[28:31], v2 offset:24576
s_waitcnt lgkmcnt(4)
v_smfmac_f32_16x16x64_bf16 v[60:63], v[44:47], v[52:59], v4
ds_read_b128 v[32:35], v2 offset:25600
s_waitcnt lgkmcnt(4)
v_smfmac_f32_16x16x64_bf16 v[60:63], v[48:51], v[216:223], v4
ds_read_b128 v[76:79], v2 offset:10240
v_smfmac_f32_16x16x64_bf16 v[64:67], v[40:43], v[224:231], v4
ds_read_b128 v[80:83], v2 offset:11264
v_smfmac_f32_16x16x64_bf16 v[64:67], v[44:47], v[232:239], v4
ds_read_b128 v[100:103], v2 offset:20480
v_cvt_pk_bf16_f32 v60, v60, v61
v_cvt_pk_bf16_f32 v61, v62, v63
v_and_b32 v60, -2, v60
v_smfmac_f32_16x16x64_bf16 v[64:67], v[48:51], v[240:247], v4
ds_read_b128 v[104:107], v2 offset:21504
buffer_store_dwordx2 v[60:61], v12, s[44:47], s67 offen sc1
v_smfmac_f32_16x16x64_bf16 v[68:71], v[40:43], v[248:255], v4
ds_read_b128 v[108:111], v2 offset:26624
s_waitcnt lgkmcnt(5)
v_smfmac_f32_16x16x64_bf16 v[68:71], v[44:47], v[20:27], v4
ds_read_b128 v[112:115], v2 offset:27648
v_cvt_pk_bf16_f32 v64, v64, v65
v_cvt_pk_bf16_f32 v65, v66, v67
v_and_b32 v64, -2, v64
v_smfmac_f32_16x16x64_bf16 v[68:71], v[48:51], v[28:35], v4
buffer_store_dwordx2 v[64:65], v12, s[44:47], s80 offen sc1
s_waitcnt lgkmcnt(2)
v_smfmac_f32_16x16x64_bf16 v[72:75], v[40:43], v[76:83], v4
v_smfmac_f32_16x16x64_bf16 v[72:75], v[44:47], v[100:107], v4
s_waitcnt lgkmcnt(0)
v_cvt_pk_bf16_f32 v68, v68, v69
v_cvt_pk_bf16_f32 v69, v70, v71
v_and_b32 v68, -2, v68
v_smfmac_f32_16x16x64_bf16 v[72:75], v[48:51], v[108:115], v4
buffer_store_dwordx2 v[68:69], v12, s[44:47], s81 offen sc1
s_nop 6
v_cvt_pk_bf16_f32 v72, v72, v73
v_cvt_pk_bf16_f32 v73, v74, v75
v_and_b32 v72, -2, v72
buffer_store_dwordx2 v[72:73], v12, s[44:47], s82 offen sc1
ds_read_b128 v[84:87], v2 offset:12288
ds_read_b128 v[88:91], v2 offset:13312
ds_read_b128 v[92:95], v2 offset:14336
ds_read_b128 v[96:99], v2 offset:15360
ds_read_b128 v[100:103], v2 offset:22528
ds_read_b128 v[104:107], v2 offset:23552
ds_read_b128 v[108:111], v2 offset:28672
ds_read_b128 v[112:115], v2 offset:29696
ds_read_b128 v[116:119], v2 offset:30720
ds_read_b128 v[120:123], v2 offset:31744
v_xor_b32 v66, 2048, v3
v_xor_b32 v74, 4096, v3
v_xor_b32 v82, 6144, v3
s_waitcnt vmcnt(4)
ds_read_b128 v[20:23], v3 offset:0
ds_read_b128 v[24:27], v3 offset:1024
s_waitcnt vmcnt(0)
buffer_load_dwordx4 v[52:55], v13, s[44:47], s69 offen sc1
buffer_load_dwordx4 v[56:59], v13, s[44:47], s70 offen sc1
v_cmp_eq_u32 vcc, 0, v0
s_cbranch_vccnz L_c_fs_60
L_c_fb_61:
s_waitcnt vmcnt(1)
v_mfma_f32_16x16x32_bf16 v[60:63], v[16:19], v[52:55], 0
s_waitcnt vmcnt(0)
v_mfma_f32_16x16x32_bf16 v[60:63], v[16:19], v[56:59], v[60:63]
v_bitop3_b32 v64, v52, v54, v56 bitop3:0xfe
v_bitop3_b32 v64, v64, v58, 1 bitop3:0xa8
v_cmp_ne_u32 vcc, 0, v64
s_cbranch_vccnz L_c_rr_62
L_c_rb_63:
s_nop 3
v_add_f32_dpp v60, v60, v60 row_ror:4 row_mask:0xf bank_mask:0xf
v_add_f32_dpp v61, v61, v61 row_ror:4 row_mask:0xf bank_mask:0xf
s_nop 0
v_add_f32_dpp v60, v60, v60 row_ror:8 row_mask:0xf bank_mask:0xf
v_add_f32_dpp v61, v61, v61 row_ror:8 row_mask:0xf bank_mask:0xf
v_cvt_pk_bf16_f32 v60, v60, v61
v_min_u32 v60, -2, v60
buffer_store_dword v60, v14, s[44:47], s74 offen sc1
s_waitcnt vmcnt(0)
buffer_load_dwordx4 v[52:55], v1, s[44:47], s72 offen offset:0 sc1
buffer_load_dwordx4 v[56:59], v1, s[44:47], s72 offen offset:1024 sc1
buffer_store_dword v15, v14, s[44:47], s75 offen sc1
v_pk_mov_b32 v[28:29], 0, 0
v_pk_mov_b32 v[30:31], 0, 0
v_pk_mov_b32 v[32:33], 0, 0
v_pk_mov_b32 v[34:35], 0, 0
v_pk_mov_b32 v[36:37], 0, 0
v_pk_mov_b32 v[38:39], 0, 0
v_pk_mov_b32 v[40:41], 0, 0
v_pk_mov_b32 v[42:43], 0, 0
v_pk_mov_b32 v[44:45], 0, 0
v_pk_mov_b32 v[46:47], 0, 0
v_pk_mov_b32 v[48:49], 0, 0
v_pk_mov_b32 v[50:51], 0, 0
s_branch L_c_top_i
L_c_gr_52:
L_c_gl_64:
s_mov_b64 exec, vcc
buffer_load_dwordx4 v[52:55], v1, s[44:47], s72 offen offset:0 sc1
buffer_load_dwordx4 v[56:59], v1, s[44:47], s72 offen offset:1024 sc1
s_mov_b64 exec, -1
s_add_u32 s54, s54, 1
s_cmp_gt_u32 s54, 400000
s_cbranch_scc1 L_end
s_waitcnt vmcnt(1) lgkmcnt(0)
ds_write_b128 v3, v[52:55] offset:8192
s_waitcnt vmcnt(0)
v_max3_u32 v64, v52, v53, v54
v_max3_u32 v65, v55, v56, v57
v_max3_u32 v64, v64, v58, v59
v_max_u32 v64, v64, v65
v_cmp_eq_u32 vcc, -1, v64
ds_write_b128 v3, v[56:59] offset:9216
s_cbranch_vccnz L_c_gl_64
s_branch L_c_gb_53
L_c_fs_54:
s_sub_u32 s56, s66, s68
L_wf_65:
s_add_u32 s54, s54, 1
s_cmp_gt_u32 s54, 400000
s_cbranch_scc1 L_end
buffer_load_dword v0, off, s[44:47], s56 offset:4 sc1
s_waitcnt vmcnt(0)
v_cmp_eq_u32 vcc, 0, v0
s_cbranch_vccnz L_wf_65
s_branch L_c_fb_55
L_c_rr_56:
L_c_rl_66:
s_mov_b64 exec, vcc
buffer_load_dwordx4 v[52:55], v13, s[44:47], s69 offen sc1
buffer_load_dwordx4 v[56:59], v13, s[44:47], s70 offen sc1
s_mov_b64 exec, -1
s_add_u32 s54, s54, 1
s_cmp_gt_u32 s54, 400000
s_cbranch_scc1 L_end
s_waitcnt vmcnt(1)
v_mfma_f32_16x16x32_bf16 v[60:63], v[16:19], v[52:55], 0
s_waitcnt vmcnt(0)
v_mfma_f32_16x16x32_bf16 v[60:63], v[16:19], v[56:59], v[60:63]
v_bitop3_b32 v64, v52, v54, v56 bitop3:0x80
v_bitop3_b32 v64, v64, v58, 1 bitop3:0x80
v_cmp_eq_u32 vcc, 0, v64
s_cbranch_vccnz L_c_rl_66
s_branch L_c_rb_57
L_c_gr_58:
L_c_gl_67:
s_mov_b64 exec, vcc
buffer_load_dwordx4 v[52:55], v1, s[44:47], s73 offen offset:0 sc1
buffer_load_dwordx4 v[56:59], v1, s[44:47], s73 offen offset:1024 sc1
s_mov_b64 exec, -1
s_add_u32 s54, s54, 1
s_cmp_gt_u32 s54, 400000
s_cbranch_scc1 L_end
s_waitcnt vmcnt(1) lgkmcnt(0)
ds_write_b128 v3, v[52:55] offset:8192
s_waitcnt vmcnt(0)
v_max3_u32 v64, v52, v53, v54
v_max3_u32 v65, v55, v56, v57
v_max3_u32 v64, v64, v58, v59
v_max_u32 v64, v64, v65
v_cmp_eq_u32 vcc, -1, v64
ds_write_b128 v3, v[56:59] offset:9216
s_cbranch_vccnz L_c_gl_67
s_branch L_c_gb_59
L_c_fs_60:
s_sub_u32 s56, s66, s68
L_wf_68:
s_add_u32 s54, s54, 1
s_cmp_gt_u32 s54, 400000
s_cbranch_scc1 L_end
buffer_load_dword v0, off, s[44:47], s56 offset:4 sc1
s_waitcnt vmcnt(0)
v_cmp_eq_u32 vcc, 0, v0
s_cbranch_vccnz L_wf_68
s_branch L_c_fb_61
L_c_rr_62:
L_c_rl_69:
s_mov_b64 exec, vcc
buffer_load_dwordx4 v[52:55], v13, s[44:47], s69 offen sc1
buffer_load_dwordx4 v[56:59], v13, s[44:47], s70 offen sc1
s_mov_b64 exec, -1
s_add_u32 s54, s54, 1
s_cmp_gt_u32 s54, 400000
s_cbranch_scc1 L_end
s_waitcnt vmcnt(1)
v_mfma_f32_16x16x32_bf16 v[60:63], v[16:19], v[52:55], 0
s_waitcnt vmcnt(0)
v_mfma_f32_16x16x32_bf16 v[60:63], v[16:19], v[56:59], v[60:63]
v_bitop3_b32 v64, v52, v54, v56 bitop3:0xfe
v_bitop3_b32 v64, v64, v58, 1 bitop3:0xa8
v_cmp_ne_u32 vcc, 0, v64
s_cbranch_vccnz L_c_rl_69
s_branch L_c_rb_63
L_c_final:
s_waitcnt vmcnt(2) lgkmcnt(0)
ds_write_b128 v3, v[52:55] offset:8192
s_waitcnt vmcnt(1)
v_max3_u32 v64, v52, v53, v54
v_max3_u32 v65, v55, v56, v57
v_max3_u32 v64, v64, v58, v59
v_max_u32 v64, v64, v65
v_cmp_eq_u32 vcc, -1, v64
ds_write_b128 v3, v[56:59] offset:9216
s_cbranch_vccnz L_c_gr_70
L_c_gb_71:
v_smfmac_f32_16x16x64_bf16 v[36:39], v[52:55], a[0:7], v4
v_min_u32 v124, -2, v124
v_smfmac_f32_16x16x64_bf16 v[40:43], v[52:55], a[64:71], v4
v_min_u32 v125, -2, v125
v_smfmac_f32_16x16x64_bf16 v[36:39], v[56:59], a[8:15], v4
v_min_u32 v126, -2, v126
v_smfmac_f32_16x16x64_bf16 v[40:43], v[56:59], a[72:79], v4
v_min_u32 v127, -2, v127
s_waitcnt lgkmcnt(0)
s_barrier
ds_read_b128 v[60:63], v66 offset:8192
ds_read_b128 v[64:67], v66 offset:9216
ds_read_b128 v[68:71], v74 offset:8192
ds_read_b128 v[72:75], v74 offset:9216
ds_read_b128 v[76:79], v82 offset:8192
ds_read_b128 v[80:83], v82 offset:9216
buffer_store_dwordx4 v[124:127], v1, s[44:47], s64 offen sc1
buffer_store_dword v15, v14, s[44:47], s65 offen sc1
v_smfmac_f32_16x16x64_bf16 v[44:47], v[52:55], a[128:135], v4
v_smfmac_f32_16x16x64_bf16 v[48:51], v[52:55], a[192:199], v4
v_smfmac_f32_16x16x64_bf16 v[44:47], v[56:59], a[136:143], v4
v_smfmac_f32_16x16x64_bf16 v[48:51], v[56:59], a[200:207], v4
s_add_u32 s65, s65, 4096
s_add_u32 s64, s64, 131072
s_waitcnt lgkmcnt(5)
v_smfmac_f32_16x16x64_bf16 v[36:39], v[60:63], a[16:23], v4
v_smfmac_f32_16x16x64_bf16 v[40:43], v[60:63], a[80:87], v4
v_smfmac_f32_16x16x64_bf16 v[44:47], v[60:63], a[144:151], v4
v_smfmac_f32_16x16x64_bf16 v[48:51], v[60:63], a[208:215], v4
s_waitcnt lgkmcnt(4)
v_smfmac_f32_16x16x64_bf16 v[36:39], v[64:67], a[24:31], v4
v_smfmac_f32_16x16x64_bf16 v[40:43], v[64:67], a[88:95], v4
v_smfmac_f32_16x16x64_bf16 v[44:47], v[64:67], a[152:159], v4
v_smfmac_f32_16x16x64_bf16 v[48:51], v[64:67], a[216:223], v4
s_waitcnt lgkmcnt(3)
v_smfmac_f32_16x16x64_bf16 v[36:39], v[68:71], a[32:39], v4
v_smfmac_f32_16x16x64_bf16 v[40:43], v[68:71], a[96:103], v4
v_smfmac_f32_16x16x64_bf16 v[44:47], v[68:71], a[160:167], v4
v_smfmac_f32_16x16x64_bf16 v[48:51], v[68:71], a[224:231], v4
s_waitcnt lgkmcnt(2)
v_smfmac_f32_16x16x64_bf16 v[36:39], v[72:75], a[40:47], v4
v_smfmac_f32_16x16x64_bf16 v[40:43], v[72:75], a[104:111], v4
v_smfmac_f32_16x16x64_bf16 v[44:47], v[72:75], a[168:175], v4
v_smfmac_f32_16x16x64_bf16 v[48:51], v[72:75], a[232:239], v4
s_waitcnt lgkmcnt(1)
v_smfmac_f32_16x16x64_bf16 v[36:39], v[76:79], a[48:55], v4
v_smfmac_f32_16x16x64_bf16 v[40:43], v[76:79], a[112:119], v4
v_smfmac_f32_16x16x64_bf16 v[44:47], v[76:79], a[176:183], v4
v_smfmac_f32_16x16x64_bf16 v[48:51], v[76:79], a[240:247], v4
s_waitcnt lgkmcnt(0)
v_smfmac_f32_16x16x64_bf16 v[36:39], v[80:83], a[56:63], v4
v_smfmac_f32_16x16x64_bf16 v[40:43], v[80:83], a[120:127], v4
v_smfmac_f32_16x16x64_bf16 v[44:47], v[80:83], a[184:191], v4
v_smfmac_f32_16x16x64_bf16 v[48:51], v[80:83], a[248:255], v4
v_add_f32 v36, v36, v38
v_add_f32 v37, v37, v39
v_cvt_pk_bf16_f32 v125, v36, v37
v_add_f32 v40, v40, v42
v_add_f32 v41, v41, v43
v_cvt_pk_bf16_f32 v127, v40, v41
v_add_f32 v44, v44, v46
v_add_f32 v45, v45, v47
v_cvt_pk_bf16_f32 v124, v44, v45
v_add_f32 v48, v48, v50
v_add_f32 v49, v49, v51
v_cvt_pk_bf16_f32 v126, v48, v49
v_min_u32 v125, -2, v125
v_min_u32 v127, -2, v127
v_min_u32 v124, -2, v124
v_min_u32 v126, -2, v126
buffer_store_dwordx4 v[124:127], v1, s[44:47], s64 offen sc1
s_branch L_end
L_c_gr_70:
L_c_gl_72:
s_mov_b64 exec, vcc
buffer_load_dwordx4 v[52:55], v1, s[44:47], s73 offen offset:0 sc1
buffer_load_dwordx4 v[56:59], v1, s[44:47], s73 offen offset:1024 sc1
s_mov_b64 exec, -1
s_add_u32 s54, s54, 1
s_cmp_gt_u32 s54, 400000
s_cbranch_scc1 L_end
s_waitcnt vmcnt(1) lgkmcnt(0)
ds_write_b128 v3, v[52:55] offset:8192
s_waitcnt vmcnt(0)
v_max3_u32 v64, v52, v53, v54
v_max3_u32 v65, v55, v56, v57
v_max3_u32 v64, v64, v58, v59
v_max_u32 v64, v64, v65
v_cmp_eq_u32 vcc, -1, v64
ds_write_b128 v3, v[56:59] offset:9216
s_cbranch_vccnz L_c_gl_72
s_branch L_c_gb_71
L_bteam:
s_or_b32 s55, s48, s52
s_cbranch_scc1 L_ci_73
s_lshl_b32 s55, 1, s50
s_lshl_b32 s56, s49, 5
v_mov_b32 v60, s55
s_cmp_lg_u32 s49, s51
s_cselect_b32 s55, s55, 0
v_mov_b32 v61, s55
v_mov_b32 v62, s56
s_mov_b64 exec, 1
buffer_atomic_or_x2 v[60:61], v62, s[40:43], 0 offen sc0
s_mov_b64 exec, -1
L_ci_73:
s_sub_u32 s55, s49, 3
s_lshl_b32 s55, s55, 5
s_add_u32 s55, s55, s50
s_lshl_b32 s55, s55, 14
s_lshl_b32 s56, s48, 12
s_add_u32 s55, s55, s56
s_cmp_eq_u32 s49, 7
s_cselect_b32 s69, 0x40000000, s55
buffer_load_dwordx4 v[4:7], v1, s[4:7], s69 offen offset:0
buffer_load_dwordx4 v[8:11], v1, s[4:7], s69 offen offset:1024
buffer_load_dwordx4 v[52:55], v1, s[4:7], s69 offen offset:2048
buffer_load_dwordx4 v[56:59], v1, s[4:7], s69 offen offset:3072
s_sub_u32 s55, s49, 3
s_lshl_b32 s56, s55, 5
s_mul_i32 s65, s56, 12288
s_add_u32 s65, s65, 0x5c00000
s_mul_i32 s64, s50, 12288
s_add_u32 s64, s64, s65
s_add_u32 s76, s56, s50
s_lshr_b32 s55, s76, 2
s_lshl_b32 s55, s55, 1
s_and_b32 s56, s50, 1
s_add_u32 s55, s55, s56
s_lshl_b32 s61, s55, 7
s_lshl_b32 s57, s48, 20
s_add_u32 s61, s61, s57
s_lshl_b32 s62, s55, 16
s_lshl_b32 s57, s48, 8
s_add_u32 s62, s62, s57
s_lshl_b32 s63, s48, 15
s_cmp_eq_u32 s49, 7
s_cselect_b32 s61, 0x40000000, s61
s_cselect_b32 s62, 0x40000000, s62
s_cselect_b32 s64, 0x40000000, s64
v_bfe_u32 v231, v0, 2, 2
v_lshl_add_u32 v218, v231, 11, s57
v_bfe_u32 v231, v0, 0, 1
v_lshl_add_u32 v218, v231, 10, v218
v_bfe_u32 v231, v0, 4, 2
v_lshl_add_u32 v218, v231, 4, v218
v_bfe_u32 v231, v0, 4, 1
v_lshlrev_b32 v212, 1, v231
v_xor_b32 v212, v212, v0
v_bfe_u32 v231, v212, 0, 3
v_lshlrev_b32 v212, 4, v231
v_bfe_u32 v231, v0, 3, 3
v_lshl_add_u32 v212, v231, 13, v212
v_xor_b32 v216, 64, v212
buffer_load_dwordx4 v[64:67], v218, s[8:11], 0 offen offset:0
buffer_load_dwordx4 v[68:71], v218, s[8:11], 0 offen offset:64
buffer_load_dwordx4 v[72:75], v218, s[8:11], 0 offen offset:128
buffer_load_dwordx4 v[76:79], v218, s[8:11], 0 offen offset:192
v_bfe_u32 v231, v0, 0, 4
v_lshl_add_u32 v220, v231, 10, s57
v_bfe_u32 v231, v0, 4, 2
v_lshl_add_u32 v220, v231, 4, v220
s_cselect_b32 s55, 0x40000000, 0
buffer_load_dwordx4 v[96:99], v220, s[4:7], s55 offen offset:0
buffer_load_dwordx4 v[100:103], v220, s[4:7], s55 offen offset:64
buffer_load_dwordx4 v[104:107], v220, s[4:7], s55 offen offset:128
buffer_load_dwordx4 v[108:111], v220, s[4:7], s55 offen offset:192
s_add_u32 s55, s55, 16384
buffer_load_dwordx4 v[112:115], v220, s[4:7], s55 offen offset:0
buffer_load_dwordx4 v[116:119], v220, s[4:7], s55 offen offset:64
buffer_load_dwordx4 v[120:123], v220, s[4:7], s55 offen offset:128
buffer_load_dwordx4 v[124:127], v220, s[4:7], s55 offen offset:192
s_add_u32 s55, s55, 16384
buffer_load_dwordx4 v[128:131], v220, s[4:7], s55 offen offset:0
buffer_load_dwordx4 v[132:135], v220, s[4:7], s55 offen offset:64
buffer_load_dwordx4 v[136:139], v220, s[4:7], s55 offen offset:128
buffer_load_dwordx4 v[140:143], v220, s[4:7], s55 offen offset:192
s_add_u32 s55, s55, 16384
buffer_load_dwordx4 v[144:147], v220, s[4:7], s55 offen offset:0
buffer_load_dwordx4 v[148:151], v220, s[4:7], s55 offen offset:64
buffer_load_dwordx4 v[152:155], v220, s[4:7], s55 offen offset:128
buffer_load_dwordx4 v[156:159], v220, s[4:7], s55 offen offset:192
s_bitcmp1_b32 s50, 1
s_cbranch_scc1 L_x_b_74
s_add_u32 m0, s63, 0
s_add_u32 s60, s61, 0
buffer_load_dwordx4 v212, s[16:19], s60 offen offset:0  lds
s_add_u32 m0, s63, 1024
s_add_u32 s60, s61, 65536
buffer_load_dwordx4 v216, s[16:19], s60 offen offset:0  lds
s_add_u32 m0, s63, 2048
s_add_u32 s60, s61, 131072
buffer_load_dwordx4 v212, s[16:19], s60 offen offset:0  lds
s_add_u32 m0, s63, 3072
s_add_u32 s60, s61, 196608
buffer_load_dwordx4 v216, s[16:19], s60 offen offset:0  lds
s_branch L_x_e_75
L_x_b_74:
s_add_u32 m0, s63, 0
s_add_u32 s60, s61, 0
buffer_load_dwordx4 v212, s[20:23], s60 offen offset:0  lds
s_add_u32 m0, s63, 1024
s_add_u32 s60, s61, 65536
buffer_load_dwordx4 v216, s[20:23], s60 offen offset:0  lds
s_add_u32 m0, s63, 2048
s_add_u32 s60, s61, 131072
buffer_load_dwordx4 v212, s[20:23], s60 offen offset:0  lds
s_add_u32 m0, s63, 3072
s_add_u32 s60, s61, 196608
buffer_load_dwordx4 v216, s[20:23], s60 offen offset:0  lds
L_x_e_75:
v_bfe_u32 v231, v0, 4, 2
v_lshlrev_b32 v213, 1, v231
v_xor_b32 v213, v213, v0
v_bfe_u32 v231, v213, 0, 4
v_lshlrev_b32 v213, 4, v231
v_bfe_u32 v231, v0, 4, 2
v_lshl_add_u32 v213, v231, 10, v213
v_xor_b32 v214, 128, v213
v_bfe_u32 v231, v0, 0, 2
v_lshl_add_u32 v215, v231, 3, s63
v_bfe_u32 v231, v0, 3, 2
v_lshl_add_u32 v215, v231, 5, v215
v_bfe_u32 v231, v0, 2, 2
v_lshl_add_u32 v215, v231, 7, v215
v_bfe_u32 v231, v0, 4, 2
v_lshl_add_u32 v215, v231, 10, v215
v_bfe_u32 v231, v0, 0, 1
v_lshl_add_u32 v217, v231, 3, s63
v_bfe_u32 v231, v0, 1, 1
v_lshl_add_u32 v217, v231, 4, v217
v_bfe_u32 v231, v0, 2, 2
v_lshl_add_u32 v217, v231, 5, v217
v_bfe_u32 v231, v0, 4, 1
v_lshl_add_u32 v217, v231, 7, v217
v_bfe_u32 v231, v0, 2, 2
v_lshl_add_u32 v217, v231, 8, v217
v_bfe_u32 v231, v0, 4, 2
v_lshl_add_u32 v217, v231, 10, v217
v_bfe_u32 v231, v0, 2, 2
v_lshlrev_b32 v219, 6, v231
v_bfe_u32 v231, v0, 0, 1
v_lshl_add_u32 v219, v231, 5, v219
v_bfe_u32 v231, v0, 4, 1
v_lshl_add_u32 v219, v231, 4, v219
v_bfe_u32 v231, v0, 5, 1
v_mul_u32_u24 v231, 12288, v231
v_add_u32 v219, v219, v231
s_mov_b32 s78, 0xcccccccc
s_mov_b32 s79, 0xcccccccc
v_bfe_u32 v231, v0, 4, 2
v_lshlrev_b32 v222, 7, v231
v_bfe_u32 v231, v0, 2, 2
v_lshl_add_u32 v222, v231, 5, v222
v_bfe_u32 v231, v0, 0, 1
v_lshl_add_u32 v222, v231, 4, v222
v_mov_b32 v232, 0x40000000
v_cndmask_b32 v221, v222, v232, s[78:79]
v_bfe_u32 v233, v0, 1, 1
v_mul_u32_u24 v233, 12288, v233
v_add_u32 v222, v233, v222
v_bfe_u32 v231, v0, 4, 2
v_lshl_add_u32 v223, v231, 11, v233
v_bfe_u32 v231, v0, 2, 2
v_lshl_add_u32 v223, v231, 4, v223
v_bfe_u32 v231, v0, 0, 1
v_lshl_add_u32 v223, v231, 3, v223
v_bfe_u32 v231, v0, 0, 2
v_lshlrev_b32 v225, 5, v231
v_bfe_u32 v231, v0, 4, 1
v_lshl_add_u32 v225, v231, 4, v225
v_and_b32 v231, 44, v0
v_cmp_eq_u32 vcc, 0, v231
s_nop 1
v_cndmask_b32 v224, v232, v225, vcc
v_lshlrev_b32 v226, 1, v225
v_cndmask_b32 v226, v232, v226, vcc
v_bfe_u32 v231, v0, 2, 2
v_mul_u32_u24 v231, 393216, v231
v_add_u32 v225, v225, v231
v_add_u32 v227, s63, v1
s_lshl_b32 s55, s48, 11
v_add_u32 v228, s55, v1
v_add_u32 v229, 0x10000, v228
v_add_u32 v230, 0x10000, v1
s_lshl_b32 s55, s48, 10
s_add_u32 s55, s55, 131072
v_add_u32 v233, s55, v1
v_bfe_u32 v84, v0, 1, 2
v_and_b32 v85, 1, v0
v_lshlrev_b32 v85, 4, v85
v_mov_b32 v86, 0x3f80
v_lshlrev_b32 v86, v85, v86
v_cmp_eq_u32 vcc, 0, v84
s_nop 1
v_cndmask_b32 v204, 0, v86, vcc
v_mov_b32 v208, 0x3f803f80
v_cmp_eq_u32 vcc, 1, v84
s_nop 1
v_cndmask_b32 v205, 0, v86, vcc
v_mov_b32 v209, 0x3f803f80
v_cmp_eq_u32 vcc, 2, v84
s_nop 1
v_cndmask_b32 v206, 0, v86, vcc
v_mov_b32 v210, 0x3f803f80
v_cmp_eq_u32 vcc, 3, v84
s_nop 1
v_cndmask_b32 v207, 0, v86, vcc
v_mov_b32 v211, 0x3f803f80
s_and_b32 s55, s50, 28
s_mul_i32 s55, s55, 12288
s_add_u32 s66, s65, s55
s_add_u32 s66, s66, 8192
s_add_u32 s67, s64, 8192
s_cmp_lg_u32 s48, 0
s_cselect_b32 s67, 0x40000000, s67
s_mul_i32 s55, s48, 98304
s_add_u32 s70, s65, s55
s_lshr_b32 s55, s50, 2
s_lshl_b32 s55, s55, 1
s_and_b32 s56, s50, 1
s_add_u32 s55, s55, s56
s_lshl_b32 s55, s55, 6
s_add_u32 s68, s70, s55
s_add_u32 s70, s70, 11776
s_lshl_b32 s55, s48, 7
s_add_u32 s55, s55, 10240
s_add_u32 s72, s64, s55
s_sub_u32 s71, s72, s65
s_add_u32 s71, s71, 0x5c00000
s_lshl_b32 s55, s48, 11
s_add_u32 s74, s64, s55
s_lshl_b32 s55, s48, 3
s_add_u32 s75, s64, s55
s_add_u32 s75, s75, 11776
s_cmp_ge_u32 s48, 2
s_cselect_b32 s55, -1, 0
v_mov_b32 v84, 0
v_mov_b32 v88, s55
v_mov_b32 v85, 0
v_mov_b32 v89, s55
v_mov_b32 v86, 0
v_mov_b32 v90, s55
v_mov_b32 v87, 0
v_mov_b32 v91, s55
s_waitcnt vmcnt(28)
s_or_b32 s55, s48, s52
s_cbranch_scc1 L_cc_rd_76
s_mov_b32 s57, s49
s_mov_b32 s58, s50
L_cc_lp_77:
v_readfirstlane_b32 s55, v60
s_nop 0
s_lshr_b32 s56, s55, s58
s_and_b32 s56, s56, 1
s_cbranch_scc0 L_cc_ok_78
s_ff0_i32_b32 s58, s55
s_cmp_lg_u32 s55, -1
s_cbranch_scc1 L_cc_nf_79
s_add_u32 s57, s57, 1
s_and_b32 s57, s57, 7
s_mov_b32 s58, 0
L_cc_nf_79:
s_add_u32 s54, s54, 1
s_cmp_gt_u32 s54, 400000
s_cbranch_scc1 L_end
s_lshl_b32 s55, 1, s58
s_lshl_b32 s56, s57, 5
v_mov_b32 v60, s55
s_cmp_lg_u32 s57, s51
s_cselect_b32 s55, s55, 0
v_mov_b32 v61, s55
v_mov_b32 v62, s56
s_mov_b64 exec, 1
buffer_atomic_or_x2 v[60:61], v62, s[40:43], 0 offen sc0
s_mov_b64 exec, -1
s_waitcnt vmcnt(0)
s_branch L_cc_lp_77
L_cc_ok_78:
s_lshl_b32 s57, s57, 8
s_or_b32 s57, s57, s58
v_mov_b32 v60, s57
v_mov_b32 v61, 162816
ds_write_b32 v61, v60
s_waitcnt lgkmcnt(0)
L_cc_rd_76:
s_barrier
s_cmp_lg_u32 s52, 0
s_cbranch_scc1 L_cc_done_80
v_mov_b32 v61, 162816
ds_read_b32 v60, v61
s_mov_b32 s52, 1
s_lshl_b32 s56, s49, 8
s_or_b32 s56, s56, s50
s_waitcnt lgkmcnt(0)
v_readfirstlane_b32 s55, v60
s_nop 0
s_cmp_eq_u32 s55, s56
s_cbranch_scc1 L_cc_done_80
s_lshr_b32 s49, s55, 8
s_and_b32 s50, s55, 31
s_waitcnt vmcnt(0)
s_barrier
s_branch L_dispatch
L_cc_done_80:
s_waitcnt vmcnt(24)
s_sub_u32 s57, s49, 3
s_lshl_b32 s57, s57, 5
s_add_u32 s57, s57, s50
s_cmp_ge_u32 s57, 201
s_cselect_b32 s55, -1, 0
v_mov_b32 v36, s55
v_mov_b32 v37, s55
v_mov_b32 v38, s55
v_mov_b32 v39, s55
s_lshl_b32 s55, s57, 12
s_lshl_b32 s56, s48, 10
s_add_u32 s55, s55, s56
s_add_u32 s55, s55, 0x5000000
s_cmp_ge_u32 s57, 269
s_cselect_b32 s59, 0x40000000, s55
buffer_store_dwordx4 v[36:39], v1, s[44:47], s59 offen sc1
s_add_u32 s57, s57, 160
s_cmp_ge_u32 s57, 201
s_cselect_b32 s55, -1, 0
v_mov_b32 v40, s55
v_mov_b32 v41, s55
v_mov_b32 v42, s55
v_mov_b32 v43, s55
s_lshl_b32 s55, s57, 12
s_lshl_b32 s56, s48, 10
s_add_u32 s55, s55, s56
s_add_u32 s55, s55, 0x5000000
s_add_u32 s56, s55, 0xfe9f3000
s_cmp_ge_u32 s57, 205
s_cselect_b32 s55, s56, s55
s_cmp_ge_u32 s57, 269
s_cselect_b32 s59, 0x40000000, s55
buffer_store_dwordx4 v[40:43], v1, s[44:47], s59 offen sc1
v_lshlrev_b32 v12, 16, v4
v_and_b32 v13, 0xffff0000, v4
v_lshlrev_b32 v14, 16, v5
v_and_b32 v15, 0xffff0000, v5
v_lshlrev_b32 v16, 16, v6
v_and_b32 v17, 0xffff0000, v6
v_lshlrev_b32 v18, 16, v7
v_and_b32 v19, 0xffff0000, v7
v_lshlrev_b32 v20, 16, v8
v_and_b32 v21, 0xffff0000, v8
v_lshlrev_b32 v22, 16, v9
v_and_b32 v23, 0xffff0000, v9
v_lshlrev_b32 v24, 16, v10
v_and_b32 v25, 0xffff0000, v10
v_lshlrev_b32 v26, 16, v11
v_and_b32 v27, 0xffff0000, v11
v_add_f32 v28, v12, v13
v_add_f32 v28, v28, v14
v_add_f32 v28, v28, v15
v_add_f32 v28, v28, v16
v_add_f32 v28, v28, v17
v_add_f32 v28, v28, v18
v_add_f32 v28, v28, v19
v_add_f32 v29, v20, v21
v_add_f32 v29, v29, v22
v_add_f32 v29, v29, v23
v_add_f32 v29, v29, v24
v_add_f32 v29, v29, v25
v_add_f32 v29, v29, v26
v_add_f32 v29, v29, v27
v_add_f32_dpp v28, v28, v28 row_ror:8 row_mask:0xf bank_mask:0xf
s_nop 0
v_add_f32_dpp v29, v29, v29 row_ror:8 row_mask:0xf bank_mask:0xf
v_add_f32_dpp v28, v28, v28 row_ror:4 row_mask:0xf bank_mask:0xf
s_nop 0
v_add_f32_dpp v29, v29, v29 row_ror:4 row_mask:0xf bank_mask:0xf
v_add_f32_dpp v28, v28, v28 row_ror:2 row_mask:0xf bank_mask:0xf
s_nop 0
v_add_f32_dpp v29, v29, v29 row_ror:2 row_mask:0xf bank_mask:0xf
v_add_f32_dpp v28, v28, v28 row_ror:1 row_mask:0xf bank_mask:0xf
s_nop 0
v_add_f32_dpp v29, v29, v29 row_ror:1 row_mask:0xf bank_mask:0xf
v_mov_b32 v30, v28
v_mov_b32 v31, v29
s_nop 0
v_permlane16_swap_b32 v28, v30
v_permlane16_swap_b32 v29, v31
v_add_f32 v28, v28, v30
v_add_f32 v29, v29, v31
v_mov_b32 v30, v28
v_mov_b32 v31, v29
s_nop 0
v_permlane32_swap_b32 v28, v30
v_permlane32_swap_b32 v29, v31
v_add_f32 v28, v28, v30
v_add_f32 v29, v29, v31
v_mul_f32 v28, 0x3b000000, v28
v_mul_f32 v29, 0x3b000000, v29
v_sub_f32 v12, v12, v28
v_sub_f32 v13, v13, v28
v_sub_f32 v14, v14, v28
v_sub_f32 v15, v15, v28
v_sub_f32 v16, v16, v28
v_sub_f32 v17, v17, v28
v_sub_f32 v18, v18, v28
v_sub_f32 v19, v19, v28
v_mul_f32 v32, v12, v12
v_fmac_f32 v32, v13, v13
v_fmac_f32 v32, v14, v14
v_fmac_f32 v32, v15, v15
v_fmac_f32 v32, v16, v16
v_fmac_f32 v32, v17, v17
v_fmac_f32 v32, v18, v18
v_fmac_f32 v32, v19, v19
v_sub_f32 v20, v20, v29
v_sub_f32 v21, v21, v29
v_sub_f32 v22, v22, v29
v_sub_f32 v23, v23, v29
v_sub_f32 v24, v24, v29
v_sub_f32 v25, v25, v29
v_sub_f32 v26, v26, v29
v_sub_f32 v27, v27, v29
v_mul_f32 v33, v20, v20
v_fmac_f32 v33, v21, v21
v_fmac_f32 v33, v22, v22
v_fmac_f32 v33, v23, v23
v_fmac_f32 v33, v24, v24
v_fmac_f32 v33, v25, v25
v_fmac_f32 v33, v26, v26
v_fmac_f32 v33, v27, v27
v_add_f32_dpp v32, v32, v32 row_ror:8 row_mask:0xf bank_mask:0xf
s_nop 0
v_add_f32_dpp v33, v33, v33 row_ror:8 row_mask:0xf bank_mask:0xf
v_add_f32_dpp v32, v32, v32 row_ror:4 row_mask:0xf bank_mask:0xf
s_nop 0
v_add_f32_dpp v33, v33, v33 row_ror:4 row_mask:0xf bank_mask:0xf
v_add_f32_dpp v32, v32, v32 row_ror:2 row_mask:0xf bank_mask:0xf
s_nop 0
v_add_f32_dpp v33, v33, v33 row_ror:2 row_mask:0xf bank_mask:0xf
v_add_f32_dpp v32, v32, v32 row_ror:1 row_mask:0xf bank_mask:0xf
s_nop 0
v_add_f32_dpp v33, v33, v33 row_ror:1 row_mask:0xf bank_mask:0xf
v_mov_b32 v30, v32
v_mov_b32 v31, v33
s_nop 0
v_permlane16_swap_b32 v32, v30
v_permlane16_swap_b32 v33, v31
v_add_f32 v32, v32, v30
v_add_f32 v33, v33, v31
v_mov_b32 v30, v32
v_mov_b32 v31, v33
s_nop 0
v_permlane32_swap_b32 v32, v30
v_permlane32_swap_b32 v33, v31
v_add_f32 v32, v32, v30
v_add_f32 v33, v33, v31
v_mov_b32 v34, 0x3727c5ac
v_mul_f32 v32, 0x3b000000, v32
v_add_f32 v32, v32, v34
v_rsq_f32 v32, v32
v_mul_f32 v33, 0x3b000000, v33
v_add_f32 v33, v33, v34
v_rsq_f32 v33, v33
v_mul_f32 v12, v12, v32
v_mul_f32 v13, v13, v32
v_mul_f32 v14, v14, v32
v_mul_f32 v15, v15, v32
v_mul_f32 v16, v16, v32
v_mul_f32 v17, v17, v32
v_mul_f32 v18, v18, v32
v_mul_f32 v19, v19, v32
v_cvt_pk_bf16_f32 v4, v12, v13
v_cvt_pk_bf16_f32 v5, v14, v15
v_cvt_pk_bf16_f32 v6, v16, v17
v_cvt_pk_bf16_f32 v7, v18, v19
buffer_store_dwordx4 v[4:7], v1, s[44:47], s69 offen offset:0 sc1
v_mul_f32 v20, v20, v33
v_mul_f32 v21, v21, v33
v_mul_f32 v22, v22, v33
v_mul_f32 v23, v23, v33
v_mul_f32 v24, v24, v33
v_mul_f32 v25, v25, v33
v_mul_f32 v26, v26, v33
v_mul_f32 v27, v27, v33
v_cvt_pk_bf16_f32 v8, v20, v21
v_cvt_pk_bf16_f32 v9, v22, v23
v_cvt_pk_bf16_f32 v10, v24, v25
v_cvt_pk_bf16_f32 v11, v26, v27
buffer_store_dwordx4 v[8:11], v1, s[44:47], s69 offen offset:1024 sc1
v_lshlrev_b32 v12, 16, v52
v_and_b32 v13, 0xffff0000, v52
v_lshlrev_b32 v14, 16, v53
v_and_b32 v15, 0xffff0000, v53
v_lshlrev_b32 v16, 16, v54
v_and_b32 v17, 0xffff0000, v54
v_lshlrev_b32 v18, 16, v55
v_and_b32 v19, 0xffff0000, v55
v_lshlrev_b32 v20, 16, v56
v_and_b32 v21, 0xffff0000, v56
v_lshlrev_b32 v22, 16, v57
v_and_b32 v23, 0xffff0000, v57
v_lshlrev_b32 v24, 16, v58
v_and_b32 v25, 0xffff0000, v58
v_lshlrev_b32 v26, 16, v59
v_and_b32 v27, 0xffff0000, v59
v_add_f32 v28, v12, v13
v_add_f32 v28, v28, v14
v_add_f32 v28, v28, v15
v_add_f32 v28, v28, v16
v_add_f32 v28, v28, v17
v_add_f32 v28, v28, v18
v_add_f32 v28, v28, v19
v_add_f32 v29, v20, v21
v_add_f32 v29, v29, v22
v_add_f32 v29, v29, v23
v_add_f32 v29, v29, v24
v_add_f32 v29, v29, v25
v_add_f32 v29, v29, v26
v_add_f32 v29, v29, v27
v_add_f32_dpp v28, v28, v28 row_ror:8 row_mask:0xf bank_mask:0xf
s_nop 0
v_add_f32_dpp v29, v29, v29 row_ror:8 row_mask:0xf bank_mask:0xf
v_add_f32_dpp v28, v28, v28 row_ror:4 row_mask:0xf bank_mask:0xf
s_nop 0
v_add_f32_dpp v29, v29, v29 row_ror:4 row_mask:0xf bank_mask:0xf
v_add_f32_dpp v28, v28, v28 row_ror:2 row_mask:0xf bank_mask:0xf
s_nop 0
v_add_f32_dpp v29, v29, v29 row_ror:2 row_mask:0xf bank_mask:0xf
v_add_f32_dpp v28, v28, v28 row_ror:1 row_mask:0xf bank_mask:0xf
s_nop 0
v_add_f32_dpp v29, v29, v29 row_ror:1 row_mask:0xf bank_mask:0xf
v_mov_b32 v30, v28
v_mov_b32 v31, v29
s_nop 0
v_permlane16_swap_b32 v28, v30
v_permlane16_swap_b32 v29, v31
v_add_f32 v28, v28, v30
v_add_f32 v29, v29, v31
v_mov_b32 v30, v28
v_mov_b32 v31, v29
s_nop 0
v_permlane32_swap_b32 v28, v30
v_permlane32_swap_b32 v29, v31
v_add_f32 v28, v28, v30
v_add_f32 v29, v29, v31
v_mul_f32 v28, 0x3b000000, v28
v_mul_f32 v29, 0x3b000000, v29
v_sub_f32 v12, v12, v28
v_sub_f32 v13, v13, v28
v_sub_f32 v14, v14, v28
v_sub_f32 v15, v15, v28
v_sub_f32 v16, v16, v28
v_sub_f32 v17, v17, v28
v_sub_f32 v18, v18, v28
v_sub_f32 v19, v19, v28
v_mul_f32 v32, v12, v12
v_fmac_f32 v32, v13, v13
v_fmac_f32 v32, v14, v14
v_fmac_f32 v32, v15, v15
v_fmac_f32 v32, v16, v16
v_fmac_f32 v32, v17, v17
v_fmac_f32 v32, v18, v18
v_fmac_f32 v32, v19, v19
v_sub_f32 v20, v20, v29
v_sub_f32 v21, v21, v29
v_sub_f32 v22, v22, v29
v_sub_f32 v23, v23, v29
v_sub_f32 v24, v24, v29
v_sub_f32 v25, v25, v29
v_sub_f32 v26, v26, v29
v_sub_f32 v27, v27, v29
v_mul_f32 v33, v20, v20
v_fmac_f32 v33, v21, v21
v_fmac_f32 v33, v22, v22
v_fmac_f32 v33, v23, v23
v_fmac_f32 v33, v24, v24
v_fmac_f32 v33, v25, v25
v_fmac_f32 v33, v26, v26
v_fmac_f32 v33, v27, v27
v_add_f32_dpp v32, v32, v32 row_ror:8 row_mask:0xf bank_mask:0xf
s_nop 0
v_add_f32_dpp v33, v33, v33 row_ror:8 row_mask:0xf bank_mask:0xf
v_add_f32_dpp v32, v32, v32 row_ror:4 row_mask:0xf bank_mask:0xf
s_nop 0
v_add_f32_dpp v33, v33, v33 row_ror:4 row_mask:0xf bank_mask:0xf
v_add_f32_dpp v32, v32, v32 row_ror:2 row_mask:0xf bank_mask:0xf
s_nop 0
v_add_f32_dpp v33, v33, v33 row_ror:2 row_mask:0xf bank_mask:0xf
v_add_f32_dpp v32, v32, v32 row_ror:1 row_mask:0xf bank_mask:0xf
s_nop 0
v_add_f32_dpp v33, v33, v33 row_ror:1 row_mask:0xf bank_mask:0xf
v_mov_b32 v30, v32
v_mov_b32 v31, v33
s_nop 0
v_permlane16_swap_b32 v32, v30
v_permlane16_swap_b32 v33, v31
v_add_f32 v32, v32, v30
v_add_f32 v33, v33, v31
v_mov_b32 v30, v32
v_mov_b32 v31, v33
s_nop 0
v_permlane32_swap_b32 v32, v30
v_permlane32_swap_b32 v33, v31
v_add_f32 v32, v32, v30
v_add_f32 v33, v33, v31
v_mov_b32 v34, 0x3727c5ac
v_mul_f32 v32, 0x3b000000, v32
v_add_f32 v32, v32, v34
v_rsq_f32 v32, v32
v_mul_f32 v33, 0x3b000000, v33
v_add_f32 v33, v33, v34
v_rsq_f32 v33, v33
v_mul_f32 v12, v12, v32
v_mul_f32 v13, v13, v32
v_mul_f32 v14, v14, v32
v_mul_f32 v15, v15, v32
v_mul_f32 v16, v16, v32
v_mul_f32 v17, v17, v32
v_mul_f32 v18, v18, v32
v_mul_f32 v19, v19, v32
v_cvt_pk_bf16_f32 v52, v12, v13
v_cvt_pk_bf16_f32 v53, v14, v15
v_cvt_pk_bf16_f32 v54, v16, v17
v_cvt_pk_bf16_f32 v55, v18, v19
buffer_store_dwordx4 v[52:55], v1, s[44:47], s69 offen offset:2048 sc1
v_mul_f32 v20, v20, v33
v_mul_f32 v21, v21, v33
v_mul_f32 v22, v22, v33
v_mul_f32 v23, v23, v33
v_mul_f32 v24, v24, v33
v_mul_f32 v25, v25, v33
v_mul_f32 v26, v26, v33
v_mul_f32 v27, v27, v33
v_cvt_pk_bf16_f32 v56, v20, v21
v_cvt_pk_bf16_f32 v57, v22, v23
v_cvt_pk_bf16_f32 v58, v24, v25
v_cvt_pk_bf16_f32 v59, v26, v27
buffer_store_dwordx4 v[56:59], v1, s[44:47], s69 offen offset:3072 sc1
s_lshl_b32 s55, s48, 10
s_add_u32 s55, s55, s64
buffer_store_dwordx4 v[84:87], v1, s[44:47], s55 offen sc1
s_add_u32 s55, s55, 4096
buffer_store_dwordx4 v[84:87], v1, s[44:47], s55 offen sc1
s_add_u32 s55, s55, 4096
buffer_store_dwordx4 v[88:91], v1, s[44:47], s55 offen sc1
s_bitcmp1_b32 s50, 1
s_cbranch_scc1 L_x_b_81
s_add_u32 m0, s63, 4096
s_add_u32 s60, s61, 262144
buffer_load_dwordx4 v212, s[16:19], s60 offen offset:0  lds
s_add_u32 m0, s63, 5120
s_add_u32 s60, s61, 327680
buffer_load_dwordx4 v216, s[16:19], s60 offen offset:0  lds
s_add_u32 m0, s63, 6144
s_add_u32 s60, s61, 393216
buffer_load_dwordx4 v212, s[16:19], s60 offen offset:0  lds
s_add_u32 m0, s63, 7168
s_add_u32 s60, s61, 458752
buffer_load_dwordx4 v216, s[16:19], s60 offen offset:0  lds
s_add_u32 m0, s63, 8192
s_add_u32 s60, s61, 524288
buffer_load_dwordx4 v212, s[16:19], s60 offen offset:0  lds
s_add_u32 m0, s63, 9216
s_add_u32 s60, s61, 589824
buffer_load_dwordx4 v216, s[16:19], s60 offen offset:0  lds
s_add_u32 m0, s63, 10240
s_add_u32 s60, s61, 655360
buffer_load_dwordx4 v212, s[16:19], s60 offen offset:0  lds
s_add_u32 m0, s63, 11264
s_add_u32 s60, s61, 720896
buffer_load_dwordx4 v216, s[16:19], s60 offen offset:0  lds
s_branch L_x_e_82
L_x_b_81:
s_add_u32 m0, s63, 4096
s_add_u32 s60, s61, 262144
buffer_load_dwordx4 v212, s[20:23], s60 offen offset:0  lds
s_add_u32 m0, s63, 5120
s_add_u32 s60, s61, 327680
buffer_load_dwordx4 v216, s[20:23], s60 offen offset:0  lds
s_add_u32 m0, s63, 6144
s_add_u32 s60, s61, 393216
buffer_load_dwordx4 v212, s[20:23], s60 offen offset:0  lds
s_add_u32 m0, s63, 7168
s_add_u32 s60, s61, 458752
buffer_load_dwordx4 v216, s[20:23], s60 offen offset:0  lds
s_add_u32 m0, s63, 8192
s_add_u32 s60, s61, 524288
buffer_load_dwordx4 v212, s[20:23], s60 offen offset:0  lds
s_add_u32 m0, s63, 9216
s_add_u32 s60, s61, 589824
buffer_load_dwordx4 v216, s[20:23], s60 offen offset:0  lds
s_add_u32 m0, s63, 10240
s_add_u32 s60, s61, 655360
buffer_load_dwordx4 v212, s[20:23], s60 offen offset:0  lds
s_add_u32 m0, s63, 11264
s_add_u32 s60, s61, 720896
buffer_load_dwordx4 v216, s[20:23], s60 offen offset:0  lds
L_x_e_82:
s_waitcnt vmcnt(8)
s_barrier
s_cmp_lg_u32 s48, 0
s_cbranch_scc1 L_ga_83
v_mov_b32 v60, 1
s_mov_b64 exec, 1
buffer_atomic_add v60, off, s[40:43], 0 offset:8
s_mov_b64 exec, -1
L_ga_83:
s_cmp_lg_u32 s49, 7
s_cbranch_scc1 L_gg_85
s_or_b32 s55, s48, s50
s_cbranch_scc1 L_end
v_lshrrev_b32 v61, 2, v1
L_gl_84:
s_add_u32 s54, s54, 1
s_cmp_gt_u32 s54, 400000
s_cbranch_scc1 L_end
buffer_load_dword v62, v61, s[40:43], 0 offen sc1
s_waitcnt vmcnt(0)
v_readlane_b32 s57, v62, 2
v_cmp_ne_u32 vcc, -1, v62
s_nop 0
s_and_b32 s55, vcc_lo, 0x1010101
s_and_b32 s56, vcc_hi, 0x1010101
s_or_b32 s55, s55, s56
s_xor_b32 s57, s57, 160
s_or_b32 s55, s55, s57
s_cbranch_scc1 L_gl_84
v_cmp_ne_u32 vcc, 0, v62
s_nop 0
s_and_b32 s55, vcc_lo, 0x2020202
s_and_b32 s56, vcc_hi, 0x2020202
s_or_b32 s55, s55, s56
s_cselect_b32 s55, 0x10001, 1
v_mov_b32 v62, s55
s_mov_b64 exec, 1
buffer_store_dword v62, off, s[40:43], 0 offset:136 sc1
s_mov_b64 exec, -1
s_branch L_end
L_gg_85:
s_bitcmp1_b32 s50, 1
s_cbranch_scc1 L_x_b_86
s_mov_b32 s80, 0xaaaaaaaa
s_mov_b32 s81, 0xaaaaaaaa
v_mfma_f32_16x16x32_bf16 v[160:163], v[208:211], v[96:99], 0
v_mfma_f32_16x16x32_bf16 v[164:167], v[96:99], v[96:99], 0
v_mfma_f32_16x16x32_bf16 v[160:163], v[208:211], v[100:103], v[160:163]
v_mfma_f32_16x16x32_bf16 v[164:167], v[100:103], v[100:103], v[164:167]
v_mfma_f32_16x16x32_bf16 v[160:163], v[208:211], v[104:107], v[160:163]
v_mfma_f32_16x16x32_bf16 v[164:167], v[104:107], v[104:107], v[164:167]
v_mfma_f32_16x16x32_bf16 v[160:163], v[208:211], v[108:111], v[160:163]
v_mfma_f32_16x16x32_bf16 v[164:167], v[108:111], v[108:111], v[164:167]
s_add_u32 m0, s63, 12288
s_add_u32 s60, s61, 786432
buffer_load_dwordx4 v212, s[16:19], s60 offen offset:0  lds
v_mfma_f32_16x16x32_bf16 v[168:171], v[208:211], v[112:115], 0
v_mfma_f32_16x16x32_bf16 v[172:175], v[112:115], v[112:115], 0
v_mfma_f32_16x16x32_bf16 v[168:171], v[208:211], v[116:119], v[168:171]
v_mfma_f32_16x16x32_bf16 v[172:175], v[116:119], v[116:119], v[172:175]
v_mfma_f32_16x16x32_bf16 v[168:171], v[208:211], v[120:123], v[168:171]
v_mfma_f32_16x16x32_bf16 v[172:175], v[120:123], v[120:123], v[172:175]
v_mfma_f32_16x16x32_bf16 v[168:171], v[208:211], v[124:127], v[168:171]
v_mfma_f32_16x16x32_bf16 v[172:175], v[124:127], v[124:127], v[172:175]
s_add_u32 m0, s63, 13312
s_add_u32 s60, s61, 851968
buffer_load_dwordx4 v216, s[16:19], s60 offen offset:0  lds
v_mfma_f32_16x16x32_bf16 v[176:179], v[208:211], v[128:131], 0
v_mfma_f32_16x16x32_bf16 v[180:183], v[128:131], v[128:131], 0
v_mfma_f32_16x16x32_bf16 v[176:179], v[208:211], v[132:135], v[176:179]
v_mfma_f32_16x16x32_bf16 v[180:183], v[132:135], v[132:135], v[180:183]
v_mfma_f32_16x16x32_bf16 v[176:179], v[208:211], v[136:139], v[176:179]
v_mfma_f32_16x16x32_bf16 v[180:183], v[136:139], v[136:139], v[180:183]
v_mfma_f32_16x16x32_bf16 v[176:179], v[208:211], v[140:143], v[176:179]
v_mfma_f32_16x16x32_bf16 v[180:183], v[140:143], v[140:143], v[180:183]
s_add_u32 m0, s63, 14336
s_add_u32 s60, s61, 917504
buffer_load_dwordx4 v212, s[16:19], s60 offen offset:0  lds
v_mfma_f32_16x16x32_bf16 v[184:187], v[208:211], v[144:147], 0
v_mfma_f32_16x16x32_bf16 v[188:191], v[144:147], v[144:147], 0
v_mfma_f32_16x16x32_bf16 v[184:187], v[208:211], v[148:151], v[184:187]
v_mfma_f32_16x16x32_bf16 v[188:191], v[148:151], v[148:151], v[188:191]
v_mfma_f32_16x16x32_bf16 v[184:187], v[208:211], v[152:155], v[184:187]
v_mfma_f32_16x16x32_bf16 v[188:191], v[152:155], v[152:155], v[188:191]
v_mfma_f32_16x16x32_bf16 v[184:187], v[208:211], v[156:159], v[184:187]
v_mfma_f32_16x16x32_bf16 v[188:191], v[156:159], v[156:159], v[188:191]
s_add_u32 m0, s63, 15360
s_add_u32 s60, s61, 983040
buffer_load_dwordx4 v216, s[16:19], s60 offen offset:0  lds
v_bfe_u32 v192, v0, 0, 4
v_lshlrev_b32 v231, 5, v192
v_add_u32 v231, 139264, v231
s_lshl_b32 s55, s48, 9
v_add_u32 v200, s55, v231
v_mov_b32 v192, v160
v_cndmask_b32 v164, v164, v165, s[80:81]
v_cndmask_b32 v166, v166, v167, s[80:81]
s_add_u32 m0, s63, 16384
s_add_u32 s60, s61, 0
buffer_load_dwordx4 v212, s[12:15], s60 offen offset:0  lds
v_cndmask_b32 v193, v164, v166, s[78:79]
v_mov_b32 v194, v168
v_cndmask_b32 v172, v172, v173, s[80:81]
v_cndmask_b32 v174, v174, v175, s[80:81]
v_cndmask_b32 v195, v172, v174, s[78:79]
v_mov_b32 v196, v176
v_cndmask_b32 v180, v180, v181, s[80:81]
v_cndmask_b32 v182, v182, v183, s[80:81]
s_add_u32 m0, s63, 17408
s_add_u32 s60, s61, 65536
buffer_load_dwordx4 v216, s[12:15], s60 offen offset:0  lds
v_cndmask_b32 v197, v180, v182, s[78:79]
v_mov_b32 v198, v184
v_cndmask_b32 v188, v188, v189, s[80:81]
v_cndmask_b32 v190, v190, v191, s[80:81]
v_cndmask_b32 v199, v188, v190, s[78:79]
s_mov_b32 exec_lo, 0x00f0000f
s_mov_b32 exec_hi, 0xf0000f00
ds_write_b128 v200, v[192:195] offset:0
ds_write_b128 v200, v[196:199] offset:16
s_mov_b64 exec, -1
s_waitcnt lgkmcnt(0)
s_barrier
ds_read_b128 v[160:163], v231 offset:0
ds_read_b128 v[164:167], v231 offset:16
ds_read_b128 v[168:171], v231 offset:512
ds_read_b128 v[172:175], v231 offset:528
ds_read_b128 v[176:179], v231 offset:1024
ds_read_b128 v[180:183], v231 offset:1040
ds_read_b128 v[184:187], v231 offset:1536
ds_read_b128 v[188:191], v231 offset:1552
s_add_u32 m0, s63, 18432
s_add_u32 s60, s61, 131072
buffer_load_dwordx4 v212, s[12:15], s60 offen offset:0  lds
s_waitcnt lgkmcnt(0)
v_pk_add_f32 v[160:161], v[160:161], v[168:169]
v_pk_add_f32 v[162:163], v[162:163], v[170:171]
v_pk_add_f32 v[164:165], v[164:165], v[172:173]
s_add_u32 m0, s63, 19456
s_add_u32 s60, s61, 196608
buffer_load_dwordx4 v216, s[12:15], s60 offen offset:0  lds
v_pk_add_f32 v[166:167], v[166:167], v[174:175]
v_pk_add_f32 v[176:177], v[176:177], v[184:185]
v_pk_add_f32 v[178:179], v[178:179], v[186:187]
v_pk_add_f32 v[180:181], v[180:181], v[188:189]
v_pk_add_f32 v[182:183], v[182:183], v[190:191]
v_pk_add_f32 v[160:161], v[160:161], v[176:177]
v_pk_add_f32 v[162:163], v[162:163], v[178:179]
v_pk_add_f32 v[164:165], v[164:165], v[180:181]
s_add_u32 m0, s63, 20480
s_add_u32 s60, s61, 262144
buffer_load_dwordx4 v212, s[12:15], s60 offen offset:0  lds
v_pk_add_f32 v[166:167], v[166:167], v[182:183]
v_mul_f32 v160, 0x3b000000, v160
v_mul_f32 v161, 0x3b000000, v161
v_fma_f32 v161, -v160, v160, v161
v_max_f32 v161, 0, v161
v_add_f32 v161, 0x3727c5ac, v161
v_rsq_f32 v192, v161
v_mul_f32 v162, 0x3b000000, v162
s_add_u32 m0, s63, 21504
s_add_u32 s60, s61, 327680
buffer_load_dwordx4 v216, s[12:15], s60 offen offset:0  lds
v_mul_f32 v163, 0x3b000000, v163
v_fma_f32 v163, -v162, v162, v163
v_max_f32 v163, 0, v163
v_add_f32 v163, 0x3727c5ac, v163
v_rsq_f32 v194, v163
v_mul_f32 v164, 0x3b000000, v164
v_mul_f32 v165, 0x3b000000, v165
v_fma_f32 v165, -v164, v164, v165
s_add_u32 m0, s63, 22528
s_add_u32 s60, s61, 393216
buffer_load_dwordx4 v212, s[12:15], s60 offen offset:0  lds
v_max_f32 v165, 0, v165
v_add_f32 v165, 0x3727c5ac, v165
v_rsq_f32 v196, v165
v_mul_f32 v166, 0x3b000000, v166
v_mul_f32 v167, 0x3b000000, v167
v_fma_f32 v167, -v166, v166, v167
v_max_f32 v167, 0, v167
v_add_f32 v167, 0x3727c5ac, v167
s_add_u32 m0, s63, 23552
s_add_u32 s60, s61, 458752
buffer_load_dwordx4 v216, s[12:15], s60 offen offset:0  lds
v_rsq_f32 v198, v167
v_mul_f32 v193, -v160, v192
v_mul_f32 v195, -v162, v194
v_mul_f32 v197, -v164, v196
v_mul_f32 v199, -v166, v198
v_lshlrev_b32 v168, 16, v96
v_and_b32 v169, 0xffff0000, v96
v_lshlrev_b32 v170, 16, v97
s_add_u32 m0, s63, 24576
s_add_u32 s60, s61, 524288
buffer_load_dwordx4 v212, s[12:15], s60 offen offset:0  lds
v_and_b32 v171, 0xffff0000, v97
v_lshlrev_b32 v172, 16, v98
v_and_b32 v173, 0xffff0000, v98
v_lshlrev_b32 v174, 16, v99
v_and_b32 v175, 0xffff0000, v99
v_pk_fma_f32 v[168:169], v[168:169], v[192:193], v[192:193] op_sel:[0,0,1] op_sel_hi:[1,0,1]
v_pk_fma_f32 v[170:171], v[170:171], v[192:193], v[192:193] op_sel:[0,0,1] op_sel_hi:[1,0,1]
v_pk_fma_f32 v[172:173], v[172:173], v[192:193], v[192:193] op_sel:[0,0,1] op_sel_hi:[1,0,1]
s_add_u32 m0, s63, 25600
s_add_u32 s60, s61, 589824
buffer_load_dwordx4 v216, s[12:15], s60 offen offset:0  lds
v_pk_fma_f32 v[174:175], v[174:175], v[192:193], v[192:193] op_sel:[0,0,1] op_sel_hi:[1,0,1]
v_cvt_pk_bf16_f32 v4, v168, v169
v_cvt_pk_bf16_f32 v5, v170, v171
v_cvt_pk_bf16_f32 v6, v172, v173
v_cvt_pk_bf16_f32 v7, v174, v175
v_lshlrev_b32 v176, 16, v100
v_and_b32 v177, 0xffff0000, v100
v_lshlrev_b32 v178, 16, v101
s_add_u32 m0, s63, 26624
s_add_u32 s60, s61, 655360
buffer_load_dwordx4 v212, s[12:15], s60 offen offset:0  lds
v_and_b32 v179, 0xffff0000, v101
v_lshlrev_b32 v180, 16, v102
v_and_b32 v181, 0xffff0000, v102
v_lshlrev_b32 v182, 16, v103
v_and_b32 v183, 0xffff0000, v103
v_pk_fma_f32 v[176:177], v[176:177], v[192:193], v[192:193] op_sel:[0,0,1] op_sel_hi:[1,0,1]
v_pk_fma_f32 v[178:179], v[178:179], v[192:193], v[192:193] op_sel:[0,0,1] op_sel_hi:[1,0,1]
v_pk_fma_f32 v[180:181], v[180:181], v[192:193], v[192:193] op_sel:[0,0,1] op_sel_hi:[1,0,1]
s_add_u32 m0, s63, 27648
s_add_u32 s60, s61, 720896
buffer_load_dwordx4 v216, s[12:15], s60 offen offset:0  lds
v_pk_fma_f32 v[182:183], v[182:183], v[192:193], v[192:193] op_sel:[0,0,1] op_sel_hi:[1,0,1]
v_cvt_pk_bf16_f32 v8, v176, v177
v_cvt_pk_bf16_f32 v9, v178, v179
v_cvt_pk_bf16_f32 v10, v180, v181
v_cvt_pk_bf16_f32 v11, v182, v183
v_lshlrev_b32 v168, 16, v104
v_and_b32 v169, 0xffff0000, v104
v_lshlrev_b32 v170, 16, v105
s_add_u32 m0, s63, 28672
s_add_u32 s60, s61, 786432
buffer_load_dwordx4 v212, s[12:15], s60 offen offset:0  lds
v_and_b32 v171, 0xffff0000, v105
v_lshlrev_b32 v172, 16, v106
v_and_b32 v173, 0xffff0000, v106
v_lshlrev_b32 v174, 16, v107
v_and_b32 v175, 0xffff0000, v107
v_pk_fma_f32 v[168:169], v[168:169], v[192:193], v[192:193] op_sel:[0,0,1] op_sel_hi:[1,0,1]
v_pk_fma_f32 v[170:171], v[170:171], v[192:193], v[192:193] op_sel:[0,0,1] op_sel_hi:[1,0,1]
v_pk_fma_f32 v[172:173], v[172:173], v[192:193], v[192:193] op_sel:[0,0,1] op_sel_hi:[1,0,1]
s_add_u32 m0, s63, 29696
s_add_u32 s60, s61, 851968
buffer_load_dwordx4 v216, s[12:15], s60 offen offset:0  lds
v_pk_fma_f32 v[174:175], v[174:175], v[192:193], v[192:193] op_sel:[0,0,1] op_sel_hi:[1,0,1]
v_cvt_pk_bf16_f32 v12, v168, v169
v_cvt_pk_bf16_f32 v13, v170, v171
v_cvt_pk_bf16_f32 v14, v172, v173
v_cvt_pk_bf16_f32 v15, v174, v175
v_lshlrev_b32 v176, 16, v108
v_and_b32 v177, 0xffff0000, v108
v_lshlrev_b32 v178, 16, v109
s_add_u32 m0, s63, 30720
s_add_u32 s60, s61, 917504
buffer_load_dwordx4 v212, s[12:15], s60 offen offset:0  lds
v_and_b32 v179, 0xffff0000, v109
v_lshlrev_b32 v180, 16, v110
v_and_b32 v181, 0xffff0000, v110
v_lshlrev_b32 v182, 16, v111
v_and_b32 v183, 0xffff0000, v111
v_pk_fma_f32 v[176:177], v[176:177], v[192:193], v[192:193] op_sel:[0,0,1] op_sel_hi:[1,0,1]
v_pk_fma_f32 v[178:179], v[178:179], v[192:193], v[192:193] op_sel:[0,0,1] op_sel_hi:[1,0,1]
v_pk_fma_f32 v[180:181], v[180:181], v[192:193], v[192:193] op_sel:[0,0,1] op_sel_hi:[1,0,1]
s_add_u32 m0, s63, 31744
s_add_u32 s60, s61, 983040
buffer_load_dwordx4 v216, s[12:15], s60 offen offset:0  lds
v_pk_fma_f32 v[182:183], v[182:183], v[192:193], v[192:193] op_sel:[0,0,1] op_sel_hi:[1,0,1]
v_cvt_pk_bf16_f32 v16, v176, v177
v_cvt_pk_bf16_f32 v17, v178, v179
v_cvt_pk_bf16_f32 v18, v180, v181
v_cvt_pk_bf16_f32 v19, v182, v183
v_lshlrev_b32 v168, 16, v112
v_and_b32 v169, 0xffff0000, v112
v_lshlrev_b32 v170, 16, v113
v_and_b32 v171, 0xffff0000, v113
v_lshlrev_b32 v172, 16, v114
v_and_b32 v173, 0xffff0000, v114
v_lshlrev_b32 v174, 16, v115
v_and_b32 v175, 0xffff0000, v115
v_pk_fma_f32 v[168:169], v[168:169], v[194:195], v[194:195] op_sel:[0,0,1] op_sel_hi:[1,0,1]
v_pk_fma_f32 v[170:171], v[170:171], v[194:195], v[194:195] op_sel:[0,0,1] op_sel_hi:[1,0,1]
v_pk_fma_f32 v[172:173], v[172:173], v[194:195], v[194:195] op_sel:[0,0,1] op_sel_hi:[1,0,1]
v_pk_fma_f32 v[174:175], v[174:175], v[194:195], v[194:195] op_sel:[0,0,1] op_sel_hi:[1,0,1]
v_cvt_pk_bf16_f32 v20, v168, v169
v_cvt_pk_bf16_f32 v21, v170, v171
v_cvt_pk_bf16_f32 v22, v172, v173
v_cvt_pk_bf16_f32 v23, v174, v175
v_lshlrev_b32 v176, 16, v116
v_and_b32 v177, 0xffff0000, v116
v_lshlrev_b32 v178, 16, v117
v_and_b32 v179, 0xffff0000, v117
v_lshlrev_b32 v180, 16, v118
v_and_b32 v181, 0xffff0000, v118
v_lshlrev_b32 v182, 16, v119
v_and_b32 v183, 0xffff0000, v119
v_pk_fma_f32 v[176:177], v[176:177], v[194:195], v[194:195] op_sel:[0,0,1] op_sel_hi:[1,0,1]
v_pk_fma_f32 v[178:179], v[178:179], v[194:195], v[194:195] op_sel:[0,0,1] op_sel_hi:[1,0,1]
v_pk_fma_f32 v[180:181], v[180:181], v[194:195], v[194:195] op_sel:[0,0,1] op_sel_hi:[1,0,1]
v_pk_fma_f32 v[182:183], v[182:183], v[194:195], v[194:195] op_sel:[0,0,1] op_sel_hi:[1,0,1]
v_cvt_pk_bf16_f32 v24, v176, v177
v_cvt_pk_bf16_f32 v25, v178, v179
v_cvt_pk_bf16_f32 v26, v180, v181
v_cvt_pk_bf16_f32 v27, v182, v183
v_lshlrev_b32 v168, 16, v120
v_and_b32 v169, 0xffff0000, v120
v_lshlrev_b32 v170, 16, v121
v_and_b32 v171, 0xffff0000, v121
v_lshlrev_b32 v172, 16, v122
v_and_b32 v173, 0xffff0000, v122
v_lshlrev_b32 v174, 16, v123
v_and_b32 v175, 0xffff0000, v123
v_pk_fma_f32 v[168:169], v[168:169], v[194:195], v[194:195] op_sel:[0,0,1] op_sel_hi:[1,0,1]
v_pk_fma_f32 v[170:171], v[170:171], v[194:195], v[194:195] op_sel:[0,0,1] op_sel_hi:[1,0,1]
v_pk_fma_f32 v[172:173], v[172:173], v[194:195], v[194:195] op_sel:[0,0,1] op_sel_hi:[1,0,1]
v_pk_fma_f32 v[174:175], v[174:175], v[194:195], v[194:195] op_sel:[0,0,1] op_sel_hi:[1,0,1]
v_cvt_pk_bf16_f32 v28, v168, v169
v_cvt_pk_bf16_f32 v29, v170, v171
v_cvt_pk_bf16_f32 v30, v172, v173
v_cvt_pk_bf16_f32 v31, v174, v175
v_lshlrev_b32 v176, 16, v124
v_and_b32 v177, 0xffff0000, v124
v_lshlrev_b32 v178, 16, v125
v_and_b32 v179, 0xffff0000, v125
v_lshlrev_b32 v180, 16, v126
v_and_b32 v181, 0xffff0000, v126
v_lshlrev_b32 v182, 16, v127
v_and_b32 v183, 0xffff0000, v127
v_pk_fma_f32 v[176:177], v[176:177], v[194:195], v[194:195] op_sel:[0,0,1] op_sel_hi:[1,0,1]
v_pk_fma_f32 v[178:179], v[178:179], v[194:195], v[194:195] op_sel:[0,0,1] op_sel_hi:[1,0,1]
v_pk_fma_f32 v[180:181], v[180:181], v[194:195], v[194:195] op_sel:[0,0,1] op_sel_hi:[1,0,1]
v_pk_fma_f32 v[182:183], v[182:183], v[194:195], v[194:195] op_sel:[0,0,1] op_sel_hi:[1,0,1]
v_cvt_pk_bf16_f32 v32, v176, v177
v_cvt_pk_bf16_f32 v33, v178, v179
v_cvt_pk_bf16_f32 v34, v180, v181
v_cvt_pk_bf16_f32 v35, v182, v183
v_lshlrev_b32 v168, 16, v128
v_and_b32 v169, 0xffff0000, v128
v_lshlrev_b32 v170, 16, v129
v_and_b32 v171, 0xffff0000, v129
v_lshlrev_b32 v172, 16, v130
v_and_b32 v173, 0xffff0000, v130
v_lshlrev_b32 v174, 16, v131
v_and_b32 v175, 0xffff0000, v131
v_pk_fma_f32 v[168:169], v[168:169], v[196:197], v[196:197] op_sel:[0,0,1] op_sel_hi:[1,0,1]
v_pk_fma_f32 v[170:171], v[170:171], v[196:197], v[196:197] op_sel:[0,0,1] op_sel_hi:[1,0,1]
v_pk_fma_f32 v[172:173], v[172:173], v[196:197], v[196:197] op_sel:[0,0,1] op_sel_hi:[1,0,1]
v_pk_fma_f32 v[174:175], v[174:175], v[196:197], v[196:197] op_sel:[0,0,1] op_sel_hi:[1,0,1]
v_cvt_pk_bf16_f32 v36, v168, v169
v_cvt_pk_bf16_f32 v37, v170, v171
v_cvt_pk_bf16_f32 v38, v172, v173
v_cvt_pk_bf16_f32 v39, v174, v175
v_lshlrev_b32 v176, 16, v132
v_and_b32 v177, 0xffff0000, v132
v_lshlrev_b32 v178, 16, v133
v_and_b32 v179, 0xffff0000, v133
v_lshlrev_b32 v180, 16, v134
v_and_b32 v181, 0xffff0000, v134
v_lshlrev_b32 v182, 16, v135
v_and_b32 v183, 0xffff0000, v135
v_pk_fma_f32 v[176:177], v[176:177], v[196:197], v[196:197] op_sel:[0,0,1] op_sel_hi:[1,0,1]
v_pk_fma_f32 v[178:179], v[178:179], v[196:197], v[196:197] op_sel:[0,0,1] op_sel_hi:[1,0,1]
v_pk_fma_f32 v[180:181], v[180:181], v[196:197], v[196:197] op_sel:[0,0,1] op_sel_hi:[1,0,1]
v_pk_fma_f32 v[182:183], v[182:183], v[196:197], v[196:197] op_sel:[0,0,1] op_sel_hi:[1,0,1]
v_cvt_pk_bf16_f32 v40, v176, v177
v_cvt_pk_bf16_f32 v41, v178, v179
v_cvt_pk_bf16_f32 v42, v180, v181
v_cvt_pk_bf16_f32 v43, v182, v183
v_lshlrev_b32 v168, 16, v136
v_and_b32 v169, 0xffff0000, v136
v_lshlrev_b32 v170, 16, v137
v_and_b32 v171, 0xffff0000, v137
v_lshlrev_b32 v172, 16, v138
v_and_b32 v173, 0xffff0000, v138
v_lshlrev_b32 v174, 16, v139
v_and_b32 v175, 0xffff0000, v139
v_pk_fma_f32 v[168:169], v[168:169], v[196:197], v[196:197] op_sel:[0,0,1] op_sel_hi:[1,0,1]
v_pk_fma_f32 v[170:171], v[170:171], v[196:197], v[196:197] op_sel:[0,0,1] op_sel_hi:[1,0,1]
v_pk_fma_f32 v[172:173], v[172:173], v[196:197], v[196:197] op_sel:[0,0,1] op_sel_hi:[1,0,1]
v_pk_fma_f32 v[174:175], v[174:175], v[196:197], v[196:197] op_sel:[0,0,1] op_sel_hi:[1,0,1]
v_cvt_pk_bf16_f32 v44, v168, v169
v_cvt_pk_bf16_f32 v45, v170, v171
v_cvt_pk_bf16_f32 v46, v172, v173
v_cvt_pk_bf16_f32 v47, v174, v175
v_lshlrev_b32 v176, 16, v140
v_and_b32 v177, 0xffff0000, v140
v_lshlrev_b32 v178, 16, v141
v_and_b32 v179, 0xffff0000, v141
v_lshlrev_b32 v180, 16, v142
v_and_b32 v181, 0xffff0000, v142
v_lshlrev_b32 v182, 16, v143
v_and_b32 v183, 0xffff0000, v143
v_pk_fma_f32 v[176:177], v[176:177], v[196:197], v[196:197] op_sel:[0,0,1] op_sel_hi:[1,0,1]
v_pk_fma_f32 v[178:179], v[178:179], v[196:197], v[196:197] op_sel:[0,0,1] op_sel_hi:[1,0,1]
v_pk_fma_f32 v[180:181], v[180:181], v[196:197], v[196:197] op_sel:[0,0,1] op_sel_hi:[1,0,1]
v_pk_fma_f32 v[182:183], v[182:183], v[196:197], v[196:197] op_sel:[0,0,1] op_sel_hi:[1,0,1]
v_cvt_pk_bf16_f32 v48, v176, v177
v_cvt_pk_bf16_f32 v49, v178, v179
v_cvt_pk_bf16_f32 v50, v180, v181
v_cvt_pk_bf16_f32 v51, v182, v183
v_lshlrev_b32 v168, 16, v144
v_and_b32 v169, 0xffff0000, v144
v_lshlrev_b32 v170, 16, v145
v_and_b32 v171, 0xffff0000, v145
v_lshlrev_b32 v172, 16, v146
v_and_b32 v173, 0xffff0000, v146
v_lshlrev_b32 v174, 16, v147
v_and_b32 v175, 0xffff0000, v147
v_pk_fma_f32 v[168:169], v[168:169], v[198:199], v[198:199] op_sel:[0,0,1] op_sel_hi:[1,0,1]
v_pk_fma_f32 v[170:171], v[170:171], v[198:199], v[198:199] op_sel:[0,0,1] op_sel_hi:[1,0,1]
v_pk_fma_f32 v[172:173], v[172:173], v[198:199], v[198:199] op_sel:[0,0,1] op_sel_hi:[1,0,1]
v_pk_fma_f32 v[174:175], v[174:175], v[198:199], v[198:199] op_sel:[0,0,1] op_sel_hi:[1,0,1]
v_cvt_pk_bf16_f32 v52, v168, v169
v_cvt_pk_bf16_f32 v53, v170, v171
v_cvt_pk_bf16_f32 v54, v172, v173
v_cvt_pk_bf16_f32 v55, v174, v175
v_lshlrev_b32 v176, 16, v148
v_and_b32 v177, 0xffff0000, v148
v_lshlrev_b32 v178, 16, v149
v_and_b32 v179, 0xffff0000, v149
v_lshlrev_b32 v180, 16, v150
v_and_b32 v181, 0xffff0000, v150
v_lshlrev_b32 v182, 16, v151
v_and_b32 v183, 0xffff0000, v151
v_pk_fma_f32 v[176:177], v[176:177], v[198:199], v[198:199] op_sel:[0,0,1] op_sel_hi:[1,0,1]
v_pk_fma_f32 v[178:179], v[178:179], v[198:199], v[198:199] op_sel:[0,0,1] op_sel_hi:[1,0,1]
v_pk_fma_f32 v[180:181], v[180:181], v[198:199], v[198:199] op_sel:[0,0,1] op_sel_hi:[1,0,1]
v_pk_fma_f32 v[182:183], v[182:183], v[198:199], v[198:199] op_sel:[0,0,1] op_sel_hi:[1,0,1]
v_cvt_pk_bf16_f32 v56, v176, v177
v_cvt_pk_bf16_f32 v57, v178, v179
v_cvt_pk_bf16_f32 v58, v180, v181
v_cvt_pk_bf16_f32 v59, v182, v183
v_lshlrev_b32 v168, 16, v152
v_and_b32 v169, 0xffff0000, v152
v_lshlrev_b32 v170, 16, v153
v_and_b32 v171, 0xffff0000, v153
v_lshlrev_b32 v172, 16, v154
v_and_b32 v173, 0xffff0000, v154
v_lshlrev_b32 v174, 16, v155
v_and_b32 v175, 0xffff0000, v155
v_pk_fma_f32 v[168:169], v[168:169], v[198:199], v[198:199] op_sel:[0,0,1] op_sel_hi:[1,0,1]
v_pk_fma_f32 v[170:171], v[170:171], v[198:199], v[198:199] op_sel:[0,0,1] op_sel_hi:[1,0,1]
v_pk_fma_f32 v[172:173], v[172:173], v[198:199], v[198:199] op_sel:[0,0,1] op_sel_hi:[1,0,1]
v_pk_fma_f32 v[174:175], v[174:175], v[198:199], v[198:199] op_sel:[0,0,1] op_sel_hi:[1,0,1]
v_cvt_pk_bf16_f32 v60, v168, v169
v_cvt_pk_bf16_f32 v61, v170, v171
v_cvt_pk_bf16_f32 v62, v172, v173
v_cvt_pk_bf16_f32 v63, v174, v175
v_lshlrev_b32 v176, 16, v156
v_and_b32 v177, 0xffff0000, v156
v_lshlrev_b32 v178, 16, v157
v_and_b32 v179, 0xffff0000, v157
v_lshlrev_b32 v180, 16, v158
v_and_b32 v181, 0xffff0000, v158
v_lshlrev_b32 v182, 16, v159
v_and_b32 v183, 0xffff0000, v159
v_pk_fma_f32 v[176:177], v[176:177], v[198:199], v[198:199] op_sel:[0,0,1] op_sel_hi:[1,0,1]
v_pk_fma_f32 v[178:179], v[178:179], v[198:199], v[198:199] op_sel:[0,0,1] op_sel_hi:[1,0,1]
v_pk_fma_f32 v[180:181], v[180:181], v[198:199], v[198:199] op_sel:[0,0,1] op_sel_hi:[1,0,1]
v_pk_fma_f32 v[182:183], v[182:183], v[198:199], v[198:199] op_sel:[0,0,1] op_sel_hi:[1,0,1]
v_cvt_pk_bf16_f32 v236, v176, v177
v_cvt_pk_bf16_f32 v237, v178, v179
v_cvt_pk_bf16_f32 v238, v180, v181
v_cvt_pk_bf16_f32 v239, v182, v183
s_waitcnt vmcnt(16)
ds_read_b64_tr_b16 a[0:1], v215 offset:0
ds_read_b64_tr_b16 a[2:3], v215 offset:512
ds_read_b64_tr_b16 a[4:5], v215 offset:4096
ds_read_b64_tr_b16 a[6:7], v215 offset:4608
ds_read_b64_tr_b16 a[8:9], v215 offset:8192
ds_read_b64_tr_b16 a[10:11], v215 offset:8704
ds_read_b64_tr_b16 a[12:13], v215 offset:12288
ds_read_b64_tr_b16 a[14:15], v215 offset:12800
v_xor_b32 v231, 32, v215
ds_read_b64_tr_b16 a[16:17], v231 offset:0
ds_read_b64_tr_b16 a[18:19], v231 offset:512
ds_read_b64_tr_b16 a[20:21], v231 offset:4096
ds_read_b64_tr_b16 a[22:23], v231 offset:4608
ds_read_b64_tr_b16 a[24:25], v231 offset:8192
ds_read_b64_tr_b16 a[26:27], v231 offset:8704
ds_read_b64_tr_b16 a[28:29], v231 offset:12288
ds_read_b64_tr_b16 a[30:31], v231 offset:12800
v_xor_b32 v231, 64, v215
ds_read_b64_tr_b16 a[32:33], v231 offset:0
ds_read_b64_tr_b16 a[34:35], v231 offset:512
ds_read_b64_tr_b16 a[36:37], v231 offset:4096
ds_read_b64_tr_b16 a[38:39], v231 offset:4608
ds_read_b64_tr_b16 a[40:41], v231 offset:8192
ds_read_b64_tr_b16 a[42:43], v231 offset:8704
ds_read_b64_tr_b16 a[44:45], v231 offset:12288
ds_read_b64_tr_b16 a[46:47], v231 offset:12800
v_xor_b32 v231, 96, v215
ds_read_b64_tr_b16 a[48:49], v231 offset:0
ds_read_b64_tr_b16 a[50:51], v231 offset:512
ds_read_b64_tr_b16 a[52:53], v231 offset:4096
ds_read_b64_tr_b16 a[54:55], v231 offset:4608
ds_read_b64_tr_b16 a[56:57], v231 offset:8192
ds_read_b64_tr_b16 a[58:59], v231 offset:8704
ds_read_b64_tr_b16 a[60:61], v231 offset:12288
ds_read_b64_tr_b16 a[62:63], v231 offset:12800
s_waitcnt lgkmcnt(0)
v_mfma_f32_16x16x32_bf16 v[80:83], a[0:3], v[4:7], 0
v_mfma_f32_16x16x32_bf16 v[80:83], a[4:7], v[8:11], v[80:83]
v_mfma_f32_16x16x32_bf16 v[80:83], a[8:11], v[12:15], v[80:83]
v_mfma_f32_16x16x32_bf16 v[80:83], a[12:15], v[16:19], v[80:83]
v_mfma_f32_16x16x32_bf16 v[84:87], a[16:19], v[4:7], 0
v_mfma_f32_16x16x32_bf16 v[84:87], a[20:23], v[8:11], v[84:87]
v_mfma_f32_16x16x32_bf16 v[84:87], a[24:27], v[12:15], v[84:87]
v_mfma_f32_16x16x32_bf16 v[84:87], a[28:31], v[16:19], v[84:87]
v_mfma_f32_16x16x32_bf16 v[88:91], a[32:35], v[4:7], 0
v_mfma_f32_16x16x32_bf16 v[88:91], a[36:39], v[8:11], v[88:91]
ds_write_b128 v227, v[80:83] offset:0
v_mfma_f32_16x16x32_bf16 v[88:91], a[40:43], v[12:15], v[88:91]
v_mfma_f32_16x16x32_bf16 v[88:91], a[44:47], v[16:19], v[88:91]
v_mfma_f32_16x16x32_bf16 v[92:95], a[48:51], v[4:7], 0
v_mfma_f32_16x16x32_bf16 v[92:95], a[52:55], v[8:11], v[92:95]
ds_write_b128 v227, v[84:87] offset:1024
v_mfma_f32_16x16x32_bf16 v[92:95], a[56:59], v[12:15], v[92:95]
v_mfma_f32_16x16x32_bf16 v[92:95], a[60:63], v[16:19], v[92:95]
v_mfma_f32_16x16x32_bf16 v[96:99], a[0:3], v[20:23], 0
v_mfma_f32_16x16x32_bf16 v[96:99], a[4:7], v[24:27], v[96:99]
ds_write_b128 v227, v[88:91] offset:2048
v_mfma_f32_16x16x32_bf16 v[96:99], a[8:11], v[28:31], v[96:99]
v_mfma_f32_16x16x32_bf16 v[96:99], a[12:15], v[32:35], v[96:99]
v_mfma_f32_16x16x32_bf16 v[100:103], a[16:19], v[20:23], 0
v_mfma_f32_16x16x32_bf16 v[100:103], a[20:23], v[24:27], v[100:103]
ds_write_b128 v227, v[92:95] offset:3072
v_mfma_f32_16x16x32_bf16 v[100:103], a[24:27], v[28:31], v[100:103]
v_mfma_f32_16x16x32_bf16 v[100:103], a[28:31], v[32:35], v[100:103]
v_mfma_f32_16x16x32_bf16 v[104:107], a[32:35], v[20:23], 0
v_mfma_f32_16x16x32_bf16 v[104:107], a[36:39], v[24:27], v[104:107]
ds_write_b128 v227, v[96:99] offset:4096
v_mfma_f32_16x16x32_bf16 v[104:107], a[40:43], v[28:31], v[104:107]
v_mfma_f32_16x16x32_bf16 v[104:107], a[44:47], v[32:35], v[104:107]
v_mfma_f32_16x16x32_bf16 v[108:111], a[48:51], v[20:23], 0
v_mfma_f32_16x16x32_bf16 v[108:111], a[52:55], v[24:27], v[108:111]
ds_write_b128 v227, v[100:103] offset:5120
v_mfma_f32_16x16x32_bf16 v[108:111], a[56:59], v[28:31], v[108:111]
v_mfma_f32_16x16x32_bf16 v[108:111], a[60:63], v[32:35], v[108:111]
ds_write_b128 v227, v[104:107] offset:6144
s_nop 6
ds_write_b128 v227, v[108:111] offset:7168
s_waitcnt lgkmcnt(0)
s_barrier
ds_read_b128 v[112:115], v228 offset:0
ds_read_b128 v[116:119], v228 offset:32768
ds_read_b128 v[120:123], v229 offset:0
ds_read_b128 v[124:127], v229 offset:32768
ds_read_b128 v[128:131], v228 offset:1024
ds_read_b128 v[132:135], v228 offset:33792
ds_read_b128 v[136:139], v229 offset:1024
ds_read_b128 v[140:143], v229 offset:33792
s_waitcnt lgkmcnt(6)
v_pk_add_f32 v[112:113], v[112:113], v[116:117]
v_pk_add_f32 v[114:115], v[114:115], v[118:119]
s_waitcnt lgkmcnt(4)
v_pk_add_f32 v[120:121], v[120:121], v[124:125]
v_pk_add_f32 v[122:123], v[122:123], v[126:127]
v_pk_add_f32 v[112:113], v[112:113], v[120:121]
v_pk_add_f32 v[114:115], v[114:115], v[122:123]
v_cvt_pk_bf16_f32 v176, v112, v113
v_cvt_pk_bf16_f32 v177, v114, v115
s_waitcnt lgkmcnt(2)
v_pk_add_f32 v[128:129], v[128:129], v[132:133]
v_pk_add_f32 v[130:131], v[130:131], v[134:135]
s_waitcnt lgkmcnt(0)
v_pk_add_f32 v[136:137], v[136:137], v[140:141]
v_pk_add_f32 v[138:139], v[138:139], v[142:143]
v_pk_add_f32 v[128:129], v[128:129], v[136:137]
v_pk_add_f32 v[130:131], v[130:131], v[138:139]
v_cvt_pk_bf16_f32 v178, v128, v129
v_cvt_pk_bf16_f32 v179, v130, v131
ds_write_b128 v233, v[176:179] offset:0
s_waitcnt lgkmcnt(0)
s_barrier
v_add_u32 v231, 0x10000, v230
ds_read_b128 v[188:191], v231 offset:0
ds_read_b128 v[192:195], v231 offset:1024
ds_read_b128 v[196:199], v231 offset:2048
ds_read_b128 v[200:203], v231 offset:3072
buffer_load_dword v232, off, s[40:43], 0 offset:136 sc1
s_waitcnt vmcnt(1)
ds_read_b64_tr_b16 a[64:65], v215 offset:16384
ds_read_b64_tr_b16 a[66:67], v215 offset:16896
ds_read_b64_tr_b16 a[68:69], v215 offset:20480
ds_read_b64_tr_b16 a[70:71], v215 offset:20992
ds_read_b64_tr_b16 a[72:73], v215 offset:24576
ds_read_b64_tr_b16 a[74:75], v215 offset:25088
ds_read_b64_tr_b16 a[76:77], v215 offset:28672
ds_read_b64_tr_b16 a[78:79], v215 offset:29184
v_xor_b32 v231, 32, v215
ds_read_b64_tr_b16 a[80:81], v231 offset:16384
ds_read_b64_tr_b16 a[82:83], v231 offset:16896
ds_read_b64_tr_b16 a[84:85], v231 offset:20480
ds_read_b64_tr_b16 a[86:87], v231 offset:20992
ds_read_b64_tr_b16 a[88:89], v231 offset:24576
ds_read_b64_tr_b16 a[90:91], v231 offset:25088
ds_read_b64_tr_b16 a[92:93], v231 offset:28672
ds_read_b64_tr_b16 a[94:95], v231 offset:29184
v_xor_b32 v231, 64, v215
ds_read_b64_tr_b16 a[96:97], v231 offset:16384
ds_read_b64_tr_b16 a[98:99], v231 offset:16896
ds_read_b64_tr_b16 a[100:101], v231 offset:20480
ds_read_b64_tr_b16 a[102:103], v231 offset:20992
ds_read_b64_tr_b16 a[104:105], v231 offset:24576
ds_read_b64_tr_b16 a[106:107], v231 offset:25088
ds_read_b64_tr_b16 a[108:109], v231 offset:28672
ds_read_b64_tr_b16 a[110:111], v231 offset:29184
v_xor_b32 v231, 96, v215
ds_read_b64_tr_b16 a[112:113], v231 offset:16384
ds_read_b64_tr_b16 a[114:115], v231 offset:16896
ds_read_b64_tr_b16 a[116:117], v231 offset:20480
ds_read_b64_tr_b16 a[118:119], v231 offset:20992
ds_read_b64_tr_b16 a[120:121], v231 offset:24576
ds_read_b64_tr_b16 a[122:123], v231 offset:25088
ds_read_b64_tr_b16 a[124:125], v231 offset:28672
ds_read_b64_tr_b16 a[126:127], v231 offset:29184
s_waitcnt lgkmcnt(0)
v_mfma_f32_16x16x32_bf16 v[80:83], a[64:67], v[64:67], 0
v_mfma_f32_16x16x32_bf16 v[96:99], a[0:3], v[64:67], 0
v_mfma_f32_16x16x32_bf16 v[80:83], a[68:71], v[68:71], v[80:83]
v_mfma_f32_16x16x32_bf16 v[96:99], a[4:7], v[68:71], v[96:99]
v_mfma_f32_16x16x32_bf16 v[80:83], a[72:75], v[72:75], v[80:83]
v_mfma_f32_16x16x32_bf16 v[96:99], a[8:11], v[72:75], v[96:99]
v_mfma_f32_16x16x32_bf16 v[80:83], a[76:79], v[76:79], v[80:83]
v_mfma_f32_16x16x32_bf16 v[96:99], a[12:15], v[76:79], v[96:99]
v_mfma_f32_16x16x32_bf16 v[84:87], a[80:83], v[64:67], 0
v_mfma_f32_16x16x32_bf16 v[100:103], a[16:19], v[64:67], 0
v_mfma_f32_16x16x32_bf16 v[84:87], a[84:87], v[68:71], v[84:87]
v_mfma_f32_16x16x32_bf16 v[100:103], a[20:23], v[68:71], v[100:103]
v_cndmask_b32 v80, v80, v96, s[78:79]
v_cndmask_b32 v81, v81, v97, s[78:79]
v_cndmask_b32 v82, v82, v98, s[78:79]
v_cndmask_b32 v83, v83, v99, s[78:79]
ds_write_b128 v227, v[80:83] offset:8192
v_mfma_f32_16x16x32_bf16 v[84:87], a[88:91], v[72:75], v[84:87]
v_mfma_f32_16x16x32_bf16 v[100:103], a[24:27], v[72:75], v[100:103]
v_mfma_f32_16x16x32_bf16 v[84:87], a[92:95], v[76:79], v[84:87]
v_mfma_f32_16x16x32_bf16 v[100:103], a[28:31], v[76:79], v[100:103]
v_mfma_f32_16x16x32_bf16 v[88:91], a[96:99], v[64:67], 0
v_mfma_f32_16x16x32_bf16 v[104:107], a[32:35], v[64:67], 0
v_mfma_f32_16x16x32_bf16 v[88:91], a[100:103], v[68:71], v[88:91]
v_mfma_f32_16x16x32_bf16 v[104:107], a[36:39], v[68:71], v[104:107]
v_cndmask_b32 v84, v84, v100, s[78:79]
v_cndmask_b32 v85, v85, v101, s[78:79]
v_cndmask_b32 v86, v86, v102, s[78:79]
v_cndmask_b32 v87, v87, v103, s[78:79]
ds_write_b128 v227, v[84:87] offset:9216
v_mfma_f32_16x16x32_bf16 v[88:91], a[104:107], v[72:75], v[88:91]
v_mfma_f32_16x16x32_bf16 v[104:107], a[40:43], v[72:75], v[104:107]
v_mfma_f32_16x16x32_bf16 v[88:91], a[108:111], v[76:79], v[88:91]
v_mfma_f32_16x16x32_bf16 v[104:107], a[44:47], v[76:79], v[104:107]
v_mfma_f32_16x16x32_bf16 v[92:95], a[112:115], v[64:67], 0
v_mfma_f32_16x16x32_bf16 v[108:111], a[48:51], v[64:67], 0
v_mfma_f32_16x16x32_bf16 v[92:95], a[116:119], v[68:71], v[92:95]
v_mfma_f32_16x16x32_bf16 v[108:111], a[52:55], v[68:71], v[108:111]
v_cndmask_b32 v88, v88, v104, s[78:79]
v_cndmask_b32 v89, v89, v105, s[78:79]
v_cndmask_b32 v90, v90, v106, s[78:79]
v_cndmask_b32 v91, v91, v107, s[78:79]
ds_write_b128 v227, v[88:91] offset:10240
v_mfma_f32_16x16x32_bf16 v[92:95], a[120:123], v[72:75], v[92:95]
v_mfma_f32_16x16x32_bf16 v[108:111], a[56:59], v[72:75], v[108:111]
v_mfma_f32_16x16x32_bf16 v[92:95], a[124:127], v[76:79], v[92:95]
v_mfma_f32_16x16x32_bf16 v[108:111], a[60:63], v[76:79], v[108:111]
s_nop 7
v_cndmask_b32 v92, v92, v108, s[78:79]
v_cndmask_b32 v93, v93, v109, s[78:79]
v_cndmask_b32 v94, v94, v110, s[78:79]
v_cndmask_b32 v95, v95, v111, s[78:79]
ds_write_b128 v227, v[92:95] offset:11264
s_waitcnt lgkmcnt(0)
s_barrier
ds_read_b128 v[80:83], v1 offset:8192
ds_read_b128 v[84:87], v1 offset:40960
ds_read_b128 v[88:91], v230 offset:8192
ds_read_b128 v[92:95], v230 offset:40960
ds_read_b128 v[96:99], v1 offset:9216
ds_read_b128 v[100:103], v1 offset:41984
ds_read_b128 v[104:107], v230 offset:9216
ds_read_b128 v[108:111], v230 offset:41984
ds_read_b128 v[112:115], v1 offset:10240
ds_read_b128 v[116:119], v1 offset:43008
ds_read_b128 v[120:123], v230 offset:10240
ds_read_b128 v[124:127], v230 offset:43008
s_waitcnt lgkmcnt(10)
v_pk_add_f32 v[80:81], v[80:81], v[84:85]
v_pk_add_f32 v[82:83], v[82:83], v[86:87]
s_waitcnt lgkmcnt(8)
ds_read_b128 v[128:131], v1 offset:11264
ds_read_b128 v[132:135], v1 offset:44032
ds_read_b128 v[136:139], v230 offset:11264
ds_read_b128 v[140:143], v230 offset:44032
v_pk_add_f32 v[88:89], v[88:89], v[92:93]
v_pk_add_f32 v[90:91], v[90:91], v[94:95]
v_pk_add_f32 v[80:81], v[80:81], v[88:89]
v_pk_add_f32 v[82:83], v[82:83], v[90:91]
v_cvt_pk_bf16_f32 v152, v80, v81
v_cvt_pk_bf16_f32 v153, v82, v83
s_waitcnt lgkmcnt(10)
v_pk_add_f32 v[96:97], v[96:97], v[100:101]
v_pk_add_f32 v[98:99], v[98:99], v[102:103]
s_waitcnt lgkmcnt(8)
v_pk_add_f32 v[104:105], v[104:105], v[108:109]
v_pk_add_f32 v[106:107], v[106:107], v[110:111]
v_pk_add_f32 v[96:97], v[96:97], v[104:105]
v_pk_add_f32 v[98:99], v[98:99], v[106:107]
v_cvt_pk_bf16_f32 v154, v96, v97
v_cvt_pk_bf16_f32 v155, v98, v99
s_waitcnt lgkmcnt(6)
v_pk_add_f32 v[112:113], v[112:113], v[116:117]
v_pk_add_f32 v[114:115], v[114:115], v[118:119]
s_waitcnt lgkmcnt(4)
v_pk_add_f32 v[120:121], v[120:121], v[124:125]
v_pk_add_f32 v[122:123], v[122:123], v[126:127]
v_pk_add_f32 v[112:113], v[112:113], v[120:121]
v_pk_add_f32 v[114:115], v[114:115], v[122:123]
v_cvt_pk_bf16_f32 v156, v112, v113
v_cvt_pk_bf16_f32 v157, v114, v115
s_waitcnt lgkmcnt(2)
v_pk_add_f32 v[128:129], v[128:129], v[132:133]
v_pk_add_f32 v[130:131], v[130:131], v[134:135]
s_waitcnt lgkmcnt(0)
v_pk_add_f32 v[136:137], v[136:137], v[140:141]
v_pk_add_f32 v[138:139], v[138:139], v[142:143]
v_pk_add_f32 v[128:129], v[128:129], v[136:137]
v_pk_add_f32 v[130:131], v[130:131], v[138:139]
v_cvt_pk_bf16_f32 v158, v128, v129
v_cvt_pk_bf16_f32 v159, v130, v131
s_waitcnt vmcnt(0)
L_gw_88:
v_readfirstlane_b32 s55, v232
s_nop 0
s_cmp_lg_u32 s55, 0
s_cbranch_scc1 L_gk_89
s_add_u32 s54, s54, 1
s_cmp_gt_u32 s54, 400000
s_cbranch_scc1 L_end
buffer_load_dword v232, off, s[40:43], 0 offset:136 sc1
s_waitcnt vmcnt(0)
s_branch L_gw_88
L_gk_89:
s_lshr_b32 s53, s55, 16
s_cmp_lg_u32 s53, 0
s_cbranch_scc1 L_x_i0
s_waitcnt lgkmcnt(0)
v_mfma_f32_16x16x32_bf16 v[80:83], v[188:191], v[152:155], 0
v_mfma_f32_16x16x32_bf16 v[84:87], v[196:199], v[152:155], 0
v_mfma_f32_16x16x32_bf16 v[88:91], v[152:155], v[152:155], 0
v_mfma_f32_16x16x32_bf16 v[80:83], v[192:195], v[156:159], v[80:83]
v_mfma_f32_16x16x32_bf16 v[84:87], v[200:203], v[156:159], v[84:87]
v_mfma_f32_16x16x32_bf16 v[88:91], v[156:159], v[156:159], v[88:91]
v_or_b32 v80, 1, v80
buffer_store_dwordx4 v[80:83], v221, s[44:47], s67 offen offset:0
s_nop 0
v_or_b32 v84, 1, v84
buffer_store_dwordx4 v[84:87], v221, s[44:47], s67 offen offset:512
s_nop 2
v_or_b32 v90, 1, v90
buffer_store_dwordx2 v[90:91], v221, s[44:47], s67 offen offset:1024
s_waitcnt vmcnt(0)
buffer_load_dwordx4 v[112:115], v1, s[44:47], s74 offen sc1
L_x_q_91:
s_waitcnt vmcnt(0)
v_bitop3_b32 v124, v112, v114, 1 bitop3:0x80
v_cmp_eq_u32 vcc, 0, v124
s_cbranch_vccz L_x_r_92
s_mov_b64 exec, vcc
buffer_load_dwordx4 v[112:115], v1, s[44:47], s74 offen sc1
s_mov_b64 exec, -1
s_add_u32 s54, s54, 1
s_cmp_gt_u32 s54, 400000
s_cbranch_scc1 L_end
s_branch L_x_q_91
L_x_r_92:
v_mfma_f32_16x16x32_bf16 v[120:123], v[204:207], v[112:115], 0
s_nop 7
v_add_f32_dpp v120, v120, v120 row_ror:4 row_mask:0xf bank_mask:0xf
v_add_f32_dpp v121, v121, v121 row_ror:4 row_mask:0xf bank_mask:0xf
v_add_f32_dpp v122, v122, v122 row_ror:4 row_mask:0xf bank_mask:0xf
v_add_f32_dpp v123, v123, v123 row_ror:4 row_mask:0xf bank_mask:0xf
v_add_f32_dpp v120, v120, v120 row_ror:8 row_mask:0xf bank_mask:0xf
v_add_f32_dpp v121, v121, v121 row_ror:8 row_mask:0xf bank_mask:0xf
v_add_f32_dpp v122, v122, v122 row_ror:8 row_mask:0xf bank_mask:0xf
v_add_f32_dpp v123, v123, v123 row_ror:8 row_mask:0xf bank_mask:0xf
v_min_u32 v120, -2, v120
v_min_u32 v121, -2, v121
v_min_u32 v122, -2, v122
v_min_u32 v123, -2, v123
buffer_store_dwordx4 v[120:123], v224, s[44:47], s72 offen offset:0 sc1
v_mfma_f32_16x16x32_bf16 v[80:83], a[0:3], v[36:39], 0
v_mfma_f32_16x16x32_bf16 v[80:83], a[4:7], v[40:43], v[80:83]
v_mfma_f32_16x16x32_bf16 v[80:83], a[8:11], v[44:47], v[80:83]
v_mfma_f32_16x16x32_bf16 v[80:83], a[12:15], v[48:51], v[80:83]
v_mfma_f32_16x16x32_bf16 v[84:87], a[16:19], v[36:39], 0
v_mfma_f32_16x16x32_bf16 v[84:87], a[20:23], v[40:43], v[84:87]
v_mfma_f32_16x16x32_bf16 v[84:87], a[24:27], v[44:47], v[84:87]
v_mfma_f32_16x16x32_bf16 v[84:87], a[28:31], v[48:51], v[84:87]
v_mfma_f32_16x16x32_bf16 v[88:91], a[32:35], v[36:39], 0
v_mfma_f32_16x16x32_bf16 v[88:91], a[36:39], v[40:43], v[88:91]
ds_write_b128 v227, v[80:83] offset:0
v_mfma_f32_16x16x32_bf16 v[88:91], a[40:43], v[44:47], v[88:91]
v_mfma_f32_16x16x32_bf16 v[88:91], a[44:47], v[48:51], v[88:91]
v_mfma_f32_16x16x32_bf16 v[92:95], a[48:51], v[36:39], 0
v_mfma_f32_16x16x32_bf16 v[92:95], a[52:55], v[40:43], v[92:95]
ds_write_b128 v227, v[84:87] offset:1024
v_mfma_f32_16x16x32_bf16 v[92:95], a[56:59], v[44:47], v[92:95]
v_mfma_f32_16x16x32_bf16 v[92:95], a[60:63], v[48:51], v[92:95]
v_mfma_f32_16x16x32_bf16 v[96:99], a[0:3], v[52:55], 0
v_mfma_f32_16x16x32_bf16 v[96:99], a[4:7], v[56:59], v[96:99]
ds_write_b128 v227, v[88:91] offset:2048
v_mfma_f32_16x16x32_bf16 v[96:99], a[8:11], v[60:63], v[96:99]
v_mfma_f32_16x16x32_bf16 v[96:99], a[12:15], v[236:239], v[96:99]
v_mfma_f32_16x16x32_bf16 v[100:103], a[16:19], v[52:55], 0
v_mfma_f32_16x16x32_bf16 v[100:103], a[20:23], v[56:59], v[100:103]
ds_write_b128 v227, v[92:95] offset:3072
v_mfma_f32_16x16x32_bf16 v[100:103], a[24:27], v[60:63], v[100:103]
v_mfma_f32_16x16x32_bf16 v[100:103], a[28:31], v[236:239], v[100:103]
v_mfma_f32_16x16x32_bf16 v[104:107], a[32:35], v[52:55], 0
v_mfma_f32_16x16x32_bf16 v[104:107], a[36:39], v[56:59], v[104:107]
ds_write_b128 v227, v[96:99] offset:4096
v_mfma_f32_16x16x32_bf16 v[104:107], a[40:43], v[60:63], v[104:107]
v_mfma_f32_16x16x32_bf16 v[104:107], a[44:47], v[236:239], v[104:107]
v_mfma_f32_16x16x32_bf16 v[108:111], a[48:51], v[52:55], 0
v_mfma_f32_16x16x32_bf16 v[108:111], a[52:55], v[56:59], v[108:111]
ds_write_b128 v227, v[100:103] offset:5120
v_mfma_f32_16x16x32_bf16 v[108:111], a[56:59], v[60:63], v[108:111]
v_mfma_f32_16x16x32_bf16 v[108:111], a[60:63], v[236:239], v[108:111]
ds_write_b128 v227, v[104:107] offset:6144
s_nop 6
ds_write_b128 v227, v[108:111] offset:7168
s_waitcnt lgkmcnt(0)
s_barrier
ds_read_b128 v[112:115], v228 offset:0
ds_read_b128 v[116:119], v228 offset:32768
ds_read_b128 v[120:123], v229 offset:0
ds_read_b128 v[124:127], v229 offset:32768
ds_read_b128 v[128:131], v228 offset:1024
ds_read_b128 v[132:135], v228 offset:33792
ds_read_b128 v[136:139], v229 offset:1024
ds_read_b128 v[140:143], v229 offset:33792
s_waitcnt lgkmcnt(6)
v_pk_add_f32 v[112:113], v[112:113], v[116:117]
v_pk_add_f32 v[114:115], v[114:115], v[118:119]
s_waitcnt lgkmcnt(4)
v_pk_add_f32 v[120:121], v[120:121], v[124:125]
v_pk_add_f32 v[122:123], v[122:123], v[126:127]
v_pk_add_f32 v[112:113], v[112:113], v[120:121]
v_pk_add_f32 v[114:115], v[114:115], v[122:123]
v_cvt_pk_bf16_f32 v180, v112, v113
v_cvt_pk_bf16_f32 v181, v114, v115
s_waitcnt lgkmcnt(2)
v_pk_add_f32 v[128:129], v[128:129], v[132:133]
v_pk_add_f32 v[130:131], v[130:131], v[134:135]
s_waitcnt lgkmcnt(0)
v_pk_add_f32 v[136:137], v[136:137], v[140:141]
v_pk_add_f32 v[138:139], v[138:139], v[142:143]
v_pk_add_f32 v[128:129], v[128:129], v[136:137]
v_pk_add_f32 v[130:131], v[130:131], v[138:139]
v_cvt_pk_bf16_f32 v182, v128, v129
v_cvt_pk_bf16_f32 v183, v130, v131
ds_write_b128 v233, v[180:183] offset:4096
s_waitcnt lgkmcnt(0)
s_barrier
v_add_u32 v231, 0x10000, v230
ds_read_b128 v[188:191], v231 offset:4096
ds_read_b128 v[192:195], v231 offset:5120
ds_read_b128 v[196:199], v231 offset:6144
ds_read_b128 v[200:203], v231 offset:7168
buffer_load_dwordx4 v[144:147], v225, s[44:47], s71 offen offset:0 sc1
L_x_q_94:
s_waitcnt vmcnt(0)
v_cmp_eq_u32 vcc, -1, v144
s_cbranch_vccz L_x_r_95
s_mov_b64 exec, vcc
buffer_load_dwordx4 v[144:147], v225, s[44:47], s71 offen offset:0 sc1
s_mov_b64 exec, -1
s_add_u32 s54, s54, 1
s_cmp_gt_u32 s54, 400000
s_cbranch_scc1 L_end
s_branch L_x_q_94
L_x_r_95:
v_add_f32_dpp v144, v144, v144 row_ror:4 row_mask:0xf bank_mask:0xf
v_add_f32_dpp v145, v145, v145 row_ror:4 row_mask:0xf bank_mask:0xf
v_add_f32_dpp v146, v146, v146 row_ror:4 row_mask:0xf bank_mask:0xf
v_add_f32_dpp v147, v147, v147 row_ror:4 row_mask:0xf bank_mask:0xf
v_add_f32_dpp v144, v144, v144 row_ror:8 row_mask:0xf bank_mask:0xf
v_add_f32_dpp v145, v145, v145 row_ror:8 row_mask:0xf bank_mask:0xf
v_add_f32_dpp v146, v146, v146 row_ror:8 row_mask:0xf bank_mask:0xf
v_add_f32_dpp v147, v147, v147 row_ror:8 row_mask:0xf bank_mask:0xf
v_cvt_pk_bf16_f32 v144, v144, v145
v_cvt_pk_bf16_f32 v145, v146, v147
v_min_u32 v144, -2, v144
buffer_store_dwordx2 v[144:145], v226, s[44:47], s75 offen offset:0
s_add_u32 s56, s70, 24576
s_add_u32 s57, s70, 49152
s_add_u32 s58, s70, 73728
s_waitcnt vmcnt(0)
buffer_load_dwordx4 v[64:67], v219, s[44:47], s70 offen offset:0 sc1
buffer_load_dwordx4 v[68:71], v219, s[44:47], s56 offen offset:0 sc1
buffer_load_dwordx4 v[72:75], v219, s[44:47], s57 offen offset:0 sc1
buffer_load_dwordx4 v[76:79], v219, s[44:47], s58 offen offset:0 sc1
L_x_q_97:
s_waitcnt vmcnt(0)
v_max3_u32 v148, v64, v66, v68
v_max3_u32 v149, v70, v72, v74
v_max3_u32 v148, v148, v76, v78
v_max_u32 v148, v148, v149
v_cmp_eq_u32 vcc, -1, v148
s_cbranch_vccz L_x_r_98
s_mov_b64 exec, vcc
buffer_load_dwordx4 v[64:67], v219, s[44:47], s70 offen offset:0 sc1
buffer_load_dwordx4 v[68:71], v219, s[44:47], s56 offen offset:0 sc1
buffer_load_dwordx4 v[72:75], v219, s[44:47], s57 offen offset:0 sc1
buffer_load_dwordx4 v[76:79], v219, s[44:47], s58 offen offset:0 sc1
s_mov_b64 exec, -1
s_add_u32 s54, s54, 1
s_cmp_gt_u32 s54, 400000
s_cbranch_scc1 L_end
s_branch L_x_q_97
L_x_r_98:
v_mfma_f32_16x16x32_bf16 v[80:83], a[64:67], v[64:67], 0
v_mfma_f32_16x16x32_bf16 v[96:99], a[0:3], v[64:67], 0
v_mfma_f32_16x16x32_bf16 v[80:83], a[68:71], v[68:71], v[80:83]
v_mfma_f32_16x16x32_bf16 v[96:99], a[4:7], v[68:71], v[96:99]
v_mfma_f32_16x16x32_bf16 v[80:83], a[72:75], v[72:75], v[80:83]
v_mfma_f32_16x16x32_bf16 v[96:99], a[8:11], v[72:75], v[96:99]
v_mfma_f32_16x16x32_bf16 v[80:83], a[76:79], v[76:79], v[80:83]
v_mfma_f32_16x16x32_bf16 v[96:99], a[12:15], v[76:79], v[96:99]
v_mfma_f32_16x16x32_bf16 v[84:87], a[80:83], v[64:67], 0
v_mfma_f32_16x16x32_bf16 v[100:103], a[16:19], v[64:67], 0
v_mfma_f32_16x16x32_bf16 v[84:87], a[84:87], v[68:71], v[84:87]
v_mfma_f32_16x16x32_bf16 v[100:103], a[20:23], v[68:71], v[100:103]
v_cndmask_b32 v80, v80, v96, s[78:79]
v_cndmask_b32 v81, v81, v97, s[78:79]
v_cndmask_b32 v82, v82, v98, s[78:79]
v_cndmask_b32 v83, v83, v99, s[78:79]
ds_write_b128 v227, v[80:83] offset:8192
v_mfma_f32_16x16x32_bf16 v[84:87], a[88:91], v[72:75], v[84:87]
v_mfma_f32_16x16x32_bf16 v[100:103], a[24:27], v[72:75], v[100:103]
v_mfma_f32_16x16x32_bf16 v[84:87], a[92:95], v[76:79], v[84:87]
v_mfma_f32_16x16x32_bf16 v[100:103], a[28:31], v[76:79], v[100:103]
v_mfma_f32_16x16x32_bf16 v[88:91], a[96:99], v[64:67], 0
v_mfma_f32_16x16x32_bf16 v[104:107], a[32:35], v[64:67], 0
v_mfma_f32_16x16x32_bf16 v[88:91], a[100:103], v[68:71], v[88:91]
v_mfma_f32_16x16x32_bf16 v[104:107], a[36:39], v[68:71], v[104:107]
v_cndmask_b32 v84, v84, v100, s[78:79]
v_cndmask_b32 v85, v85, v101, s[78:79]
v_cndmask_b32 v86, v86, v102, s[78:79]
v_cndmask_b32 v87, v87, v103, s[78:79]
ds_write_b128 v227, v[84:87] offset:9216
v_mfma_f32_16x16x32_bf16 v[88:91], a[104:107], v[72:75], v[88:91]
v_mfma_f32_16x16x32_bf16 v[104:107], a[40:43], v[72:75], v[104:107]
v_mfma_f32_16x16x32_bf16 v[88:91], a[108:111], v[76:79], v[88:91]
v_mfma_f32_16x16x32_bf16 v[104:107], a[44:47], v[76:79], v[104:107]
v_mfma_f32_16x16x32_bf16 v[92:95], a[112:115], v[64:67], 0
v_mfma_f32_16x16x32_bf16 v[108:111], a[48:51], v[64:67], 0
v_mfma_f32_16x16x32_bf16 v[92:95], a[116:119], v[68:71], v[92:95]
v_mfma_f32_16x16x32_bf16 v[108:111], a[52:55], v[68:71], v[108:111]
v_cndmask_b32 v88, v88, v104, s[78:79]
v_cndmask_b32 v89, v89, v105, s[78:79]
v_cndmask_b32 v90, v90, v106, s[78:79]
v_cndmask_b32 v91, v91, v107, s[78:79]
ds_write_b128 v227, v[88:91] offset:10240
v_mfma_f32_16x16x32_bf16 v[92:95], a[120:123], v[72:75], v[92:95]
v_mfma_f32_16x16x32_bf16 v[108:111], a[56:59], v[72:75], v[108:111]
v_mfma_f32_16x16x32_bf16 v[92:95], a[124:127], v[76:79], v[92:95]
v_mfma_f32_16x16x32_bf16 v[108:111], a[60:63], v[76:79], v[108:111]
s_nop 7
v_cndmask_b32 v92, v92, v108, s[78:79]
v_cndmask_b32 v93, v93, v109, s[78:79]
v_cndmask_b32 v94, v94, v110, s[78:79]
v_cndmask_b32 v95, v95, v111, s[78:79]
ds_write_b128 v227, v[92:95] offset:11264
s_waitcnt lgkmcnt(0)
s_barrier
ds_read_b128 v[80:83], v1 offset:8192
ds_read_b128 v[84:87], v1 offset:40960
ds_read_b128 v[88:91], v230 offset:8192
ds_read_b128 v[92:95], v230 offset:40960
ds_read_b128 v[96:99], v1 offset:9216
ds_read_b128 v[100:103], v1 offset:41984
ds_read_b128 v[104:107], v230 offset:9216
ds_read_b128 v[108:111], v230 offset:41984
ds_read_b128 v[112:115], v1 offset:10240
ds_read_b128 v[116:119], v1 offset:43008
ds_read_b128 v[120:123], v230 offset:10240
ds_read_b128 v[124:127], v230 offset:43008
s_waitcnt lgkmcnt(10)
v_pk_add_f32 v[80:81], v[80:81], v[84:85]
v_pk_add_f32 v[82:83], v[82:83], v[86:87]
s_waitcnt lgkmcnt(8)
ds_read_b128 v[128:131], v1 offset:11264
ds_read_b128 v[132:135], v1 offset:44032
ds_read_b128 v[136:139], v230 offset:11264
ds_read_b128 v[140:143], v230 offset:44032
v_pk_add_f32 v[88:89], v[88:89], v[92:93]
v_pk_add_f32 v[90:91], v[90:91], v[94:95]
v_pk_add_f32 v[80:81], v[80:81], v[88:89]
v_pk_add_f32 v[82:83], v[82:83], v[90:91]
v_cvt_pk_bf16_f32 v160, v80, v81
v_cvt_pk_bf16_f32 v161, v82, v83
s_waitcnt lgkmcnt(10)
v_pk_add_f32 v[96:97], v[96:97], v[100:101]
v_pk_add_f32 v[98:99], v[98:99], v[102:103]
s_waitcnt lgkmcnt(8)
v_pk_add_f32 v[104:105], v[104:105], v[108:109]
v_pk_add_f32 v[106:107], v[106:107], v[110:111]
v_pk_add_f32 v[96:97], v[96:97], v[104:105]
v_pk_add_f32 v[98:99], v[98:99], v[106:107]
v_cvt_pk_bf16_f32 v162, v96, v97
v_cvt_pk_bf16_f32 v163, v98, v99
s_waitcnt lgkmcnt(6)
v_pk_add_f32 v[112:113], v[112:113], v[116:117]
v_pk_add_f32 v[114:115], v[114:115], v[118:119]
s_waitcnt lgkmcnt(4)
v_pk_add_f32 v[120:121], v[120:121], v[124:125]
v_pk_add_f32 v[122:123], v[122:123], v[126:127]
v_pk_add_f32 v[112:113], v[112:113], v[120:121]
v_pk_add_f32 v[114:115], v[114:115], v[122:123]
v_cvt_pk_bf16_f32 v164, v112, v113
v_cvt_pk_bf16_f32 v165, v114, v115
s_waitcnt lgkmcnt(2)
v_pk_add_f32 v[128:129], v[128:129], v[132:133]
v_pk_add_f32 v[130:131], v[130:131], v[134:135]
s_waitcnt lgkmcnt(0)
v_pk_add_f32 v[136:137], v[136:137], v[140:141]
v_pk_add_f32 v[138:139], v[138:139], v[142:143]
v_pk_add_f32 v[128:129], v[128:129], v[136:137]
v_pk_add_f32 v[130:131], v[130:131], v[138:139]
v_cvt_pk_bf16_f32 v166, v128, v129
v_cvt_pk_bf16_f32 v167, v130, v131
s_waitcnt lgkmcnt(0)
v_mfma_f32_16x16x32_bf16 v[80:83], v[188:191], v[160:163], 0
v_mfma_f32_16x16x32_bf16 v[84:87], v[196:199], v[160:163], 0
v_mfma_f32_16x16x32_bf16 v[88:91], v[160:163], v[160:163], 0
v_mfma_f32_16x16x32_bf16 v[80:83], v[192:195], v[164:167], v[80:83]
v_mfma_f32_16x16x32_bf16 v[84:87], v[200:203], v[164:167], v[84:87]
v_mfma_f32_16x16x32_bf16 v[88:91], v[164:167], v[164:167], v[88:91]
v_and_b32 v80, -2, v80
buffer_store_dwordx4 v[80:83], v221, s[44:47], s67 offen offset:0
s_nop 0
v_and_b32 v84, -2, v84
buffer_store_dwordx4 v[84:87], v221, s[44:47], s67 offen offset:512
s_nop 2
v_and_b32 v90, -2, v90
buffer_store_dwordx2 v[90:91], v221, s[44:47], s67 offen offset:1024
s_waitcnt vmcnt(0)
buffer_load_dwordx4 v[112:115], v1, s[44:47], s74 offen sc1
L_x_q_100:
s_waitcnt vmcnt(0)
v_bitop3_b32 v124, v112, v114, 1 bitop3:0xa8
v_cmp_ne_u32 vcc, 0, v124
s_cbranch_vccz L_x_r_101
s_mov_b64 exec, vcc
buffer_load_dwordx4 v[112:115], v1, s[44:47], s74 offen sc1
s_mov_b64 exec, -1
s_add_u32 s54, s54, 1
s_cmp_gt_u32 s54, 400000
s_cbranch_scc1 L_end
s_branch L_x_q_100
L_x_r_101:
v_mfma_f32_16x16x32_bf16 v[120:123], v[204:207], v[112:115], 0
s_nop 7
v_add_f32_dpp v120, v120, v120 row_ror:4 row_mask:0xf bank_mask:0xf
v_add_f32_dpp v121, v121, v121 row_ror:4 row_mask:0xf bank_mask:0xf
v_add_f32_dpp v122, v122, v122 row_ror:4 row_mask:0xf bank_mask:0xf
v_add_f32_dpp v123, v123, v123 row_ror:4 row_mask:0xf bank_mask:0xf
v_add_f32_dpp v120, v120, v120 row_ror:8 row_mask:0xf bank_mask:0xf
v_add_f32_dpp v121, v121, v121 row_ror:8 row_mask:0xf bank_mask:0xf
v_add_f32_dpp v122, v122, v122 row_ror:8 row_mask:0xf bank_mask:0xf
v_add_f32_dpp v123, v123, v123 row_ror:8 row_mask:0xf bank_mask:0xf
v_min_u32 v120, -2, v120
v_min_u32 v121, -2, v121
v_min_u32 v122, -2, v122
v_min_u32 v123, -2, v123
buffer_store_dwordx4 v[120:123], v224, s[44:47], s72 offen offset:512 sc1
L_x_fin0:
s_lshr_b32 s59, s76, 2
s_mul_i32 s73, s59, 24576
s_add_u32 s73, s73, 0x202000
s_and_b32 s58, s50, 1
s_and_b32 s56, s48, 1
s_lshr_b32 s57, s48, 1
s_lshl_b32 s62, s58, 1
s_add_u32 s62, s62, s56
s_lshl_b32 s55, s57, 2
s_add_u32 s55, s55, s62
s_lshl_b32 s55, s55, 10
s_add_u32 s73, s73, s55
s_sub_u32 s61, s73, 8192
s_waitcnt vmcnt(0)
buffer_store_dwordx4 v[176:179], v1, s[44:47], s73 offen sc1
s_add_u32 s73, s73, 786432
buffer_store_dwordx4 v[180:183], v1, s[44:47], s73 offen sc1
s_add_u32 s73, s73, 786432
s_lshl_b32 s57, s57, 5
s_add_u32 s57, s57, s59
s_lshl_b32 s57, s57, 2
s_add_u32 s62, s62, s57
s_lshl_b32 s62, s62, 10
s_add_u32 s62, s62, 0x3b00000
v_mov_b32 v84, v152
v_mov_b32 v85, v153
v_mov_b32 v86, v154
v_mov_b32 v87, v155
s_cmp_eq_u32 s48, 1
s_cselect_b64 vcc, -1, 0
v_cndmask_b32 v84, v84, v156, vcc
v_cndmask_b32 v85, v85, v157, vcc
v_cndmask_b32 v86, v86, v158, vcc
v_cndmask_b32 v87, v87, v159, vcc
s_cmp_eq_u32 s48, 2
s_cselect_b64 vcc, -1, 0
v_cndmask_b32 v84, v84, v160, vcc
v_cndmask_b32 v85, v85, v161, vcc
v_cndmask_b32 v86, v86, v162, vcc
v_cndmask_b32 v87, v87, v163, vcc
s_cmp_eq_u32 s48, 3
s_cselect_b64 vcc, -1, 0
v_cndmask_b32 v84, v84, v164, vcc
v_cndmask_b32 v85, v85, v165, vcc
v_cndmask_b32 v86, v86, v166, vcc
v_cndmask_b32 v87, v87, v167, vcc
v_bfe_u32 v72, v0, 2, 2
v_lshrrev_b32 v73, 4, v0
v_and_b32 v74, 1, v0
v_lshlrev_b32 v74, 4, v74
v_mov_b32 v75, 0x3f80
v_lshlrev_b32 v75, v74, v75
v_cmp_eq_u32 vcc, v72, v73
s_nop 1
v_cndmask_b32 v75, 0, v75, vcc
v_cndmask_b32 v64, v75, 0, s[78:79]
v_cndmask_b32 v65, 0, v75, s[78:79]
v_mov_b32 v66, 0
v_mov_b32 v67, 0
v_mov_b32 v68, 0
v_mov_b32 v69, 0
v_mov_b32 v70, v64
v_mov_b32 v71, v65
v_mfma_f32_16x16x32_bf16 v[76:79], v[84:87], v[64:67], 0
s_nop 0
v_mfma_f32_16x16x32_bf16 v[80:83], v[84:87], v[68:71], 0
s_nop 5
v_cvt_pk_bf16_f32 v88, v78, v79
buffer_store_dword v88, v1, s[44:47], s62 offen offset:4 sc1
v_cvt_pk_bf16_f32 v89, v82, v83
buffer_store_dword v89, v1, s[44:47], s62 offen offset:12 sc1
s_barrier
v_mfma_f32_16x16x32_bf16 v[96:99], a[64:67], v[4:7], 0
v_mfma_f32_16x16x32_bf16 v[96:99], a[68:71], v[8:11], v[96:99]
v_mfma_f32_16x16x32_bf16 v[96:99], a[72:75], v[12:15], v[96:99]
v_mfma_f32_16x16x32_bf16 v[96:99], a[76:79], v[16:19], v[96:99]
v_mfma_f32_16x16x32_bf16 v[100:103], a[80:83], v[4:7], 0
v_mfma_f32_16x16x32_bf16 v[100:103], a[84:87], v[8:11], v[100:103]
v_mfma_f32_16x16x32_bf16 v[100:103], a[88:91], v[12:15], v[100:103]
v_mfma_f32_16x16x32_bf16 v[100:103], a[92:95], v[16:19], v[100:103]
v_mfma_f32_16x16x32_bf16 v[104:107], a[96:99], v[4:7], 0
v_mfma_f32_16x16x32_bf16 v[104:107], a[100:103], v[8:11], v[104:107]
v_mfma_f32_16x16x32_bf16 v[104:107], a[104:107], v[12:15], v[104:107]
v_mfma_f32_16x16x32_bf16 v[104:107], a[108:111], v[16:19], v[104:107]
v_mfma_f32_16x16x32_bf16 v[108:111], a[112:115], v[4:7], 0
v_mfma_f32_16x16x32_bf16 v[108:111], a[116:119], v[8:11], v[108:111]
v_mfma_f32_16x16x32_bf16 v[108:111], a[120:123], v[12:15], v[108:111]
v_mfma_f32_16x16x32_bf16 v[108:111], a[124:127], v[16:19], v[108:111]
v_mfma_f32_16x16x32_bf16 v[112:115], a[64:67], v[20:23], 0
v_mfma_f32_16x16x32_bf16 v[112:115], a[68:71], v[24:27], v[112:115]
v_mfma_f32_16x16x32_bf16 v[112:115], a[72:75], v[28:31], v[112:115]
v_mfma_f32_16x16x32_bf16 v[112:115], a[76:79], v[32:35], v[112:115]
v_mfma_f32_16x16x32_bf16 v[116:119], a[80:83], v[20:23], 0
v_mfma_f32_16x16x32_bf16 v[116:119], a[84:87], v[24:27], v[116:119]
v_mfma_f32_16x16x32_bf16 v[116:119], a[88:91], v[28:31], v[116:119]
v_mfma_f32_16x16x32_bf16 v[116:119], a[92:95], v[32:35], v[116:119]
v_mfma_f32_16x16x32_bf16 v[120:123], a[96:99], v[20:23], 0
v_mfma_f32_16x16x32_bf16 v[120:123], a[100:103], v[24:27], v[120:123]
v_mfma_f32_16x16x32_bf16 v[120:123], a[104:107], v[28:31], v[120:123]
v_mfma_f32_16x16x32_bf16 v[120:123], a[108:111], v[32:35], v[120:123]
v_mfma_f32_16x16x32_bf16 v[124:127], a[112:115], v[20:23], 0
v_mfma_f32_16x16x32_bf16 v[124:127], a[116:119], v[24:27], v[124:127]
v_mfma_f32_16x16x32_bf16 v[124:127], a[120:123], v[28:31], v[124:127]
v_mfma_f32_16x16x32_bf16 v[124:127], a[124:127], v[32:35], v[124:127]
ds_write_b128 v227, v[96:99] offset:0
ds_write_b128 v227, v[100:103] offset:1024
ds_write_b128 v227, v[104:107] offset:2048
ds_write_b128 v227, v[108:111] offset:3072
ds_write_b128 v227, v[112:115] offset:4096
ds_write_b128 v227, v[116:119] offset:5120
ds_write_b128 v227, v[120:123] offset:6144
s_nop 0
ds_write_b128 v227, v[124:127] offset:7168
v_mfma_f32_16x16x32_bf16 v[96:99], a[64:67], v[36:39], 0
v_mfma_f32_16x16x32_bf16 v[96:99], a[68:71], v[40:43], v[96:99]
v_mfma_f32_16x16x32_bf16 v[96:99], a[72:75], v[44:47], v[96:99]
v_mfma_f32_16x16x32_bf16 v[96:99], a[76:79], v[48:51], v[96:99]
v_mfma_f32_16x16x32_bf16 v[100:103], a[80:83], v[36:39], 0
v_mfma_f32_16x16x32_bf16 v[100:103], a[84:87], v[40:43], v[100:103]
v_mfma_f32_16x16x32_bf16 v[100:103], a[88:91], v[44:47], v[100:103]
v_mfma_f32_16x16x32_bf16 v[100:103], a[92:95], v[48:51], v[100:103]
v_mfma_f32_16x16x32_bf16 v[104:107], a[96:99], v[36:39], 0
v_mfma_f32_16x16x32_bf16 v[104:107], a[100:103], v[40:43], v[104:107]
v_mfma_f32_16x16x32_bf16 v[104:107], a[104:107], v[44:47], v[104:107]
v_mfma_f32_16x16x32_bf16 v[104:107], a[108:111], v[48:51], v[104:107]
v_mfma_f32_16x16x32_bf16 v[108:111], a[112:115], v[36:39], 0
v_mfma_f32_16x16x32_bf16 v[108:111], a[116:119], v[40:43], v[108:111]
v_mfma_f32_16x16x32_bf16 v[108:111], a[120:123], v[44:47], v[108:111]
v_mfma_f32_16x16x32_bf16 v[108:111], a[124:127], v[48:51], v[108:111]
v_mfma_f32_16x16x32_bf16 v[112:115], a[64:67], v[52:55], 0
v_mfma_f32_16x16x32_bf16 v[112:115], a[68:71], v[56:59], v[112:115]
v_mfma_f32_16x16x32_bf16 v[112:115], a[72:75], v[60:63], v[112:115]
v_mfma_f32_16x16x32_bf16 v[112:115], a[76:79], v[236:239], v[112:115]
v_mfma_f32_16x16x32_bf16 v[116:119], a[80:83], v[52:55], 0
v_mfma_f32_16x16x32_bf16 v[116:119], a[84:87], v[56:59], v[116:119]
v_mfma_f32_16x16x32_bf16 v[116:119], a[88:91], v[60:63], v[116:119]
v_mfma_f32_16x16x32_bf16 v[116:119], a[92:95], v[236:239], v[116:119]
v_mfma_f32_16x16x32_bf16 v[120:123], a[96:99], v[52:55], 0
v_mfma_f32_16x16x32_bf16 v[120:123], a[100:103], v[56:59], v[120:123]
v_mfma_f32_16x16x32_bf16 v[120:123], a[104:107], v[60:63], v[120:123]
v_mfma_f32_16x16x32_bf16 v[120:123], a[108:111], v[236:239], v[120:123]
v_mfma_f32_16x16x32_bf16 v[124:127], a[112:115], v[52:55], 0
v_mfma_f32_16x16x32_bf16 v[124:127], a[116:119], v[56:59], v[124:127]
v_mfma_f32_16x16x32_bf16 v[124:127], a[120:123], v[60:63], v[124:127]
v_mfma_f32_16x16x32_bf16 v[124:127], a[124:127], v[236:239], v[124:127]
ds_write_b128 v227, v[96:99] offset:8192
ds_write_b128 v227, v[100:103] offset:9216
ds_write_b128 v227, v[104:107] offset:10240
ds_write_b128 v227, v[108:111] offset:11264
ds_write_b128 v227, v[112:115] offset:12288
ds_write_b128 v227, v[116:119] offset:13312
ds_write_b128 v227, v[120:123] offset:14336
s_nop 0
ds_write_b128 v227, v[124:127] offset:15360
s_waitcnt lgkmcnt(0)
s_barrier
ds_read_b128 v[112:115], v228 offset:0
ds_read_b128 v[116:119], v228 offset:32768
ds_read_b128 v[120:123], v229 offset:0
ds_read_b128 v[124:127], v229 offset:32768
ds_read_b128 v[128:131], v228 offset:1024
ds_read_b128 v[132:135], v228 offset:33792
ds_read_b128 v[136:139], v229 offset:1024
ds_read_b128 v[140:143], v229 offset:33792
s_waitcnt lgkmcnt(6)
v_pk_add_f32 v[112:113], v[112:113], v[116:117]
v_pk_add_f32 v[114:115], v[114:115], v[118:119]
s_waitcnt lgkmcnt(4)
v_pk_add_f32 v[120:121], v[120:121], v[124:125]
v_pk_add_f32 v[122:123], v[122:123], v[126:127]
v_pk_add_f32 v[112:113], v[112:113], v[120:121]
v_pk_add_f32 v[114:115], v[114:115], v[122:123]
v_cvt_pk_bf16_f32 v144, v112, v113
v_cvt_pk_bf16_f32 v145, v114, v115
s_waitcnt lgkmcnt(2)
v_pk_add_f32 v[128:129], v[128:129], v[132:133]
v_pk_add_f32 v[130:131], v[130:131], v[134:135]
s_waitcnt lgkmcnt(0)
v_pk_add_f32 v[136:137], v[136:137], v[140:141]
v_pk_add_f32 v[138:139], v[138:139], v[142:143]
v_pk_add_f32 v[128:129], v[128:129], v[136:137]
v_pk_add_f32 v[130:131], v[130:131], v[138:139]
v_cvt_pk_bf16_f32 v146, v128, v129
v_cvt_pk_bf16_f32 v147, v130, v131
buffer_store_dwordx4 v[144:147], v1, s[44:47], s61 offen sc1
s_add_u32 s61, s61, 786432
ds_read_b128 v[112:115], v228 offset:8192
ds_read_b128 v[116:119], v228 offset:40960
ds_read_b128 v[120:123], v229 offset:8192
ds_read_b128 v[124:127], v229 offset:40960
ds_read_b128 v[128:131], v228 offset:9216
ds_read_b128 v[132:135], v228 offset:41984
ds_read_b128 v[136:139], v229 offset:9216
ds_read_b128 v[140:143], v229 offset:41984
s_waitcnt lgkmcnt(6)
v_pk_add_f32 v[112:113], v[112:113], v[116:117]
v_pk_add_f32 v[114:115], v[114:115], v[118:119]
s_waitcnt lgkmcnt(4)
v_pk_add_f32 v[120:121], v[120:121], v[124:125]
v_pk_add_f32 v[122:123], v[122:123], v[126:127]
v_pk_add_f32 v[112:113], v[112:113], v[120:121]
v_pk_add_f32 v[114:115], v[114:115], v[122:123]
v_cvt_pk_bf16_f32 v148, v112, v113
v_cvt_pk_bf16_f32 v149, v114, v115
s_waitcnt lgkmcnt(2)
v_pk_add_f32 v[128:129], v[128:129], v[132:133]
v_pk_add_f32 v[130:131], v[130:131], v[134:135]
s_waitcnt lgkmcnt(0)
v_pk_add_f32 v[136:137], v[136:137], v[140:141]
v_pk_add_f32 v[138:139], v[138:139], v[142:143]
v_pk_add_f32 v[128:129], v[128:129], v[136:137]
v_pk_add_f32 v[130:131], v[130:131], v[138:139]
v_cvt_pk_bf16_f32 v150, v128, v129
v_cvt_pk_bf16_f32 v151, v130, v131
buffer_store_dwordx4 v[148:151], v1, s[44:47], s61 offen sc1
s_add_u32 s61, s61, 786432
s_branch L_x_e_87
L_x_b_86:
s_mov_b32 s80, 0xaaaaaaaa
s_mov_b32 s81, 0xaaaaaaaa
v_mfma_f32_16x16x32_bf16 v[160:163], v[208:211], v[96:99], 0
v_mfma_f32_16x16x32_bf16 v[164:167], v[96:99], v[96:99], 0
v_mfma_f32_16x16x32_bf16 v[160:163], v[208:211], v[100:103], v[160:163]
v_mfma_f32_16x16x32_bf16 v[164:167], v[100:103], v[100:103], v[164:167]
v_mfma_f32_16x16x32_bf16 v[160:163], v[208:211], v[104:107], v[160:163]
v_mfma_f32_16x16x32_bf16 v[164:167], v[104:107], v[104:107], v[164:167]
v_mfma_f32_16x16x32_bf16 v[160:163], v[208:211], v[108:111], v[160:163]
v_mfma_f32_16x16x32_bf16 v[164:167], v[108:111], v[108:111], v[164:167]
s_add_u32 m0, s63, 12288
s_add_u32 s60, s61, 786432
buffer_load_dwordx4 v212, s[20:23], s60 offen offset:0  lds
v_mfma_f32_16x16x32_bf16 v[168:171], v[208:211], v[112:115], 0
v_mfma_f32_16x16x32_bf16 v[172:175], v[112:115], v[112:115], 0
v_mfma_f32_16x16x32_bf16 v[168:171], v[208:211], v[116:119], v[168:171]
v_mfma_f32_16x16x32_bf16 v[172:175], v[116:119], v[116:119], v[172:175]
v_mfma_f32_16x16x32_bf16 v[168:171], v[208:211], v[120:123], v[168:171]
v_mfma_f32_16x16x32_bf16 v[172:175], v[120:123], v[120:123], v[172:175]
v_mfma_f32_16x16x32_bf16 v[168:171], v[208:211], v[124:127], v[168:171]
v_mfma_f32_16x16x32_bf16 v[172:175], v[124:127], v[124:127], v[172:175]
s_add_u32 m0, s63, 13312
s_add_u32 s60, s61, 851968
buffer_load_dwordx4 v216, s[20:23], s60 offen offset:0  lds
v_mfma_f32_16x16x32_bf16 v[176:179], v[208:211], v[128:131], 0
v_mfma_f32_16x16x32_bf16 v[180:183], v[128:131], v[128:131], 0
v_mfma_f32_16x16x32_bf16 v[176:179], v[208:211], v[132:135], v[176:179]
v_mfma_f32_16x16x32_bf16 v[180:183], v[132:135], v[132:135], v[180:183]
v_mfma_f32_16x16x32_bf16 v[176:179], v[208:211], v[136:139], v[176:179]
v_mfma_f32_16x16x32_bf16 v[180:183], v[136:139], v[136:139], v[180:183]
v_mfma_f32_16x16x32_bf16 v[176:179], v[208:211], v[140:143], v[176:179]
v_mfma_f32_16x16x32_bf16 v[180:183], v[140:143], v[140:143], v[180:183]
s_add_u32 m0, s63, 14336
s_add_u32 s60, s61, 917504
buffer_load_dwordx4 v212, s[20:23], s60 offen offset:0  lds
v_mfma_f32_16x16x32_bf16 v[184:187], v[208:211], v[144:147], 0
v_mfma_f32_16x16x32_bf16 v[188:191], v[144:147], v[144:147], 0
v_mfma_f32_16x16x32_bf16 v[184:187], v[208:211], v[148:151], v[184:187]
v_mfma_f32_16x16x32_bf16 v[188:191], v[148:151], v[148:151], v[188:191]
v_mfma_f32_16x16x32_bf16 v[184:187], v[208:211], v[152:155], v[184:187]
v_mfma_f32_16x16x32_bf16 v[188:191], v[152:155], v[152:155], v[188:191]
v_mfma_f32_16x16x32_bf16 v[184:187], v[208:211], v[156:159], v[184:187]
v_mfma_f32_16x16x32_bf16 v[188:191], v[156:159], v[156:159], v[188:191]
s_add_u32 m0, s63, 15360
s_add_u32 s60, s61, 983040
buffer_load_dwordx4 v216, s[20:23], s60 offen offset:0  lds
v_bfe_u32 v192, v0, 0, 4
v_lshlrev_b32 v231, 5, v192
v_add_u32 v231, 139264, v231
s_lshl_b32 s55, s48, 9
v_add_u32 v200, s55, v231
v_mov_b32 v192, v160
v_cndmask_b32 v164, v164, v165, s[80:81]
v_cndmask_b32 v166, v166, v167, s[80:81]
s_add_u32 m0, s63, 16384
s_add_u32 s60, s62, 0
buffer_load_dwordx4 v213, s[24:27], s60 offen offset:0  lds
v_cndmask_b32 v193, v164, v166, s[78:79]
v_mov_b32 v194, v168
v_cndmask_b32 v172, v172, v173, s[80:81]
v_cndmask_b32 v174, v174, v175, s[80:81]
v_cndmask_b32 v195, v172, v174, s[78:79]
v_mov_b32 v196, v176
v_cndmask_b32 v180, v180, v181, s[80:81]
v_cndmask_b32 v182, v182, v183, s[80:81]
s_add_u32 m0, s63, 17408
s_add_u32 s60, s62, 4096
buffer_load_dwordx4 v214, s[24:27], s60 offen offset:0  lds
v_cndmask_b32 v197, v180, v182, s[78:79]
v_mov_b32 v198, v184
v_cndmask_b32 v188, v188, v189, s[80:81]
v_cndmask_b32 v190, v190, v191, s[80:81]
v_cndmask_b32 v199, v188, v190, s[78:79]
s_mov_b32 exec_lo, 0x00f0000f
s_mov_b32 exec_hi, 0xf0000f00
ds_write_b128 v200, v[192:195] offset:0
ds_write_b128 v200, v[196:199] offset:16
s_mov_b64 exec, -1
s_waitcnt lgkmcnt(0)
s_barrier
ds_read_b128 v[160:163], v231 offset:0
ds_read_b128 v[164:167], v231 offset:16
ds_read_b128 v[168:171], v231 offset:512
ds_read_b128 v[172:175], v231 offset:528
ds_read_b128 v[176:179], v231 offset:1024
ds_read_b128 v[180:183], v231 offset:1040
ds_read_b128 v[184:187], v231 offset:1536
ds_read_b128 v[188:191], v231 offset:1552
s_add_u32 m0, s63, 18432
s_add_u32 s60, s62, 8192
buffer_load_dwordx4 v213, s[24:27], s60 offen offset:0  lds
s_waitcnt lgkmcnt(0)
v_pk_add_f32 v[160:161], v[160:161], v[168:169]
v_pk_add_f32 v[162:163], v[162:163], v[170:171]
v_pk_add_f32 v[164:165], v[164:165], v[172:173]
s_add_u32 m0, s63, 19456
s_add_u32 s60, s62, 12288
buffer_load_dwordx4 v214, s[24:27], s60 offen offset:0  lds
v_pk_add_f32 v[166:167], v[166:167], v[174:175]
v_pk_add_f32 v[176:177], v[176:177], v[184:185]
v_pk_add_f32 v[178:179], v[178:179], v[186:187]
v_pk_add_f32 v[180:181], v[180:181], v[188:189]
v_pk_add_f32 v[182:183], v[182:183], v[190:191]
v_pk_add_f32 v[160:161], v[160:161], v[176:177]
v_pk_add_f32 v[162:163], v[162:163], v[178:179]
v_pk_add_f32 v[164:165], v[164:165], v[180:181]
s_add_u32 m0, s63, 20480
s_add_u32 s60, s62, 16384
buffer_load_dwordx4 v213, s[24:27], s60 offen offset:0  lds
v_pk_add_f32 v[166:167], v[166:167], v[182:183]
v_mul_f32 v160, 0x3b000000, v160
v_mul_f32 v161, 0x3b000000, v161
v_fma_f32 v161, -v160, v160, v161
v_max_f32 v161, 0, v161
v_add_f32 v161, 0x3727c5ac, v161
v_rsq_f32 v192, v161
v_mul_f32 v162, 0x3b000000, v162
s_add_u32 m0, s63, 21504
s_add_u32 s60, s62, 20480
buffer_load_dwordx4 v214, s[24:27], s60 offen offset:0  lds
v_mul_f32 v163, 0x3b000000, v163
v_fma_f32 v163, -v162, v162, v163
v_max_f32 v163, 0, v163
v_add_f32 v163, 0x3727c5ac, v163
v_rsq_f32 v194, v163
v_mul_f32 v164, 0x3b000000, v164
v_mul_f32 v165, 0x3b000000, v165
v_fma_f32 v165, -v164, v164, v165
s_add_u32 m0, s63, 22528
s_add_u32 s60, s62, 24576
buffer_load_dwordx4 v213, s[24:27], s60 offen offset:0  lds
v_max_f32 v165, 0, v165
v_add_f32 v165, 0x3727c5ac, v165
v_rsq_f32 v196, v165
v_mul_f32 v166, 0x3b000000, v166
v_mul_f32 v167, 0x3b000000, v167
v_fma_f32 v167, -v166, v166, v167
v_max_f32 v167, 0, v167
v_add_f32 v167, 0x3727c5ac, v167
s_add_u32 m0, s63, 23552
s_add_u32 s60, s62, 28672
buffer_load_dwordx4 v214, s[24:27], s60 offen offset:0  lds
v_rsq_f32 v198, v167
v_mul_f32 v193, -v160, v192
v_mul_f32 v195, -v162, v194
v_mul_f32 v197, -v164, v196
v_mul_f32 v199, -v166, v198
v_lshlrev_b32 v168, 16, v96
v_and_b32 v169, 0xffff0000, v96
v_lshlrev_b32 v170, 16, v97
s_add_u32 m0, s63, 24576
s_add_u32 s60, s62, 32768
buffer_load_dwordx4 v213, s[24:27], s60 offen offset:0  lds
v_and_b32 v171, 0xffff0000, v97
v_lshlrev_b32 v172, 16, v98
v_and_b32 v173, 0xffff0000, v98
v_lshlrev_b32 v174, 16, v99
v_and_b32 v175, 0xffff0000, v99
v_pk_fma_f32 v[168:169], v[168:169], v[192:193], v[192:193] op_sel:[0,0,1] op_sel_hi:[1,0,1]
v_pk_fma_f32 v[170:171], v[170:171], v[192:193], v[192:193] op_sel:[0,0,1] op_sel_hi:[1,0,1]
v_pk_fma_f32 v[172:173], v[172:173], v[192:193], v[192:193] op_sel:[0,0,1] op_sel_hi:[1,0,1]
s_add_u32 m0, s63, 25600
s_add_u32 s60, s62, 36864
buffer_load_dwordx4 v214, s[24:27], s60 offen offset:0  lds
v_pk_fma_f32 v[174:175], v[174:175], v[192:193], v[192:193] op_sel:[0,0,1] op_sel_hi:[1,0,1]
v_cvt_pk_bf16_f32 v4, v168, v169
v_cvt_pk_bf16_f32 v5, v170, v171
v_cvt_pk_bf16_f32 v6, v172, v173
v_cvt_pk_bf16_f32 v7, v174, v175
v_lshlrev_b32 v176, 16, v100
v_and_b32 v177, 0xffff0000, v100
v_lshlrev_b32 v178, 16, v101
s_add_u32 m0, s63, 26624
s_add_u32 s60, s62, 40960
buffer_load_dwordx4 v213, s[24:27], s60 offen offset:0  lds
v_and_b32 v179, 0xffff0000, v101
v_lshlrev_b32 v180, 16, v102
v_and_b32 v181, 0xffff0000, v102
v_lshlrev_b32 v182, 16, v103
v_and_b32 v183, 0xffff0000, v103
v_pk_fma_f32 v[176:177], v[176:177], v[192:193], v[192:193] op_sel:[0,0,1] op_sel_hi:[1,0,1]
v_pk_fma_f32 v[178:179], v[178:179], v[192:193], v[192:193] op_sel:[0,0,1] op_sel_hi:[1,0,1]
v_pk_fma_f32 v[180:181], v[180:181], v[192:193], v[192:193] op_sel:[0,0,1] op_sel_hi:[1,0,1]
s_add_u32 m0, s63, 27648
s_add_u32 s60, s62, 45056
buffer_load_dwordx4 v214, s[24:27], s60 offen offset:0  lds
v_pk_fma_f32 v[182:183], v[182:183], v[192:193], v[192:193] op_sel:[0,0,1] op_sel_hi:[1,0,1]
v_cvt_pk_bf16_f32 v8, v176, v177
v_cvt_pk_bf16_f32 v9, v178, v179
v_cvt_pk_bf16_f32 v10, v180, v181
v_cvt_pk_bf16_f32 v11, v182, v183
v_lshlrev_b32 v168, 16, v104
v_and_b32 v169, 0xffff0000, v104
v_lshlrev_b32 v170, 16, v105
s_add_u32 m0, s63, 28672
s_add_u32 s60, s62, 49152
buffer_load_dwordx4 v213, s[24:27], s60 offen offset:0  lds
v_and_b32 v171, 0xffff0000, v105
v_lshlrev_b32 v172, 16, v106
v_and_b32 v173, 0xffff0000, v106
v_lshlrev_b32 v174, 16, v107
v_and_b32 v175, 0xffff0000, v107
v_pk_fma_f32 v[168:169], v[168:169], v[192:193], v[192:193] op_sel:[0,0,1] op_sel_hi:[1,0,1]
v_pk_fma_f32 v[170:171], v[170:171], v[192:193], v[192:193] op_sel:[0,0,1] op_sel_hi:[1,0,1]
v_pk_fma_f32 v[172:173], v[172:173], v[192:193], v[192:193] op_sel:[0,0,1] op_sel_hi:[1,0,1]
s_add_u32 m0, s63, 29696
s_add_u32 s60, s62, 53248
buffer_load_dwordx4 v214, s[24:27], s60 offen offset:0  lds
v_pk_fma_f32 v[174:175], v[174:175], v[192:193], v[192:193] op_sel:[0,0,1] op_sel_hi:[1,0,1]
v_cvt_pk_bf16_f32 v12, v168, v169
v_cvt_pk_bf16_f32 v13, v170, v171
v_cvt_pk_bf16_f32 v14, v172, v173
v_cvt_pk_bf16_f32 v15, v174, v175
v_lshlrev_b32 v176, 16, v108
v_and_b32 v177, 0xffff0000, v108
v_lshlrev_b32 v178, 16, v109
s_add_u32 m0, s63, 30720
s_add_u32 s60, s62, 57344
buffer_load_dwordx4 v213, s[24:27], s60 offen offset:0  lds
v_and_b32 v179, 0xffff0000, v109
v_lshlrev_b32 v180, 16, v110
v_and_b32 v181, 0xffff0000, v110
v_lshlrev_b32 v182, 16, v111
v_and_b32 v183, 0xffff0000, v111
v_pk_fma_f32 v[176:177], v[176:177], v[192:193], v[192:193] op_sel:[0,0,1] op_sel_hi:[1,0,1]
v_pk_fma_f32 v[178:179], v[178:179], v[192:193], v[192:193] op_sel:[0,0,1] op_sel_hi:[1,0,1]
v_pk_fma_f32 v[180:181], v[180:181], v[192:193], v[192:193] op_sel:[0,0,1] op_sel_hi:[1,0,1]
s_add_u32 m0, s63, 31744
s_add_u32 s60, s62, 61440
buffer_load_dwordx4 v214, s[24:27], s60 offen offset:0  lds
v_pk_fma_f32 v[182:183], v[182:183], v[192:193], v[192:193] op_sel:[0,0,1] op_sel_hi:[1,0,1]
v_cvt_pk_bf16_f32 v16, v176, v177
v_cvt_pk_bf16_f32 v17, v178, v179
v_cvt_pk_bf16_f32 v18, v180, v181
v_cvt_pk_bf16_f32 v19, v182, v183
v_lshlrev_b32 v168, 16, v112
v_and_b32 v169, 0xffff0000, v112
v_lshlrev_b32 v170, 16, v113
v_and_b32 v171, 0xffff0000, v113
v_lshlrev_b32 v172, 16, v114
v_and_b32 v173, 0xffff0000, v114
v_lshlrev_b32 v174, 16, v115
v_and_b32 v175, 0xffff0000, v115
v_pk_fma_f32 v[168:169], v[168:169], v[194:195], v[194:195] op_sel:[0,0,1] op_sel_hi:[1,0,1]
v_pk_fma_f32 v[170:171], v[170:171], v[194:195], v[194:195] op_sel:[0,0,1] op_sel_hi:[1,0,1]
v_pk_fma_f32 v[172:173], v[172:173], v[194:195], v[194:195] op_sel:[0,0,1] op_sel_hi:[1,0,1]
v_pk_fma_f32 v[174:175], v[174:175], v[194:195], v[194:195] op_sel:[0,0,1] op_sel_hi:[1,0,1]
v_cvt_pk_bf16_f32 v20, v168, v169
v_cvt_pk_bf16_f32 v21, v170, v171
v_cvt_pk_bf16_f32 v22, v172, v173
v_cvt_pk_bf16_f32 v23, v174, v175
v_lshlrev_b32 v176, 16, v116
v_and_b32 v177, 0xffff0000, v116
v_lshlrev_b32 v178, 16, v117
v_and_b32 v179, 0xffff0000, v117
v_lshlrev_b32 v180, 16, v118
v_and_b32 v181, 0xffff0000, v118
v_lshlrev_b32 v182, 16, v119
v_and_b32 v183, 0xffff0000, v119
v_pk_fma_f32 v[176:177], v[176:177], v[194:195], v[194:195] op_sel:[0,0,1] op_sel_hi:[1,0,1]
v_pk_fma_f32 v[178:179], v[178:179], v[194:195], v[194:195] op_sel:[0,0,1] op_sel_hi:[1,0,1]
v_pk_fma_f32 v[180:181], v[180:181], v[194:195], v[194:195] op_sel:[0,0,1] op_sel_hi:[1,0,1]
v_pk_fma_f32 v[182:183], v[182:183], v[194:195], v[194:195] op_sel:[0,0,1] op_sel_hi:[1,0,1]
v_cvt_pk_bf16_f32 v24, v176, v177
v_cvt_pk_bf16_f32 v25, v178, v179
v_cvt_pk_bf16_f32 v26, v180, v181
v_cvt_pk_bf16_f32 v27, v182, v183
v_lshlrev_b32 v168, 16, v120
v_and_b32 v169, 0xffff0000, v120
v_lshlrev_b32 v170, 16, v121
v_and_b32 v171, 0xffff0000, v121
v_lshlrev_b32 v172, 16, v122
v_and_b32 v173, 0xffff0000, v122
v_lshlrev_b32 v174, 16, v123
v_and_b32 v175, 0xffff0000, v123
v_pk_fma_f32 v[168:169], v[168:169], v[194:195], v[194:195] op_sel:[0,0,1] op_sel_hi:[1,0,1]
v_pk_fma_f32 v[170:171], v[170:171], v[194:195], v[194:195] op_sel:[0,0,1] op_sel_hi:[1,0,1]
v_pk_fma_f32 v[172:173], v[172:173], v[194:195], v[194:195] op_sel:[0,0,1] op_sel_hi:[1,0,1]
v_pk_fma_f32 v[174:175], v[174:175], v[194:195], v[194:195] op_sel:[0,0,1] op_sel_hi:[1,0,1]
v_cvt_pk_bf16_f32 v28, v168, v169
v_cvt_pk_bf16_f32 v29, v170, v171
v_cvt_pk_bf16_f32 v30, v172, v173
v_cvt_pk_bf16_f32 v31, v174, v175
v_lshlrev_b32 v176, 16, v124
v_and_b32 v177, 0xffff0000, v124
v_lshlrev_b32 v178, 16, v125
v_and_b32 v179, 0xffff0000, v125
v_lshlrev_b32 v180, 16, v126
v_and_b32 v181, 0xffff0000, v126
v_lshlrev_b32 v182, 16, v127
v_and_b32 v183, 0xffff0000, v127
v_pk_fma_f32 v[176:177], v[176:177], v[194:195], v[194:195] op_sel:[0,0,1] op_sel_hi:[1,0,1]
v_pk_fma_f32 v[178:179], v[178:179], v[194:195], v[194:195] op_sel:[0,0,1] op_sel_hi:[1,0,1]
v_pk_fma_f32 v[180:181], v[180:181], v[194:195], v[194:195] op_sel:[0,0,1] op_sel_hi:[1,0,1]
v_pk_fma_f32 v[182:183], v[182:183], v[194:195], v[194:195] op_sel:[0,0,1] op_sel_hi:[1,0,1]
v_cvt_pk_bf16_f32 v32, v176, v177
v_cvt_pk_bf16_f32 v33, v178, v179
v_cvt_pk_bf16_f32 v34, v180, v181
v_cvt_pk_bf16_f32 v35, v182, v183
v_lshlrev_b32 v168, 16, v128
v_and_b32 v169, 0xffff0000, v128
v_lshlrev_b32 v170, 16, v129
v_and_b32 v171, 0xffff0000, v129
v_lshlrev_b32 v172, 16, v130
v_and_b32 v173, 0xffff0000, v130
v_lshlrev_b32 v174, 16, v131
v_and_b32 v175, 0xffff0000, v131
v_pk_fma_f32 v[168:169], v[168:169], v[196:197], v[196:197] op_sel:[0,0,1] op_sel_hi:[1,0,1]
v_pk_fma_f32 v[170:171], v[170:171], v[196:197], v[196:197] op_sel:[0,0,1] op_sel_hi:[1,0,1]
v_pk_fma_f32 v[172:173], v[172:173], v[196:197], v[196:197] op_sel:[0,0,1] op_sel_hi:[1,0,1]
v_pk_fma_f32 v[174:175], v[174:175], v[196:197], v[196:197] op_sel:[0,0,1] op_sel_hi:[1,0,1]
v_cvt_pk_bf16_f32 v36, v168, v169
v_cvt_pk_bf16_f32 v37, v170, v171
v_cvt_pk_bf16_f32 v38, v172, v173
v_cvt_pk_bf16_f32 v39, v174, v175
v_lshlrev_b32 v176, 16, v132
v_and_b32 v177, 0xffff0000, v132
v_lshlrev_b32 v178, 16, v133
v_and_b32 v179, 0xffff0000, v133
v_lshlrev_b32 v180, 16, v134
v_and_b32 v181, 0xffff0000, v134
v_lshlrev_b32 v182, 16, v135
v_and_b32 v183, 0xffff0000, v135
v_pk_fma_f32 v[176:177], v[176:177], v[196:197], v[196:197] op_sel:[0,0,1] op_sel_hi:[1,0,1]
v_pk_fma_f32 v[178:179], v[178:179], v[196:197], v[196:197] op_sel:[0,0,1] op_sel_hi:[1,0,1]
v_pk_fma_f32 v[180:181], v[180:181], v[196:197], v[196:197] op_sel:[0,0,1] op_sel_hi:[1,0,1]
v_pk_fma_f32 v[182:183], v[182:183], v[196:197], v[196:197] op_sel:[0,0,1] op_sel_hi:[1,0,1]
v_cvt_pk_bf16_f32 v40, v176, v177
v_cvt_pk_bf16_f32 v41, v178, v179
v_cvt_pk_bf16_f32 v42, v180, v181
v_cvt_pk_bf16_f32 v43, v182, v183
v_lshlrev_b32 v168, 16, v136
v_and_b32 v169, 0xffff0000, v136
v_lshlrev_b32 v170, 16, v137
v_and_b32 v171, 0xffff0000, v137
v_lshlrev_b32 v172, 16, v138
v_and_b32 v173, 0xffff0000, v138
v_lshlrev_b32 v174, 16, v139
v_and_b32 v175, 0xffff0000, v139
v_pk_fma_f32 v[168:169], v[168:169], v[196:197], v[196:197] op_sel:[0,0,1] op_sel_hi:[1,0,1]
v_pk_fma_f32 v[170:171], v[170:171], v[196:197], v[196:197] op_sel:[0,0,1] op_sel_hi:[1,0,1]
v_pk_fma_f32 v[172:173], v[172:173], v[196:197], v[196:197] op_sel:[0,0,1] op_sel_hi:[1,0,1]
v_pk_fma_f32 v[174:175], v[174:175], v[196:197], v[196:197] op_sel:[0,0,1] op_sel_hi:[1,0,1]
v_cvt_pk_bf16_f32 v44, v168, v169
v_cvt_pk_bf16_f32 v45, v170, v171
v_cvt_pk_bf16_f32 v46, v172, v173
v_cvt_pk_bf16_f32 v47, v174, v175
v_lshlrev_b32 v176, 16, v140
v_and_b32 v177, 0xffff0000, v140
v_lshlrev_b32 v178, 16, v141
v_and_b32 v179, 0xffff0000, v141
v_lshlrev_b32 v180, 16, v142
v_and_b32 v181, 0xffff0000, v142
v_lshlrev_b32 v182, 16, v143
v_and_b32 v183, 0xffff0000, v143
v_pk_fma_f32 v[176:177], v[176:177], v[196:197], v[196:197] op_sel:[0,0,1] op_sel_hi:[1,0,1]
v_pk_fma_f32 v[178:179], v[178:179], v[196:197], v[196:197] op_sel:[0,0,1] op_sel_hi:[1,0,1]
v_pk_fma_f32 v[180:181], v[180:181], v[196:197], v[196:197] op_sel:[0,0,1] op_sel_hi:[1,0,1]
v_pk_fma_f32 v[182:183], v[182:183], v[196:197], v[196:197] op_sel:[0,0,1] op_sel_hi:[1,0,1]
v_cvt_pk_bf16_f32 v48, v176, v177
v_cvt_pk_bf16_f32 v49, v178, v179
v_cvt_pk_bf16_f32 v50, v180, v181
v_cvt_pk_bf16_f32 v51, v182, v183
v_lshlrev_b32 v168, 16, v144
v_and_b32 v169, 0xffff0000, v144
v_lshlrev_b32 v170, 16, v145
v_and_b32 v171, 0xffff0000, v145
v_lshlrev_b32 v172, 16, v146
v_and_b32 v173, 0xffff0000, v146
v_lshlrev_b32 v174, 16, v147
v_and_b32 v175, 0xffff0000, v147
v_pk_fma_f32 v[168:169], v[168:169], v[198:199], v[198:199] op_sel:[0,0,1] op_sel_hi:[1,0,1]
v_pk_fma_f32 v[170:171], v[170:171], v[198:199], v[198:199] op_sel:[0,0,1] op_sel_hi:[1,0,1]
v_pk_fma_f32 v[172:173], v[172:173], v[198:199], v[198:199] op_sel:[0,0,1] op_sel_hi:[1,0,1]
v_pk_fma_f32 v[174:175], v[174:175], v[198:199], v[198:199] op_sel:[0,0,1] op_sel_hi:[1,0,1]
v_cvt_pk_bf16_f32 v52, v168, v169
v_cvt_pk_bf16_f32 v53, v170, v171
v_cvt_pk_bf16_f32 v54, v172, v173
v_cvt_pk_bf16_f32 v55, v174, v175
v_lshlrev_b32 v176, 16, v148
v_and_b32 v177, 0xffff0000, v148
v_lshlrev_b32 v178, 16, v149
v_and_b32 v179, 0xffff0000, v149
v_lshlrev_b32 v180, 16, v150
v_and_b32 v181, 0xffff0000, v150
v_lshlrev_b32 v182, 16, v151
v_and_b32 v183, 0xffff0000, v151
v_pk_fma_f32 v[176:177], v[176:177], v[198:199], v[198:199] op_sel:[0,0,1] op_sel_hi:[1,0,1]
v_pk_fma_f32 v[178:179], v[178:179], v[198:199], v[198:199] op_sel:[0,0,1] op_sel_hi:[1,0,1]
v_pk_fma_f32 v[180:181], v[180:181], v[198:199], v[198:199] op_sel:[0,0,1] op_sel_hi:[1,0,1]
v_pk_fma_f32 v[182:183], v[182:183], v[198:199], v[198:199] op_sel:[0,0,1] op_sel_hi:[1,0,1]
v_cvt_pk_bf16_f32 v56, v176, v177
v_cvt_pk_bf16_f32 v57, v178, v179
v_cvt_pk_bf16_f32 v58, v180, v181
v_cvt_pk_bf16_f32 v59, v182, v183
v_lshlrev_b32 v168, 16, v152
v_and_b32 v169, 0xffff0000, v152
v_lshlrev_b32 v170, 16, v153
v_and_b32 v171, 0xffff0000, v153
v_lshlrev_b32 v172, 16, v154
v_and_b32 v173, 0xffff0000, v154
v_lshlrev_b32 v174, 16, v155
v_and_b32 v175, 0xffff0000, v155
v_pk_fma_f32 v[168:169], v[168:169], v[198:199], v[198:199] op_sel:[0,0,1] op_sel_hi:[1,0,1]
v_pk_fma_f32 v[170:171], v[170:171], v[198:199], v[198:199] op_sel:[0,0,1] op_sel_hi:[1,0,1]
v_pk_fma_f32 v[172:173], v[172:173], v[198:199], v[198:199] op_sel:[0,0,1] op_sel_hi:[1,0,1]
v_pk_fma_f32 v[174:175], v[174:175], v[198:199], v[198:199] op_sel:[0,0,1] op_sel_hi:[1,0,1]
v_cvt_pk_bf16_f32 v60, v168, v169
v_cvt_pk_bf16_f32 v61, v170, v171
v_cvt_pk_bf16_f32 v62, v172, v173
v_cvt_pk_bf16_f32 v63, v174, v175
v_lshlrev_b32 v176, 16, v156
v_and_b32 v177, 0xffff0000, v156
v_lshlrev_b32 v178, 16, v157
v_and_b32 v179, 0xffff0000, v157
v_lshlrev_b32 v180, 16, v158
v_and_b32 v181, 0xffff0000, v158
v_lshlrev_b32 v182, 16, v159
v_and_b32 v183, 0xffff0000, v159
v_pk_fma_f32 v[176:177], v[176:177], v[198:199], v[198:199] op_sel:[0,0,1] op_sel_hi:[1,0,1]
v_pk_fma_f32 v[178:179], v[178:179], v[198:199], v[198:199] op_sel:[0,0,1] op_sel_hi:[1,0,1]
v_pk_fma_f32 v[180:181], v[180:181], v[198:199], v[198:199] op_sel:[0,0,1] op_sel_hi:[1,0,1]
v_pk_fma_f32 v[182:183], v[182:183], v[198:199], v[198:199] op_sel:[0,0,1] op_sel_hi:[1,0,1]
v_cvt_pk_bf16_f32 v236, v176, v177
v_cvt_pk_bf16_f32 v237, v178, v179
v_cvt_pk_bf16_f32 v238, v180, v181
v_cvt_pk_bf16_f32 v239, v182, v183
s_waitcnt vmcnt(16)
ds_read_b64_tr_b16 a[0:1], v215 offset:0
ds_read_b64_tr_b16 a[2:3], v215 offset:512
ds_read_b64_tr_b16 a[4:5], v215 offset:4096
ds_read_b64_tr_b16 a[6:7], v215 offset:4608
ds_read_b64_tr_b16 a[8:9], v215 offset:8192
ds_read_b64_tr_b16 a[10:11], v215 offset:8704
ds_read_b64_tr_b16 a[12:13], v215 offset:12288
ds_read_b64_tr_b16 a[14:15], v215 offset:12800
v_xor_b32 v231, 32, v215
ds_read_b64_tr_b16 a[16:17], v231 offset:0
ds_read_b64_tr_b16 a[18:19], v231 offset:512
ds_read_b64_tr_b16 a[20:21], v231 offset:4096
ds_read_b64_tr_b16 a[22:23], v231 offset:4608
ds_read_b64_tr_b16 a[24:25], v231 offset:8192
ds_read_b64_tr_b16 a[26:27], v231 offset:8704
ds_read_b64_tr_b16 a[28:29], v231 offset:12288
ds_read_b64_tr_b16 a[30:31], v231 offset:12800
v_xor_b32 v231, 64, v215
ds_read_b64_tr_b16 a[32:33], v231 offset:0
ds_read_b64_tr_b16 a[34:35], v231 offset:512
ds_read_b64_tr_b16 a[36:37], v231 offset:4096
ds_read_b64_tr_b16 a[38:39], v231 offset:4608
ds_read_b64_tr_b16 a[40:41], v231 offset:8192
ds_read_b64_tr_b16 a[42:43], v231 offset:8704
ds_read_b64_tr_b16 a[44:45], v231 offset:12288
ds_read_b64_tr_b16 a[46:47], v231 offset:12800
v_xor_b32 v231, 96, v215
ds_read_b64_tr_b16 a[48:49], v231 offset:0
ds_read_b64_tr_b16 a[50:51], v231 offset:512
ds_read_b64_tr_b16 a[52:53], v231 offset:4096
ds_read_b64_tr_b16 a[54:55], v231 offset:4608
ds_read_b64_tr_b16 a[56:57], v231 offset:8192
ds_read_b64_tr_b16 a[58:59], v231 offset:8704
ds_read_b64_tr_b16 a[60:61], v231 offset:12288
ds_read_b64_tr_b16 a[62:63], v231 offset:12800
s_waitcnt lgkmcnt(0)
v_mfma_f32_16x16x32_bf16 v[80:83], v[4:7], a[0:3], 0
v_mfma_f32_16x16x32_bf16 v[80:83], v[8:11], a[4:7], v[80:83]
v_mfma_f32_16x16x32_bf16 v[80:83], v[12:15], a[8:11], v[80:83]
v_mfma_f32_16x16x32_bf16 v[80:83], v[16:19], a[12:15], v[80:83]
v_mfma_f32_16x16x32_bf16 v[84:87], v[20:23], a[0:3], 0
v_mfma_f32_16x16x32_bf16 v[84:87], v[24:27], a[4:7], v[84:87]
v_mfma_f32_16x16x32_bf16 v[84:87], v[28:31], a[8:11], v[84:87]
v_mfma_f32_16x16x32_bf16 v[84:87], v[32:35], a[12:15], v[84:87]
v_mfma_f32_16x16x32_bf16 v[88:91], v[4:7], a[16:19], 0
v_mfma_f32_16x16x32_bf16 v[88:91], v[8:11], a[20:23], v[88:91]
ds_write_b128 v227, v[80:83] offset:0
v_mfma_f32_16x16x32_bf16 v[88:91], v[12:15], a[24:27], v[88:91]
v_mfma_f32_16x16x32_bf16 v[88:91], v[16:19], a[28:31], v[88:91]
v_mfma_f32_16x16x32_bf16 v[92:95], v[20:23], a[16:19], 0
v_mfma_f32_16x16x32_bf16 v[92:95], v[24:27], a[20:23], v[92:95]
ds_write_b128 v227, v[84:87] offset:1024
v_mfma_f32_16x16x32_bf16 v[92:95], v[28:31], a[24:27], v[92:95]
v_mfma_f32_16x16x32_bf16 v[92:95], v[32:35], a[28:31], v[92:95]
v_mfma_f32_16x16x32_bf16 v[96:99], v[4:7], a[32:35], 0
v_mfma_f32_16x16x32_bf16 v[96:99], v[8:11], a[36:39], v[96:99]
ds_write_b128 v227, v[88:91] offset:2048
v_mfma_f32_16x16x32_bf16 v[96:99], v[12:15], a[40:43], v[96:99]
v_mfma_f32_16x16x32_bf16 v[96:99], v[16:19], a[44:47], v[96:99]
v_mfma_f32_16x16x32_bf16 v[100:103], v[20:23], a[32:35], 0
v_mfma_f32_16x16x32_bf16 v[100:103], v[24:27], a[36:39], v[100:103]
ds_write_b128 v227, v[92:95] offset:3072
v_mfma_f32_16x16x32_bf16 v[100:103], v[28:31], a[40:43], v[100:103]
v_mfma_f32_16x16x32_bf16 v[100:103], v[32:35], a[44:47], v[100:103]
v_mfma_f32_16x16x32_bf16 v[104:107], v[4:7], a[48:51], 0
v_mfma_f32_16x16x32_bf16 v[104:107], v[8:11], a[52:55], v[104:107]
ds_write_b128 v227, v[96:99] offset:4096
v_mfma_f32_16x16x32_bf16 v[104:107], v[12:15], a[56:59], v[104:107]
v_mfma_f32_16x16x32_bf16 v[104:107], v[16:19], a[60:63], v[104:107]
v_mfma_f32_16x16x32_bf16 v[108:111], v[20:23], a[48:51], 0
v_mfma_f32_16x16x32_bf16 v[108:111], v[24:27], a[52:55], v[108:111]
ds_write_b128 v227, v[100:103] offset:5120
v_mfma_f32_16x16x32_bf16 v[108:111], v[28:31], a[56:59], v[108:111]
v_mfma_f32_16x16x32_bf16 v[108:111], v[32:35], a[60:63], v[108:111]
ds_write_b128 v227, v[104:107] offset:6144
s_nop 6
ds_write_b128 v227, v[108:111] offset:7168
s_waitcnt lgkmcnt(0)
s_barrier
ds_read_b128 v[112:115], v228 offset:0
ds_read_b128 v[116:119], v228 offset:32768
ds_read_b128 v[120:123], v229 offset:0
ds_read_b128 v[124:127], v229 offset:32768
ds_read_b128 v[128:131], v228 offset:1024
ds_read_b128 v[132:135], v228 offset:33792
ds_read_b128 v[136:139], v229 offset:1024
ds_read_b128 v[140:143], v229 offset:33792
s_waitcnt lgkmcnt(6)
v_pk_add_f32 v[112:113], v[112:113], v[116:117]
v_pk_add_f32 v[114:115], v[114:115], v[118:119]
s_waitcnt lgkmcnt(4)
v_pk_add_f32 v[120:121], v[120:121], v[124:125]
v_pk_add_f32 v[122:123], v[122:123], v[126:127]
v_pk_add_f32 v[112:113], v[112:113], v[120:121]
v_pk_add_f32 v[114:115], v[114:115], v[122:123]
v_cvt_pk_bf16_f32 v176, v112, v113
v_cvt_pk_bf16_f32 v177, v114, v115
s_waitcnt lgkmcnt(2)
v_pk_add_f32 v[128:129], v[128:129], v[132:133]
v_pk_add_f32 v[130:131], v[130:131], v[134:135]
s_waitcnt lgkmcnt(0)
v_pk_add_f32 v[136:137], v[136:137], v[140:141]
v_pk_add_f32 v[138:139], v[138:139], v[142:143]
v_pk_add_f32 v[128:129], v[128:129], v[136:137]
v_pk_add_f32 v[130:131], v[130:131], v[138:139]
v_cvt_pk_bf16_f32 v178, v128, v129
v_cvt_pk_bf16_f32 v179, v130, v131
ds_write_b128 v233, v[176:179] offset:0
s_waitcnt lgkmcnt(0)
s_barrier
v_add_u32 v231, 0x10000, v230
ds_read_b128 v[188:191], v231 offset:0
ds_read_b128 v[192:195], v231 offset:1024
ds_read_b128 v[196:199], v231 offset:2048
ds_read_b128 v[200:203], v231 offset:3072
buffer_load_dword v232, off, s[40:43], 0 offset:136 sc1
v_mfma_f32_16x16x32_bf16 v[80:83], v[64:67], a[0:3], 0
v_mfma_f32_16x16x32_bf16 v[84:87], v[64:67], a[16:19], 0
v_mfma_f32_16x16x32_bf16 v[88:91], v[64:67], a[32:35], 0
v_mfma_f32_16x16x32_bf16 v[92:95], v[64:67], a[48:51], 0
v_mfma_f32_16x16x32_bf16 v[80:83], v[68:71], a[4:7], v[80:83]
v_mfma_f32_16x16x32_bf16 v[84:87], v[68:71], a[20:23], v[84:87]
v_mfma_f32_16x16x32_bf16 v[88:91], v[68:71], a[36:39], v[88:91]
v_mfma_f32_16x16x32_bf16 v[92:95], v[68:71], a[52:55], v[92:95]
v_mfma_f32_16x16x32_bf16 v[80:83], v[72:75], a[8:11], v[80:83]
v_mfma_f32_16x16x32_bf16 v[84:87], v[72:75], a[24:27], v[84:87]
v_mfma_f32_16x16x32_bf16 v[88:91], v[72:75], a[40:43], v[88:91]
v_mfma_f32_16x16x32_bf16 v[92:95], v[72:75], a[56:59], v[92:95]
v_mfma_f32_16x16x32_bf16 v[80:83], v[76:79], a[12:15], v[80:83]
v_mfma_f32_16x16x32_bf16 v[84:87], v[76:79], a[28:31], v[84:87]
v_mfma_f32_16x16x32_bf16 v[88:91], v[76:79], a[44:47], v[88:91]
v_mfma_f32_16x16x32_bf16 v[92:95], v[76:79], a[60:63], v[92:95]
ds_write_b64 v227, v[80:81] offset:8192
s_nop 2
ds_write_b64 v227, v[84:85] offset:8200
s_nop 1
ds_write_b64 v227, v[88:89] offset:9216
ds_write_b64 v227, v[92:93] offset:9224
s_waitcnt lgkmcnt(0)
s_barrier
ds_read_b128 v[80:83], v1 offset:8192
ds_read_b128 v[84:87], v1 offset:40960
ds_read_b128 v[88:91], v230 offset:8192
ds_read_b128 v[92:95], v230 offset:40960
ds_read_b128 v[96:99], v1 offset:9216
ds_read_b128 v[100:103], v1 offset:41984
ds_read_b128 v[104:107], v230 offset:9216
ds_read_b128 v[108:111], v230 offset:41984
s_waitcnt lgkmcnt(6)
v_pk_add_f32 v[80:81], v[80:81], v[84:85]
v_pk_add_f32 v[82:83], v[82:83], v[86:87]
s_waitcnt lgkmcnt(4)
v_pk_add_f32 v[88:89], v[88:89], v[92:93]
v_pk_add_f32 v[90:91], v[90:91], v[94:95]
v_pk_add_f32 v[80:81], v[80:81], v[88:89]
v_pk_add_f32 v[82:83], v[82:83], v[90:91]
v_cvt_pk_bf16_f32 v152, v80, v81
v_cvt_pk_bf16_f32 v153, v82, v83
s_waitcnt lgkmcnt(2)
v_pk_add_f32 v[96:97], v[96:97], v[100:101]
v_pk_add_f32 v[98:99], v[98:99], v[102:103]
s_waitcnt lgkmcnt(0)
v_pk_add_f32 v[104:105], v[104:105], v[108:109]
v_pk_add_f32 v[106:107], v[106:107], v[110:111]
v_pk_add_f32 v[96:97], v[96:97], v[104:105]
v_pk_add_f32 v[98:99], v[98:99], v[106:107]
v_cvt_pk_bf16_f32 v154, v96, v97
v_cvt_pk_bf16_f32 v155, v98, v99
s_waitcnt vmcnt(0)
ds_read_b64_tr_b16 a[64:65], v217 offset:16384
ds_read_b64_tr_b16 a[66:67], v217 offset:20480
ds_read_b64_tr_b16 a[68:69], v217 offset:24576
ds_read_b64_tr_b16 a[70:71], v217 offset:28672
v_xor_b32 v231, 32, v217
ds_read_b64_tr_b16 a[72:73], v231 offset:16384
ds_read_b64_tr_b16 a[74:75], v231 offset:20480
ds_read_b64_tr_b16 a[76:77], v231 offset:24576
ds_read_b64_tr_b16 a[78:79], v231 offset:28672
v_xor_b32 v231, 64, v217
ds_read_b64_tr_b16 a[80:81], v231 offset:16384
ds_read_b64_tr_b16 a[82:83], v231 offset:20480
ds_read_b64_tr_b16 a[84:85], v231 offset:24576
ds_read_b64_tr_b16 a[86:87], v231 offset:28672
v_xor_b32 v231, 96, v217
ds_read_b64_tr_b16 a[88:89], v231 offset:16384
ds_read_b64_tr_b16 a[90:91], v231 offset:20480
ds_read_b64_tr_b16 a[92:93], v231 offset:24576
ds_read_b64_tr_b16 a[94:95], v231 offset:28672
v_xor_b32 v231, 128, v217
ds_read_b64_tr_b16 a[96:97], v231 offset:16384
ds_read_b64_tr_b16 a[98:99], v231 offset:20480
ds_read_b64_tr_b16 a[100:101], v231 offset:24576
ds_read_b64_tr_b16 a[102:103], v231 offset:28672
v_xor_b32 v231, 160, v217
ds_read_b64_tr_b16 a[104:105], v231 offset:16384
ds_read_b64_tr_b16 a[106:107], v231 offset:20480
ds_read_b64_tr_b16 a[108:109], v231 offset:24576
ds_read_b64_tr_b16 a[110:111], v231 offset:28672
v_xor_b32 v231, 192, v217
ds_read_b64_tr_b16 a[112:113], v231 offset:16384
ds_read_b64_tr_b16 a[114:115], v231 offset:20480
ds_read_b64_tr_b16 a[116:117], v231 offset:24576
ds_read_b64_tr_b16 a[118:119], v231 offset:28672
v_xor_b32 v231, 224, v217
ds_read_b64_tr_b16 a[120:121], v231 offset:16384
ds_read_b64_tr_b16 a[122:123], v231 offset:20480
ds_read_b64_tr_b16 a[124:125], v231 offset:24576
ds_read_b64_tr_b16 a[126:127], v231 offset:28672
L_gw_102:
v_readfirstlane_b32 s55, v232
s_nop 0
s_cmp_lg_u32 s55, 0
s_cbranch_scc1 L_gk_103
s_add_u32 s54, s54, 1
s_cmp_gt_u32 s54, 400000
s_cbranch_scc1 L_end
buffer_load_dword v232, off, s[40:43], 0 offset:136 sc1
s_waitcnt vmcnt(0)
s_branch L_gw_102
L_gk_103:
s_lshr_b32 s53, s55, 16
s_cmp_lg_u32 s53, 0
s_cbranch_scc1 L_x_i1
s_waitcnt lgkmcnt(0)
buffer_load_dwordx4 v[92:95], v222, s[44:47], s66 offen offset:0 sc1
buffer_load_dwordx4 v[96:99], v222, s[44:47], s66 offen offset:512 sc1
buffer_load_dwordx2 v[100:101], v222, s[44:47], s66 offen offset:1024 sc1
L_x_q_105:
s_waitcnt vmcnt(0)
v_bitop3_b32 v116, v92, v96, v100 bitop3:0x80
v_bitop3_b32 v116, v116, v92, 1 bitop3:0x80
v_cmp_eq_u32 vcc, 0, v116
s_cbranch_vccz L_x_r_106
s_mov_b64 exec, vcc
buffer_load_dwordx4 v[92:95], v222, s[44:47], s66 offen offset:0 sc1
buffer_load_dwordx4 v[96:99], v222, s[44:47], s66 offen offset:512 sc1
buffer_load_dwordx2 v[100:101], v222, s[44:47], s66 offen offset:1024 sc1
s_mov_b64 exec, -1
s_add_u32 s54, s54, 1
s_cmp_gt_u32 s54, 400000
s_cbranch_scc1 L_end
s_branch L_x_q_105
L_x_r_106:
v_add_f32_dpp v92, v92, v92 quad_perm:[2,3,0,1] row_mask:0xf bank_mask:0xf
v_add_f32_dpp v93, v93, v93 quad_perm:[2,3,0,1] row_mask:0xf bank_mask:0xf
v_add_f32_dpp v94, v94, v94 quad_perm:[2,3,0,1] row_mask:0xf bank_mask:0xf
v_add_f32_dpp v95, v95, v95 quad_perm:[2,3,0,1] row_mask:0xf bank_mask:0xf
v_add_f32_dpp v96, v96, v96 quad_perm:[2,3,0,1] row_mask:0xf bank_mask:0xf
v_add_f32_dpp v97, v97, v97 quad_perm:[2,3,0,1] row_mask:0xf bank_mask:0xf
v_add_f32_dpp v98, v98, v98 quad_perm:[2,3,0,1] row_mask:0xf bank_mask:0xf
v_add_f32_dpp v99, v99, v99 quad_perm:[2,3,0,1] row_mask:0xf bank_mask:0xf
v_add_f32_dpp v100, v100, v100 quad_perm:[2,3,0,1] row_mask:0xf bank_mask:0xf
v_add_f32_dpp v101, v101, v101 quad_perm:[2,3,0,1] row_mask:0xf bank_mask:0xf
v_max3_f32 v114, v92, v93, v94
v_max3_f32 v114, v114, v95, v96
v_max3_f32 v114, v114, v97, v98
v_max3_f32 v114, v114, v99, v100
v_max_f32 v114, v114, v101
v_mov_b32 v115, v114
s_nop 1
v_permlane16_swap_b32 v114, v115
v_max_f32 v114, v114, v115
v_mov_b32 v115, v114
s_nop 1
v_permlane32_swap_b32 v114, v115
v_max_f32 v114, v114, v115
v_mul_f32 v114, 0xbe0293ee, v114
v_fmamk_f32 v92, v92, 0x3e0293ee, v114
v_fmamk_f32 v93, v93, 0x3e0293ee, v114
v_fmamk_f32 v94, v94, 0x3e0293ee, v114
v_fmamk_f32 v95, v95, 0x3e0293ee, v114
v_fmamk_f32 v96, v96, 0x3e0293ee, v114
v_fmamk_f32 v97, v97, 0x3e0293ee, v114
v_fmamk_f32 v98, v98, 0x3e0293ee, v114
v_fmamk_f32 v99, v99, 0x3e0293ee, v114
v_fmamk_f32 v100, v100, 0x3e0293ee, v114
v_fmamk_f32 v101, v101, 0x3e0293ee, v114
v_exp_f32 v92, v92
v_exp_f32 v93, v93
v_exp_f32 v94, v94
v_exp_f32 v95, v95
v_exp_f32 v96, v96
v_exp_f32 v97, v97
v_exp_f32 v98, v98
v_exp_f32 v99, v99
v_exp_f32 v100, v100
v_exp_f32 v101, v101
v_mov_b32 v121, 0
v_mov_b32 v122, 0
v_cvt_pk_bf16_f32 v116, v92, v93
v_cvt_pk_bf16_f32 v117, v94, v95
v_cvt_pk_bf16_f32 v118, v96, v97
v_cvt_pk_bf16_f32 v119, v98, v99
v_cvt_pk_bf16_f32 v120, v100, v101
v_cvt_pk_bf16_f32 v123, v100, v101
v_mfma_f32_16x16x32_bf16 v[124:127], v[208:211], v[116:119], 0
v_mfma_f32_16x16x32_bf16 v[128:131], v[188:191], v[116:119], 0
v_mfma_f32_16x16x32_bf16 v[132:135], v[192:195], v[116:119], 0
v_mfma_f32_16x16x32_bf16 v[136:139], v[196:199], v[116:119], 0
v_mfma_f32_16x16x32_bf16 v[140:143], v[200:203], v[116:119], 0
v_mfma_f32_16x16x16_bf16 v[124:127], v[208:209], v[120:121], v[124:127]
v_mfma_f32_16x16x16_bf16 v[128:131], v[152:153], v[120:121], v[128:131]
v_mfma_f32_16x16x16_bf16 v[132:135], v[152:153], v[122:123], v[132:135]
v_mfma_f32_16x16x16_bf16 v[136:139], v[154:155], v[120:121], v[136:139]
v_mfma_f32_16x16x16_bf16 v[140:143], v[154:155], v[122:123], v[140:143]
v_rcp_f32 v124, v124
s_nop 0
v_mul_f32 v128, v128, v124
v_mul_f32 v129, v129, v124
v_mul_f32 v130, v130, v124
v_mul_f32 v131, v131, v124
v_mul_f32 v132, v132, v124
v_mul_f32 v133, v133, v124
v_mul_f32 v134, v134, v124
v_mul_f32 v135, v135, v124
v_cvt_pk_bf16_f32 v144, v128, v129
v_cvt_pk_bf16_f32 v145, v130, v131
v_cvt_pk_bf16_f32 v146, v132, v133
v_cvt_pk_bf16_f32 v147, v134, v135
v_mul_f32 v136, v136, v124
v_mul_f32 v137, v137, v124
v_mul_f32 v138, v138, v124
v_mul_f32 v139, v139, v124
v_mul_f32 v140, v140, v124
v_mul_f32 v141, v141, v124
v_mul_f32 v142, v142, v124
v_mul_f32 v143, v143, v124
v_cvt_pk_bf16_f32 v148, v136, v137
v_cvt_pk_bf16_f32 v149, v138, v139
v_cvt_pk_bf16_f32 v150, v140, v141
v_cvt_pk_bf16_f32 v151, v142, v143
v_mfma_f32_16x16x32_bf16 v[80:83], a[64:67], v[144:147], 0
s_nop 0
v_mfma_f32_16x16x32_bf16 v[80:83], a[68:71], v[148:151], v[80:83]
v_mfma_f32_16x16x32_bf16 v[84:87], a[72:75], v[144:147], 0
v_mfma_f32_16x16x32_bf16 v[84:87], a[76:79], v[148:151], v[84:87]
v_mfma_f32_16x16x32_bf16 v[88:91], a[80:83], v[144:147], 0
v_mfma_f32_16x16x32_bf16 v[88:91], a[84:87], v[148:151], v[88:91]
v_mfma_f32_16x16x32_bf16 v[92:95], a[88:91], v[144:147], 0
v_mfma_f32_16x16x32_bf16 v[92:95], a[92:95], v[148:151], v[92:95]
v_mfma_f32_16x16x32_bf16 v[96:99], a[96:99], v[144:147], 0
v_mfma_f32_16x16x32_bf16 v[96:99], a[100:103], v[148:151], v[96:99]
v_mfma_f32_16x16x32_bf16 v[100:103], a[104:107], v[144:147], 0
v_mfma_f32_16x16x32_bf16 v[100:103], a[108:111], v[148:151], v[100:103]
v_mfma_f32_16x16x32_bf16 v[104:107], a[112:115], v[144:147], 0
v_mfma_f32_16x16x32_bf16 v[104:107], a[116:119], v[148:151], v[104:107]
v_mfma_f32_16x16x32_bf16 v[108:111], a[120:123], v[144:147], 0
v_mfma_f32_16x16x32_bf16 v[108:111], a[124:127], v[148:151], v[108:111]
v_cvt_pk_bf16_f32 v80, v80, v81
v_cvt_pk_bf16_f32 v81, v82, v83
v_cvt_pk_bf16_f32 v82, v84, v85
v_cvt_pk_bf16_f32 v83, v86, v87
v_cndmask_b32 v80, v80, v82, s[78:79]
v_cndmask_b32 v81, v81, v83, s[78:79]
v_or_b32 v80, 1, v80
buffer_store_dwordx2 v[80:81], v223, s[44:47], s68 offen
v_cvt_pk_bf16_f32 v88, v88, v89
v_cvt_pk_bf16_f32 v89, v90, v91
v_cvt_pk_bf16_f32 v90, v92, v93
v_cvt_pk_bf16_f32 v91, v94, v95
v_cndmask_b32 v88, v88, v90, s[78:79]
v_cndmask_b32 v89, v89, v91, s[78:79]
v_or_b32 v88, 1, v88
s_add_u32 s56, s68, 24576
buffer_store_dwordx2 v[88:89], v223, s[44:47], s56 offen
v_cvt_pk_bf16_f32 v96, v96, v97
v_cvt_pk_bf16_f32 v97, v98, v99
v_cvt_pk_bf16_f32 v98, v100, v101
v_cvt_pk_bf16_f32 v99, v102, v103
v_cndmask_b32 v96, v96, v98, s[78:79]
v_cndmask_b32 v97, v97, v99, s[78:79]
v_or_b32 v96, 1, v96
s_add_u32 s56, s68, 49152
buffer_store_dwordx2 v[96:97], v223, s[44:47], s56 offen
v_cvt_pk_bf16_f32 v104, v104, v105
v_cvt_pk_bf16_f32 v105, v106, v107
v_cvt_pk_bf16_f32 v106, v108, v109
v_cvt_pk_bf16_f32 v107, v110, v111
v_cndmask_b32 v104, v104, v106, s[78:79]
v_cndmask_b32 v105, v105, v107, s[78:79]
v_or_b32 v104, 1, v104
s_add_u32 s56, s68, 73728
buffer_store_dwordx2 v[104:105], v223, s[44:47], s56 offen
s_waitcnt vmcnt(0)
buffer_load_dwordx4 v[112:115], v1, s[44:47], s74 offen sc1
L_x_q_108:
s_waitcnt vmcnt(0)
v_bitop3_b32 v124, v112, v114, 1 bitop3:0x80
v_cmp_eq_u32 vcc, 0, v124
s_cbranch_vccz L_x_r_109
s_mov_b64 exec, vcc
buffer_load_dwordx4 v[112:115], v1, s[44:47], s74 offen sc1
s_mov_b64 exec, -1
s_add_u32 s54, s54, 1
s_cmp_gt_u32 s54, 400000
s_cbranch_scc1 L_end
s_branch L_x_q_108
L_x_r_109:
v_mfma_f32_16x16x32_bf16 v[120:123], v[204:207], v[112:115], 0
s_nop 7
v_add_f32_dpp v120, v120, v120 row_ror:4 row_mask:0xf bank_mask:0xf
v_add_f32_dpp v121, v121, v121 row_ror:4 row_mask:0xf bank_mask:0xf
v_add_f32_dpp v122, v122, v122 row_ror:4 row_mask:0xf bank_mask:0xf
v_add_f32_dpp v123, v123, v123 row_ror:4 row_mask:0xf bank_mask:0xf
v_add_f32_dpp v120, v120, v120 row_ror:8 row_mask:0xf bank_mask:0xf
v_add_f32_dpp v121, v121, v121 row_ror:8 row_mask:0xf bank_mask:0xf
v_add_f32_dpp v122, v122, v122 row_ror:8 row_mask:0xf bank_mask:0xf
v_add_f32_dpp v123, v123, v123 row_ror:8 row_mask:0xf bank_mask:0xf
v_min_u32 v120, -2, v120
v_min_u32 v121, -2, v121
v_min_u32 v122, -2, v122
v_min_u32 v123, -2, v123
buffer_store_dwordx4 v[120:123], v224, s[44:47], s72 offen offset:0 sc1
v_mfma_f32_16x16x32_bf16 v[80:83], v[36:39], a[0:3], 0
v_mfma_f32_16x16x32_bf16 v[80:83], v[40:43], a[4:7], v[80:83]
v_mfma_f32_16x16x32_bf16 v[80:83], v[44:47], a[8:11], v[80:83]
v_mfma_f32_16x16x32_bf16 v[80:83], v[48:51], a[12:15], v[80:83]
v_mfma_f32_16x16x32_bf16 v[84:87], v[52:55], a[0:3], 0
v_mfma_f32_16x16x32_bf16 v[84:87], v[56:59], a[4:7], v[84:87]
v_mfma_f32_16x16x32_bf16 v[84:87], v[60:63], a[8:11], v[84:87]
v_mfma_f32_16x16x32_bf16 v[84:87], v[236:239], a[12:15], v[84:87]
v_mfma_f32_16x16x32_bf16 v[88:91], v[36:39], a[16:19], 0
v_mfma_f32_16x16x32_bf16 v[88:91], v[40:43], a[20:23], v[88:91]
ds_write_b128 v227, v[80:83] offset:0
v_mfma_f32_16x16x32_bf16 v[88:91], v[44:47], a[24:27], v[88:91]
v_mfma_f32_16x16x32_bf16 v[88:91], v[48:51], a[28:31], v[88:91]
v_mfma_f32_16x16x32_bf16 v[92:95], v[52:55], a[16:19], 0
v_mfma_f32_16x16x32_bf16 v[92:95], v[56:59], a[20:23], v[92:95]
ds_write_b128 v227, v[84:87] offset:1024
v_mfma_f32_16x16x32_bf16 v[92:95], v[60:63], a[24:27], v[92:95]
v_mfma_f32_16x16x32_bf16 v[92:95], v[236:239], a[28:31], v[92:95]
v_mfma_f32_16x16x32_bf16 v[96:99], v[36:39], a[32:35], 0
v_mfma_f32_16x16x32_bf16 v[96:99], v[40:43], a[36:39], v[96:99]
ds_write_b128 v227, v[88:91] offset:2048
v_mfma_f32_16x16x32_bf16 v[96:99], v[44:47], a[40:43], v[96:99]
v_mfma_f32_16x16x32_bf16 v[96:99], v[48:51], a[44:47], v[96:99]
v_mfma_f32_16x16x32_bf16 v[100:103], v[52:55], a[32:35], 0
v_mfma_f32_16x16x32_bf16 v[100:103], v[56:59], a[36:39], v[100:103]
ds_write_b128 v227, v[92:95] offset:3072
v_mfma_f32_16x16x32_bf16 v[100:103], v[60:63], a[40:43], v[100:103]
v_mfma_f32_16x16x32_bf16 v[100:103], v[236:239], a[44:47], v[100:103]
v_mfma_f32_16x16x32_bf16 v[104:107], v[36:39], a[48:51], 0
v_mfma_f32_16x16x32_bf16 v[104:107], v[40:43], a[52:55], v[104:107]
ds_write_b128 v227, v[96:99] offset:4096
v_mfma_f32_16x16x32_bf16 v[104:107], v[44:47], a[56:59], v[104:107]
v_mfma_f32_16x16x32_bf16 v[104:107], v[48:51], a[60:63], v[104:107]
v_mfma_f32_16x16x32_bf16 v[108:111], v[52:55], a[48:51], 0
v_mfma_f32_16x16x32_bf16 v[108:111], v[56:59], a[52:55], v[108:111]
ds_write_b128 v227, v[100:103] offset:5120
v_mfma_f32_16x16x32_bf16 v[108:111], v[60:63], a[56:59], v[108:111]
v_mfma_f32_16x16x32_bf16 v[108:111], v[236:239], a[60:63], v[108:111]
ds_write_b128 v227, v[104:107] offset:6144
s_nop 6
ds_write_b128 v227, v[108:111] offset:7168
s_waitcnt lgkmcnt(0)
s_barrier
ds_read_b128 v[112:115], v228 offset:0
ds_read_b128 v[116:119], v228 offset:32768
ds_read_b128 v[120:123], v229 offset:0
ds_read_b128 v[124:127], v229 offset:32768
ds_read_b128 v[128:131], v228 offset:1024
ds_read_b128 v[132:135], v228 offset:33792
ds_read_b128 v[136:139], v229 offset:1024
ds_read_b128 v[140:143], v229 offset:33792
s_waitcnt lgkmcnt(6)
v_pk_add_f32 v[112:113], v[112:113], v[116:117]
v_pk_add_f32 v[114:115], v[114:115], v[118:119]
s_waitcnt lgkmcnt(4)
v_pk_add_f32 v[120:121], v[120:121], v[124:125]
v_pk_add_f32 v[122:123], v[122:123], v[126:127]
v_pk_add_f32 v[112:113], v[112:113], v[120:121]
v_pk_add_f32 v[114:115], v[114:115], v[122:123]
v_cvt_pk_bf16_f32 v180, v112, v113
v_cvt_pk_bf16_f32 v181, v114, v115
s_waitcnt lgkmcnt(2)
v_pk_add_f32 v[128:129], v[128:129], v[132:133]
v_pk_add_f32 v[130:131], v[130:131], v[134:135]
s_waitcnt lgkmcnt(0)
v_pk_add_f32 v[136:137], v[136:137], v[140:141]
v_pk_add_f32 v[138:139], v[138:139], v[142:143]
v_pk_add_f32 v[128:129], v[128:129], v[136:137]
v_pk_add_f32 v[130:131], v[130:131], v[138:139]
v_cvt_pk_bf16_f32 v182, v128, v129
v_cvt_pk_bf16_f32 v183, v130, v131
ds_write_b128 v233, v[180:183] offset:4096
s_waitcnt lgkmcnt(0)
s_barrier
v_add_u32 v231, 0x10000, v230
ds_read_b128 v[188:191], v231 offset:4096
ds_read_b128 v[192:195], v231 offset:5120
ds_read_b128 v[196:199], v231 offset:6144
ds_read_b128 v[200:203], v231 offset:7168
buffer_load_dwordx4 v[144:147], v225, s[44:47], s71 offen offset:0 sc1
L_x_q_111:
s_waitcnt vmcnt(0)
v_cmp_eq_u32 vcc, -1, v144
s_cbranch_vccz L_x_r_112
s_mov_b64 exec, vcc
buffer_load_dwordx4 v[144:147], v225, s[44:47], s71 offen offset:0 sc1
s_mov_b64 exec, -1
s_add_u32 s54, s54, 1
s_cmp_gt_u32 s54, 400000
s_cbranch_scc1 L_end
s_branch L_x_q_111
L_x_r_112:
v_add_f32_dpp v144, v144, v144 row_ror:4 row_mask:0xf bank_mask:0xf
v_add_f32_dpp v145, v145, v145 row_ror:4 row_mask:0xf bank_mask:0xf
v_add_f32_dpp v146, v146, v146 row_ror:4 row_mask:0xf bank_mask:0xf
v_add_f32_dpp v147, v147, v147 row_ror:4 row_mask:0xf bank_mask:0xf
v_add_f32_dpp v144, v144, v144 row_ror:8 row_mask:0xf bank_mask:0xf
v_add_f32_dpp v145, v145, v145 row_ror:8 row_mask:0xf bank_mask:0xf
v_add_f32_dpp v146, v146, v146 row_ror:8 row_mask:0xf bank_mask:0xf
v_add_f32_dpp v147, v147, v147 row_ror:8 row_mask:0xf bank_mask:0xf
v_cvt_pk_bf16_f32 v144, v144, v145
v_cvt_pk_bf16_f32 v145, v146, v147
v_min_u32 v144, -2, v144
buffer_store_dwordx2 v[144:145], v226, s[44:47], s75 offen offset:0
s_add_u32 s56, s70, 24576
s_add_u32 s57, s70, 49152
s_add_u32 s58, s70, 73728
s_waitcnt vmcnt(0)
buffer_load_dwordx4 v[64:67], v219, s[44:47], s70 offen offset:0 sc1
buffer_load_dwordx4 v[68:71], v219, s[44:47], s56 offen offset:0 sc1
buffer_load_dwordx4 v[72:75], v219, s[44:47], s57 offen offset:0 sc1
buffer_load_dwordx4 v[76:79], v219, s[44:47], s58 offen offset:0 sc1
L_x_q_114:
s_waitcnt vmcnt(0)
v_max3_u32 v148, v64, v66, v68
v_max3_u32 v149, v70, v72, v74
v_max3_u32 v148, v148, v76, v78
v_max_u32 v148, v148, v149
v_cmp_eq_u32 vcc, -1, v148
s_cbranch_vccz L_x_r_115
s_mov_b64 exec, vcc
buffer_load_dwordx4 v[64:67], v219, s[44:47], s70 offen offset:0 sc1
buffer_load_dwordx4 v[68:71], v219, s[44:47], s56 offen offset:0 sc1
buffer_load_dwordx4 v[72:75], v219, s[44:47], s57 offen offset:0 sc1
buffer_load_dwordx4 v[76:79], v219, s[44:47], s58 offen offset:0 sc1
s_mov_b64 exec, -1
s_add_u32 s54, s54, 1
s_cmp_gt_u32 s54, 400000
s_cbranch_scc1 L_end
s_branch L_x_q_114
L_x_r_115:
v_mfma_f32_16x16x32_bf16 v[80:83], v[64:67], a[0:3], 0
v_mfma_f32_16x16x32_bf16 v[84:87], v[64:67], a[16:19], 0
v_mfma_f32_16x16x32_bf16 v[88:91], v[64:67], a[32:35], 0
v_mfma_f32_16x16x32_bf16 v[92:95], v[64:67], a[48:51], 0
v_mfma_f32_16x16x32_bf16 v[80:83], v[68:71], a[4:7], v[80:83]
v_mfma_f32_16x16x32_bf16 v[84:87], v[68:71], a[20:23], v[84:87]
v_mfma_f32_16x16x32_bf16 v[88:91], v[68:71], a[36:39], v[88:91]
v_mfma_f32_16x16x32_bf16 v[92:95], v[68:71], a[52:55], v[92:95]
v_mfma_f32_16x16x32_bf16 v[80:83], v[72:75], a[8:11], v[80:83]
v_mfma_f32_16x16x32_bf16 v[84:87], v[72:75], a[24:27], v[84:87]
v_mfma_f32_16x16x32_bf16 v[88:91], v[72:75], a[40:43], v[88:91]
v_mfma_f32_16x16x32_bf16 v[92:95], v[72:75], a[56:59], v[92:95]
v_mfma_f32_16x16x32_bf16 v[80:83], v[76:79], a[12:15], v[80:83]
v_mfma_f32_16x16x32_bf16 v[84:87], v[76:79], a[28:31], v[84:87]
v_mfma_f32_16x16x32_bf16 v[88:91], v[76:79], a[44:47], v[88:91]
v_mfma_f32_16x16x32_bf16 v[92:95], v[76:79], a[60:63], v[92:95]
ds_write_b64 v227, v[80:81] offset:8192
s_nop 2
ds_write_b64 v227, v[84:85] offset:8200
s_nop 1
ds_write_b64 v227, v[88:89] offset:9216
ds_write_b64 v227, v[92:93] offset:9224
s_waitcnt lgkmcnt(0)
s_barrier
ds_read_b128 v[80:83], v1 offset:8192
ds_read_b128 v[84:87], v1 offset:40960
ds_read_b128 v[88:91], v230 offset:8192
ds_read_b128 v[92:95], v230 offset:40960
ds_read_b128 v[96:99], v1 offset:9216
ds_read_b128 v[100:103], v1 offset:41984
ds_read_b128 v[104:107], v230 offset:9216
ds_read_b128 v[108:111], v230 offset:41984
s_waitcnt lgkmcnt(6)
v_pk_add_f32 v[80:81], v[80:81], v[84:85]
v_pk_add_f32 v[82:83], v[82:83], v[86:87]
s_waitcnt lgkmcnt(4)
v_pk_add_f32 v[88:89], v[88:89], v[92:93]
v_pk_add_f32 v[90:91], v[90:91], v[94:95]
v_pk_add_f32 v[80:81], v[80:81], v[88:89]
v_pk_add_f32 v[82:83], v[82:83], v[90:91]
v_cvt_pk_bf16_f32 v160, v80, v81
v_cvt_pk_bf16_f32 v161, v82, v83
s_waitcnt lgkmcnt(2)
v_pk_add_f32 v[96:97], v[96:97], v[100:101]
v_pk_add_f32 v[98:99], v[98:99], v[102:103]
s_waitcnt lgkmcnt(0)
v_pk_add_f32 v[104:105], v[104:105], v[108:109]
v_pk_add_f32 v[106:107], v[106:107], v[110:111]
v_pk_add_f32 v[96:97], v[96:97], v[104:105]
v_pk_add_f32 v[98:99], v[98:99], v[106:107]
v_cvt_pk_bf16_f32 v162, v96, v97
v_cvt_pk_bf16_f32 v163, v98, v99
s_waitcnt lgkmcnt(0)
buffer_load_dwordx4 v[92:95], v222, s[44:47], s66 offen offset:0 sc1
buffer_load_dwordx4 v[96:99], v222, s[44:47], s66 offen offset:512 sc1
buffer_load_dwordx2 v[100:101], v222, s[44:47], s66 offen offset:1024 sc1
L_x_q_117:
s_waitcnt vmcnt(0)
v_bitop3_b32 v116, v92, v96, v100 bitop3:0xfe
v_bitop3_b32 v116, v116, v92, 1 bitop3:0xa8
v_cmp_ne_u32 vcc, 0, v116
s_cbranch_vccz L_x_r_118
s_mov_b64 exec, vcc
buffer_load_dwordx4 v[92:95], v222, s[44:47], s66 offen offset:0 sc1
buffer_load_dwordx4 v[96:99], v222, s[44:47], s66 offen offset:512 sc1
buffer_load_dwordx2 v[100:101], v222, s[44:47], s66 offen offset:1024 sc1
s_mov_b64 exec, -1
s_add_u32 s54, s54, 1
s_cmp_gt_u32 s54, 400000
s_cbranch_scc1 L_end
s_branch L_x_q_117
L_x_r_118:
v_add_f32_dpp v92, v92, v92 quad_perm:[2,3,0,1] row_mask:0xf bank_mask:0xf
v_add_f32_dpp v93, v93, v93 quad_perm:[2,3,0,1] row_mask:0xf bank_mask:0xf
v_add_f32_dpp v94, v94, v94 quad_perm:[2,3,0,1] row_mask:0xf bank_mask:0xf
v_add_f32_dpp v95, v95, v95 quad_perm:[2,3,0,1] row_mask:0xf bank_mask:0xf
v_add_f32_dpp v96, v96, v96 quad_perm:[2,3,0,1] row_mask:0xf bank_mask:0xf
v_add_f32_dpp v97, v97, v97 quad_perm:[2,3,0,1] row_mask:0xf bank_mask:0xf
v_add_f32_dpp v98, v98, v98 quad_perm:[2,3,0,1] row_mask:0xf bank_mask:0xf
v_add_f32_dpp v99, v99, v99 quad_perm:[2,3,0,1] row_mask:0xf bank_mask:0xf
v_add_f32_dpp v100, v100, v100 quad_perm:[2,3,0,1] row_mask:0xf bank_mask:0xf
v_add_f32_dpp v101, v101, v101 quad_perm:[2,3,0,1] row_mask:0xf bank_mask:0xf
v_max3_f32 v114, v92, v93, v94
v_max3_f32 v114, v114, v95, v96
v_max3_f32 v114, v114, v97, v98
v_max3_f32 v114, v114, v99, v100
v_max_f32 v114, v114, v101
v_mov_b32 v115, v114
s_nop 1
v_permlane16_swap_b32 v114, v115
v_max_f32 v114, v114, v115
v_mov_b32 v115, v114
s_nop 1
v_permlane32_swap_b32 v114, v115
v_max_f32 v114, v114, v115
v_mul_f32 v114, 0xbe0293ee, v114
v_fmamk_f32 v92, v92, 0x3e0293ee, v114
v_fmamk_f32 v93, v93, 0x3e0293ee, v114
v_fmamk_f32 v94, v94, 0x3e0293ee, v114
v_fmamk_f32 v95, v95, 0x3e0293ee, v114
v_fmamk_f32 v96, v96, 0x3e0293ee, v114
v_fmamk_f32 v97, v97, 0x3e0293ee, v114
v_fmamk_f32 v98, v98, 0x3e0293ee, v114
v_fmamk_f32 v99, v99, 0x3e0293ee, v114
v_fmamk_f32 v100, v100, 0x3e0293ee, v114
v_fmamk_f32 v101, v101, 0x3e0293ee, v114
v_exp_f32 v92, v92
v_exp_f32 v93, v93
v_exp_f32 v94, v94
v_exp_f32 v95, v95
v_exp_f32 v96, v96
v_exp_f32 v97, v97
v_exp_f32 v98, v98
v_exp_f32 v99, v99
v_exp_f32 v100, v100
v_exp_f32 v101, v101
v_mov_b32 v121, 0
v_mov_b32 v122, 0
v_cvt_pk_bf16_f32 v116, v92, v93
v_cvt_pk_bf16_f32 v117, v94, v95
v_cvt_pk_bf16_f32 v118, v96, v97
v_cvt_pk_bf16_f32 v119, v98, v99
v_cvt_pk_bf16_f32 v120, v100, v101
v_cvt_pk_bf16_f32 v123, v100, v101
v_mfma_f32_16x16x32_bf16 v[124:127], v[208:211], v[116:119], 0
v_mfma_f32_16x16x32_bf16 v[128:131], v[188:191], v[116:119], 0
v_mfma_f32_16x16x32_bf16 v[132:135], v[192:195], v[116:119], 0
v_mfma_f32_16x16x32_bf16 v[136:139], v[196:199], v[116:119], 0
v_mfma_f32_16x16x32_bf16 v[140:143], v[200:203], v[116:119], 0
v_mfma_f32_16x16x16_bf16 v[124:127], v[208:209], v[120:121], v[124:127]
v_mfma_f32_16x16x16_bf16 v[128:131], v[160:161], v[120:121], v[128:131]
v_mfma_f32_16x16x16_bf16 v[132:135], v[160:161], v[122:123], v[132:135]
v_mfma_f32_16x16x16_bf16 v[136:139], v[162:163], v[120:121], v[136:139]
v_mfma_f32_16x16x16_bf16 v[140:143], v[162:163], v[122:123], v[140:143]
v_rcp_f32 v124, v124
s_nop 0
v_mul_f32 v128, v128, v124
v_mul_f32 v129, v129, v124
v_mul_f32 v130, v130, v124
v_mul_f32 v131, v131, v124
v_mul_f32 v132, v132, v124
v_mul_f32 v133, v133, v124
v_mul_f32 v134, v134, v124
v_mul_f32 v135, v135, v124
v_cvt_pk_bf16_f32 v144, v128, v129
v_cvt_pk_bf16_f32 v145, v130, v131
v_cvt_pk_bf16_f32 v146, v132, v133
v_cvt_pk_bf16_f32 v147, v134, v135
v_mul_f32 v136, v136, v124
v_mul_f32 v137, v137, v124
v_mul_f32 v138, v138, v124
v_mul_f32 v139, v139, v124
v_mul_f32 v140, v140, v124
v_mul_f32 v141, v141, v124
v_mul_f32 v142, v142, v124
v_mul_f32 v143, v143, v124
v_cvt_pk_bf16_f32 v148, v136, v137
v_cvt_pk_bf16_f32 v149, v138, v139
v_cvt_pk_bf16_f32 v150, v140, v141
v_cvt_pk_bf16_f32 v151, v142, v143
v_mfma_f32_16x16x32_bf16 v[80:83], a[64:67], v[144:147], 0
s_nop 0
v_mfma_f32_16x16x32_bf16 v[80:83], a[68:71], v[148:151], v[80:83]
v_mfma_f32_16x16x32_bf16 v[84:87], a[72:75], v[144:147], 0
v_mfma_f32_16x16x32_bf16 v[84:87], a[76:79], v[148:151], v[84:87]
v_mfma_f32_16x16x32_bf16 v[88:91], a[80:83], v[144:147], 0
v_mfma_f32_16x16x32_bf16 v[88:91], a[84:87], v[148:151], v[88:91]
v_mfma_f32_16x16x32_bf16 v[92:95], a[88:91], v[144:147], 0
v_mfma_f32_16x16x32_bf16 v[92:95], a[92:95], v[148:151], v[92:95]
v_mfma_f32_16x16x32_bf16 v[96:99], a[96:99], v[144:147], 0
v_mfma_f32_16x16x32_bf16 v[96:99], a[100:103], v[148:151], v[96:99]
v_mfma_f32_16x16x32_bf16 v[100:103], a[104:107], v[144:147], 0
v_mfma_f32_16x16x32_bf16 v[100:103], a[108:111], v[148:151], v[100:103]
v_mfma_f32_16x16x32_bf16 v[104:107], a[112:115], v[144:147], 0
v_mfma_f32_16x16x32_bf16 v[104:107], a[116:119], v[148:151], v[104:107]
v_mfma_f32_16x16x32_bf16 v[108:111], a[120:123], v[144:147], 0
v_mfma_f32_16x16x32_bf16 v[108:111], a[124:127], v[148:151], v[108:111]
v_cvt_pk_bf16_f32 v80, v80, v81
v_cvt_pk_bf16_f32 v81, v82, v83
v_cvt_pk_bf16_f32 v82, v84, v85
v_cvt_pk_bf16_f32 v83, v86, v87
v_cndmask_b32 v80, v80, v82, s[78:79]
v_cndmask_b32 v81, v81, v83, s[78:79]
v_and_b32 v80, -2, v80
buffer_store_dwordx2 v[80:81], v223, s[44:47], s68 offen
v_cvt_pk_bf16_f32 v88, v88, v89
v_cvt_pk_bf16_f32 v89, v90, v91
v_cvt_pk_bf16_f32 v90, v92, v93
v_cvt_pk_bf16_f32 v91, v94, v95
v_cndmask_b32 v88, v88, v90, s[78:79]
v_cndmask_b32 v89, v89, v91, s[78:79]
v_and_b32 v88, -2, v88
s_add_u32 s56, s68, 24576
buffer_store_dwordx2 v[88:89], v223, s[44:47], s56 offen
v_cvt_pk_bf16_f32 v96, v96, v97
v_cvt_pk_bf16_f32 v97, v98, v99
v_cvt_pk_bf16_f32 v98, v100, v101
v_cvt_pk_bf16_f32 v99, v102, v103
v_cndmask_b32 v96, v96, v98, s[78:79]
v_cndmask_b32 v97, v97, v99, s[78:79]
v_and_b32 v96, -2, v96
s_add_u32 s56, s68, 49152
buffer_store_dwordx2 v[96:97], v223, s[44:47], s56 offen
v_cvt_pk_bf16_f32 v104, v104, v105
v_cvt_pk_bf16_f32 v105, v106, v107
v_cvt_pk_bf16_f32 v106, v108, v109
v_cvt_pk_bf16_f32 v107, v110, v111
v_cndmask_b32 v104, v104, v106, s[78:79]
v_cndmask_b32 v105, v105, v107, s[78:79]
v_and_b32 v104, -2, v104
s_add_u32 s56, s68, 73728
buffer_store_dwordx2 v[104:105], v223, s[44:47], s56 offen
s_waitcnt vmcnt(0)
buffer_load_dwordx4 v[112:115], v1, s[44:47], s74 offen sc1
L_x_q_120:
s_waitcnt vmcnt(0)
v_bitop3_b32 v124, v112, v114, 1 bitop3:0xa8
v_cmp_ne_u32 vcc, 0, v124
s_cbranch_vccz L_x_r_121
s_mov_b64 exec, vcc
buffer_load_dwordx4 v[112:115], v1, s[44:47], s74 offen sc1
s_mov_b64 exec, -1
s_add_u32 s54, s54, 1
s_cmp_gt_u32 s54, 400000
s_cbranch_scc1 L_end
s_branch L_x_q_120
L_x_r_121:
v_mfma_f32_16x16x32_bf16 v[120:123], v[204:207], v[112:115], 0
s_nop 7
v_add_f32_dpp v120, v120, v120 row_ror:4 row_mask:0xf bank_mask:0xf
v_add_f32_dpp v121, v121, v121 row_ror:4 row_mask:0xf bank_mask:0xf
v_add_f32_dpp v122, v122, v122 row_ror:4 row_mask:0xf bank_mask:0xf
v_add_f32_dpp v123, v123, v123 row_ror:4 row_mask:0xf bank_mask:0xf
v_add_f32_dpp v120, v120, v120 row_ror:8 row_mask:0xf bank_mask:0xf
v_add_f32_dpp v121, v121, v121 row_ror:8 row_mask:0xf bank_mask:0xf
v_add_f32_dpp v122, v122, v122 row_ror:8 row_mask:0xf bank_mask:0xf
v_add_f32_dpp v123, v123, v123 row_ror:8 row_mask:0xf bank_mask:0xf
v_min_u32 v120, -2, v120
v_min_u32 v121, -2, v121
v_min_u32 v122, -2, v122
v_min_u32 v123, -2, v123
buffer_store_dwordx4 v[120:123], v224, s[44:47], s72 offen offset:512 sc1
L_x_fin1:
s_lshr_b32 s59, s76, 2
s_mul_i32 s73, s59, 24576
s_add_u32 s73, s73, 0x204000
s_and_b32 s58, s50, 1
s_and_b32 s56, s48, 1
s_lshr_b32 s57, s48, 1
s_lshl_b32 s62, s58, 1
s_add_u32 s62, s62, s56
s_lshl_b32 s55, s58, 2
s_add_u32 s55, s55, s48
s_lshl_b32 s55, s55, 10
s_add_u32 s73, s73, s55
s_sub_u32 s61, s73, 8192
s_waitcnt vmcnt(0)
buffer_store_dwordx4 v[176:179], v1, s[44:47], s73 offen sc1
s_add_u32 s73, s73, 786432
buffer_store_dwordx4 v[180:183], v1, s[44:47], s73 offen sc1
s_add_u32 s73, s73, 786432
s_lshl_b32 s57, s57, 5
s_add_u32 s57, s57, s59
s_lshl_b32 s57, s57, 2
s_add_u32 s62, s62, s57
s_lshl_b32 s62, s62, 10
s_add_u32 s62, s62, 0x3b00000
v_mov_b32 v84, v152
v_mov_b32 v85, v153
s_cmp_eq_u32 s48, 1
s_cselect_b64 vcc, -1, 0
v_cndmask_b32 v84, v84, v154, vcc
v_cndmask_b32 v85, v85, v155, vcc
s_cmp_eq_u32 s48, 2
s_cselect_b64 vcc, -1, 0
v_cndmask_b32 v84, v84, v160, vcc
v_cndmask_b32 v85, v85, v161, vcc
s_cmp_eq_u32 s48, 3
s_cselect_b64 vcc, -1, 0
v_cndmask_b32 v84, v84, v162, vcc
v_cndmask_b32 v85, v85, v163, vcc
buffer_store_dword v84, v1, s[44:47], s62 offen offset:0 sc1
buffer_store_dword v85, v1, s[44:47], s62 offen offset:8 sc1
L_x_e_87:
s_lshr_b32 s59, s76, 2
s_and_b32 s58, s76, 3
s_waitcnt vmcnt(0)
s_barrier
s_cmp_lg_u32 s48, 0
s_cbranch_scc1 L_x_sk_122
s_lshl_b32 s59, s59, 7
s_add_u32 s55, s59, 0x5040000
s_lshl_b32 s56, s58, 2
s_add_u32 s56, s56, s55
v_mov_b32 v64, 1
v_and_b32 v65, 3, v0
v_lshlrev_b32 v65, 2, v65
s_mov_b64 exec, 1
buffer_store_dword v64, off, s[44:47], s56 offset:16 sc1
s_mov_b64 exec, -1
s_cmp_lg_u32 s58, 0
s_cbranch_scc1 L_x_sk_122
L_x_lp_123:
s_add_u32 s54, s54, 1
s_cmp_gt_u32 s54, 400000
s_cbranch_scc1 L_end
buffer_load_dword v66, v65, s[44:47], s55 offen offset:16 sc1
s_waitcnt vmcnt(0)
v_cmp_eq_u32 vcc, 0, v66
s_cbranch_vccnz L_x_lp_123
s_add_u32 s56, s59, 0x50c5000
s_mov_b64 exec, 1
buffer_store_dword v64, off, s[44:47], s55 sc1
s_add_u32 s55, s55, 4096
buffer_store_dword v64, off, s[44:47], s56 sc1
s_add_u32 s56, s56, 4096
buffer_store_dword v64, off, s[44:47], s55 sc1
s_add_u32 s55, s55, 4096
buffer_store_dword v64, off, s[44:47], s56 sc1
s_add_u32 s56, s56, 4096
s_mov_b64 exec, -1
L_x_sk_122:
s_sub_u32 s57, s49, 3
s_mul_i32 s57, s57, 6
s_lshr_b32 s57, 0xa2481c6, s57
s_and_b32 s57, s57, 63
s_lshl_b32 s57, s57, 5
s_add_u32 s57, s57, s50
s_lshl_b32 s57, s57, 7
s_add_u32 s57, s57, 0x5040000
L_b_gate_124:
s_add_u32 s54, s54, 1
s_cmp_gt_u32 s54, 400000
s_cbranch_scc1 L_end
buffer_load_dword v60, off, s[44:47], s57 sc1
s_waitcnt vmcnt(0)
v_cmp_eq_u32 vcc, 0, v60
s_cbranch_vccnz L_b_gate_124
L_b_load:
v_lshrrev_b32 v52, 4, v0
v_and_b32 v53, 15, v0
v_lshlrev_b32 v54, 1, v52
v_xor_b32 v53, v53, v54
v_lshlrev_b32 v53, 4, v53
v_lshl_add_u32 v48, v52, 10, v53
v_xor_b32 v49, 128, v48
v_lshrrev_b32 v53, 3, v0
v_mul_u32_u24 v53, 2752, v53
v_and_b32 v52, 1, v52
v_lshlrev_b32 v52, 1, v52
v_and_b32 v54, 7, v0
v_xor_b32 v54, v54, v52
v_lshl_add_u32 v50, v54, 4, v53
v_xor_b32 v54, 4, v54
v_lshl_add_u32 v51, v54, 4, v53
s_lshl_b32 s75, s48, 15
s_lshl_b32 s55, s48, 8
s_lshl_b32 s76, s50, 17
s_add_u32 s76, s76, s55
s_lshl_b32 s78, s50, 16
s_add_u32 s78, s78, s55
s_mul_i32 s77, s48, 176128
s_lshl_b32 s55, s50, 7
s_add_u32 s77, s77, s55
s_cmp_ge_u32 s50, 22
s_cselect_b32 s77, 0x40000000, s77
s_add_u32 m0, s75, 0
s_add_u32 s60, s76, 0
buffer_load_dwordx4 v48, s[24:27], s60 offen offset:0  lds
s_add_u32 s60, s76, 3072
buffer_load_dwordx4 v49, s[24:27], s60 offen offset:1024  lds
s_add_u32 s60, s76, 6144
buffer_load_dwordx4 v48, s[24:27], s60 offen offset:2048  lds
s_add_u32 s60, s76, 9216
buffer_load_dwordx4 v49, s[24:27], s60 offen offset:3072  lds
s_add_u32 m0, s75, 4096
s_add_u32 s60, s76, 16384
buffer_load_dwordx4 v48, s[24:27], s60 offen offset:0  lds
s_add_u32 s60, s76, 19456
buffer_load_dwordx4 v49, s[24:27], s60 offen offset:1024  lds
s_add_u32 s60, s76, 22528
buffer_load_dwordx4 v48, s[24:27], s60 offen offset:2048  lds
s_add_u32 s60, s76, 25600
buffer_load_dwordx4 v49, s[24:27], s60 offen offset:3072  lds
s_add_u32 m0, s75, 8192
s_add_u32 s60, s76, 32768
buffer_load_dwordx4 v48, s[24:27], s60 offen offset:0  lds
s_add_u32 s60, s76, 35840
buffer_load_dwordx4 v49, s[24:27], s60 offen offset:1024  lds
s_add_u32 s60, s76, 38912
buffer_load_dwordx4 v48, s[24:27], s60 offen offset:2048  lds
s_add_u32 s60, s76, 41984
buffer_load_dwordx4 v49, s[24:27], s60 offen offset:3072  lds
s_add_u32 m0, s75, 12288
s_add_u32 s60, s76, 49152
buffer_load_dwordx4 v48, s[24:27], s60 offen offset:0  lds
s_add_u32 s60, s76, 52224
buffer_load_dwordx4 v49, s[24:27], s60 offen offset:1024  lds
s_add_u32 s60, s76, 55296
buffer_load_dwordx4 v48, s[24:27], s60 offen offset:2048  lds
s_add_u32 s60, s76, 58368
buffer_load_dwordx4 v49, s[24:27], s60 offen offset:3072  lds
s_add_u32 m0, s75, 16384
s_add_u32 s60, s76, 65536
buffer_load_dwordx4 v48, s[24:27], s60 offen offset:0  lds
s_add_u32 s60, s76, 68608
buffer_load_dwordx4 v49, s[24:27], s60 offen offset:1024  lds
s_add_u32 s60, s76, 71680
buffer_load_dwordx4 v48, s[24:27], s60 offen offset:2048  lds
s_add_u32 s60, s76, 74752
buffer_load_dwordx4 v49, s[24:27], s60 offen offset:3072  lds
s_add_u32 m0, s75, 20480
s_add_u32 s60, s76, 81920
buffer_load_dwordx4 v48, s[24:27], s60 offen offset:0  lds
s_add_u32 s60, s76, 84992
buffer_load_dwordx4 v49, s[24:27], s60 offen offset:1024  lds
s_add_u32 s60, s76, 88064
buffer_load_dwordx4 v48, s[24:27], s60 offen offset:2048  lds
s_add_u32 s60, s76, 91136
buffer_load_dwordx4 v49, s[24:27], s60 offen offset:3072  lds
v_lshrrev_b32 v20, 4, v0
v_bfe_u32 v21, v0, 2, 2
v_and_b32 v22, 3, v0
v_lshrrev_b32 v23, 1, v22
v_and_b32 v24, 1, v22
v_and_b32 v25, 1, v20
v_lshlrev_b32 v26, 3, v25
v_lshl_add_u32 v26, v21, 1, v26
v_lshlrev_b32 v27, 2, v22
v_xor_b32 v26, v26, v27
v_lshl_add_u32 v27, v20, 2, v21
v_lshlrev_b32 v27, 8, v27
v_lshl_add_u32 v27, v26, 4, v27
v_add_u32 v8, s75, v27
v_lshrrev_b32 v26, 1, v21
v_lshl_add_u32 v26, v25, 1, v26
v_lshlrev_b32 v26, 1, v26
s_lshr_b32 s55, s48, 1
s_lshl_b32 s55, s55, 2
v_add_u32 v27, s55, v23
v_xor_b32 v26, v26, v27
v_lshl_add_u32 v27, v20, 3, v21
v_lshlrev_b32 v27, 7, v27
v_lshl_add_u32 v27, v26, 4, v27
v_lshl_add_u32 v4, v24, 3, v27
v_add_u32 v5, 0x10000, v4
v_xor_b32 v6, 32, v4
v_xor_b32 v7, 32, v5
s_waitcnt vmcnt(16) lgkmcnt(0)
s_barrier
s_add_u32 m0, s75, 24576
s_add_u32 s60, s76, 98304
buffer_load_dwordx4 v48, s[24:27], s60 offen offset:0  lds
s_add_u32 s60, s76, 101376
buffer_load_dwordx4 v49, s[24:27], s60 offen offset:1024  lds
s_add_u32 s60, s76, 104448
buffer_load_dwordx4 v48, s[24:27], s60 offen offset:2048  lds
s_add_u32 s60, s76, 107520
buffer_load_dwordx4 v49, s[24:27], s60 offen offset:3072  lds
s_add_u32 m0, s75, 28672
s_add_u32 s60, s76, 114688
buffer_load_dwordx4 v48, s[24:27], s60 offen offset:0  lds
s_add_u32 s60, s76, 117760
buffer_load_dwordx4 v49, s[24:27], s60 offen offset:1024  lds
s_add_u32 s60, s76, 120832
buffer_load_dwordx4 v48, s[24:27], s60 offen offset:2048  lds
s_add_u32 s60, s76, 123904
buffer_load_dwordx4 v49, s[24:27], s60 offen offset:3072  lds
ds_read_b64_tr_b16 a[0:1], v8 offset:0
ds_read_b64_tr_b16 a[2:3], v8 offset:4096
v_xor_b32 v9, 8, v8
ds_read_b64_tr_b16 a[16:17], v9 offset:0
ds_read_b64_tr_b16 a[18:19], v9 offset:4096
v_xor_b32 v9, 16, v8
ds_read_b64_tr_b16 a[32:33], v9 offset:0
ds_read_b64_tr_b16 a[34:35], v9 offset:4096
v_xor_b32 v9, 24, v8
ds_read_b64_tr_b16 a[48:49], v9 offset:0
ds_read_b64_tr_b16 a[50:51], v9 offset:4096
v_xor_b32 v9, 32, v8
ds_read_b64_tr_b16 a[64:65], v9 offset:0
ds_read_b64_tr_b16 a[66:67], v9 offset:4096
v_xor_b32 v9, 40, v8
ds_read_b64_tr_b16 a[80:81], v9 offset:0
ds_read_b64_tr_b16 a[82:83], v9 offset:4096
v_xor_b32 v9, 48, v8
ds_read_b64_tr_b16 a[96:97], v9 offset:0
ds_read_b64_tr_b16 a[98:99], v9 offset:4096
v_xor_b32 v9, 56, v8
ds_read_b64_tr_b16 a[112:113], v9 offset:0
ds_read_b64_tr_b16 a[114:115], v9 offset:4096
s_waitcnt vmcnt(16) lgkmcnt(0)
s_barrier
s_add_u32 m0, s75, 0
s_add_u32 s60, s77, 0
buffer_load_dwordx4 v50, s[28:31], s60 offen offset:0  lds
s_add_u32 s60, s77, 20992
buffer_load_dwordx4 v51, s[28:31], s60 offen offset:1024  lds
s_add_u32 s60, s77, 41984
buffer_load_dwordx4 v50, s[28:31], s60 offen offset:2048  lds
s_add_u32 s60, s77, 62976
buffer_load_dwordx4 v51, s[28:31], s60 offen offset:3072  lds
s_add_u32 m0, s75, 4096
s_add_u32 s60, s77, 88064
buffer_load_dwordx4 v50, s[28:31], s60 offen offset:0  lds
s_add_u32 s60, s77, 109056
buffer_load_dwordx4 v51, s[28:31], s60 offen offset:1024  lds
s_add_u32 s60, s77, 130048
buffer_load_dwordx4 v50, s[28:31], s60 offen offset:2048  lds
s_add_u32 s60, s77, 151040
buffer_load_dwordx4 v51, s[28:31], s60 offen offset:3072  lds
ds_read_b64_tr_b16 a[4:5], v8 offset:8192
ds_read_b64_tr_b16 a[6:7], v8 offset:12288
v_xor_b32 v9, 8, v8
ds_read_b64_tr_b16 a[20:21], v9 offset:8192
ds_read_b64_tr_b16 a[22:23], v9 offset:12288
v_xor_b32 v9, 16, v8
ds_read_b64_tr_b16 a[36:37], v9 offset:8192
ds_read_b64_tr_b16 a[38:39], v9 offset:12288
v_xor_b32 v9, 24, v8
ds_read_b64_tr_b16 a[52:53], v9 offset:8192
ds_read_b64_tr_b16 a[54:55], v9 offset:12288
v_xor_b32 v9, 32, v8
ds_read_b64_tr_b16 a[68:69], v9 offset:8192
ds_read_b64_tr_b16 a[70:71], v9 offset:12288
v_xor_b32 v9, 40, v8
ds_read_b64_tr_b16 a[84:85], v9 offset:8192
ds_read_b64_tr_b16 a[86:87], v9 offset:12288
v_xor_b32 v9, 48, v8
ds_read_b64_tr_b16 a[100:101], v9 offset:8192
ds_read_b64_tr_b16 a[102:103], v9 offset:12288
v_xor_b32 v9, 56, v8
ds_read_b64_tr_b16 a[116:117], v9 offset:8192
ds_read_b64_tr_b16 a[118:119], v9 offset:12288
s_waitcnt vmcnt(16) lgkmcnt(0)
s_barrier
s_add_u32 m0, s75, 8192
s_add_u32 s60, s77, 704512
buffer_load_dwordx4 v50, s[28:31], s60 offen offset:0  lds
s_add_u32 s60, s77, 725504
buffer_load_dwordx4 v51, s[28:31], s60 offen offset:1024  lds
s_add_u32 s60, s77, 746496
buffer_load_dwordx4 v50, s[28:31], s60 offen offset:2048  lds
s_add_u32 s60, s77, 767488
buffer_load_dwordx4 v51, s[28:31], s60 offen offset:3072  lds
s_add_u32 m0, s75, 12288
s_add_u32 s60, s77, 792576
buffer_load_dwordx4 v50, s[28:31], s60 offen offset:0  lds
s_add_u32 s60, s77, 813568
buffer_load_dwordx4 v51, s[28:31], s60 offen offset:1024  lds
s_add_u32 s60, s77, 834560
buffer_load_dwordx4 v50, s[28:31], s60 offen offset:2048  lds
s_add_u32 s60, s77, 855552
buffer_load_dwordx4 v51, s[28:31], s60 offen offset:3072  lds
ds_read_b64_tr_b16 a[8:9], v8 offset:16384
ds_read_b64_tr_b16 a[10:11], v8 offset:20480
v_xor_b32 v9, 8, v8
ds_read_b64_tr_b16 a[24:25], v9 offset:16384
ds_read_b64_tr_b16 a[26:27], v9 offset:20480
v_xor_b32 v9, 16, v8
ds_read_b64_tr_b16 a[40:41], v9 offset:16384
ds_read_b64_tr_b16 a[42:43], v9 offset:20480
v_xor_b32 v9, 24, v8
ds_read_b64_tr_b16 a[56:57], v9 offset:16384
ds_read_b64_tr_b16 a[58:59], v9 offset:20480
v_xor_b32 v9, 32, v8
ds_read_b64_tr_b16 a[72:73], v9 offset:16384
ds_read_b64_tr_b16 a[74:75], v9 offset:20480
v_xor_b32 v9, 40, v8
ds_read_b64_tr_b16 a[88:89], v9 offset:16384
ds_read_b64_tr_b16 a[90:91], v9 offset:20480
v_xor_b32 v9, 48, v8
ds_read_b64_tr_b16 a[104:105], v9 offset:16384
ds_read_b64_tr_b16 a[106:107], v9 offset:20480
v_xor_b32 v9, 56, v8
ds_read_b64_tr_b16 a[120:121], v9 offset:16384
ds_read_b64_tr_b16 a[122:123], v9 offset:20480
s_waitcnt vmcnt(16) lgkmcnt(0)
s_barrier
s_add_u32 m0, s75, 16384
s_add_u32 s60, s78, 0
buffer_load_dwordx4 v48, s[32:35], s60 offen offset:0  lds
s_add_u32 s60, s78, 3072
buffer_load_dwordx4 v49, s[32:35], s60 offen offset:1024  lds
s_add_u32 s60, s78, 6144
buffer_load_dwordx4 v48, s[32:35], s60 offen offset:2048  lds
s_add_u32 s60, s78, 9216
buffer_load_dwordx4 v49, s[32:35], s60 offen offset:3072  lds
s_add_u32 m0, s75, 20480
s_add_u32 s60, s78, 16384
buffer_load_dwordx4 v48, s[32:35], s60 offen offset:0  lds
s_add_u32 s60, s78, 19456
buffer_load_dwordx4 v49, s[32:35], s60 offen offset:1024  lds
s_add_u32 s60, s78, 22528
buffer_load_dwordx4 v48, s[32:35], s60 offen offset:2048  lds
s_add_u32 s60, s78, 25600
buffer_load_dwordx4 v49, s[32:35], s60 offen offset:3072  lds
ds_read_b64_tr_b16 a[12:13], v8 offset:24576
ds_read_b64_tr_b16 a[14:15], v8 offset:28672
v_xor_b32 v9, 8, v8
ds_read_b64_tr_b16 a[28:29], v9 offset:24576
ds_read_b64_tr_b16 a[30:31], v9 offset:28672
v_xor_b32 v9, 16, v8
ds_read_b64_tr_b16 a[44:45], v9 offset:24576
ds_read_b64_tr_b16 a[46:47], v9 offset:28672
v_xor_b32 v9, 24, v8
ds_read_b64_tr_b16 a[60:61], v9 offset:24576
ds_read_b64_tr_b16 a[62:63], v9 offset:28672
v_xor_b32 v9, 32, v8
ds_read_b64_tr_b16 a[76:77], v9 offset:24576
ds_read_b64_tr_b16 a[78:79], v9 offset:28672
v_xor_b32 v9, 40, v8
ds_read_b64_tr_b16 a[92:93], v9 offset:24576
ds_read_b64_tr_b16 a[94:95], v9 offset:28672
v_xor_b32 v9, 48, v8
ds_read_b64_tr_b16 a[108:109], v9 offset:24576
ds_read_b64_tr_b16 a[110:111], v9 offset:28672
v_xor_b32 v9, 56, v8
ds_read_b64_tr_b16 a[124:125], v9 offset:24576
ds_read_b64_tr_b16 a[126:127], v9 offset:28672
s_waitcnt vmcnt(16) lgkmcnt(0)
s_barrier
s_add_u32 m0, s75, 24576
s_add_u32 s60, s78, 32768
buffer_load_dwordx4 v48, s[32:35], s60 offen offset:0  lds
s_add_u32 s60, s78, 35840
buffer_load_dwordx4 v49, s[32:35], s60 offen offset:1024  lds
s_add_u32 s60, s78, 38912
buffer_load_dwordx4 v48, s[32:35], s60 offen offset:2048  lds
s_add_u32 s60, s78, 41984
buffer_load_dwordx4 v49, s[32:35], s60 offen offset:3072  lds
s_add_u32 m0, s75, 28672
s_add_u32 s60, s78, 49152
buffer_load_dwordx4 v48, s[32:35], s60 offen offset:0  lds
s_add_u32 s60, s78, 52224
buffer_load_dwordx4 v49, s[32:35], s60 offen offset:1024  lds
s_add_u32 s60, s78, 55296
buffer_load_dwordx4 v48, s[32:35], s60 offen offset:2048  lds
s_add_u32 s60, s78, 58368
buffer_load_dwordx4 v49, s[32:35], s60 offen offset:3072  lds
ds_read_b64_tr_b16 a[128:129], v4 offset:0
ds_read_b64_tr_b16 a[130:131], v4 offset:512
ds_read_b64_tr_b16 a[192:193], v6 offset:0
ds_read_b64_tr_b16 a[194:195], v6 offset:512
ds_read_b64_tr_b16 a[132:133], v4 offset:4096
ds_read_b64_tr_b16 a[134:135], v4 offset:4608
ds_read_b64_tr_b16 a[196:197], v6 offset:4096
ds_read_b64_tr_b16 a[198:199], v6 offset:4608
ds_read_b64_tr_b16 a[136:137], v4 offset:32768
ds_read_b64_tr_b16 a[138:139], v4 offset:33280
ds_read_b64_tr_b16 a[200:201], v6 offset:32768
ds_read_b64_tr_b16 a[202:203], v6 offset:33280
ds_read_b64_tr_b16 a[140:141], v4 offset:36864
ds_read_b64_tr_b16 a[142:143], v4 offset:37376
ds_read_b64_tr_b16 a[204:205], v6 offset:36864
ds_read_b64_tr_b16 a[206:207], v6 offset:37376
ds_read_b64_tr_b16 a[144:145], v5 offset:0
ds_read_b64_tr_b16 a[146:147], v5 offset:512
ds_read_b64_tr_b16 a[208:209], v7 offset:0
ds_read_b64_tr_b16 a[210:211], v7 offset:512
ds_read_b64_tr_b16 a[148:149], v5 offset:4096
ds_read_b64_tr_b16 a[150:151], v5 offset:4608
ds_read_b64_tr_b16 a[212:213], v7 offset:4096
ds_read_b64_tr_b16 a[214:215], v7 offset:4608
ds_read_b64_tr_b16 a[152:153], v5 offset:32768
ds_read_b64_tr_b16 a[154:155], v5 offset:33280
ds_read_b64_tr_b16 a[216:217], v7 offset:32768
ds_read_b64_tr_b16 a[218:219], v7 offset:33280
ds_read_b64_tr_b16 a[156:157], v5 offset:36864
ds_read_b64_tr_b16 a[158:159], v5 offset:37376
ds_read_b64_tr_b16 a[220:221], v7 offset:36864
ds_read_b64_tr_b16 a[222:223], v7 offset:37376
s_waitcnt vmcnt(16) lgkmcnt(0)
s_barrier
ds_read_b64_tr_b16 a[160:161], v4 offset:8192
ds_read_b64_tr_b16 a[162:163], v4 offset:8704
ds_read_b64_tr_b16 a[224:225], v6 offset:8192
ds_read_b64_tr_b16 a[226:227], v6 offset:8704
ds_read_b64_tr_b16 a[164:165], v4 offset:12288
ds_read_b64_tr_b16 a[166:167], v4 offset:12800
ds_read_b64_tr_b16 a[228:229], v6 offset:12288
ds_read_b64_tr_b16 a[230:231], v6 offset:12800
ds_read_b64_tr_b16 a[168:169], v4 offset:40960
ds_read_b64_tr_b16 a[170:171], v4 offset:41472
ds_read_b64_tr_b16 a[232:233], v6 offset:40960
ds_read_b64_tr_b16 a[234:235], v6 offset:41472
ds_read_b64_tr_b16 a[172:173], v4 offset:45056
ds_read_b64_tr_b16 a[174:175], v4 offset:45568
ds_read_b64_tr_b16 a[236:237], v6 offset:45056
ds_read_b64_tr_b16 a[238:239], v6 offset:45568
ds_read_b64_tr_b16 a[176:177], v5 offset:8192
ds_read_b64_tr_b16 a[178:179], v5 offset:8704
ds_read_b64_tr_b16 a[240:241], v7 offset:8192
ds_read_b64_tr_b16 a[242:243], v7 offset:8704
ds_read_b64_tr_b16 a[180:181], v5 offset:12288
ds_read_b64_tr_b16 a[182:183], v5 offset:12800
ds_read_b64_tr_b16 a[244:245], v7 offset:12288
ds_read_b64_tr_b16 a[246:247], v7 offset:12800
ds_read_b64_tr_b16 a[184:185], v5 offset:40960
ds_read_b64_tr_b16 a[186:187], v5 offset:41472
ds_read_b64_tr_b16 a[248:249], v7 offset:40960
ds_read_b64_tr_b16 a[250:251], v7 offset:41472
ds_read_b64_tr_b16 a[188:189], v5 offset:45056
ds_read_b64_tr_b16 a[190:191], v5 offset:45568
ds_read_b64_tr_b16 a[252:253], v7 offset:45056
ds_read_b64_tr_b16 a[254:255], v7 offset:45568
s_waitcnt vmcnt(8) lgkmcnt(0)
s_barrier
ds_read_b64_tr_b16 v[192:193], v8 offset:16384
ds_read_b64_tr_b16 v[194:195], v8 offset:20480
v_xor_b32 v9, 8, v8
ds_read_b64_tr_b16 v[200:201], v9 offset:16384
ds_read_b64_tr_b16 v[202:203], v9 offset:20480
v_xor_b32 v9, 16, v8
ds_read_b64_tr_b16 v[208:209], v9 offset:16384
ds_read_b64_tr_b16 v[210:211], v9 offset:20480
v_xor_b32 v9, 24, v8
ds_read_b64_tr_b16 v[216:217], v9 offset:16384
ds_read_b64_tr_b16 v[218:219], v9 offset:20480
v_xor_b32 v9, 32, v8
ds_read_b64_tr_b16 v[224:225], v9 offset:16384
ds_read_b64_tr_b16 v[226:227], v9 offset:20480
v_xor_b32 v9, 40, v8
ds_read_b64_tr_b16 v[232:233], v9 offset:16384
ds_read_b64_tr_b16 v[234:235], v9 offset:20480
v_xor_b32 v9, 48, v8
ds_read_b64_tr_b16 v[240:241], v9 offset:16384
ds_read_b64_tr_b16 v[242:243], v9 offset:20480
v_xor_b32 v9, 56, v8
ds_read_b64_tr_b16 v[248:249], v9 offset:16384
ds_read_b64_tr_b16 v[250:251], v9 offset:20480
s_waitcnt vmcnt(0) lgkmcnt(0)
s_barrier
ds_read_b64_tr_b16 v[196:197], v8 offset:24576
ds_read_b64_tr_b16 v[198:199], v8 offset:28672
v_xor_b32 v9, 8, v8
ds_read_b64_tr_b16 v[204:205], v9 offset:24576
ds_read_b64_tr_b16 v[206:207], v9 offset:28672
v_xor_b32 v9, 16, v8
ds_read_b64_tr_b16 v[212:213], v9 offset:24576
ds_read_b64_tr_b16 v[214:215], v9 offset:28672
v_xor_b32 v9, 24, v8
ds_read_b64_tr_b16 v[220:221], v9 offset:24576
ds_read_b64_tr_b16 v[222:223], v9 offset:28672
v_xor_b32 v9, 32, v8
ds_read_b64_tr_b16 v[228:229], v9 offset:24576
ds_read_b64_tr_b16 v[230:231], v9 offset:28672
v_xor_b32 v9, 40, v8
ds_read_b64_tr_b16 v[236:237], v9 offset:24576
ds_read_b64_tr_b16 v[238:239], v9 offset:28672
v_xor_b32 v9, 48, v8
ds_read_b64_tr_b16 v[244:245], v9 offset:24576
ds_read_b64_tr_b16 v[246:247], v9 offset:28672
v_xor_b32 v9, 56, v8
ds_read_b64_tr_b16 v[252:253], v9 offset:24576
ds_read_b64_tr_b16 v[254:255], v9 offset:28672
s_waitcnt lgkmcnt(0)
v_and_b32 v40, 15, v0
v_lshrrev_b32 v41, 4, v0
v_and_b32 v42, 3, v0
s_and_b32 s57, s48, 1
s_lshr_b32 s58, s48, 1
s_lshl_b32 s55, s48, 7
v_and_b32 v43, 31, v0
v_lshl_add_u32 v3, v43, 2, s55
v_min_u32 v43, 21, v43
v_lshl_add_u32 v5, v43, 2, s55
v_bfe_u32 v43, v0, 3, 2
v_lshlrev_b32 v43, 7, v43
v_and_b32 v44, 7, v0
v_lshl_add_u32 v43, v44, 2, v43
s_lshl_b32 s55, s48, 5
v_add_u32 v4, s55, v43
v_add_u32 v43, s55, v40
v_lshlrev_b32 v43, 5, v43
v_lshl_add_u32 v43, v41, 3, v43
v_add_u32 v6, 40960, v43
v_lshrrev_b32 v43, 2, v0
v_lshlrev_b32 v43, 5, v43
v_lshl_add_u32 v43, v42, 3, v43
v_add_u32 v7, 40960, v43
s_lshl_b32 s55, s57, 12
s_lshl_b32 s56, s58, 11
s_add_u32 s55, s55, s56
s_add_u32 s55, s55, 32768
v_add_u32 v8, s55, v1
s_lshl_b32 s55, s57, 11
s_lshl_b32 s56, s58, 10
s_add_u32 s55, s55, s56
s_add_u32 s55, s55, 45056
v_add_u32 v19, s55, v1
v_lshlrev_b32 v43, 17, v41
v_lshl_add_u32 v9, v40, 4, v43
v_lshlrev_b32 v43, 10, v41
v_lshl_add_u32 v10, v40, 4, v43
v_mov_b32 v44, 0x40000000
v_cmp_gt_u32 vcc, 2, v41
s_nop 1
v_cndmask_b32 v11, v44, v10, vcc
v_and_b32 v43, 7, v0
v_lshlrev_b32 v43, 3, v43
v_lshl_add_u32 v43, v41, 6, v43
s_lshl_b32 s55, s48, 8
v_add_u32 v12, s55, v43
v_cmp_gt_u32 vcc, 8, v40
s_nop 1
v_cndmask_b32 v13, v44, v12, vcc
s_lshl_b32 s55, s57, 14
v_add_u32 v43, 0, v41
v_xor_b32 v43, v43, v40
v_lshlrev_b32 v43, 4, v43
v_lshl_add_u32 v43, v40, 10, v43
v_add_u32 v14, s55, v43
v_add_u32 v43, 4, v41
v_xor_b32 v43, v43, v40
v_lshlrev_b32 v43, 4, v43
v_lshl_add_u32 v43, v40, 10, v43
v_add_u32 v15, s55, v43
v_add_u32 v43, 8, v41
v_xor_b32 v43, v43, v40
v_lshlrev_b32 v43, 4, v43
v_lshl_add_u32 v43, v40, 10, v43
v_add_u32 v16, s55, v43
v_add_u32 v43, 12, v41
v_xor_b32 v43, v43, v40
v_lshlrev_b32 v43, 4, v43
v_lshl_add_u32 v43, v40, 10, v43
v_add_u32 v17, s55, v43
s_lshl_b32 s55, s57, 7
v_xor_b32 v18, s55, v1
s_lshl_b32 s55, s57, 4
v_add_u32 v43, s55, v40
v_lshlrev_b32 v45, 2, v41
v_sub_u32 v43, v43, v45
v_mov_b32 v44, 0xf149f2ca
v_cmp_le_i32 vcc, 0, v43
s_nop 1
v_cndmask_b32 v20, v44, 0, vcc
v_cmp_le_i32 vcc, 1, v43
s_nop 1
v_cndmask_b32 v21, v44, 0, vcc
v_cmp_le_i32 vcc, 2, v43
s_nop 1
v_cndmask_b32 v22, v44, 0, vcc
v_cmp_le_i32 vcc, 3, v43
s_nop 1
v_cndmask_b32 v23, v44, 0, vcc
v_cmp_le_i32 vcc, 16, v43
s_nop 1
v_cndmask_b32 v24, v44, 0, vcc
v_cmp_le_i32 vcc, 17, v43
s_nop 1
v_cndmask_b32 v25, v44, 0, vcc
v_cmp_le_i32 vcc, 18, v43
s_nop 1
v_cndmask_b32 v26, v44, 0, vcc
v_cmp_le_i32 vcc, 19, v43
s_nop 1
v_cndmask_b32 v27, v44, 0, vcc
v_bfe_u32 v43, v0, 1, 2
v_and_b32 v44, 1, v0
v_lshlrev_b32 v44, 4, v44
v_mov_b32 v45, 0x3f80
v_lshlrev_b32 v45, v44, v45
v_cmp_eq_u32 vcc, 0, v43
s_nop 1
v_cndmask_b32 v28, 0, v45, vcc
v_cmp_eq_u32 vcc, 1, v43
s_nop 1
v_cndmask_b32 v29, 0, v45, vcc
v_cmp_eq_u32 vcc, 2, v43
s_nop 1
v_cndmask_b32 v30, 0, v45, vcc
v_cmp_eq_u32 vcc, 3, v43
s_nop 1
v_cndmask_b32 v31, 0, v45, vcc
s_mov_b32 s74, 0x3e0293ee
s_mov_b32 s61, 0x42e
s_mov_b32 s76, 0x666
s_mov_b32 s77, 0x0
s_cmp_eq_u32 s49, 2
s_cselect_b32 s61, 0x52f, s61
s_cselect_b32 s76, 0x566, s76
s_cselect_b32 s77, 0x0, s77
s_cmp_eq_u32 s49, 3
s_cselect_b32 s61, 0x0, s61
s_cselect_b32 s76, 0x44444444, s76
s_cselect_b32 s77, 0x2666444, s77
s_cmp_eq_u32 s49, 4
s_cselect_b32 s61, 0x101, s61
s_cselect_b32 s76, 0x44444444, s76
s_cselect_b32 s77, 0x1666444, s77
s_cmp_eq_u32 s49, 5
s_cselect_b32 s61, 0x202, s61
s_cselect_b32 s76, 0x44444444, s76
s_cselect_b32 s77, 0x466644, s77
s_cmp_eq_u32 s49, 6
s_cselect_b32 s61, 0x303, s61
s_cselect_b32 s76, 0x44444444, s76
s_cselect_b32 s77, 0x366644, s77
s_lshr_b32 s59, s61, 8
s_and_b32 s61, s61, 63
s_lshl_b32 s55, s61, 5
s_add_u32 s55, s55, s50
s_mul_i32 s62, s55, 24576
s_add_u32 s62, s62, 0x200000
s_lshl_b32 s63, s55, 12
s_add_u32 s63, s63, 0x3300000
s_lshl_b32 s83, s55, 7
s_add_u32 s64, s83, 0x5040000
s_add_u32 s83, s83, 0x5085000
s_cmp_lt_u32 s61, 2
s_cselect_b32 s78, 262144, 0
s_add_u32 s83, s83, s78
s_lshl_b32 s56, s78, 5
s_add_u32 s63, s63, s56
s_lshl_b32 s69, s55, 10
s_lshl_b32 s79, s57, 12
s_lshl_b32 s80, s58, 12
s_add_u32 s80, s80, 16384
v_add_u32 v176, s79, v1
v_add_u32 v177, s80, v1
s_mul_i32 s79, s48, 6144
s_add_u32 s62, s62, s79
s_lshl_b32 s81, s58, 11
s_add_u32 s81, s81, 77824
s_lshl_b32 s82, s48, 13
s_lshl_b32 s70, s59, 15
s_add_u32 s70, s70, s82
s_lshl_b32 s55, s59, 20
s_lshl_b32 s56, s48, 8
s_add_u32 s55, s55, s56
s_lshl_b32 s56, s50, 10
s_add_u32 s56, s56, s55
s_add_u32 s65, s56, 0x4200000
s_add_u32 s66, s56, 0x4200000
s_lshl_b32 s56, s50, 15
s_add_u32 s56, s56, s55
s_add_u32 s67, s56, 0x4200000
s_add_u32 s68, s56, 0x4200000
s_mul_i32 s72, s59, 2048
s_add_u32 s72, s72, 0x5080000
s_lshl_b32 s55, s48, 7
s_lshl_b32 s56, s50, 2
s_add_u32 s55, s55, s56
s_add_u32 s71, s72, s55
s_mov_b32 s73, 2
buffer_load_dword v38, off, s[40:43], 0 offset:136 sc1
s_waitcnt vmcnt(0)
L_gw_125:
v_readfirstlane_b32 s55, v38
s_nop 0
s_cmp_lg_u32 s55, 0
s_cbranch_scc1 L_gk_126
s_add_u32 s54, s54, 1
s_cmp_gt_u32 s54, 400000
s_cbranch_scc1 L_end
buffer_load_dword v38, off, s[40:43], 0 offset:136 sc1
s_waitcnt vmcnt(0)
s_branch L_gw_125
L_gk_126:
s_lshr_b32 s53, s55, 16
v_mov_b32 v180, 0x10001
v_mov_b32 v40, 0
v_mov_b32 v41, 0
v_mov_b32 v42, 0
v_mov_b32 v43, 0
s_add_u32 s56, s67, 0
buffer_store_dwordx4 v[40:43], v10, s[44:47], s56 offen sc1
s_add_u32 s56, s67, 4096
buffer_store_dwordx4 v[40:43], v10, s[44:47], s56 offen sc1
s_add_u32 s56, s67, 8192
buffer_store_dwordx4 v[40:43], v10, s[44:47], s56 offen sc1
s_add_u32 s56, s67, 12288
buffer_store_dwordx4 v[40:43], v10, s[44:47], s56 offen sc1
s_add_u32 s56, s67, 16384
buffer_store_dwordx4 v[40:43], v10, s[44:47], s56 offen sc1
s_add_u32 s56, s67, 20480
buffer_store_dwordx4 v[40:43], v10, s[44:47], s56 offen sc1
s_add_u32 s56, s67, 24576
buffer_store_dwordx4 v[40:43], v10, s[44:47], s56 offen sc1
s_add_u32 s56, s67, 28672
buffer_store_dwordx4 v[40:43], v10, s[44:47], s56 offen sc1
v_mov_b32 v38, 1
s_waitcnt vmcnt(0)
s_mov_b64 exec, 1
buffer_store_dword v38, off, s[44:47], s71 offset:1536 sc1
s_mov_b64 exec, -1
s_barrier
L_bp_127:
s_add_u32 s54, s54, 1
s_cmp_gt_u32 s54, 400000
s_cbranch_scc1 L_end
buffer_load_dword v0, off, s[44:47], s64 offset:0 sc1
s_waitcnt vmcnt(0)
v_cmp_eq_u32 vcc, 0, v0
s_cbranch_vccnz L_bp_127
s_add_u32 m0, s79, 49152
s_add_u32 s60, s62, 0
buffer_load_dwordx4 v1, s[44:47], s60 offen offset:0 sc1 lds
s_add_u32 s60, s62, 0
buffer_load_dwordx4 v1, s[44:47], s60 offen offset:1024 sc1 lds
s_add_u32 s60, s62, 0
buffer_load_dwordx4 v1, s[44:47], s60 offen offset:2048 sc1 lds
s_add_u32 s60, s62, 0
buffer_load_dwordx4 v1, s[44:47], s60 offen offset:3072 sc1 lds
s_add_u32 m0, s79, 53248
s_add_u32 s60, s62, 4096
buffer_load_dwordx4 v1, s[44:47], s60 offen offset:0 sc1 lds
s_add_u32 s60, s62, 4096
buffer_load_dwordx4 v1, s[44:47], s60 offen offset:1024 sc1 lds
s_bfe_u32 s55, s76, 0x40000
s_mul_i32 s55, s55, 786432
s_add_u32 s62, s62, s55
s_bfe_u32 s55, s76, 0x40000
s_mul_i32 s55, s55, 4096
s_add_u32 s64, s64, s55
buffer_load_dword v179, off, s[44:47], s83 sc1
buffer_load_dword v178, off, s[44:47], s64 sc1
s_waitcnt vmcnt(0)
s_cmp_lg_u32 s53, 0
s_cbranch_scc1 L_b_loop_i
L_b_loop_p:
s_barrier
ds_read_b128 v[72:75], v176 offset:49152
ds_read_b128 v[40:43], v1 offset:57344
ds_read_b128 v[56:59], v1 offset:61440
ds_read_b128 v[76:79], v176 offset:50176
ds_read_b128 v[44:47], v1 offset:58368
ds_read_b128 v[60:63], v1 offset:62464
ds_read_b128 v[80:83], v176 offset:51200
ds_read_b128 v[48:51], v1 offset:59392
ds_read_b128 v[64:67], v1 offset:63488
ds_read_b128 v[84:87], v176 offset:52224
ds_read_b128 v[52:55], v1 offset:60416
ds_read_b128 v[68:71], v1 offset:64512
ds_read_b128 v[88:91], v177 offset:49152
ds_read_b128 v[92:95], v177 offset:50176
ds_read_b128 v[96:99], v177 offset:51200
ds_read_b128 v[100:103], v177 offset:52224
s_waitcnt vmcnt(2)
v_cmp_eq_u32 vcc, 0, v179
buffer_load_dwordx2 v[36:37], v12, s[4:7], s69 offen
s_mov_b32 s80, vcc_lo
s_cbranch_vccnz L_b_nk_128
s_lshl_b32 s55, s48, 10
s_add_u32 s55, s55, s63
buffer_load_dwordx4 v[104:107], v1, s[44:47], s55 offen sc1
L_b_nk_128:
s_waitcnt lgkmcnt(13)
v_mfma_f32_16x16x32_bf16 v[128:131], v[40:43], v[72:75], v[20:23]
v_mfma_f32_16x16x32_bf16 v[132:135], v[56:59], v[72:75], v[24:27]
s_waitcnt lgkmcnt(10)
v_mfma_f32_16x16x32_bf16 v[128:131], v[44:47], v[76:79], v[128:131]
v_mfma_f32_16x16x32_bf16 v[132:135], v[60:63], v[76:79], v[132:135]
s_waitcnt lgkmcnt(7)
v_mfma_f32_16x16x32_bf16 v[128:131], v[48:51], v[80:83], v[128:131]
v_mfma_f32_16x16x32_bf16 v[132:135], v[64:67], v[80:83], v[132:135]
s_waitcnt lgkmcnt(4)
v_mfma_f32_16x16x32_bf16 v[128:131], v[52:55], v[84:87], v[128:131]
v_mfma_f32_16x16x32_bf16 v[132:135], v[68:71], v[84:87], v[132:135]
s_cmp_eq_u32 s80, 0
s_cbranch_scc1 L_b_hk_129
s_cmp_ge_u32 s61, 62
s_cbranch_scc1 L_b_kp_130
L_bp_132:
s_add_u32 s54, s54, 1
s_cmp_gt_u32 s54, 400000
s_cbranch_scc1 L_end
buffer_load_dword v0, off, s[44:47], s83 offset:0 sc1
s_waitcnt vmcnt(0)
v_cmp_eq_u32 vcc, 0, v0
s_cbranch_vccnz L_bp_132
s_lshl_b32 s55, s48, 10
s_add_u32 s55, s55, s63
buffer_load_dwordx4 v[104:107], v1, s[44:47], s55 offen sc1
L_b_hk_129:
s_nop 4
v_max3_f32 v164, v128, v129, v130
v_max3_f32 v164, v164, v131, v132
v_max3_f32 v164, v164, v133, v134
v_max_f32 v164, v164, v135
v_mov_b32 v145, 0
s_lshl_b32 s55, s48, 10
s_add_u32 s55, s55, 77824
v_add_u32 v165, s55, v1
v_add_u32 v140, s81, v1
s_waitcnt vmcnt(0)
ds_write_b32 v6, v105
ds_write_b32 v6, v107 offset:512
ds_write_b128 v165, v[104:107]
s_waitcnt lgkmcnt(0)
s_barrier
ds_read_b64_tr_b16 v[112:113], v7 offset:0
ds_read_b64_tr_b16 v[114:115], v7 offset:512
ds_read_b64_tr_b16 v[116:117], v7 offset:1024
ds_read_b64_tr_b16 v[118:119], v7 offset:1536
ds_read_b64_tr_b16 v[120:121], v7 offset:2048
ds_read_b64_tr_b16 v[122:123], v7 offset:2560
ds_read_b64_tr_b16 v[124:125], v7 offset:3072
ds_read_b64_tr_b16 v[126:127], v7 offset:3584
ds_read_b128 v[168:171], v140 offset:0
ds_read_b128 v[172:175], v140 offset:1024
s_waitcnt lgkmcnt(8)
v_mfma_f32_16x16x32_bf16 v[136:139], v[112:115], v[72:75], 0
s_waitcnt lgkmcnt(6)
v_mfma_f32_16x16x32_bf16 v[136:139], v[116:119], v[76:79], v[136:139]
s_waitcnt lgkmcnt(4)
v_mfma_f32_16x16x32_bf16 v[136:139], v[120:123], v[80:83], v[136:139]
s_waitcnt lgkmcnt(2)
v_mfma_f32_16x16x32_bf16 v[136:139], v[124:127], v[84:87], v[136:139]
s_nop 7
v_max3_f32 v164, v164, v136, v137
v_mov_b32 v165, v164
s_nop 1
v_permlane16_swap_b32 v164, v165
v_max_f32 v164, v164, v165
v_mov_b32 v165, v164
s_nop 1
v_permlane32_swap_b32 v164, v165
v_max_f32 v164, v164, v165
v_mul_f32 v164, s74, v164
v_fma_f32 v128, v128, s74, -v164
v_fma_f32 v129, v129, s74, -v164
v_fma_f32 v130, v130, s74, -v164
v_fma_f32 v131, v131, s74, -v164
v_fma_f32 v132, v132, s74, -v164
v_fma_f32 v133, v133, s74, -v164
v_fma_f32 v134, v134, s74, -v164
v_fma_f32 v135, v135, s74, -v164
v_fma_f32 v136, v136, s74, -v164
v_fma_f32 v137, v137, s74, -v164
v_exp_f32 v128, v128
v_exp_f32 v129, v129
v_exp_f32 v130, v130
v_exp_f32 v131, v131
v_exp_f32 v132, v132
v_exp_f32 v133, v133
v_exp_f32 v134, v134
v_exp_f32 v135, v135
v_exp_f32 v136, v136
v_exp_f32 v137, v137
v_cvt_pk_bf16_f32 v140, v128, v129
v_cvt_pk_bf16_f32 v141, v130, v131
v_cvt_pk_bf16_f32 v142, v132, v133
v_cvt_pk_bf16_f32 v143, v134, v135
v_cvt_pk_bf16_f32 v144, v136, v137
s_waitcnt lgkmcnt(0)
buffer_load_dword v179, v3, s[44:47], s72 offen offset:1536 sc1
v_mfma_f32_16x16x32_bf16 v[148:151], v[88:91], v[140:143], 0
v_add_f32 v164, v128, v129
v_add_f32 v165, v130, v131
v_add_f32 v164, v164, v132
v_mfma_f32_16x16x32_bf16 v[152:155], v[92:95], v[140:143], 0
v_add_f32 v165, v165, v133
v_add_f32 v164, v164, v134
v_add_f32 v165, v165, v135
v_mfma_f32_16x16x32_bf16 v[156:159], v[96:99], v[140:143], 0
v_add_f32 v164, v164, v136
v_add_f32 v165, v165, v137
v_add_f32 v164, v164, v165
v_mfma_f32_16x16x32_bf16 v[160:163], v[100:103], v[140:143], 0
v_mfma_f32_16x16x16_bf16 v[148:151], v[168:169], v[144:145], v[148:151]
v_mov_b32 v165, v164
s_nop 1
v_permlane16_swap_b32 v164, v165
v_add_f32 v164, v164, v165
v_mfma_f32_16x16x16_bf16 v[152:155], v[170:171], v[144:145], v[152:155]
v_mov_b32 v165, v164
s_nop 1
v_permlane32_swap_b32 v164, v165
v_add_f32 v164, v164, v165
v_mfma_f32_16x16x16_bf16 v[156:159], v[172:173], v[144:145], v[156:159]
v_rcp_f32 v164, v164
v_mfma_f32_16x16x16_bf16 v[160:163], v[174:175], v[144:145], v[160:163]
v_mul_f32 v148, v148, v164
v_mul_f32 v149, v149, v164
v_mul_f32 v150, v150, v164
v_mul_f32 v151, v151, v164
v_mul_f32 v152, v152, v164
v_mul_f32 v153, v153, v164
v_mul_f32 v154, v154, v164
v_mul_f32 v155, v155, v164
v_cvt_pk_bf16_f32 v128, v148, v149
v_cvt_pk_bf16_f32 v129, v150, v151
v_cvt_pk_bf16_f32 v130, v152, v153
v_cvt_pk_bf16_f32 v131, v154, v155
ds_write_b128 v8, v[128:131] offset:0
v_mul_f32 v156, v156, v164
v_mul_f32 v157, v157, v164
v_mul_f32 v158, v158, v164
v_mul_f32 v159, v159, v164
v_mul_f32 v160, v160, v164
v_mul_f32 v161, v161, v164
v_mul_f32 v162, v162, v164
v_mul_f32 v163, v163, v164
v_cvt_pk_bf16_f32 v132, v156, v157
v_cvt_pk_bf16_f32 v133, v158, v159
v_cvt_pk_bf16_f32 v134, v160, v161
v_cvt_pk_bf16_f32 v135, v162, v163
ds_write_b128 v8, v[132:135] offset:1024
s_waitcnt lgkmcnt(0)
s_barrier
ds_read_b128 v[40:43], v1 offset:32768
ds_read_b128 v[48:51], v1 offset:33792
ds_read_b128 v[56:59], v1 offset:34816
ds_read_b128 v[64:67], v1 offset:35840
ds_read_b128 v[44:47], v1 offset:36864
ds_read_b128 v[52:55], v1 offset:37888
ds_read_b128 v[60:63], v1 offset:38912
ds_read_b128 v[68:71], v1 offset:39936
L_b_3b_134:
s_waitcnt vmcnt(0)
v_add_u32 v179, 1, v179
v_cmp_ne_u32 vcc, s73, v179
s_cbranch_vccnz L_b_3s_133
s_and_b32 s60, s73, 1
s_lshl_b32 s60, s60, 16
s_or_b32 s60, s60, 1
s_add_u32 s56, s65, 32768
s_add_u32 s57, s65, 65536
s_add_u32 s58, s65, 98304
s_waitcnt lgkmcnt(7)
v_mfma_f32_16x16x32_bf16 v[72:75], v[40:43], a[0:3], 0
v_mfma_f32_16x16x32_bf16 v[76:79], v[40:43], a[16:19], 0
v_mfma_f32_16x16x32_bf16 v[80:83], v[40:43], a[32:35], 0
v_mfma_f32_16x16x32_bf16 v[84:87], v[40:43], a[48:51], 0
v_mfma_f32_16x16x32_bf16 v[88:91], v[40:43], a[64:67], 0
v_mfma_f32_16x16x32_bf16 v[92:95], v[40:43], a[80:83], 0
v_mfma_f32_16x16x32_bf16 v[96:99], v[40:43], a[96:99], 0
v_mfma_f32_16x16x32_bf16 v[100:103], v[40:43], a[112:115], 0
s_waitcnt lgkmcnt(6)
v_mfma_f32_16x16x32_bf16 v[72:75], v[48:51], a[4:7], v[72:75]
v_mfma_f32_16x16x32_bf16 v[76:79], v[48:51], a[20:23], v[76:79]
v_mfma_f32_16x16x32_bf16 v[80:83], v[48:51], a[36:39], v[80:83]
v_mfma_f32_16x16x32_bf16 v[84:87], v[48:51], a[52:55], v[84:87]
v_mfma_f32_16x16x32_bf16 v[88:91], v[48:51], a[68:71], v[88:91]
v_mfma_f32_16x16x32_bf16 v[92:95], v[48:51], a[84:87], v[92:95]
v_mfma_f32_16x16x32_bf16 v[96:99], v[48:51], a[100:103], v[96:99]
v_mfma_f32_16x16x32_bf16 v[100:103], v[48:51], a[116:119], v[100:103]
s_waitcnt lgkmcnt(5)
v_mfma_f32_16x16x32_bf16 v[72:75], v[56:59], a[8:11], v[72:75]
v_mfma_f32_16x16x32_bf16 v[76:79], v[56:59], a[24:27], v[76:79]
v_mfma_f32_16x16x32_bf16 v[80:83], v[56:59], a[40:43], v[80:83]
v_mfma_f32_16x16x32_bf16 v[84:87], v[56:59], a[56:59], v[84:87]
v_mfma_f32_16x16x32_bf16 v[88:91], v[56:59], a[72:75], v[88:91]
v_mfma_f32_16x16x32_bf16 v[92:95], v[56:59], a[88:91], v[92:95]
v_mfma_f32_16x16x32_bf16 v[96:99], v[56:59], a[104:107], v[96:99]
v_mfma_f32_16x16x32_bf16 v[100:103], v[56:59], a[120:123], v[100:103]
s_waitcnt lgkmcnt(4)
v_mfma_f32_16x16x32_bf16 v[72:75], v[64:67], a[12:15], v[72:75]
v_mfma_f32_16x16x32_bf16 v[76:79], v[64:67], a[28:31], v[76:79]
v_mfma_f32_16x16x32_bf16 v[80:83], v[64:67], a[44:47], v[80:83]
v_mfma_f32_16x16x32_bf16 v[84:87], v[64:67], a[60:63], v[84:87]
v_mfma_f32_16x16x32_bf16 v[88:91], v[64:67], a[76:79], v[88:91]
v_mfma_f32_16x16x32_bf16 v[92:95], v[64:67], a[92:95], v[92:95]
v_mfma_f32_16x16x32_bf16 v[96:99], v[64:67], a[108:111], v[96:99]
v_mfma_f32_16x16x32_bf16 v[100:103], v[64:67], a[124:127], v[100:103]
s_waitcnt lgkmcnt(0)
v_mfma_f32_16x16x32_bf16 v[104:107], v[44:47], a[0:3], 0
v_mfma_f32_16x16x32_bf16 v[104:107], v[52:55], a[4:7], v[104:107]
v_cvt_pk_bf16_f32 v136, v72, v76
v_cvt_pk_bf16_f32 v137, v80, v84
v_mfma_f32_16x16x32_bf16 v[104:107], v[60:63], a[8:11], v[104:107]
v_cvt_pk_bf16_f32 v138, v88, v92
v_cvt_pk_bf16_f32 v139, v96, v100
v_mfma_f32_16x16x32_bf16 v[104:107], v[68:71], a[12:15], v[104:107]
v_bfi_b32 v136, v180, s60, v136
buffer_store_dwordx4 v[136:139], v9, s[44:47], s65 offen
v_cvt_pk_bf16_f32 v140, v73, v77
v_mfma_f32_16x16x32_bf16 v[108:111], v[44:47], a[16:19], 0
v_cvt_pk_bf16_f32 v141, v81, v85
v_cvt_pk_bf16_f32 v142, v89, v93
v_mfma_f32_16x16x32_bf16 v[108:111], v[52:55], a[20:23], v[108:111]
v_cvt_pk_bf16_f32 v143, v97, v101
v_bfi_b32 v140, v180, s60, v140
buffer_store_dwordx4 v[140:143], v9, s[44:47], s56 offen
v_mfma_f32_16x16x32_bf16 v[108:111], v[60:63], a[24:27], v[108:111]
v_cvt_pk_bf16_f32 v144, v74, v78
v_cvt_pk_bf16_f32 v145, v82, v86
v_mfma_f32_16x16x32_bf16 v[108:111], v[68:71], a[28:31], v[108:111]
v_cvt_pk_bf16_f32 v146, v90, v94
v_cvt_pk_bf16_f32 v147, v98, v102
v_mfma_f32_16x16x32_bf16 v[112:115], v[44:47], a[32:35], 0
v_bfi_b32 v144, v180, s60, v144
buffer_store_dwordx4 v[144:147], v9, s[44:47], s57 offen
v_cvt_pk_bf16_f32 v148, v75, v79
v_mfma_f32_16x16x32_bf16 v[112:115], v[52:55], a[36:39], v[112:115]
v_cvt_pk_bf16_f32 v149, v83, v87
v_cvt_pk_bf16_f32 v150, v91, v95
v_mfma_f32_16x16x32_bf16 v[112:115], v[60:63], a[40:43], v[112:115]
v_cvt_pk_bf16_f32 v151, v99, v103
v_bfi_b32 v148, v180, s60, v148
buffer_store_dwordx4 v[148:151], v9, s[44:47], s58 offen
s_add_u32 s59, s65, 524288
s_add_u32 s56, s65, 557056
s_add_u32 s57, s65, 589824
s_add_u32 s58, s65, 622592
v_mfma_f32_16x16x32_bf16 v[112:115], v[68:71], a[44:47], v[112:115]
v_cvt_pk_bf16_f32 v72, v104, v108
v_cvt_pk_bf16_f32 v76, v105, v109
v_mfma_f32_16x16x32_bf16 v[116:119], v[44:47], a[48:51], 0
v_cvt_pk_bf16_f32 v80, v106, v110
v_cvt_pk_bf16_f32 v84, v107, v111
v_mfma_f32_16x16x32_bf16 v[116:119], v[52:55], a[52:55], v[116:119]
v_bfi_b32 v72, v180, s60, v72
v_bfi_b32 v76, v180, s60, v76
v_mfma_f32_16x16x32_bf16 v[116:119], v[60:63], a[56:59], v[116:119]
v_bfi_b32 v80, v180, s60, v80
v_bfi_b32 v84, v180, s60, v84
v_mfma_f32_16x16x32_bf16 v[116:119], v[68:71], a[60:63], v[116:119]
v_mfma_f32_16x16x32_bf16 v[120:123], v[44:47], a[64:67], 0
v_mfma_f32_16x16x32_bf16 v[120:123], v[52:55], a[68:71], v[120:123]
v_cvt_pk_bf16_f32 v73, v112, v116
v_cvt_pk_bf16_f32 v77, v113, v117
v_mfma_f32_16x16x32_bf16 v[120:123], v[60:63], a[72:75], v[120:123]
v_cvt_pk_bf16_f32 v81, v114, v118
v_cvt_pk_bf16_f32 v85, v115, v119
v_mfma_f32_16x16x32_bf16 v[120:123], v[68:71], a[76:79], v[120:123]
v_mfma_f32_16x16x32_bf16 v[124:127], v[44:47], a[80:83], 0
v_mfma_f32_16x16x32_bf16 v[124:127], v[52:55], a[84:87], v[124:127]
v_mfma_f32_16x16x32_bf16 v[124:127], v[60:63], a[88:91], v[124:127]
v_mfma_f32_16x16x32_bf16 v[124:127], v[68:71], a[92:95], v[124:127]
v_mfma_f32_16x16x32_bf16 v[128:131], v[44:47], a[96:99], 0
v_mfma_f32_16x16x32_bf16 v[128:131], v[52:55], a[100:103], v[128:131]
v_cvt_pk_bf16_f32 v74, v120, v124
v_cvt_pk_bf16_f32 v78, v121, v125
v_mfma_f32_16x16x32_bf16 v[128:131], v[60:63], a[104:107], v[128:131]
v_cvt_pk_bf16_f32 v82, v122, v126
v_cvt_pk_bf16_f32 v86, v123, v127
v_mfma_f32_16x16x32_bf16 v[128:131], v[68:71], a[108:111], v[128:131]
v_mfma_f32_16x16x32_bf16 v[132:135], v[44:47], a[112:115], 0
v_mfma_f32_16x16x32_bf16 v[132:135], v[52:55], a[116:119], v[132:135]
v_mfma_f32_16x16x32_bf16 v[132:135], v[60:63], a[120:123], v[132:135]
v_mfma_f32_16x16x32_bf16 v[132:135], v[68:71], a[124:127], v[132:135]
s_nop 7
v_cvt_pk_bf16_f32 v75, v128, v132
buffer_store_dwordx4 v[72:75], v9, s[44:47], s59 offen
v_cvt_pk_bf16_f32 v79, v129, v133
buffer_store_dwordx4 v[76:79], v9, s[44:47], s56 offen
v_cvt_pk_bf16_f32 v83, v130, v134
buffer_store_dwordx4 v[80:83], v9, s[44:47], s57 offen
v_cvt_pk_bf16_f32 v87, v131, v135
buffer_store_dwordx4 v[84:87], v9, s[44:47], s58 offen
buffer_load_dwordx4 v[40:43], v10, s[44:47], s67 offen sc1
s_add_u32 s56, s67, 4096
buffer_load_dwordx4 v[44:47], v10, s[44:47], s56 offen sc1
s_add_u32 s56, s67, 8192
buffer_load_dwordx4 v[48:51], v10, s[44:47], s56 offen sc1
s_add_u32 s56, s67, 12288
buffer_load_dwordx4 v[52:55], v10, s[44:47], s56 offen sc1
s_add_u32 s56, s67, 16384
buffer_load_dwordx4 v[56:59], v10, s[44:47], s56 offen sc1
s_add_u32 s56, s67, 20480
buffer_load_dwordx4 v[60:63], v10, s[44:47], s56 offen sc1
s_add_u32 s56, s67, 24576
buffer_load_dwordx4 v[64:67], v10, s[44:47], s56 offen sc1
s_add_u32 s56, s67, 28672
buffer_load_dwordx4 v[68:71], v10, s[44:47], s56 offen sc1
L_b_ck_135:
s_waitcnt vmcnt(7)
v_mfma_f32_16x16x32_bf16 v[80:83], v[40:43], v[28:31], 0
v_xor_b32 v72, s60, v40
s_waitcnt vmcnt(6)
v_mfma_f32_16x16x32_bf16 v[84:87], v[44:47], v[28:31], 0
v_bitop3_b32 v72, v72, v44, s60 bitop3:0xf6
s_waitcnt vmcnt(5)
v_mfma_f32_16x16x32_bf16 v[80:83], v[48:51], v[28:31], v[80:83]
v_bitop3_b32 v72, v72, v48, s60 bitop3:0xf6
s_waitcnt vmcnt(4)
v_mfma_f32_16x16x32_bf16 v[84:87], v[52:55], v[28:31], v[84:87]
v_bitop3_b32 v72, v72, v52, s60 bitop3:0xf6
s_waitcnt vmcnt(3)
v_mfma_f32_16x16x32_bf16 v[80:83], v[56:59], v[28:31], v[80:83]
v_bitop3_b32 v72, v72, v56, s60 bitop3:0xf6
s_waitcnt vmcnt(2)
v_mfma_f32_16x16x32_bf16 v[84:87], v[60:63], v[28:31], v[84:87]
v_bitop3_b32 v72, v72, v60, s60 bitop3:0xf6
s_waitcnt vmcnt(1)
v_mfma_f32_16x16x32_bf16 v[80:83], v[64:67], v[28:31], v[80:83]
v_bitop3_b32 v72, v72, v64, s60 bitop3:0xf6
s_waitcnt vmcnt(0)
v_mfma_f32_16x16x32_bf16 v[84:87], v[68:71], v[28:31], v[84:87]
v_bitop3_b32 v72, v72, v68, s60 bitop3:0xf6
v_and_b32 v72, v180, v72
v_cmp_ne_u32 vcc, 0, v72
s_cbranch_vccnz L_b_rt_136
L_b_bk_137:
v_lshlrev_b32 v32, 16, v36
v_and_b32 v33, 0xffff0000, v36
v_lshlrev_b32 v34, 16, v37
v_and_b32 v35, 0xffff0000, v37
v_add_f32 v32, v32, v80
v_add_f32 v33, v33, v81
v_add_f32 v34, v34, v82
v_add_f32 v35, v35, v83
v_add_f32 v32, v32, v84
v_add_f32 v33, v33, v85
v_add_f32 v34, v34, v86
v_add_f32 v35, v35, v87
v_add_f32 v40, v32, v33
v_add_f32 v42, v34, v35
v_add_f32 v40, v40, v42
s_nop 1
v_add_f32_dpp v40, v40, v40 row_ror:4 row_mask:0xf bank_mask:0xf
s_nop 1
v_add_f32_dpp v40, v40, v40 row_ror:2 row_mask:0xf bank_mask:0xf
s_nop 1
v_add_f32_dpp v40, v40, v40 row_ror:1 row_mask:0xf bank_mask:0xf
v_mov_b32 v42, v40
s_nop 1
v_permlane16_swap_b32 v40, v42
v_add_f32 v40, v40, v42
v_mov_b32 v42, v40
s_nop 1
v_permlane32_swap_b32 v40, v42
v_add_f32 v40, v40, v42
v_mul_f32 v40, 0x3c000000, v40
v_sub_f32 v44, v32, v40
v_sub_f32 v45, v33, v40
v_sub_f32 v46, v34, v40
v_sub_f32 v47, v35, v40
v_mul_f32 v41, v44, v44
v_fmac_f32 v41, v45, v45
v_fmac_f32 v41, v46, v46
v_fmac_f32 v41, v47, v47
s_nop 1
v_add_f32_dpp v41, v41, v41 row_ror:4 row_mask:0xf bank_mask:0xf
s_nop 1
v_add_f32_dpp v41, v41, v41 row_ror:2 row_mask:0xf bank_mask:0xf
s_nop 1
v_add_f32_dpp v41, v41, v41 row_ror:1 row_mask:0xf bank_mask:0xf
v_mov_b32 v42, v41
s_nop 1
v_permlane16_swap_b32 v41, v42
v_add_f32 v41, v41, v42
v_mov_b32 v42, v41
s_nop 1
v_permlane32_swap_b32 v41, v42
v_add_f32 v41, v41, v42
s_lshl_b32 s55, s48, 3
s_add_u32 s55, s55, 73728
v_mov_b32 v43, s55
v_mov_b32 v56, 73728
s_mov_b64 exec, 1
ds_write_b64 v43, v[40:41]
s_mov_b64 exec, -1
s_waitcnt lgkmcnt(0)
s_barrier
ds_read_b128 v[48:51], v56
ds_read_b128 v[52:55], v56 offset:16
s_waitcnt lgkmcnt(0)
v_add_f32 v40, v48, v50
v_add_f32 v42, v52, v54
v_add_f32 v40, v40, v42
v_mul_f32 v40, 0x3e800000, v40
v_add_f32 v41, v49, v51
v_add_f32 v42, v53, v55
v_add_f32 v41, v41, v42
v_sub_f32 v48, v48, v40
v_sub_f32 v50, v50, v40
v_sub_f32 v52, v52, v40
v_sub_f32 v54, v54, v40
v_mul_f32 v42, v48, v48
v_fmac_f32 v42, v50, v50
v_fmac_f32 v42, v52, v52
v_fmac_f32 v42, v54, v54
v_fmac_f32 v41, 0x43000000, v42
v_mov_b32 v42, 0x3727c5ac
v_fmac_f32 v42, 0x3b000000, v41
v_rsq_f32 v42, v42
v_sub_f32 v44, v32, v40
v_sub_f32 v45, v33, v40
v_sub_f32 v46, v34, v40
v_sub_f32 v47, v35, v40
v_mul_f32 v44, v44, v42
v_mul_f32 v45, v45, v42
v_mul_f32 v46, v46, v42
v_mul_f32 v47, v47, v42
v_cvt_pk_bf16_f32 v44, v44, v45
v_cvt_pk_bf16_f32 v45, v46, v47
s_sub_u32 s55, s70, s82
s_lshl_b32 s56, s50, 10
s_add_u32 s55, s55, s56
s_add_u32 s55, s55, 0x5400000
buffer_store_dwordx2 v[44:45], v13, s[44:47], s55 offen
v_mov_b32 v38, s73
s_waitcnt vmcnt(0)
s_mov_b64 exec, 1
buffer_store_dword v38, off, s[44:47], s71 offset:512
s_mov_b64 exec, -1
s_cmp_ge_u32 s50, 22
s_cbranch_scc1 L_b_idle_139
L_bp_140:
s_add_u32 s54, s54, 1
s_cmp_gt_u32 s54, 400000
s_cbranch_scc1 L_end
buffer_load_dword v0, v4, s[44:47], s72 offen offset:512 sc1
s_waitcnt vmcnt(0)
v_cmp_ne_u32 vcc, s73, v0
s_cbranch_vccnz L_bp_140
v_xor_b32 v38, 0, v18
s_add_u32 m0, s82, 0
s_add_u32 s60, s70, 88080384
buffer_load_dwordx4 v38, s[44:47], s60 offen offset:0 sc1 lds
v_xor_b32 v38, 16, v18
s_add_u32 s60, s70, 88080384
buffer_load_dwordx4 v38, s[44:47], s60 offen offset:1024 sc1 lds
v_xor_b32 v38, 32, v18
s_add_u32 s60, s70, 88080384
buffer_load_dwordx4 v38, s[44:47], s60 offen offset:2048 sc1 lds
v_xor_b32 v38, 48, v18
s_add_u32 s60, s70, 88080384
buffer_load_dwordx4 v38, s[44:47], s60 offen offset:3072 sc1 lds
v_xor_b32 v38, 64, v18
s_add_u32 m0, s82, 4096
s_add_u32 s60, s70, 88084480
buffer_load_dwordx4 v38, s[44:47], s60 offen offset:0 sc1 lds
v_xor_b32 v38, 80, v18
s_add_u32 s60, s70, 88084480
buffer_load_dwordx4 v38, s[44:47], s60 offen offset:1024 sc1 lds
v_xor_b32 v38, 96, v18
s_add_u32 s60, s70, 88084480
buffer_load_dwordx4 v38, s[44:47], s60 offen offset:2048 sc1 lds
v_xor_b32 v38, 112, v18
s_add_u32 s60, s70, 88084480
buffer_load_dwordx4 v38, s[44:47], s60 offen offset:3072 sc1 lds
s_waitcnt vmcnt(0)
s_barrier
s_bfe_u32 s55, s76, 0x40000
s_mul_i32 s55, s55, 1
s_add_u32 s55, s55, s61
s_cmp_ge_u32 s55, 64
s_cbranch_scc1 L_b_nd_141
v_cmp_eq_u32 vcc, 0, v178
s_cbranch_vccnz L_b_fs_142
L_b_fb_143:
s_add_u32 m0, s79, 49152
s_add_u32 s60, s62, 0
buffer_load_dwordx4 v1, s[44:47], s60 offen offset:0 sc1 lds
s_add_u32 s60, s62, 0
buffer_load_dwordx4 v1, s[44:47], s60 offen offset:1024 sc1 lds
s_add_u32 s60, s62, 0
buffer_load_dwordx4 v1, s[44:47], s60 offen offset:2048 sc1 lds
s_add_u32 s60, s62, 0
buffer_load_dwordx4 v1, s[44:47], s60 offen offset:3072 sc1 lds
s_add_u32 m0, s79, 53248
s_add_u32 s60, s62, 4096
buffer_load_dwordx4 v1, s[44:47], s60 offen offset:0 sc1 lds
s_add_u32 s60, s62, 4096
buffer_load_dwordx4 v1, s[44:47], s60 offen offset:1024 sc1 lds
s_bfe_u32 s55, s76, 0x40004
s_mul_i32 s55, s55, 786432
s_add_u32 s62, s62, s55
L_b_nd_141:
ds_read_b128 v[40:43], v14 offset:0
ds_read_b128 v[44:47], v15 offset:0
ds_read_b128 v[48:51], v16 offset:0
ds_read_b128 v[52:55], v17 offset:0
ds_read_b128 v[56:59], v14 offset:256
ds_read_b128 v[60:63], v15 offset:256
ds_read_b128 v[64:67], v16 offset:256
s_waitcnt lgkmcnt(6)
v_mfma_f32_16x16x32_bf16 v[72:75], a[128:131], v[40:43], 0
v_mfma_f32_16x16x32_bf16 v[76:79], a[192:195], v[40:43], 0
ds_read_b128 v[68:71], v17 offset:256
s_waitcnt lgkmcnt(6)
v_mfma_f32_16x16x32_bf16 v[80:83], a[132:135], v[44:47], 0
v_mfma_f32_16x16x32_bf16 v[84:87], a[196:199], v[44:47], 0
ds_read_b128 v[40:43], v14 offset:512
s_waitcnt lgkmcnt(6)
v_mfma_f32_16x16x32_bf16 v[72:75], a[136:139], v[48:51], v[72:75]
v_mfma_f32_16x16x32_bf16 v[76:79], a[200:203], v[48:51], v[76:79]
ds_read_b128 v[44:47], v15 offset:512
s_waitcnt lgkmcnt(6)
v_mfma_f32_16x16x32_bf16 v[80:83], a[140:143], v[52:55], v[80:83]
v_mfma_f32_16x16x32_bf16 v[84:87], a[204:207], v[52:55], v[84:87]
ds_read_b128 v[48:51], v16 offset:512
s_waitcnt lgkmcnt(6)
v_mfma_f32_16x16x32_bf16 v[72:75], a[144:147], v[56:59], v[72:75]
v_mfma_f32_16x16x32_bf16 v[76:79], a[208:211], v[56:59], v[76:79]
ds_read_b128 v[52:55], v17 offset:512
s_waitcnt lgkmcnt(6)
v_mfma_f32_16x16x32_bf16 v[80:83], a[148:151], v[60:63], v[80:83]
v_mfma_f32_16x16x32_bf16 v[84:87], a[212:215], v[60:63], v[84:87]
ds_read_b128 v[56:59], v14 offset:768
s_waitcnt lgkmcnt(6)
v_mfma_f32_16x16x32_bf16 v[72:75], a[152:155], v[64:67], v[72:75]
v_mfma_f32_16x16x32_bf16 v[76:79], a[216:219], v[64:67], v[76:79]
ds_read_b128 v[60:63], v15 offset:768
s_waitcnt lgkmcnt(6)
v_mfma_f32_16x16x32_bf16 v[80:83], a[156:159], v[68:71], v[80:83]
v_mfma_f32_16x16x32_bf16 v[84:87], a[220:223], v[68:71], v[84:87]
ds_read_b128 v[64:67], v16 offset:768
s_waitcnt lgkmcnt(6)
v_mfma_f32_16x16x32_bf16 v[72:75], a[160:163], v[40:43], v[72:75]
v_mfma_f32_16x16x32_bf16 v[76:79], a[224:227], v[40:43], v[76:79]
ds_read_b128 v[68:71], v17 offset:768
s_waitcnt lgkmcnt(6)
v_mfma_f32_16x16x32_bf16 v[80:83], a[164:167], v[44:47], v[80:83]
v_mfma_f32_16x16x32_bf16 v[84:87], a[228:231], v[44:47], v[84:87]
s_waitcnt lgkmcnt(5)
v_mfma_f32_16x16x32_bf16 v[72:75], a[168:171], v[48:51], v[72:75]
v_mfma_f32_16x16x32_bf16 v[76:79], a[232:235], v[48:51], v[76:79]
s_waitcnt lgkmcnt(4)
v_mfma_f32_16x16x32_bf16 v[80:83], a[172:175], v[52:55], v[80:83]
v_mfma_f32_16x16x32_bf16 v[84:87], a[236:239], v[52:55], v[84:87]
s_waitcnt lgkmcnt(3)
v_mfma_f32_16x16x32_bf16 v[72:75], a[176:179], v[56:59], v[72:75]
v_mfma_f32_16x16x32_bf16 v[76:79], a[240:243], v[56:59], v[76:79]
s_waitcnt lgkmcnt(2)
v_mfma_f32_16x16x32_bf16 v[80:83], a[180:183], v[60:63], v[80:83]
v_mfma_f32_16x16x32_bf16 v[84:87], a[244:247], v[60:63], v[84:87]
s_waitcnt lgkmcnt(1)
v_mfma_f32_16x16x32_bf16 v[72:75], a[184:187], v[64:67], v[72:75]
v_mfma_f32_16x16x32_bf16 v[76:79], a[248:251], v[64:67], v[76:79]
s_waitcnt lgkmcnt(0)
v_mfma_f32_16x16x32_bf16 v[80:83], a[188:191], v[68:71], v[80:83]
v_mfma_f32_16x16x32_bf16 v[84:87], a[252:255], v[68:71], v[84:87]
s_nop 6
v_add_f32 v72, v72, v80
v_add_f32 v73, v73, v81
v_add_f32 v74, v74, v82
v_add_f32 v75, v75, v83
v_add_f32 v76, v76, v84
v_add_f32 v77, v77, v85
v_add_f32 v78, v78, v86
v_add_f32 v79, v79, v87
v_max_f32 v72, 0, v72
v_max_f32 v73, 0, v73
v_max_f32 v74, 0, v74
v_max_f32 v75, 0, v75
v_max_f32 v76, 0, v76
v_max_f32 v77, 0, v77
v_max_f32 v78, 0, v78
v_max_f32 v79, 0, v79
v_cvt_pk_bf16_f32 v72, v72, v73
v_cvt_pk_bf16_f32 v73, v74, v75
v_cvt_pk_bf16_f32 v74, v76, v77
v_cvt_pk_bf16_f32 v75, v78, v79
ds_write_b128 v19, v[72:75]
s_waitcnt lgkmcnt(0)
s_barrier
ds_read_b128 v[40:43], v1 offset:45056
ds_read_b128 v[48:51], v1 offset:46080
ds_read_b128 v[44:47], v1 offset:47104
ds_read_b128 v[52:55], v1 offset:48128
s_add_u32 s56, s66, 32768
s_add_u32 s57, s66, 65536
s_add_u32 s58, s66, 98304
s_waitcnt lgkmcnt(3)
v_mfma_f32_16x16x32_bf16 v[72:75], v[40:43], v[192:195], 0
v_mfma_f32_16x16x32_bf16 v[76:79], v[40:43], v[200:203], 0
v_mfma_f32_16x16x32_bf16 v[80:83], v[40:43], v[208:211], 0
v_mfma_f32_16x16x32_bf16 v[84:87], v[40:43], v[216:219], 0
v_mfma_f32_16x16x32_bf16 v[88:91], v[40:43], v[224:227], 0
v_mfma_f32_16x16x32_bf16 v[92:95], v[40:43], v[232:235], 0
v_mfma_f32_16x16x32_bf16 v[96:99], v[40:43], v[240:243], 0
v_mfma_f32_16x16x32_bf16 v[100:103], v[40:43], v[248:251], 0
s_waitcnt lgkmcnt(2)
v_mfma_f32_16x16x32_bf16 v[72:75], v[48:51], v[196:199], v[72:75]
v_mfma_f32_16x16x32_bf16 v[76:79], v[48:51], v[204:207], v[76:79]
v_mfma_f32_16x16x32_bf16 v[80:83], v[48:51], v[212:215], v[80:83]
v_mfma_f32_16x16x32_bf16 v[84:87], v[48:51], v[220:223], v[84:87]
v_mfma_f32_16x16x32_bf16 v[88:91], v[48:51], v[228:231], v[88:91]
v_mfma_f32_16x16x32_bf16 v[92:95], v[48:51], v[236:239], v[92:95]
v_mfma_f32_16x16x32_bf16 v[96:99], v[48:51], v[244:247], v[96:99]
v_mfma_f32_16x16x32_bf16 v[100:103], v[48:51], v[252:255], v[100:103]
s_waitcnt lgkmcnt(0)
v_mfma_f32_16x16x32_bf16 v[104:107], v[44:47], v[192:195], 0
v_mfma_f32_16x16x32_bf16 v[104:107], v[52:55], v[196:199], v[104:107]
v_cvt_pk_bf16_f32 v136, v72, v76
v_cvt_pk_bf16_f32 v137, v80, v84
v_mfma_f32_16x16x32_bf16 v[108:111], v[44:47], v[200:203], 0
v_cvt_pk_bf16_f32 v138, v88, v92
v_cvt_pk_bf16_f32 v139, v96, v100
v_mfma_f32_16x16x32_bf16 v[108:111], v[52:55], v[204:207], v[108:111]
v_and_b32 v136, -2, v136
buffer_store_dwordx4 v[136:139], v9, s[44:47], s66 offen
v_cvt_pk_bf16_f32 v140, v73, v77
v_mfma_f32_16x16x32_bf16 v[112:115], v[44:47], v[208:211], 0
v_cvt_pk_bf16_f32 v141, v81, v85
v_cvt_pk_bf16_f32 v142, v89, v93
v_mfma_f32_16x16x32_bf16 v[112:115], v[52:55], v[212:215], v[112:115]
v_cvt_pk_bf16_f32 v143, v97, v101
v_and_b32 v140, -2, v140
buffer_store_dwordx4 v[140:143], v9, s[44:47], s56 offen
v_mfma_f32_16x16x32_bf16 v[116:119], v[44:47], v[216:219], 0
v_cvt_pk_bf16_f32 v144, v74, v78
v_cvt_pk_bf16_f32 v145, v82, v86
v_mfma_f32_16x16x32_bf16 v[116:119], v[52:55], v[220:223], v[116:119]
v_cvt_pk_bf16_f32 v146, v90, v94
v_cvt_pk_bf16_f32 v147, v98, v102
v_mfma_f32_16x16x32_bf16 v[120:123], v[44:47], v[224:227], 0
v_and_b32 v144, -2, v144
buffer_store_dwordx4 v[144:147], v9, s[44:47], s57 offen
v_cvt_pk_bf16_f32 v148, v75, v79
v_mfma_f32_16x16x32_bf16 v[120:123], v[52:55], v[228:231], v[120:123]
v_cvt_pk_bf16_f32 v149, v83, v87
v_cvt_pk_bf16_f32 v150, v91, v95
v_mfma_f32_16x16x32_bf16 v[124:127], v[44:47], v[232:235], 0
v_cvt_pk_bf16_f32 v151, v99, v103
v_and_b32 v148, -2, v148
buffer_store_dwordx4 v[148:151], v9, s[44:47], s58 offen
s_add_u32 s59, s66, 524288
s_add_u32 s56, s66, 557056
s_add_u32 s57, s66, 589824
s_add_u32 s58, s66, 622592
v_mfma_f32_16x16x32_bf16 v[124:127], v[52:55], v[236:239], v[124:127]
v_cvt_pk_bf16_f32 v72, v104, v108
v_cvt_pk_bf16_f32 v76, v105, v109
v_mfma_f32_16x16x32_bf16 v[128:131], v[44:47], v[240:243], 0
v_cvt_pk_bf16_f32 v80, v106, v110
v_cvt_pk_bf16_f32 v84, v107, v111
v_mfma_f32_16x16x32_bf16 v[128:131], v[52:55], v[244:247], v[128:131]
v_and_b32 v72, -2, v72
v_and_b32 v76, -2, v76
v_mfma_f32_16x16x32_bf16 v[132:135], v[44:47], v[248:251], 0
v_and_b32 v80, -2, v80
v_and_b32 v84, -2, v84
v_mfma_f32_16x16x32_bf16 v[132:135], v[52:55], v[252:255], v[132:135]
v_cvt_pk_bf16_f32 v73, v112, v116
v_cvt_pk_bf16_f32 v77, v113, v117
v_cvt_pk_bf16_f32 v81, v114, v118
v_cvt_pk_bf16_f32 v85, v115, v119
v_cvt_pk_bf16_f32 v74, v120, v124
v_cvt_pk_bf16_f32 v78, v121, v125
v_cvt_pk_bf16_f32 v82, v122, v126
v_cvt_pk_bf16_f32 v86, v123, v127
v_cvt_pk_bf16_f32 v75, v128, v132
buffer_store_dwordx4 v[72:75], v9, s[44:47], s59 offen
v_cvt_pk_bf16_f32 v79, v129, v133
buffer_store_dwordx4 v[76:79], v9, s[44:47], s56 offen
v_cvt_pk_bf16_f32 v83, v130, v134
buffer_store_dwordx4 v[80:83], v9, s[44:47], s57 offen
v_cvt_pk_bf16_f32 v87, v131, v135
buffer_store_dwordx4 v[84:87], v9, s[44:47], s58 offen
L_b_nf_138:
s_bfe_u32 s55, s76, 0x40000
s_mul_i32 s55, s55, 4096
s_add_u32 s83, s83, s55
s_sub_u32 s83, s83, s78
s_lshl_b32 s55, s78, 5
s_sub_u32 s63, s63, s55
s_mov_b32 s78, 0
buffer_load_dwordx4 v[40:43], v10, s[44:47], s68 offen sc1
s_add_u32 s56, s68, 4096
buffer_load_dwordx4 v[44:47], v10, s[44:47], s56 offen sc1
s_add_u32 s56, s68, 8192
buffer_load_dwordx4 v[48:51], v10, s[44:47], s56 offen sc1
s_add_u32 s56, s68, 12288
buffer_load_dwordx4 v[52:55], v10, s[44:47], s56 offen sc1
s_add_u32 s56, s68, 16384
buffer_load_dwordx4 v[56:59], v10, s[44:47], s56 offen sc1
s_add_u32 s56, s68, 20480
buffer_load_dwordx4 v[60:63], v11, s[44:47], s56 offen sc1
s_bfe_u32 s55, s76, 0x40004
s_mul_i32 s55, s55, 4096
s_add_u32 s64, s64, s55
buffer_load_dword v179, off, s[44:47], s83 sc1
buffer_load_dword v178, off, s[44:47], s64 sc1
L_b_ck_144:
s_waitcnt vmcnt(7)
v_mfma_f32_16x16x32_bf16 v[80:83], v[40:43], v[28:31], 0
s_waitcnt vmcnt(6)
v_mfma_f32_16x16x32_bf16 v[84:87], v[44:47], v[28:31], 0
v_or_b32 v72, v40, v44
s_waitcnt vmcnt(5)
v_mfma_f32_16x16x32_bf16 v[80:83], v[48:51], v[28:31], v[80:83]
s_waitcnt vmcnt(4)
v_mfma_f32_16x16x32_bf16 v[84:87], v[52:55], v[28:31], v[84:87]
v_or3_b32 v72, v72, v48, v52
s_waitcnt vmcnt(3)
v_mfma_f32_16x16x32_bf16 v[80:83], v[56:59], v[28:31], v[80:83]
s_waitcnt vmcnt(2)
v_mfma_f32_16x16x32_bf16 v[84:87], v[60:63], v[28:31], v[84:87]
v_or3_b32 v72, v72, v56, v60
v_and_b32 v72, 1, v72
v_cmp_ne_u32 vcc, 0, v72
s_cbranch_vccnz L_b_rt_145
L_b_bk_146:
v_mov_b32 v38, s73
s_mov_b64 exec, 1
buffer_store_dword v38, off, s[44:47], s71 offset:1536
s_mov_b64 exec, -1
s_bfe_u32 s55, s76, 0x40000
s_mul_i32 s55, s55, 1
s_lshr_b64 s[76:77], s[76:77], 4
s_add_u32 s61, s61, s55
s_lshl_b32 s56, s55, 17
s_add_u32 s63, s63, s56
s_lshl_b32 s55, s55, 15
s_add_u32 s73, s73, 1
v_add_f32 v32, v32, v80
v_add_f32 v33, v33, v81
v_add_f32 v34, v34, v82
v_add_f32 v35, v35, v83
v_add_f32 v32, v32, v84
v_add_f32 v33, v33, v85
v_add_f32 v34, v34, v86
v_add_f32 v35, v35, v87
v_cvt_pk_bf16_f32 v44, v32, v33
v_cvt_pk_bf16_f32 v45, v34, v35
buffer_store_dwordx2 v[44:45], v13, s[36:39], s69 offen sc1
s_add_u32 s69, s69, s55
s_cmp_lt_u32 s61, 64
s_cbranch_scc1 L_b_loop_p
s_branch L_end
L_b_kp_130:
s_lshl_b32 s55, s48, 10
s_add_u32 s55, s55, s63
buffer_load_dwordx4 v[104:107], v1, s[44:47], s55 offen sc1
L_b_kq_131:
s_waitcnt vmcnt(0)
v_max3_u32 v164, v104, v105, v106
v_max_u32 v164, v164, v107
v_cmp_eq_u32 vcc, -1, v164
s_cbranch_vccz L_b_hk_129
s_mov_b64 exec, vcc
buffer_load_dwordx4 v[104:107], v1, s[44:47], s55 offen sc1
s_mov_b64 exec, -1
s_add_u32 s54, s54, 1
s_cmp_gt_u32 s54, 400000
s_cbranch_scc1 L_end
s_branch L_b_kq_131
L_b_3s_133:
s_add_u32 s54, s54, 1
s_cmp_gt_u32 s54, 400000
s_cbranch_scc1 L_end
buffer_load_dword v179, v3, s[44:47], s72 offen offset:1536 sc1
s_branch L_b_3b_134
L_b_rt_136:
s_mov_b64 exec, vcc
buffer_load_dwordx4 v[40:43], v10, s[44:47], s67 offen sc1
s_add_u32 s56, s67, 4096
buffer_load_dwordx4 v[44:47], v10, s[44:47], s56 offen sc1
s_add_u32 s56, s67, 8192
buffer_load_dwordx4 v[48:51], v10, s[44:47], s56 offen sc1
s_add_u32 s56, s67, 12288
buffer_load_dwordx4 v[52:55], v10, s[44:47], s56 offen sc1
s_add_u32 s56, s67, 16384
buffer_load_dwordx4 v[56:59], v10, s[44:47], s56 offen sc1
s_add_u32 s56, s67, 20480
buffer_load_dwordx4 v[60:63], v10, s[44:47], s56 offen sc1
s_add_u32 s56, s67, 24576
buffer_load_dwordx4 v[64:67], v10, s[44:47], s56 offen sc1
s_add_u32 s56, s67, 28672
buffer_load_dwordx4 v[68:71], v10, s[44:47], s56 offen sc1
s_mov_b64 exec, -1
s_add_u32 s54, s54, 1
s_cmp_gt_u32 s54, 400000
s_cbranch_scc1 L_end
s_waitcnt vmcnt(7)
v_xor_b32 v72, s60, v40
s_waitcnt vmcnt(6)
v_bitop3_b32 v72, v72, v44, s60 bitop3:0xf6
s_waitcnt vmcnt(5)
v_bitop3_b32 v72, v72, v48, s60 bitop3:0xf6
s_waitcnt vmcnt(4)
v_bitop3_b32 v72, v72, v52, s60 bitop3:0xf6
s_waitcnt vmcnt(3)
v_bitop3_b32 v72, v72, v56, s60 bitop3:0xf6
s_waitcnt vmcnt(2)
v_bitop3_b32 v72, v72, v60, s60 bitop3:0xf6
s_waitcnt vmcnt(1)
v_bitop3_b32 v72, v72, v64, s60 bitop3:0xf6
s_waitcnt vmcnt(0)
v_bitop3_b32 v72, v72, v68, s60 bitop3:0xf6
v_and_b32 v72, v180, v72
v_cmp_ne_u32 vcc, 0, v72
s_cbranch_vccnz L_b_rt_136
v_mfma_f32_16x16x32_bf16 v[80:83], v[40:43], v[28:31], 0
v_mfma_f32_16x16x32_bf16 v[84:87], v[44:47], v[28:31], 0
v_mfma_f32_16x16x32_bf16 v[80:83], v[48:51], v[28:31], v[80:83]
v_mfma_f32_16x16x32_bf16 v[84:87], v[52:55], v[28:31], v[84:87]
v_mfma_f32_16x16x32_bf16 v[80:83], v[56:59], v[28:31], v[80:83]
v_mfma_f32_16x16x32_bf16 v[84:87], v[60:63], v[28:31], v[84:87]
v_mfma_f32_16x16x32_bf16 v[80:83], v[64:67], v[28:31], v[80:83]
v_mfma_f32_16x16x32_bf16 v[84:87], v[68:71], v[28:31], v[84:87]
s_nop 7
s_branch L_b_bk_137
L_b_idle_139:
s_bfe_u32 s55, s76, 0x40000
s_mul_i32 s55, s55, 1
s_add_u32 s55, s55, s61
s_cmp_ge_u32 s55, 64
s_cbranch_scc1 L_b_nd_147
v_cmp_eq_u32 vcc, 0, v178
s_cbranch_vccnz L_b_fs_148
L_b_fb_149:
s_add_u32 m0, s79, 49152
s_add_u32 s60, s62, 0
buffer_load_dwordx4 v1, s[44:47], s60 offen offset:0 sc1 lds
s_add_u32 s60, s62, 0
buffer_load_dwordx4 v1, s[44:47], s60 offen offset:1024 sc1 lds
s_add_u32 s60, s62, 0
buffer_load_dwordx4 v1, s[44:47], s60 offen offset:2048 sc1 lds
s_add_u32 s60, s62, 0
buffer_load_dwordx4 v1, s[44:47], s60 offen offset:3072 sc1 lds
s_add_u32 m0, s79, 53248
s_add_u32 s60, s62, 4096
buffer_load_dwordx4 v1, s[44:47], s60 offen offset:0 sc1 lds
s_add_u32 s60, s62, 4096
buffer_load_dwordx4 v1, s[44:47], s60 offen offset:1024 sc1 lds
s_bfe_u32 s55, s76, 0x40004
s_mul_i32 s55, s55, 786432
s_add_u32 s62, s62, s55
L_b_nd_147:
L_b_il_150:
s_add_u32 s54, s54, 1
s_cmp_gt_u32 s54, 400000
s_cbranch_scc1 L_end
buffer_load_dword v40, v10, s[44:47], s68 offen sc1
s_waitcnt vmcnt(0)
v_and_b32 v40, 1, v40
v_cmp_ne_u32 vcc, 0, v40
s_cbranch_vccnz L_b_il_150
s_branch L_b_nf_138
L_b_fs_142:
L_bp_151:
s_add_u32 s54, s54, 1
s_cmp_gt_u32 s54, 400000
s_cbranch_scc1 L_end
buffer_load_dword v0, off, s[44:47], s64 offset:0 sc1
s_waitcnt vmcnt(0)
v_cmp_eq_u32 vcc, 0, v0
s_cbranch_vccnz L_bp_151
s_branch L_b_fb_143
L_b_rt_145:
s_mov_b64 exec, vcc
buffer_load_dwordx4 v[40:43], v10, s[44:47], s68 offen sc1
s_add_u32 s56, s68, 4096
buffer_load_dwordx4 v[44:47], v10, s[44:47], s56 offen sc1
s_add_u32 s56, s68, 8192
buffer_load_dwordx4 v[48:51], v10, s[44:47], s56 offen sc1
s_add_u32 s56, s68, 12288
buffer_load_dwordx4 v[52:55], v10, s[44:47], s56 offen sc1
s_add_u32 s56, s68, 16384
buffer_load_dwordx4 v[56:59], v10, s[44:47], s56 offen sc1
s_add_u32 s56, s68, 20480
buffer_load_dwordx4 v[60:63], v11, s[44:47], s56 offen sc1
s_mov_b64 exec, -1
s_add_u32 s54, s54, 1
s_cmp_gt_u32 s54, 400000
s_cbranch_scc1 L_end
s_waitcnt vmcnt(4)
v_or_b32 v72, v40, v44
s_waitcnt vmcnt(2)
v_or3_b32 v72, v72, v48, v52
s_waitcnt vmcnt(0)
v_or3_b32 v72, v72, v56, v60
v_and_b32 v72, 1, v72
v_cmp_ne_u32 vcc, 0, v72
s_cbranch_vccnz L_b_rt_145
v_mfma_f32_16x16x32_bf16 v[80:83], v[40:43], v[28:31], 0
v_mfma_f32_16x16x32_bf16 v[84:87], v[44:47], v[28:31], 0
v_mfma_f32_16x16x32_bf16 v[80:83], v[48:51], v[28:31], v[80:83]
v_mfma_f32_16x16x32_bf16 v[84:87], v[52:55], v[28:31], v[84:87]
v_mfma_f32_16x16x32_bf16 v[80:83], v[56:59], v[28:31], v[80:83]
v_mfma_f32_16x16x32_bf16 v[84:87], v[60:63], v[28:31], v[84:87]
s_nop 7
s_branch L_b_bk_146
L_b_fs_148:
L_bp_152:
s_add_u32 s54, s54, 1
s_cmp_gt_u32 s54, 400000
s_cbranch_scc1 L_end
buffer_load_dword v0, off, s[44:47], s64 offset:0 sc1
s_waitcnt vmcnt(0)
v_cmp_eq_u32 vcc, 0, v0
s_cbranch_vccnz L_bp_152
s_branch L_b_fb_149
L_b_loop_i:
s_barrier
ds_read_b128 v[72:75], v176 offset:49152
ds_read_b128 v[40:43], v1 offset:57344
ds_read_b128 v[56:59], v1 offset:61440
ds_read_b128 v[76:79], v176 offset:50176
ds_read_b128 v[44:47], v1 offset:58368
ds_read_b128 v[60:63], v1 offset:62464
ds_read_b128 v[80:83], v176 offset:51200
ds_read_b128 v[48:51], v1 offset:59392
ds_read_b128 v[64:67], v1 offset:63488
ds_read_b128 v[84:87], v176 offset:52224
ds_read_b128 v[52:55], v1 offset:60416
ds_read_b128 v[68:71], v1 offset:64512
ds_read_b128 v[88:91], v177 offset:49152
ds_read_b128 v[92:95], v177 offset:50176
ds_read_b128 v[96:99], v177 offset:51200
ds_read_b128 v[100:103], v177 offset:52224
s_waitcnt vmcnt(2)
v_cmp_eq_u32 vcc, 0, v179
buffer_load_dwordx2 v[36:37], v12, s[4:7], s69 offen
s_mov_b32 s80, vcc_lo
s_cbranch_vccnz L_b_nk_153
s_lshl_b32 s55, s48, 10
s_add_u32 s55, s55, s63
buffer_load_dwordx4 v[104:107], v1, s[44:47], s55 offen sc1
L_b_nk_153:
s_waitcnt lgkmcnt(13)
v_mfma_f32_16x16x32_bf16 v[128:131], v[40:43], v[72:75], v[20:23]
v_mfma_f32_16x16x32_bf16 v[132:135], v[56:59], v[72:75], v[24:27]
s_waitcnt lgkmcnt(10)
v_mfma_f32_16x16x32_bf16 v[128:131], v[44:47], v[76:79], v[128:131]
v_mfma_f32_16x16x32_bf16 v[132:135], v[60:63], v[76:79], v[132:135]
s_waitcnt lgkmcnt(7)
v_mfma_f32_16x16x32_bf16 v[128:131], v[48:51], v[80:83], v[128:131]
v_mfma_f32_16x16x32_bf16 v[132:135], v[64:67], v[80:83], v[132:135]
s_waitcnt lgkmcnt(4)
v_mfma_f32_16x16x32_bf16 v[128:131], v[52:55], v[84:87], v[128:131]
v_mfma_f32_16x16x32_bf16 v[132:135], v[68:71], v[84:87], v[132:135]
s_cmp_eq_u32 s80, 0
s_cbranch_scc1 L_b_hk_154
s_cmp_ge_u32 s61, 62
s_cbranch_scc1 L_b_kp_155
L_bp_157:
s_add_u32 s54, s54, 1
s_cmp_gt_u32 s54, 400000
s_cbranch_scc1 L_end
buffer_load_dword v0, off, s[44:47], s83 offset:0 sc1
s_waitcnt vmcnt(0)
v_cmp_eq_u32 vcc, 0, v0
s_cbranch_vccnz L_bp_157
s_lshl_b32 s55, s48, 10
s_add_u32 s55, s55, s63
buffer_load_dwordx4 v[104:107], v1, s[44:47], s55 offen sc1
L_b_hk_154:
s_nop 4
v_max3_f32 v164, v128, v129, v130
v_max3_f32 v164, v164, v131, v132
v_max3_f32 v164, v164, v133, v134
v_max_f32 v164, v164, v135
v_mov_b32 v145, 0
s_lshl_b32 s55, s48, 10
s_add_u32 s55, s55, 77824
v_add_u32 v165, s55, v1
v_add_u32 v140, s81, v1
s_waitcnt vmcnt(0)
ds_write_b32 v6, v105
ds_write_b32 v6, v107 offset:512
ds_write_b128 v165, v[104:107]
s_waitcnt lgkmcnt(0)
s_barrier
ds_read_b64_tr_b16 v[112:113], v7 offset:0
ds_read_b64_tr_b16 v[114:115], v7 offset:512
ds_read_b64_tr_b16 v[116:117], v7 offset:1024
ds_read_b64_tr_b16 v[118:119], v7 offset:1536
ds_read_b64_tr_b16 v[120:121], v7 offset:2048
ds_read_b64_tr_b16 v[122:123], v7 offset:2560
ds_read_b64_tr_b16 v[124:125], v7 offset:3072
ds_read_b64_tr_b16 v[126:127], v7 offset:3584
ds_read_b128 v[168:171], v140 offset:0
ds_read_b128 v[172:175], v140 offset:1024
s_waitcnt lgkmcnt(8)
v_mfma_f32_16x16x32_bf16 v[136:139], v[112:115], v[72:75], 0
s_waitcnt lgkmcnt(6)
v_mfma_f32_16x16x32_bf16 v[136:139], v[116:119], v[76:79], v[136:139]
s_waitcnt lgkmcnt(4)
v_mfma_f32_16x16x32_bf16 v[136:139], v[120:123], v[80:83], v[136:139]
s_waitcnt lgkmcnt(2)
v_mfma_f32_16x16x32_bf16 v[136:139], v[124:127], v[84:87], v[136:139]
s_nop 7
v_max3_f32 v164, v164, v136, v137
v_mov_b32 v165, v164
s_nop 1
v_permlane16_swap_b32 v164, v165
v_max_f32 v164, v164, v165
v_mov_b32 v165, v164
s_nop 1
v_permlane32_swap_b32 v164, v165
v_max_f32 v164, v164, v165
v_mul_f32 v164, s74, v164
v_fma_f32 v128, v128, s74, -v164
v_fma_f32 v129, v129, s74, -v164
v_fma_f32 v130, v130, s74, -v164
v_fma_f32 v131, v131, s74, -v164
v_fma_f32 v132, v132, s74, -v164
v_fma_f32 v133, v133, s74, -v164
v_fma_f32 v134, v134, s74, -v164
v_fma_f32 v135, v135, s74, -v164
v_fma_f32 v136, v136, s74, -v164
v_fma_f32 v137, v137, s74, -v164
v_exp_f32 v128, v128
v_exp_f32 v129, v129
v_exp_f32 v130, v130
v_exp_f32 v131, v131
v_exp_f32 v132, v132
v_exp_f32 v133, v133
v_exp_f32 v134, v134
v_exp_f32 v135, v135
v_exp_f32 v136, v136
v_exp_f32 v137, v137
v_cvt_pk_bf16_f32 v140, v128, v129
v_cvt_pk_bf16_f32 v141, v130, v131
v_cvt_pk_bf16_f32 v142, v132, v133
v_cvt_pk_bf16_f32 v143, v134, v135
v_cvt_pk_bf16_f32 v144, v136, v137
s_waitcnt lgkmcnt(0)
buffer_load_dword v179, v3, s[44:47], s72 offen offset:1536 sc1
v_mfma_f32_16x16x32_bf16 v[148:151], v[88:91], v[140:143], 0
v_add_f32 v164, v128, v129
v_add_f32 v165, v130, v131
v_add_f32 v164, v164, v132
v_mfma_f32_16x16x32_bf16 v[152:155], v[92:95], v[140:143], 0
v_add_f32 v165, v165, v133
v_add_f32 v164, v164, v134
v_add_f32 v165, v165, v135
v_mfma_f32_16x16x32_bf16 v[156:159], v[96:99], v[140:143], 0
v_add_f32 v164, v164, v136
v_add_f32 v165, v165, v137
v_add_f32 v164, v164, v165
v_mfma_f32_16x16x32_bf16 v[160:163], v[100:103], v[140:143], 0
v_mfma_f32_16x16x16_bf16 v[148:151], v[168:169], v[144:145], v[148:151]
v_mov_b32 v165, v164
s_nop 1
v_permlane16_swap_b32 v164, v165
v_add_f32 v164, v164, v165
v_mfma_f32_16x16x16_bf16 v[152:155], v[170:171], v[144:145], v[152:155]
v_mov_b32 v165, v164
s_nop 1
v_permlane32_swap_b32 v164, v165
v_add_f32 v164, v164, v165
v_mfma_f32_16x16x16_bf16 v[156:159], v[172:173], v[144:145], v[156:159]
v_rcp_f32 v164, v164
v_mfma_f32_16x16x16_bf16 v[160:163], v[174:175], v[144:145], v[160:163]
v_mul_f32 v148, v148, v164
v_mul_f32 v149, v149, v164
v_mul_f32 v150, v150, v164
v_mul_f32 v151, v151, v164
v_mul_f32 v152, v152, v164
v_mul_f32 v153, v153, v164
v_mul_f32 v154, v154, v164
v_mul_f32 v155, v155, v164
v_cvt_pk_bf16_f32 v128, v148, v149
v_cvt_pk_bf16_f32 v129, v150, v151
v_cvt_pk_bf16_f32 v130, v152, v153
v_cvt_pk_bf16_f32 v131, v154, v155
ds_write_b128 v8, v[128:131] offset:0
v_mul_f32 v156, v156, v164
v_mul_f32 v157, v157, v164
v_mul_f32 v158, v158, v164
v_mul_f32 v159, v159, v164
v_mul_f32 v160, v160, v164
v_mul_f32 v161, v161, v164
v_mul_f32 v162, v162, v164
v_mul_f32 v163, v163, v164
v_cvt_pk_bf16_f32 v132, v156, v157
v_cvt_pk_bf16_f32 v133, v158, v159
v_cvt_pk_bf16_f32 v134, v160, v161
v_cvt_pk_bf16_f32 v135, v162, v163
ds_write_b128 v8, v[132:135] offset:1024
s_waitcnt lgkmcnt(0)
s_barrier
ds_read_b128 v[40:43], v1 offset:32768
ds_read_b128 v[48:51], v1 offset:33792
ds_read_b128 v[56:59], v1 offset:34816
ds_read_b128 v[64:67], v1 offset:35840
ds_read_b128 v[44:47], v1 offset:36864
ds_read_b128 v[52:55], v1 offset:37888
ds_read_b128 v[60:63], v1 offset:38912
ds_read_b128 v[68:71], v1 offset:39936
L_b_3b_159:
s_waitcnt vmcnt(0)
v_add_u32 v179, 1, v179
v_cmp_ne_u32 vcc, s73, v179
s_cbranch_vccnz L_b_3s_158
s_and_b32 s60, s73, 1
s_lshl_b32 s60, s60, 16
s_or_b32 s60, s60, 1
s_add_u32 s56, s65, 32768
s_add_u32 s57, s65, 65536
s_add_u32 s58, s65, 98304
s_waitcnt lgkmcnt(7)
v_mfma_f32_16x16x32_bf16 v[72:75], v[40:43], a[0:3], 0
v_mfma_f32_16x16x32_bf16 v[76:79], v[40:43], a[16:19], 0
v_mfma_f32_16x16x32_bf16 v[80:83], v[40:43], a[32:35], 0
v_mfma_f32_16x16x32_bf16 v[84:87], v[40:43], a[48:51], 0
v_mfma_f32_16x16x32_bf16 v[88:91], v[40:43], a[64:67], 0
v_mfma_f32_16x16x32_bf16 v[92:95], v[40:43], a[80:83], 0
v_mfma_f32_16x16x32_bf16 v[96:99], v[40:43], a[96:99], 0
v_mfma_f32_16x16x32_bf16 v[100:103], v[40:43], a[112:115], 0
s_waitcnt lgkmcnt(6)
v_mfma_f32_16x16x32_bf16 v[72:75], v[48:51], a[4:7], v[72:75]
v_mfma_f32_16x16x32_bf16 v[76:79], v[48:51], a[20:23], v[76:79]
v_mfma_f32_16x16x32_bf16 v[80:83], v[48:51], a[36:39], v[80:83]
v_mfma_f32_16x16x32_bf16 v[84:87], v[48:51], a[52:55], v[84:87]
v_mfma_f32_16x16x32_bf16 v[88:91], v[48:51], a[68:71], v[88:91]
v_mfma_f32_16x16x32_bf16 v[92:95], v[48:51], a[84:87], v[92:95]
v_mfma_f32_16x16x32_bf16 v[96:99], v[48:51], a[100:103], v[96:99]
v_mfma_f32_16x16x32_bf16 v[100:103], v[48:51], a[116:119], v[100:103]
s_waitcnt lgkmcnt(5)
v_mfma_f32_16x16x32_bf16 v[72:75], v[56:59], a[8:11], v[72:75]
v_mfma_f32_16x16x32_bf16 v[76:79], v[56:59], a[24:27], v[76:79]
v_mfma_f32_16x16x32_bf16 v[80:83], v[56:59], a[40:43], v[80:83]
v_mfma_f32_16x16x32_bf16 v[84:87], v[56:59], a[56:59], v[84:87]
v_mfma_f32_16x16x32_bf16 v[88:91], v[56:59], a[72:75], v[88:91]
v_mfma_f32_16x16x32_bf16 v[92:95], v[56:59], a[88:91], v[92:95]
v_mfma_f32_16x16x32_bf16 v[96:99], v[56:59], a[104:107], v[96:99]
v_mfma_f32_16x16x32_bf16 v[100:103], v[56:59], a[120:123], v[100:103]
s_waitcnt lgkmcnt(4)
v_mfma_f32_16x16x32_bf16 v[72:75], v[64:67], a[12:15], v[72:75]
v_mfma_f32_16x16x32_bf16 v[76:79], v[64:67], a[28:31], v[76:79]
v_mfma_f32_16x16x32_bf16 v[80:83], v[64:67], a[44:47], v[80:83]
v_mfma_f32_16x16x32_bf16 v[84:87], v[64:67], a[60:63], v[84:87]
v_mfma_f32_16x16x32_bf16 v[88:91], v[64:67], a[76:79], v[88:91]
v_mfma_f32_16x16x32_bf16 v[92:95], v[64:67], a[92:95], v[92:95]
v_mfma_f32_16x16x32_bf16 v[96:99], v[64:67], a[108:111], v[96:99]
v_mfma_f32_16x16x32_bf16 v[100:103], v[64:67], a[124:127], v[100:103]
s_waitcnt lgkmcnt(0)
v_mfma_f32_16x16x32_bf16 v[104:107], v[44:47], a[0:3], 0
v_mfma_f32_16x16x32_bf16 v[104:107], v[52:55], a[4:7], v[104:107]
v_cvt_pk_bf16_f32 v136, v72, v76
v_cvt_pk_bf16_f32 v137, v80, v84
v_mfma_f32_16x16x32_bf16 v[104:107], v[60:63], a[8:11], v[104:107]
v_cvt_pk_bf16_f32 v138, v88, v92
v_cvt_pk_bf16_f32 v139, v96, v100
v_mfma_f32_16x16x32_bf16 v[104:107], v[68:71], a[12:15], v[104:107]
v_bfi_b32 v136, v180, s60, v136
buffer_store_dwordx4 v[136:139], v9, s[44:47], s65 offen sc1
v_cvt_pk_bf16_f32 v140, v73, v77
v_mfma_f32_16x16x32_bf16 v[108:111], v[44:47], a[16:19], 0
v_cvt_pk_bf16_f32 v141, v81, v85
v_cvt_pk_bf16_f32 v142, v89, v93
v_mfma_f32_16x16x32_bf16 v[108:111], v[52:55], a[20:23], v[108:111]
v_cvt_pk_bf16_f32 v143, v97, v101
v_bfi_b32 v140, v180, s60, v140
buffer_store_dwordx4 v[140:143], v9, s[44:47], s56 offen sc1
v_mfma_f32_16x16x32_bf16 v[108:111], v[60:63], a[24:27], v[108:111]
v_cvt_pk_bf16_f32 v144, v74, v78
v_cvt_pk_bf16_f32 v145, v82, v86
v_mfma_f32_16x16x32_bf16 v[108:111], v[68:71], a[28:31], v[108:111]
v_cvt_pk_bf16_f32 v146, v90, v94
v_cvt_pk_bf16_f32 v147, v98, v102
v_mfma_f32_16x16x32_bf16 v[112:115], v[44:47], a[32:35], 0
v_bfi_b32 v144, v180, s60, v144
buffer_store_dwordx4 v[144:147], v9, s[44:47], s57 offen sc1
v_cvt_pk_bf16_f32 v148, v75, v79
v_mfma_f32_16x16x32_bf16 v[112:115], v[52:55], a[36:39], v[112:115]
v_cvt_pk_bf16_f32 v149, v83, v87
v_cvt_pk_bf16_f32 v150, v91, v95
v_mfma_f32_16x16x32_bf16 v[112:115], v[60:63], a[40:43], v[112:115]
v_cvt_pk_bf16_f32 v151, v99, v103
v_bfi_b32 v148, v180, s60, v148
buffer_store_dwordx4 v[148:151], v9, s[44:47], s58 offen sc1
s_add_u32 s59, s65, 524288
s_add_u32 s56, s65, 557056
s_add_u32 s57, s65, 589824
s_add_u32 s58, s65, 622592
v_mfma_f32_16x16x32_bf16 v[112:115], v[68:71], a[44:47], v[112:115]
v_cvt_pk_bf16_f32 v72, v104, v108
v_cvt_pk_bf16_f32 v76, v105, v109
v_mfma_f32_16x16x32_bf16 v[116:119], v[44:47], a[48:51], 0
v_cvt_pk_bf16_f32 v80, v106, v110
v_cvt_pk_bf16_f32 v84, v107, v111
v_mfma_f32_16x16x32_bf16 v[116:119], v[52:55], a[52:55], v[116:119]
v_bfi_b32 v72, v180, s60, v72
v_bfi_b32 v76, v180, s60, v76
v_mfma_f32_16x16x32_bf16 v[116:119], v[60:63], a[56:59], v[116:119]
v_bfi_b32 v80, v180, s60, v80
v_bfi_b32 v84, v180, s60, v84
v_mfma_f32_16x16x32_bf16 v[116:119], v[68:71], a[60:63], v[116:119]
v_mfma_f32_16x16x32_bf16 v[120:123], v[44:47], a[64:67], 0
v_mfma_f32_16x16x32_bf16 v[120:123], v[52:55], a[68:71], v[120:123]
v_cvt_pk_bf16_f32 v73, v112, v116
v_cvt_pk_bf16_f32 v77, v113, v117
v_mfma_f32_16x16x32_bf16 v[120:123], v[60:63], a[72:75], v[120:123]
v_cvt_pk_bf16_f32 v81, v114, v118
v_cvt_pk_bf16_f32 v85, v115, v119
v_mfma_f32_16x16x32_bf16 v[120:123], v[68:71], a[76:79], v[120:123]
v_mfma_f32_16x16x32_bf16 v[124:127], v[44:47], a[80:83], 0
v_mfma_f32_16x16x32_bf16 v[124:127], v[52:55], a[84:87], v[124:127]
v_mfma_f32_16x16x32_bf16 v[124:127], v[60:63], a[88:91], v[124:127]
v_mfma_f32_16x16x32_bf16 v[124:127], v[68:71], a[92:95], v[124:127]
v_mfma_f32_16x16x32_bf16 v[128:131], v[44:47], a[96:99], 0
v_mfma_f32_16x16x32_bf16 v[128:131], v[52:55], a[100:103], v[128:131]
v_cvt_pk_bf16_f32 v74, v120, v124
v_cvt_pk_bf16_f32 v78, v121, v125
v_mfma_f32_16x16x32_bf16 v[128:131], v[60:63], a[104:107], v[128:131]
v_cvt_pk_bf16_f32 v82, v122, v126
v_cvt_pk_bf16_f32 v86, v123, v127
v_mfma_f32_16x16x32_bf16 v[128:131], v[68:71], a[108:111], v[128:131]
v_mfma_f32_16x16x32_bf16 v[132:135], v[44:47], a[112:115], 0
v_mfma_f32_16x16x32_bf16 v[132:135], v[52:55], a[116:119], v[132:135]
v_mfma_f32_16x16x32_bf16 v[132:135], v[60:63], a[120:123], v[132:135]
v_mfma_f32_16x16x32_bf16 v[132:135], v[68:71], a[124:127], v[132:135]
s_nop 7
v_cvt_pk_bf16_f32 v75, v128, v132
buffer_store_dwordx4 v[72:75], v9, s[44:47], s59 offen sc1
v_cvt_pk_bf16_f32 v79, v129, v133
buffer_store_dwordx4 v[76:79], v9, s[44:47], s56 offen sc1
v_cvt_pk_bf16_f32 v83, v130, v134
buffer_store_dwordx4 v[80:83], v9, s[44:47], s57 offen sc1
v_cvt_pk_bf16_f32 v87, v131, v135
buffer_store_dwordx4 v[84:87], v9, s[44:47], s58 offen sc1
buffer_load_dwordx4 v[40:43], v10, s[44:47], s67 offen sc1
s_add_u32 s56, s67, 4096
buffer_load_dwordx4 v[44:47], v10, s[44:47], s56 offen sc1
s_add_u32 s56, s67, 8192
buffer_load_dwordx4 v[48:51], v10, s[44:47], s56 offen sc1
s_add_u32 s56, s67, 12288
buffer_load_dwordx4 v[52:55], v10, s[44:47], s56 offen sc1
s_add_u32 s56, s67, 16384
buffer_load_dwordx4 v[56:59], v10, s[44:47], s56 offen sc1
s_add_u32 s56, s67, 20480
buffer_load_dwordx4 v[60:63], v10, s[44:47], s56 offen sc1
s_add_u32 s56, s67, 24576
buffer_load_dwordx4 v[64:67], v10, s[44:47], s56 offen sc1
s_add_u32 s56, s67, 28672
buffer_load_dwordx4 v[68:71], v10, s[44:47], s56 offen sc1
L_b_ck_160:
s_waitcnt vmcnt(7)
v_mfma_f32_16x16x32_bf16 v[80:83], v[40:43], v[28:31], 0
v_xor_b32 v72, s60, v40
s_waitcnt vmcnt(6)
v_mfma_f32_16x16x32_bf16 v[84:87], v[44:47], v[28:31], 0
v_bitop3_b32 v72, v72, v44, s60 bitop3:0xf6
s_waitcnt vmcnt(5)
v_mfma_f32_16x16x32_bf16 v[80:83], v[48:51], v[28:31], v[80:83]
v_bitop3_b32 v72, v72, v48, s60 bitop3:0xf6
s_waitcnt vmcnt(4)
v_mfma_f32_16x16x32_bf16 v[84:87], v[52:55], v[28:31], v[84:87]
v_bitop3_b32 v72, v72, v52, s60 bitop3:0xf6
s_waitcnt vmcnt(3)
v_mfma_f32_16x16x32_bf16 v[80:83], v[56:59], v[28:31], v[80:83]
v_bitop3_b32 v72, v72, v56, s60 bitop3:0xf6
s_waitcnt vmcnt(2)
v_mfma_f32_16x16x32_bf16 v[84:87], v[60:63], v[28:31], v[84:87]
v_bitop3_b32 v72, v72, v60, s60 bitop3:0xf6
s_waitcnt vmcnt(1)
v_mfma_f32_16x16x32_bf16 v[80:83], v[64:67], v[28:31], v[80:83]
v_bitop3_b32 v72, v72, v64, s60 bitop3:0xf6
s_waitcnt vmcnt(0)
v_mfma_f32_16x16x32_bf16 v[84:87], v[68:71], v[28:31], v[84:87]
v_bitop3_b32 v72, v72, v68, s60 bitop3:0xf6
v_and_b32 v72, v180, v72
v_cmp_ne_u32 vcc, 0, v72
s_cbranch_vccnz L_b_rt_161
L_b_bk_162:
v_lshlrev_b32 v32, 16, v36
v_and_b32 v33, 0xffff0000, v36
v_lshlrev_b32 v34, 16, v37
v_and_b32 v35, 0xffff0000, v37
v_add_f32 v32, v32, v80
v_add_f32 v33, v33, v81
v_add_f32 v34, v34, v82
v_add_f32 v35, v35, v83
v_add_f32 v32, v32, v84
v_add_f32 v33, v33, v85
v_add_f32 v34, v34, v86
v_add_f32 v35, v35, v87
v_add_f32 v40, v32, v33
v_add_f32 v42, v34, v35
v_add_f32 v40, v40, v42
s_nop 1
v_add_f32_dpp v40, v40, v40 row_ror:4 row_mask:0xf bank_mask:0xf
s_nop 1
v_add_f32_dpp v40, v40, v40 row_ror:2 row_mask:0xf bank_mask:0xf
s_nop 1
v_add_f32_dpp v40, v40, v40 row_ror:1 row_mask:0xf bank_mask:0xf
v_mov_b32 v42, v40
s_nop 1
v_permlane16_swap_b32 v40, v42
v_add_f32 v40, v40, v42
v_mov_b32 v42, v40
s_nop 1
v_permlane32_swap_b32 v40, v42
v_add_f32 v40, v40, v42
v_mul_f32 v40, 0x3c000000, v40
v_sub_f32 v44, v32, v40
v_sub_f32 v45, v33, v40
v_sub_f32 v46, v34, v40
v_sub_f32 v47, v35, v40
v_mul_f32 v41, v44, v44
v_fmac_f32 v41, v45, v45
v_fmac_f32 v41, v46, v46
v_fmac_f32 v41, v47, v47
s_nop 1
v_add_f32_dpp v41, v41, v41 row_ror:4 row_mask:0xf bank_mask:0xf
s_nop 1
v_add_f32_dpp v41, v41, v41 row_ror:2 row_mask:0xf bank_mask:0xf
s_nop 1
v_add_f32_dpp v41, v41, v41 row_ror:1 row_mask:0xf bank_mask:0xf
v_mov_b32 v42, v41
s_nop 1
v_permlane16_swap_b32 v41, v42
v_add_f32 v41, v41, v42
v_mov_b32 v42, v41
s_nop 1
v_permlane32_swap_b32 v41, v42
v_add_f32 v41, v41, v42
s_lshl_b32 s55, s48, 3
s_add_u32 s55, s55, 73728
v_mov_b32 v43, s55
v_mov_b32 v56, 73728
s_mov_b64 exec, 1
ds_write_b64 v43, v[40:41]
s_mov_b64 exec, -1
s_waitcnt lgkmcnt(0)
s_barrier
ds_read_b128 v[48:51], v56
ds_read_b128 v[52:55], v56 offset:16
s_waitcnt lgkmcnt(0)
v_add_f32 v40, v48, v50
v_add_f32 v42, v52, v54
v_add_f32 v40, v40, v42
v_mul_f32 v40, 0x3e800000, v40
v_add_f32 v41, v49, v51
v_add_f32 v42, v53, v55
v_add_f32 v41, v41, v42
v_sub_f32 v48, v48, v40
v_sub_f32 v50, v50, v40
v_sub_f32 v52, v52, v40
v_sub_f32 v54, v54, v40
v_mul_f32 v42, v48, v48
v_fmac_f32 v42, v50, v50
v_fmac_f32 v42, v52, v52
v_fmac_f32 v42, v54, v54
v_fmac_f32 v41, 0x43000000, v42
v_mov_b32 v42, 0x3727c5ac
v_fmac_f32 v42, 0x3b000000, v41
v_rsq_f32 v42, v42
v_sub_f32 v44, v32, v40
v_sub_f32 v45, v33, v40
v_sub_f32 v46, v34, v40
v_sub_f32 v47, v35, v40
v_mul_f32 v44, v44, v42
v_mul_f32 v45, v45, v42
v_mul_f32 v46, v46, v42
v_mul_f32 v47, v47, v42
v_cvt_pk_bf16_f32 v44, v44, v45
v_cvt_pk_bf16_f32 v45, v46, v47
s_sub_u32 s55, s70, s82
s_lshl_b32 s56, s50, 10
s_add_u32 s55, s55, s56
s_add_u32 s55, s55, 0x5400000
buffer_store_dwordx2 v[44:45], v13, s[44:47], s55 offen sc1
v_mov_b32 v38, s73
s_waitcnt vmcnt(0)
s_mov_b64 exec, 1
buffer_store_dword v38, off, s[44:47], s71 offset:512 sc1
s_mov_b64 exec, -1
s_cmp_ge_u32 s50, 22
s_cbranch_scc1 L_b_idle_164
L_bp_165:
s_add_u32 s54, s54, 1
s_cmp_gt_u32 s54, 400000
s_cbranch_scc1 L_end
buffer_load_dword v0, v4, s[44:47], s72 offen offset:512 sc1
s_waitcnt vmcnt(0)
v_cmp_ne_u32 vcc, s73, v0
s_cbranch_vccnz L_bp_165
v_xor_b32 v38, 0, v18
s_add_u32 m0, s82, 0
s_add_u32 s60, s70, 88080384
buffer_load_dwordx4 v38, s[44:47], s60 offen offset:0 sc1 lds
v_xor_b32 v38, 16, v18
s_add_u32 s60, s70, 88080384
buffer_load_dwordx4 v38, s[44:47], s60 offen offset:1024 sc1 lds
v_xor_b32 v38, 32, v18
s_add_u32 s60, s70, 88080384
buffer_load_dwordx4 v38, s[44:47], s60 offen offset:2048 sc1 lds
v_xor_b32 v38, 48, v18
s_add_u32 s60, s70, 88080384
buffer_load_dwordx4 v38, s[44:47], s60 offen offset:3072 sc1 lds
v_xor_b32 v38, 64, v18
s_add_u32 m0, s82, 4096
s_add_u32 s60, s70, 88084480
buffer_load_dwordx4 v38, s[44:47], s60 offen offset:0 sc1 lds
v_xor_b32 v38, 80, v18
s_add_u32 s60, s70, 88084480
buffer_load_dwordx4 v38, s[44:47], s60 offen offset:1024 sc1 lds
v_xor_b32 v38, 96, v18
s_add_u32 s60, s70, 88084480
buffer_load_dwordx4 v38, s[44:47], s60 offen offset:2048 sc1 lds
v_xor_b32 v38, 112, v18
s_add_u32 s60, s70, 88084480
buffer_load_dwordx4 v38, s[44:47], s60 offen offset:3072 sc1 lds
s_waitcnt vmcnt(0)
s_barrier
s_bfe_u32 s55, s76, 0x40000
s_mul_i32 s55, s55, 1
s_add_u32 s55, s55, s61
s_cmp_ge_u32 s55, 64
s_cbranch_scc1 L_b_nd_166
v_cmp_eq_u32 vcc, 0, v178
s_cbranch_vccnz L_b_fs_167
L_b_fb_168:
s_add_u32 m0, s79, 49152
s_add_u32 s60, s62, 0
buffer_load_dwordx4 v1, s[44:47], s60 offen offset:0 sc1 lds
s_add_u32 s60, s62, 0
buffer_load_dwordx4 v1, s[44:47], s60 offen offset:1024 sc1 lds
s_add_u32 s60, s62, 0
buffer_load_dwordx4 v1, s[44:47], s60 offen offset:2048 sc1 lds
s_add_u32 s60, s62, 0
buffer_load_dwordx4 v1, s[44:47], s60 offen offset:3072 sc1 lds
s_add_u32 m0, s79, 53248
s_add_u32 s60, s62, 4096
buffer_load_dwordx4 v1, s[44:47], s60 offen offset:0 sc1 lds
s_add_u32 s60, s62, 4096
buffer_load_dwordx4 v1, s[44:47], s60 offen offset:1024 sc1 lds
s_bfe_u32 s55, s76, 0x40004
s_mul_i32 s55, s55, 786432
s_add_u32 s62, s62, s55
L_b_nd_166:
ds_read_b128 v[40:43], v14 offset:0
ds_read_b128 v[44:47], v15 offset:0
ds_read_b128 v[48:51], v16 offset:0
ds_read_b128 v[52:55], v17 offset:0
ds_read_b128 v[56:59], v14 offset:256
ds_read_b128 v[60:63], v15 offset:256
ds_read_b128 v[64:67], v16 offset:256
s_waitcnt lgkmcnt(6)
v_mfma_f32_16x16x32_bf16 v[72:75], a[128:131], v[40:43], 0
v_mfma_f32_16x16x32_bf16 v[76:79], a[192:195], v[40:43], 0
ds_read_b128 v[68:71], v17 offset:256
s_waitcnt lgkmcnt(6)
v_mfma_f32_16x16x32_bf16 v[80:83], a[132:135], v[44:47], 0
v_mfma_f32_16x16x32_bf16 v[84:87], a[196:199], v[44:47], 0
ds_read_b128 v[40:43], v14 offset:512
s_waitcnt lgkmcnt(6)
v_mfma_f32_16x16x32_bf16 v[72:75], a[136:139], v[48:51], v[72:75]
v_mfma_f32_16x16x32_bf16 v[76:79], a[200:203], v[48:51], v[76:79]
ds_read_b128 v[44:47], v15 offset:512
s_waitcnt lgkmcnt(6)
v_mfma_f32_16x16x32_bf16 v[80:83], a[140:143], v[52:55], v[80:83]
v_mfma_f32_16x16x32_bf16 v[84:87], a[204:207], v[52:55], v[84:87]
ds_read_b128 v[48:51], v16 offset:512
s_waitcnt lgkmcnt(6)
v_mfma_f32_16x16x32_bf16 v[72:75], a[144:147], v[56:59], v[72:75]
v_mfma_f32_16x16x32_bf16 v[76:79], a[208:211], v[56:59], v[76:79]
ds_read_b128 v[52:55], v17 offset:512
s_waitcnt lgkmcnt(6)
v_mfma_f32_16x16x32_bf16 v[80:83], a[148:151], v[60:63], v[80:83]
v_mfma_f32_16x16x32_bf16 v[84:87], a[212:215], v[60:63], v[84:87]
ds_read_b128 v[56:59], v14 offset:768
s_waitcnt lgkmcnt(6)
v_mfma_f32_16x16x32_bf16 v[72:75], a[152:155], v[64:67], v[72:75]
v_mfma_f32_16x16x32_bf16 v[76:79], a[216:219], v[64:67], v[76:79]
ds_read_b128 v[60:63], v15 offset:768
s_waitcnt lgkmcnt(6)
v_mfma_f32_16x16x32_bf16 v[80:83], a[156:159], v[68:71], v[80:83]
v_mfma_f32_16x16x32_bf16 v[84:87], a[220:223], v[68:71], v[84:87]
ds_read_b128 v[64:67], v16 offset:768
s_waitcnt lgkmcnt(6)
v_mfma_f32_16x16x32_bf16 v[72:75], a[160:163], v[40:43], v[72:75]
v_mfma_f32_16x16x32_bf16 v[76:79], a[224:227], v[40:43], v[76:79]
ds_read_b128 v[68:71], v17 offset:768
s_waitcnt lgkmcnt(6)
v_mfma_f32_16x16x32_bf16 v[80:83], a[164:167], v[44:47], v[80:83]
v_mfma_f32_16x16x32_bf16 v[84:87], a[228:231], v[44:47], v[84:87]
s_waitcnt lgkmcnt(5)
v_mfma_f32_16x16x32_bf16 v[72:75], a[168:171], v[48:51], v[72:75]
v_mfma_f32_16x16x32_bf16 v[76:79], a[232:235], v[48:51], v[76:79]
s_waitcnt lgkmcnt(4)
v_mfma_f32_16x16x32_bf16 v[80:83], a[172:175], v[52:55], v[80:83]
v_mfma_f32_16x16x32_bf16 v[84:87], a[236:239], v[52:55], v[84:87]
s_waitcnt lgkmcnt(3)
v_mfma_f32_16x16x32_bf16 v[72:75], a[176:179], v[56:59], v[72:75]
v_mfma_f32_16x16x32_bf16 v[76:79], a[240:243], v[56:59], v[76:79]
s_waitcnt lgkmcnt(2)
v_mfma_f32_16x16x32_bf16 v[80:83], a[180:183], v[60:63], v[80:83]
v_mfma_f32_16x16x32_bf16 v[84:87], a[244:247], v[60:63], v[84:87]
s_waitcnt lgkmcnt(1)
v_mfma_f32_16x16x32_bf16 v[72:75], a[184:187], v[64:67], v[72:75]
v_mfma_f32_16x16x32_bf16 v[76:79], a[248:251], v[64:67], v[76:79]
s_waitcnt lgkmcnt(0)
v_mfma_f32_16x16x32_bf16 v[80:83], a[188:191], v[68:71], v[80:83]
v_mfma_f32_16x16x32_bf16 v[84:87], a[252:255], v[68:71], v[84:87]
s_nop 6
v_add_f32 v72, v72, v80
v_add_f32 v73, v73, v81
v_add_f32 v74, v74, v82
v_add_f32 v75, v75, v83
v_add_f32 v76, v76, v84
v_add_f32 v77, v77, v85
v_add_f32 v78, v78, v86
v_add_f32 v79, v79, v87
v_max_f32 v72, 0, v72
v_max_f32 v73, 0, v73
v_max_f32 v74, 0, v74
v_max_f32 v75, 0, v75
v_max_f32 v76, 0, v76
v_max_f32 v77, 0, v77
v_max_f32 v78, 0, v78
v_max_f32 v79, 0, v79
v_cvt_pk_bf16_f32 v72, v72, v73
v_cvt_pk_bf16_f32 v73, v74, v75
v_cvt_pk_bf16_f32 v74, v76, v77
v_cvt_pk_bf16_f32 v75, v78, v79
ds_write_b128 v19, v[72:75]
s_waitcnt lgkmcnt(0)
s_barrier
ds_read_b128 v[40:43], v1 offset:45056
ds_read_b128 v[48:51], v1 offset:46080
ds_read_b128 v[44:47], v1 offset:47104
ds_read_b128 v[52:55], v1 offset:48128
s_add_u32 s56, s66, 32768
s_add_u32 s57, s66, 65536
s_add_u32 s58, s66, 98304
s_waitcnt lgkmcnt(3)
v_mfma_f32_16x16x32_bf16 v[72:75], v[40:43], v[192:195], 0
v_mfma_f32_16x16x32_bf16 v[76:79], v[40:43], v[200:203], 0
v_mfma_f32_16x16x32_bf16 v[80:83], v[40:43], v[208:211], 0
v_mfma_f32_16x16x32_bf16 v[84:87], v[40:43], v[216:219], 0
v_mfma_f32_16x16x32_bf16 v[88:91], v[40:43], v[224:227], 0
v_mfma_f32_16x16x32_bf16 v[92:95], v[40:43], v[232:235], 0
v_mfma_f32_16x16x32_bf16 v[96:99], v[40:43], v[240:243], 0
v_mfma_f32_16x16x32_bf16 v[100:103], v[40:43], v[248:251], 0
s_waitcnt lgkmcnt(2)
v_mfma_f32_16x16x32_bf16 v[72:75], v[48:51], v[196:199], v[72:75]
v_mfma_f32_16x16x32_bf16 v[76:79], v[48:51], v[204:207], v[76:79]
v_mfma_f32_16x16x32_bf16 v[80:83], v[48:51], v[212:215], v[80:83]
v_mfma_f32_16x16x32_bf16 v[84:87], v[48:51], v[220:223], v[84:87]
v_mfma_f32_16x16x32_bf16 v[88:91], v[48:51], v[228:231], v[88:91]
v_mfma_f32_16x16x32_bf16 v[92:95], v[48:51], v[236:239], v[92:95]
v_mfma_f32_16x16x32_bf16 v[96:99], v[48:51], v[244:247], v[96:99]
v_mfma_f32_16x16x32_bf16 v[100:103], v[48:51], v[252:255], v[100:103]
s_waitcnt lgkmcnt(0)
v_mfma_f32_16x16x32_bf16 v[104:107], v[44:47], v[192:195], 0
v_mfma_f32_16x16x32_bf16 v[104:107], v[52:55], v[196:199], v[104:107]
v_cvt_pk_bf16_f32 v136, v72, v76
v_cvt_pk_bf16_f32 v137, v80, v84
v_mfma_f32_16x16x32_bf16 v[108:111], v[44:47], v[200:203], 0
v_cvt_pk_bf16_f32 v138, v88, v92
v_cvt_pk_bf16_f32 v139, v96, v100
v_mfma_f32_16x16x32_bf16 v[108:111], v[52:55], v[204:207], v[108:111]
v_and_b32 v136, -2, v136
buffer_store_dwordx4 v[136:139], v9, s[44:47], s66 offen sc1
v_cvt_pk_bf16_f32 v140, v73, v77
v_mfma_f32_16x16x32_bf16 v[112:115], v[44:47], v[208:211], 0
v_cvt_pk_bf16_f32 v141, v81, v85
v_cvt_pk_bf16_f32 v142, v89, v93
v_mfma_f32_16x16x32_bf16 v[112:115], v[52:55], v[212:215], v[112:115]
v_cvt_pk_bf16_f32 v143, v97, v101
v_and_b32 v140, -2, v140
buffer_store_dwordx4 v[140:143], v9, s[44:47], s56 offen sc1
v_mfma_f32_16x16x32_bf16 v[116:119], v[44:47], v[216:219], 0
v_cvt_pk_bf16_f32 v144, v74, v78
v_cvt_pk_bf16_f32 v145, v82, v86
v_mfma_f32_16x16x32_bf16 v[116:119], v[52:55], v[220:223], v[116:119]
v_cvt_pk_bf16_f32 v146, v90, v94
v_cvt_pk_bf16_f32 v147, v98, v102
v_mfma_f32_16x16x32_bf16 v[120:123], v[44:47], v[224:227], 0
v_and_b32 v144, -2, v144
buffer_store_dwordx4 v[144:147], v9, s[44:47], s57 offen sc1
v_cvt_pk_bf16_f32 v148, v75, v79
v_mfma_f32_16x16x32_bf16 v[120:123], v[52:55], v[228:231], v[120:123]
v_cvt_pk_bf16_f32 v149, v83, v87
v_cvt_pk_bf16_f32 v150, v91, v95
v_mfma_f32_16x16x32_bf16 v[124:127], v[44:47], v[232:235], 0
v_cvt_pk_bf16_f32 v151, v99, v103
v_and_b32 v148, -2, v148
buffer_store_dwordx4 v[148:151], v9, s[44:47], s58 offen sc1
s_add_u32 s59, s66, 524288
s_add_u32 s56, s66, 557056
s_add_u32 s57, s66, 589824
s_add_u32 s58, s66, 622592
v_mfma_f32_16x16x32_bf16 v[124:127], v[52:55], v[236:239], v[124:127]
v_cvt_pk_bf16_f32 v72, v104, v108
v_cvt_pk_bf16_f32 v76, v105, v109
v_mfma_f32_16x16x32_bf16 v[128:131], v[44:47], v[240:243], 0
v_cvt_pk_bf16_f32 v80, v106, v110
v_cvt_pk_bf16_f32 v84, v107, v111
v_mfma_f32_16x16x32_bf16 v[128:131], v[52:55], v[244:247], v[128:131]
v_and_b32 v72, -2, v72
v_and_b32 v76, -2, v76
v_mfma_f32_16x16x32_bf16 v[132:135], v[44:47], v[248:251], 0
v_and_b32 v80, -2, v80
v_and_b32 v84, -2, v84
v_mfma_f32_16x16x32_bf16 v[132:135], v[52:55], v[252:255], v[132:135]
v_cvt_pk_bf16_f32 v73, v112, v116
v_cvt_pk_bf16_f32 v77, v113, v117
v_cvt_pk_bf16_f32 v81, v114, v118
v_cvt_pk_bf16_f32 v85, v115, v119
v_cvt_pk_bf16_f32 v74, v120, v124
v_cvt_pk_bf16_f32 v78, v121, v125
v_cvt_pk_bf16_f32 v82, v122, v126
v_cvt_pk_bf16_f32 v86, v123, v127
v_cvt_pk_bf16_f32 v75, v128, v132
buffer_store_dwordx4 v[72:75], v9, s[44:47], s59 offen sc1
v_cvt_pk_bf16_f32 v79, v129, v133
buffer_store_dwordx4 v[76:79], v9, s[44:47], s56 offen sc1
v_cvt_pk_bf16_f32 v83, v130, v134
buffer_store_dwordx4 v[80:83], v9, s[44:47], s57 offen sc1
v_cvt_pk_bf16_f32 v87, v131, v135
buffer_store_dwordx4 v[84:87], v9, s[44:47], s58 offen sc1
L_b_nf_163:
s_bfe_u32 s55, s76, 0x40000
s_mul_i32 s55, s55, 4096
s_add_u32 s83, s83, s55
s_sub_u32 s83, s83, s78
s_lshl_b32 s55, s78, 5
s_sub_u32 s63, s63, s55
s_mov_b32 s78, 0
buffer_load_dwordx4 v[40:43], v10, s[44:47], s68 offen sc1
s_add_u32 s56, s68, 4096
buffer_load_dwordx4 v[44:47], v10, s[44:47], s56 offen sc1
s_add_u32 s56, s68, 8192
buffer_load_dwordx4 v[48:51], v10, s[44:47], s56 offen sc1
s_add_u32 s56, s68, 12288
buffer_load_dwordx4 v[52:55], v10, s[44:47], s56 offen sc1
s_add_u32 s56, s68, 16384
buffer_load_dwordx4 v[56:59], v10, s[44:47], s56 offen sc1
s_add_u32 s56, s68, 20480
buffer_load_dwordx4 v[60:63], v11, s[44:47], s56 offen sc1
s_bfe_u32 s55, s76, 0x40004
s_mul_i32 s55, s55, 4096
s_add_u32 s64, s64, s55
buffer_load_dword v179, off, s[44:47], s83 sc1
buffer_load_dword v178, off, s[44:47], s64 sc1
L_b_ck_169:
s_waitcnt vmcnt(7)
v_mfma_f32_16x16x32_bf16 v[80:83], v[40:43], v[28:31], 0
s_waitcnt vmcnt(6)
v_mfma_f32_16x16x32_bf16 v[84:87], v[44:47], v[28:31], 0
v_or_b32 v72, v40, v44
s_waitcnt vmcnt(5)
v_mfma_f32_16x16x32_bf16 v[80:83], v[48:51], v[28:31], v[80:83]
s_waitcnt vmcnt(4)
v_mfma_f32_16x16x32_bf16 v[84:87], v[52:55], v[28:31], v[84:87]
v_or3_b32 v72, v72, v48, v52
s_waitcnt vmcnt(3)
v_mfma_f32_16x16x32_bf16 v[80:83], v[56:59], v[28:31], v[80:83]
s_waitcnt vmcnt(2)
v_mfma_f32_16x16x32_bf16 v[84:87], v[60:63], v[28:31], v[84:87]
v_or3_b32 v72, v72, v56, v60
v_and_b32 v72, 1, v72
v_cmp_ne_u32 vcc, 0, v72
s_cbranch_vccnz L_b_rt_170
L_b_bk_171:
v_mov_b32 v38, s73
s_mov_b64 exec, 1
buffer_store_dword v38, off, s[44:47], s71 offset:1536 sc1
s_mov_b64 exec, -1
s_bfe_u32 s55, s76, 0x40000
s_mul_i32 s55, s55, 1
s_lshr_b64 s[76:77], s[76:77], 4
s_add_u32 s61, s61, s55
s_lshl_b32 s56, s55, 17
s_add_u32 s63, s63, s56
s_lshl_b32 s55, s55, 15
s_add_u32 s73, s73, 1
v_add_f32 v32, v32, v80
v_add_f32 v33, v33, v81
v_add_f32 v34, v34, v82
v_add_f32 v35, v35, v83
v_add_f32 v32, v32, v84
v_add_f32 v33, v33, v85
v_add_f32 v34, v34, v86
v_add_f32 v35, v35, v87
v_cvt_pk_bf16_f32 v44, v32, v33
v_cvt_pk_bf16_f32 v45, v34, v35
buffer_store_dwordx2 v[44:45], v13, s[36:39], s69 offen sc1
s_add_u32 s69, s69, s55
s_cmp_lt_u32 s61, 64
s_cbranch_scc1 L_b_loop_i
s_branch L_end
L_b_kp_155:
s_lshl_b32 s55, s48, 10
s_add_u32 s55, s55, s63
buffer_load_dwordx4 v[104:107], v1, s[44:47], s55 offen sc1
L_b_kq_156:
s_waitcnt vmcnt(0)
v_max3_u32 v164, v104, v105, v106
v_max_u32 v164, v164, v107
v_cmp_eq_u32 vcc, -1, v164
s_cbranch_vccz L_b_hk_154
s_mov_b64 exec, vcc
buffer_load_dwordx4 v[104:107], v1, s[44:47], s55 offen sc1
s_mov_b64 exec, -1
s_add_u32 s54, s54, 1
s_cmp_gt_u32 s54, 400000
s_cbranch_scc1 L_end
s_branch L_b_kq_156
L_b_3s_158:
s_add_u32 s54, s54, 1
s_cmp_gt_u32 s54, 400000
s_cbranch_scc1 L_end
buffer_load_dword v179, v3, s[44:47], s72 offen offset:1536 sc1
s_branch L_b_3b_159
L_b_rt_161:
s_mov_b64 exec, vcc
buffer_load_dwordx4 v[40:43], v10, s[44:47], s67 offen sc1
s_add_u32 s56, s67, 4096
buffer_load_dwordx4 v[44:47], v10, s[44:47], s56 offen sc1
s_add_u32 s56, s67, 8192
buffer_load_dwordx4 v[48:51], v10, s[44:47], s56 offen sc1
s_add_u32 s56, s67, 12288
buffer_load_dwordx4 v[52:55], v10, s[44:47], s56 offen sc1
s_add_u32 s56, s67, 16384
buffer_load_dwordx4 v[56:59], v10, s[44:47], s56 offen sc1
s_add_u32 s56, s67, 20480
buffer_load_dwordx4 v[60:63], v10, s[44:47], s56 offen sc1
s_add_u32 s56, s67, 24576
buffer_load_dwordx4 v[64:67], v10, s[44:47], s56 offen sc1
s_add_u32 s56, s67, 28672
buffer_load_dwordx4 v[68:71], v10, s[44:47], s56 offen sc1
s_mov_b64 exec, -1
s_add_u32 s54, s54, 1
s_cmp_gt_u32 s54, 400000
s_cbranch_scc1 L_end
s_waitcnt vmcnt(7)
v_xor_b32 v72, s60, v40
s_waitcnt vmcnt(6)
v_bitop3_b32 v72, v72, v44, s60 bitop3:0xf6
s_waitcnt vmcnt(5)
v_bitop3_b32 v72, v72, v48, s60 bitop3:0xf6
s_waitcnt vmcnt(4)
v_bitop3_b32 v72, v72, v52, s60 bitop3:0xf6
s_waitcnt vmcnt(3)
v_bitop3_b32 v72, v72, v56, s60 bitop3:0xf6
s_waitcnt vmcnt(2)
v_bitop3_b32 v72, v72, v60, s60 bitop3:0xf6
s_waitcnt vmcnt(1)
v_bitop3_b32 v72, v72, v64, s60 bitop3:0xf6
s_waitcnt vmcnt(0)
v_bitop3_b32 v72, v72, v68, s60 bitop3:0xf6
v_and_b32 v72, v180, v72
v_cmp_ne_u32 vcc, 0, v72
s_cbranch_vccnz L_b_rt_161
v_mfma_f32_16x16x32_bf16 v[80:83], v[40:43], v[28:31], 0
v_mfma_f32_16x16x32_bf16 v[84:87], v[44:47], v[28:31], 0
v_mfma_f32_16x16x32_bf16 v[80:83], v[48:51], v[28:31], v[80:83]
v_mfma_f32_16x16x32_bf16 v[84:87], v[52:55], v[28:31], v[84:87]
v_mfma_f32_16x16x32_bf16 v[80:83], v[56:59], v[28:31], v[80:83]
v_mfma_f32_16x16x32_bf16 v[84:87], v[60:63], v[28:31], v[84:87]
v_mfma_f32_16x16x32_bf16 v[80:83], v[64:67], v[28:31], v[80:83]
v_mfma_f32_16x16x32_bf16 v[84:87], v[68:71], v[28:31], v[84:87]
s_nop 7
s_branch L_b_bk_162
L_b_idle_164:
s_bfe_u32 s55, s76, 0x40000
s_mul_i32 s55, s55, 1
s_add_u32 s55, s55, s61
s_cmp_ge_u32 s55, 64
s_cbranch_scc1 L_b_nd_172
v_cmp_eq_u32 vcc, 0, v178
s_cbranch_vccnz L_b_fs_173
L_b_fb_174:
s_add_u32 m0, s79, 49152
s_add_u32 s60, s62, 0
buffer_load_dwordx4 v1, s[44:47], s60 offen offset:0 sc1 lds
s_add_u32 s60, s62, 0
buffer_load_dwordx4 v1, s[44:47], s60 offen offset:1024 sc1 lds
s_add_u32 s60, s62, 0
buffer_load_dwordx4 v1, s[44:47], s60 offen offset:2048 sc1 lds
s_add_u32 s60, s62, 0
buffer_load_dwordx4 v1, s[44:47], s60 offen offset:3072 sc1 lds
s_add_u32 m0, s79, 53248
s_add_u32 s60, s62, 4096
buffer_load_dwordx4 v1, s[44:47], s60 offen offset:0 sc1 lds
s_add_u32 s60, s62, 4096
buffer_load_dwordx4 v1, s[44:47], s60 offen offset:1024 sc1 lds
s_bfe_u32 s55, s76, 0x40004
s_mul_i32 s55, s55, 786432
s_add_u32 s62, s62, s55
L_b_nd_172:
L_b_il_175:
s_add_u32 s54, s54, 1
s_cmp_gt_u32 s54, 400000
s_cbranch_scc1 L_end
buffer_load_dword v40, v10, s[44:47], s68 offen sc1
s_waitcnt vmcnt(0)
v_and_b32 v40, 1, v40
v_cmp_ne_u32 vcc, 0, v40
s_cbranch_vccnz L_b_il_175
s_branch L_b_nf_163
L_b_fs_167:
L_bp_176:
s_add_u32 s54, s54, 1
s_cmp_gt_u32 s54, 400000
s_cbranch_scc1 L_end
buffer_load_dword v0, off, s[44:47], s64 offset:0 sc1
s_waitcnt vmcnt(0)
v_cmp_eq_u32 vcc, 0, v0
s_cbranch_vccnz L_bp_176
s_branch L_b_fb_168
L_b_rt_170:
s_mov_b64 exec, vcc
buffer_load_dwordx4 v[40:43], v10, s[44:47], s68 offen sc1
s_add_u32 s56, s68, 4096
buffer_load_dwordx4 v[44:47], v10, s[44:47], s56 offen sc1
s_add_u32 s56, s68, 8192
buffer_load_dwordx4 v[48:51], v10, s[44:47], s56 offen sc1
s_add_u32 s56, s68, 12288
buffer_load_dwordx4 v[52:55], v10, s[44:47], s56 offen sc1
s_add_u32 s56, s68, 16384
buffer_load_dwordx4 v[56:59], v10, s[44:47], s56 offen sc1
s_add_u32 s56, s68, 20480
buffer_load_dwordx4 v[60:63], v11, s[44:47], s56 offen sc1
s_mov_b64 exec, -1
s_add_u32 s54, s54, 1
s_cmp_gt_u32 s54, 400000
s_cbranch_scc1 L_end
s_waitcnt vmcnt(4)
v_or_b32 v72, v40, v44
s_waitcnt vmcnt(2)
v_or3_b32 v72, v72, v48, v52
s_waitcnt vmcnt(0)
v_or3_b32 v72, v72, v56, v60
v_and_b32 v72, 1, v72
v_cmp_ne_u32 vcc, 0, v72
s_cbranch_vccnz L_b_rt_170
v_mfma_f32_16x16x32_bf16 v[80:83], v[40:43], v[28:31], 0
v_mfma_f32_16x16x32_bf16 v[84:87], v[44:47], v[28:31], 0
v_mfma_f32_16x16x32_bf16 v[80:83], v[48:51], v[28:31], v[80:83]
v_mfma_f32_16x16x32_bf16 v[84:87], v[52:55], v[28:31], v[84:87]
v_mfma_f32_16x16x32_bf16 v[80:83], v[56:59], v[28:31], v[80:83]
v_mfma_f32_16x16x32_bf16 v[84:87], v[60:63], v[28:31], v[84:87]
s_nop 7
s_branch L_b_bk_171
L_b_fs_173:
L_bp_177:
s_add_u32 s54, s54, 1
s_cmp_gt_u32 s54, 400000
s_cbranch_scc1 L_end
buffer_load_dword v0, off, s[44:47], s64 offset:0 sc1
s_waitcnt vmcnt(0)
v_cmp_eq_u32 vcc, 0, v0
s_cbranch_vccnz L_bp_177
s_branch L_b_fb_174
L_x_i0:
s_waitcnt lgkmcnt(0)
v_mfma_f32_16x16x32_bf16 v[80:83], v[188:191], v[152:155], 0
v_mfma_f32_16x16x32_bf16 v[84:87], v[196:199], v[152:155], 0
v_mfma_f32_16x16x32_bf16 v[88:91], v[152:155], v[152:155], 0
v_mfma_f32_16x16x32_bf16 v[80:83], v[192:195], v[156:159], v[80:83]
v_mfma_f32_16x16x32_bf16 v[84:87], v[200:203], v[156:159], v[84:87]
v_mfma_f32_16x16x32_bf16 v[88:91], v[156:159], v[156:159], v[88:91]
v_or_b32 v80, 1, v80
buffer_store_dwordx4 v[80:83], v221, s[44:47], s67 offen offset:0 sc1
s_nop 0
v_or_b32 v84, 1, v84
buffer_store_dwordx4 v[84:87], v221, s[44:47], s67 offen offset:512 sc1
s_nop 2
v_or_b32 v90, 1, v90
buffer_store_dwordx2 v[90:91], v221, s[44:47], s67 offen offset:1024 sc1
s_waitcnt vmcnt(0)
buffer_load_dwordx4 v[112:115], v1, s[44:47], s74 offen sc1
L_x_q_179:
s_waitcnt vmcnt(0)
v_bitop3_b32 v124, v112, v114, 1 bitop3:0x80
v_cmp_eq_u32 vcc, 0, v124
s_cbranch_vccz L_x_r_180
s_mov_b64 exec, vcc
buffer_load_dwordx4 v[112:115], v1, s[44:47], s74 offen sc1
s_mov_b64 exec, -1
s_add_u32 s54, s54, 1
s_cmp_gt_u32 s54, 400000
s_cbranch_scc1 L_end
s_branch L_x_q_179
L_x_r_180:
v_mfma_f32_16x16x32_bf16 v[120:123], v[204:207], v[112:115], 0
s_nop 7
v_add_f32_dpp v120, v120, v120 row_ror:4 row_mask:0xf bank_mask:0xf
v_add_f32_dpp v121, v121, v121 row_ror:4 row_mask:0xf bank_mask:0xf
v_add_f32_dpp v122, v122, v122 row_ror:4 row_mask:0xf bank_mask:0xf
v_add_f32_dpp v123, v123, v123 row_ror:4 row_mask:0xf bank_mask:0xf
v_add_f32_dpp v120, v120, v120 row_ror:8 row_mask:0xf bank_mask:0xf
v_add_f32_dpp v121, v121, v121 row_ror:8 row_mask:0xf bank_mask:0xf
v_add_f32_dpp v122, v122, v122 row_ror:8 row_mask:0xf bank_mask:0xf
v_add_f32_dpp v123, v123, v123 row_ror:8 row_mask:0xf bank_mask:0xf
v_min_u32 v120, -2, v120
v_min_u32 v121, -2, v121
v_min_u32 v122, -2, v122
v_min_u32 v123, -2, v123
buffer_store_dwordx4 v[120:123], v224, s[44:47], s72 offen offset:0 sc1
v_mfma_f32_16x16x32_bf16 v[80:83], a[0:3], v[36:39], 0
v_mfma_f32_16x16x32_bf16 v[80:83], a[4:7], v[40:43], v[80:83]
v_mfma_f32_16x16x32_bf16 v[80:83], a[8:11], v[44:47], v[80:83]
v_mfma_f32_16x16x32_bf16 v[80:83], a[12:15], v[48:51], v[80:83]
v_mfma_f32_16x16x32_bf16 v[84:87], a[16:19], v[36:39], 0
v_mfma_f32_16x16x32_bf16 v[84:87], a[20:23], v[40:43], v[84:87]
v_mfma_f32_16x16x32_bf16 v[84:87], a[24:27], v[44:47], v[84:87]
v_mfma_f32_16x16x32_bf16 v[84:87], a[28:31], v[48:51], v[84:87]
v_mfma_f32_16x16x32_bf16 v[88:91], a[32:35], v[36:39], 0
v_mfma_f32_16x16x32_bf16 v[88:91], a[36:39], v[40:43], v[88:91]
ds_write_b128 v227, v[80:83] offset:0
v_mfma_f32_16x16x32_bf16 v[88:91], a[40:43], v[44:47], v[88:91]
v_mfma_f32_16x16x32_bf16 v[88:91], a[44:47], v[48:51], v[88:91]
v_mfma_f32_16x16x32_bf16 v[92:95], a[48:51], v[36:39], 0
v_mfma_f32_16x16x32_bf16 v[92:95], a[52:55], v[40:43], v[92:95]
ds_write_b128 v227, v[84:87] offset:1024
v_mfma_f32_16x16x32_bf16 v[92:95], a[56:59], v[44:47], v[92:95]
v_mfma_f32_16x16x32_bf16 v[92:95], a[60:63], v[48:51], v[92:95]
v_mfma_f32_16x16x32_bf16 v[96:99], a[0:3], v[52:55], 0
v_mfma_f32_16x16x32_bf16 v[96:99], a[4:7], v[56:59], v[96:99]
ds_write_b128 v227, v[88:91] offset:2048
v_mfma_f32_16x16x32_bf16 v[96:99], a[8:11], v[60:63], v[96:99]
v_mfma_f32_16x16x32_bf16 v[96:99], a[12:15], v[236:239], v[96:99]
v_mfma_f32_16x16x32_bf16 v[100:103], a[16:19], v[52:55], 0
v_mfma_f32_16x16x32_bf16 v[100:103], a[20:23], v[56:59], v[100:103]
ds_write_b128 v227, v[92:95] offset:3072
v_mfma_f32_16x16x32_bf16 v[100:103], a[24:27], v[60:63], v[100:103]
v_mfma_f32_16x16x32_bf16 v[100:103], a[28:31], v[236:239], v[100:103]
v_mfma_f32_16x16x32_bf16 v[104:107], a[32:35], v[52:55], 0
v_mfma_f32_16x16x32_bf16 v[104:107], a[36:39], v[56:59], v[104:107]
ds_write_b128 v227, v[96:99] offset:4096
v_mfma_f32_16x16x32_bf16 v[104:107], a[40:43], v[60:63], v[104:107]
v_mfma_f32_16x16x32_bf16 v[104:107], a[44:47], v[236:239], v[104:107]
v_mfma_f32_16x16x32_bf16 v[108:111], a[48:51], v[52:55], 0
v_mfma_f32_16x16x32_bf16 v[108:111], a[52:55], v[56:59], v[108:111]
ds_write_b128 v227, v[100:103] offset:5120
v_mfma_f32_16x16x32_bf16 v[108:111], a[56:59], v[60:63], v[108:111]
v_mfma_f32_16x16x32_bf16 v[108:111], a[60:63], v[236:239], v[108:111]
ds_write_b128 v227, v[104:107] offset:6144
s_nop 6
ds_write_b128 v227, v[108:111] offset:7168
s_waitcnt lgkmcnt(0)
s_barrier
ds_read_b128 v[112:115], v228 offset:0
ds_read_b128 v[116:119], v228 offset:32768
ds_read_b128 v[120:123], v229 offset:0
ds_read_b128 v[124:127], v229 offset:32768
ds_read_b128 v[128:131], v228 offset:1024
ds_read_b128 v[132:135], v228 offset:33792
ds_read_b128 v[136:139], v229 offset:1024
ds_read_b128 v[140:143], v229 offset:33792
s_waitcnt lgkmcnt(6)
v_pk_add_f32 v[112:113], v[112:113], v[116:117]
v_pk_add_f32 v[114:115], v[114:115], v[118:119]
s_waitcnt lgkmcnt(4)
v_pk_add_f32 v[120:121], v[120:121], v[124:125]
v_pk_add_f32 v[122:123], v[122:123], v[126:127]
v_pk_add_f32 v[112:113], v[112:113], v[120:121]
v_pk_add_f32 v[114:115], v[114:115], v[122:123]
v_cvt_pk_bf16_f32 v180, v112, v113
v_cvt_pk_bf16_f32 v181, v114, v115
s_waitcnt lgkmcnt(2)
v_pk_add_f32 v[128:129], v[128:129], v[132:133]
v_pk_add_f32 v[130:131], v[130:131], v[134:135]
s_waitcnt lgkmcnt(0)
v_pk_add_f32 v[136:137], v[136:137], v[140:141]
v_pk_add_f32 v[138:139], v[138:139], v[142:143]
v_pk_add_f32 v[128:129], v[128:129], v[136:137]
v_pk_add_f32 v[130:131], v[130:131], v[138:139]
v_cvt_pk_bf16_f32 v182, v128, v129
v_cvt_pk_bf16_f32 v183, v130, v131
ds_write_b128 v233, v[180:183] offset:4096
s_waitcnt lgkmcnt(0)
s_barrier
v_add_u32 v231, 0x10000, v230
ds_read_b128 v[188:191], v231 offset:4096
ds_read_b128 v[192:195], v231 offset:5120
ds_read_b128 v[196:199], v231 offset:6144
ds_read_b128 v[200:203], v231 offset:7168
buffer_load_dwordx4 v[144:147], v225, s[44:47], s71 offen offset:0 sc1
L_x_q_182:
s_waitcnt vmcnt(0)
v_cmp_eq_u32 vcc, -1, v144
s_cbranch_vccz L_x_r_183
s_mov_b64 exec, vcc
buffer_load_dwordx4 v[144:147], v225, s[44:47], s71 offen offset:0 sc1
s_mov_b64 exec, -1
s_add_u32 s54, s54, 1
s_cmp_gt_u32 s54, 400000
s_cbranch_scc1 L_end
s_branch L_x_q_182
L_x_r_183:
v_add_f32_dpp v144, v144, v144 row_ror:4 row_mask:0xf bank_mask:0xf
v_add_f32_dpp v145, v145, v145 row_ror:4 row_mask:0xf bank_mask:0xf
v_add_f32_dpp v146, v146, v146 row_ror:4 row_mask:0xf bank_mask:0xf
v_add_f32_dpp v147, v147, v147 row_ror:4 row_mask:0xf bank_mask:0xf
v_add_f32_dpp v144, v144, v144 row_ror:8 row_mask:0xf bank_mask:0xf
v_add_f32_dpp v145, v145, v145 row_ror:8 row_mask:0xf bank_mask:0xf
v_add_f32_dpp v146, v146, v146 row_ror:8 row_mask:0xf bank_mask:0xf
v_add_f32_dpp v147, v147, v147 row_ror:8 row_mask:0xf bank_mask:0xf
v_cvt_pk_bf16_f32 v144, v144, v145
v_cvt_pk_bf16_f32 v145, v146, v147
v_min_u32 v144, -2, v144
buffer_store_dwordx2 v[144:145], v226, s[44:47], s75 offen offset:0 sc1
s_add_u32 s56, s70, 24576
s_add_u32 s57, s70, 49152
s_add_u32 s58, s70, 73728
s_waitcnt vmcnt(0)
buffer_load_dwordx4 v[64:67], v219, s[44:47], s70 offen offset:0 sc1
buffer_load_dwordx4 v[68:71], v219, s[44:47], s56 offen offset:0 sc1
buffer_load_dwordx4 v[72:75], v219, s[44:47], s57 offen offset:0 sc1
buffer_load_dwordx4 v[76:79], v219, s[44:47], s58 offen offset:0 sc1
L_x_q_185:
s_waitcnt vmcnt(0)
v_max3_u32 v148, v64, v66, v68
v_max3_u32 v149, v70, v72, v74
v_max3_u32 v148, v148, v76, v78
v_max_u32 v148, v148, v149
v_cmp_eq_u32 vcc, -1, v148
s_cbranch_vccz L_x_r_186
s_mov_b64 exec, vcc
buffer_load_dwordx4 v[64:67], v219, s[44:47], s70 offen offset:0 sc1
buffer_load_dwordx4 v[68:71], v219, s[44:47], s56 offen offset:0 sc1
buffer_load_dwordx4 v[72:75], v219, s[44:47], s57 offen offset:0 sc1
buffer_load_dwordx4 v[76:79], v219, s[44:47], s58 offen offset:0 sc1
s_mov_b64 exec, -1
s_add_u32 s54, s54, 1
s_cmp_gt_u32 s54, 400000
s_cbranch_scc1 L_end
s_branch L_x_q_185
L_x_r_186:
v_mfma_f32_16x16x32_bf16 v[80:83], a[64:67], v[64:67], 0
v_mfma_f32_16x16x32_bf16 v[96:99], a[0:3], v[64:67], 0
v_mfma_f32_16x16x32_bf16 v[80:83], a[68:71], v[68:71], v[80:83]
v_mfma_f32_16x16x32_bf16 v[96:99], a[4:7], v[68:71], v[96:99]
v_mfma_f32_16x16x32_bf16 v[80:83], a[72:75], v[72:75], v[80:83]
v_mfma_f32_16x16x32_bf16 v[96:99], a[8:11], v[72:75], v[96:99]
v_mfma_f32_16x16x32_bf16 v[80:83], a[76:79], v[76:79], v[80:83]
v_mfma_f32_16x16x32_bf16 v[96:99], a[12:15], v[76:79], v[96:99]
v_mfma_f32_16x16x32_bf16 v[84:87], a[80:83], v[64:67], 0
v_mfma_f32_16x16x32_bf16 v[100:103], a[16:19], v[64:67], 0
v_mfma_f32_16x16x32_bf16 v[84:87], a[84:87], v[68:71], v[84:87]
v_mfma_f32_16x16x32_bf16 v[100:103], a[20:23], v[68:71], v[100:103]
v_cndmask_b32 v80, v80, v96, s[78:79]
v_cndmask_b32 v81, v81, v97, s[78:79]
v_cndmask_b32 v82, v82, v98, s[78:79]
v_cndmask_b32 v83, v83, v99, s[78:79]
ds_write_b128 v227, v[80:83] offset:8192
v_mfma_f32_16x16x32_bf16 v[84:87], a[88:91], v[72:75], v[84:87]
v_mfma_f32_16x16x32_bf16 v[100:103], a[24:27], v[72:75], v[100:103]
v_mfma_f32_16x16x32_bf16 v[84:87], a[92:95], v[76:79], v[84:87]
v_mfma_f32_16x16x32_bf16 v[100:103], a[28:31], v[76:79], v[100:103]
v_mfma_f32_16x16x32_bf16 v[88:91], a[96:99], v[64:67], 0
v_mfma_f32_16x16x32_bf16 v[104:107], a[32:35], v[64:67], 0
v_mfma_f32_16x16x32_bf16 v[88:91], a[100:103], v[68:71], v[88:91]
v_mfma_f32_16x16x32_bf16 v[104:107], a[36:39], v[68:71], v[104:107]
v_cndmask_b32 v84, v84, v100, s[78:79]
v_cndmask_b32 v85, v85, v101, s[78:79]
v_cndmask_b32 v86, v86, v102, s[78:79]
v_cndmask_b32 v87, v87, v103, s[78:79]
ds_write_b128 v227, v[84:87] offset:9216
v_mfma_f32_16x16x32_bf16 v[88:91], a[104:107], v[72:75], v[88:91]
v_mfma_f32_16x16x32_bf16 v[104:107], a[40:43], v[72:75], v[104:107]
v_mfma_f32_16x16x32_bf16 v[88:91], a[108:111], v[76:79], v[88:91]
v_mfma_f32_16x16x32_bf16 v[104:107], a[44:47], v[76:79], v[104:107]
v_mfma_f32_16x16x32_bf16 v[92:95], a[112:115], v[64:67], 0
v_mfma_f32_16x16x32_bf16 v[108:111], a[48:51], v[64:67], 0
v_mfma_f32_16x16x32_bf16 v[92:95], a[116:119], v[68:71], v[92:95]
v_mfma_f32_16x16x32_bf16 v[108:111], a[52:55], v[68:71], v[108:111]
v_cndmask_b32 v88, v88, v104, s[78:79]
v_cndmask_b32 v89, v89, v105, s[78:79]
v_cndmask_b32 v90, v90, v106, s[78:79]
v_cndmask_b32 v91, v91, v107, s[78:79]
ds_write_b128 v227, v[88:91] offset:10240
v_mfma_f32_16x16x32_bf16 v[92:95], a[120:123], v[72:75], v[92:95]
v_mfma_f32_16x16x32_bf16 v[108:111], a[56:59], v[72:75], v[108:111]
v_mfma_f32_16x16x32_bf16 v[92:95], a[124:127], v[76:79], v[92:95]
v_mfma_f32_16x16x32_bf16 v[108:111], a[60:63], v[76:79], v[108:111]
s_nop 7
v_cndmask_b32 v92, v92, v108, s[78:79]
v_cndmask_b32 v93, v93, v109, s[78:79]
v_cndmask_b32 v94, v94, v110, s[78:79]
v_cndmask_b32 v95, v95, v111, s[78:79]
ds_write_b128 v227, v[92:95] offset:11264
s_waitcnt lgkmcnt(0)
s_barrier
ds_read_b128 v[80:83], v1 offset:8192
ds_read_b128 v[84:87], v1 offset:40960
ds_read_b128 v[88:91], v230 offset:8192
ds_read_b128 v[92:95], v230 offset:40960
ds_read_b128 v[96:99], v1 offset:9216
ds_read_b128 v[100:103], v1 offset:41984
ds_read_b128 v[104:107], v230 offset:9216
ds_read_b128 v[108:111], v230 offset:41984
ds_read_b128 v[112:115], v1 offset:10240
ds_read_b128 v[116:119], v1 offset:43008
ds_read_b128 v[120:123], v230 offset:10240
ds_read_b128 v[124:127], v230 offset:43008
s_waitcnt lgkmcnt(10)
v_pk_add_f32 v[80:81], v[80:81], v[84:85]
v_pk_add_f32 v[82:83], v[82:83], v[86:87]
s_waitcnt lgkmcnt(8)
ds_read_b128 v[128:131], v1 offset:11264
ds_read_b128 v[132:135], v1 offset:44032
ds_read_b128 v[136:139], v230 offset:11264
ds_read_b128 v[140:143], v230 offset:44032
v_pk_add_f32 v[88:89], v[88:89], v[92:93]
v_pk_add_f32 v[90:91], v[90:91], v[94:95]
v_pk_add_f32 v[80:81], v[80:81], v[88:89]
v_pk_add_f32 v[82:83], v[82:83], v[90:91]
v_cvt_pk_bf16_f32 v160, v80, v81
v_cvt_pk_bf16_f32 v161, v82, v83
s_waitcnt lgkmcnt(10)
v_pk_add_f32 v[96:97], v[96:97], v[100:101]
v_pk_add_f32 v[98:99], v[98:99], v[102:103]
s_waitcnt lgkmcnt(8)
v_pk_add_f32 v[104:105], v[104:105], v[108:109]
v_pk_add_f32 v[106:107], v[106:107], v[110:111]
v_pk_add_f32 v[96:97], v[96:97], v[104:105]
v_pk_add_f32 v[98:99], v[98:99], v[106:107]
v_cvt_pk_bf16_f32 v162, v96, v97
v_cvt_pk_bf16_f32 v163, v98, v99
s_waitcnt lgkmcnt(6)
v_pk_add_f32 v[112:113], v[112:113], v[116:117]
v_pk_add_f32 v[114:115], v[114:115], v[118:119]
s_waitcnt lgkmcnt(4)
v_pk_add_f32 v[120:121], v[120:121], v[124:125]
v_pk_add_f32 v[122:123], v[122:123], v[126:127]
v_pk_add_f32 v[112:113], v[112:113], v[120:121]
v_pk_add_f32 v[114:115], v[114:115], v[122:123]
v_cvt_pk_bf16_f32 v164, v112, v113
v_cvt_pk_bf16_f32 v165, v114, v115
s_waitcnt lgkmcnt(2)
v_pk_add_f32 v[128:129], v[128:129], v[132:133]
v_pk_add_f32 v[130:131], v[130:131], v[134:135]
s_waitcnt lgkmcnt(0)
v_pk_add_f32 v[136:137], v[136:137], v[140:141]
v_pk_add_f32 v[138:139], v[138:139], v[142:143]
v_pk_add_f32 v[128:129], v[128:129], v[136:137]
v_pk_add_f32 v[130:131], v[130:131], v[138:139]
v_cvt_pk_bf16_f32 v166, v128, v129
v_cvt_pk_bf16_f32 v167, v130, v131
s_waitcnt lgkmcnt(0)
v_mfma_f32_16x16x32_bf16 v[80:83], v[188:191], v[160:163], 0
v_mfma_f32_16x16x32_bf16 v[84:87], v[196:199], v[160:163], 0
v_mfma_f32_16x16x32_bf16 v[88:91], v[160:163], v[160:163], 0
v_mfma_f32_16x16x32_bf16 v[80:83], v[192:195], v[164:167], v[80:83]
v_mfma_f32_16x16x32_bf16 v[84:87], v[200:203], v[164:167], v[84:87]
v_mfma_f32_16x16x32_bf16 v[88:91], v[164:167], v[164:167], v[88:91]
v_and_b32 v80, -2, v80
buffer_store_dwordx4 v[80:83], v221, s[44:47], s67 offen offset:0 sc1
s_nop 0
v_and_b32 v84, -2, v84
buffer_store_dwordx4 v[84:87], v221, s[44:47], s67 offen offset:512 sc1
s_nop 2
v_and_b32 v90, -2, v90
buffer_store_dwordx2 v[90:91], v221, s[44:47], s67 offen offset:1024 sc1
s_waitcnt vmcnt(0)
buffer_load_dwordx4 v[112:115], v1, s[44:47], s74 offen sc1
L_x_q_188:
s_waitcnt vmcnt(0)
v_bitop3_b32 v124, v112, v114, 1 bitop3:0xa8
v_cmp_ne_u32 vcc, 0, v124
s_cbranch_vccz L_x_r_189
s_mov_b64 exec, vcc
buffer_load_dwordx4 v[112:115], v1, s[44:47], s74 offen sc1
s_mov_b64 exec, -1
s_add_u32 s54, s54, 1
s_cmp_gt_u32 s54, 400000
s_cbranch_scc1 L_end
s_branch L_x_q_188
L_x_r_189:
v_mfma_f32_16x16x32_bf16 v[120:123], v[204:207], v[112:115], 0
s_nop 7
v_add_f32_dpp v120, v120, v120 row_ror:4 row_mask:0xf bank_mask:0xf
v_add_f32_dpp v121, v121, v121 row_ror:4 row_mask:0xf bank_mask:0xf
v_add_f32_dpp v122, v122, v122 row_ror:4 row_mask:0xf bank_mask:0xf
v_add_f32_dpp v123, v123, v123 row_ror:4 row_mask:0xf bank_mask:0xf
v_add_f32_dpp v120, v120, v120 row_ror:8 row_mask:0xf bank_mask:0xf
v_add_f32_dpp v121, v121, v121 row_ror:8 row_mask:0xf bank_mask:0xf
v_add_f32_dpp v122, v122, v122 row_ror:8 row_mask:0xf bank_mask:0xf
v_add_f32_dpp v123, v123, v123 row_ror:8 row_mask:0xf bank_mask:0xf
v_min_u32 v120, -2, v120
v_min_u32 v121, -2, v121
v_min_u32 v122, -2, v122
v_min_u32 v123, -2, v123
buffer_store_dwordx4 v[120:123], v224, s[44:47], s72 offen offset:512 sc1
s_branch L_x_fin0
L_x_i1:
s_waitcnt lgkmcnt(0)
buffer_load_dwordx4 v[92:95], v222, s[44:47], s66 offen offset:0 sc1
buffer_load_dwordx4 v[96:99], v222, s[44:47], s66 offen offset:512 sc1
buffer_load_dwordx2 v[100:101], v222, s[44:47], s66 offen offset:1024 sc1
L_x_q_191:
s_waitcnt vmcnt(0)
v_bitop3_b32 v116, v92, v96, v100 bitop3:0x80
v_bitop3_b32 v116, v116, v92, 1 bitop3:0x80
v_cmp_eq_u32 vcc, 0, v116
s_cbranch_vccz L_x_r_192
s_mov_b64 exec, vcc
buffer_load_dwordx4 v[92:95], v222, s[44:47], s66 offen offset:0 sc1
buffer_load_dwordx4 v[96:99], v222, s[44:47], s66 offen offset:512 sc1
buffer_load_dwordx2 v[100:101], v222, s[44:47], s66 offen offset:1024 sc1
s_mov_b64 exec, -1
s_add_u32 s54, s54, 1
s_cmp_gt_u32 s54, 400000
s_cbranch_scc1 L_end
s_branch L_x_q_191
L_x_r_192:
v_add_f32_dpp v92, v92, v92 quad_perm:[2,3,0,1] row_mask:0xf bank_mask:0xf
v_add_f32_dpp v93, v93, v93 quad_perm:[2,3,0,1] row_mask:0xf bank_mask:0xf
v_add_f32_dpp v94, v94, v94 quad_perm:[2,3,0,1] row_mask:0xf bank_mask:0xf
v_add_f32_dpp v95, v95, v95 quad_perm:[2,3,0,1] row_mask:0xf bank_mask:0xf
v_add_f32_dpp v96, v96, v96 quad_perm:[2,3,0,1] row_mask:0xf bank_mask:0xf
v_add_f32_dpp v97, v97, v97 quad_perm:[2,3,0,1] row_mask:0xf bank_mask:0xf
v_add_f32_dpp v98, v98, v98 quad_perm:[2,3,0,1] row_mask:0xf bank_mask:0xf
v_add_f32_dpp v99, v99, v99 quad_perm:[2,3,0,1] row_mask:0xf bank_mask:0xf
v_add_f32_dpp v100, v100, v100 quad_perm:[2,3,0,1] row_mask:0xf bank_mask:0xf
v_add_f32_dpp v101, v101, v101 quad_perm:[2,3,0,1] row_mask:0xf bank_mask:0xf
v_max3_f32 v114, v92, v93, v94
v_max3_f32 v114, v114, v95, v96
v_max3_f32 v114, v114, v97, v98
v_max3_f32 v114, v114, v99, v100
v_max_f32 v114, v114, v101
v_mov_b32 v115, v114
s_nop 1
v_permlane16_swap_b32 v114, v115
v_max_f32 v114, v114, v115
v_mov_b32 v115, v114
s_nop 1
v_permlane32_swap_b32 v114, v115
v_max_f32 v114, v114, v115
v_mul_f32 v114, 0xbe0293ee, v114
v_fmamk_f32 v92, v92, 0x3e0293ee, v114
v_fmamk_f32 v93, v93, 0x3e0293ee, v114
v_fmamk_f32 v94, v94, 0x3e0293ee, v114
v_fmamk_f32 v95, v95, 0x3e0293ee, v114
v_fmamk_f32 v96, v96, 0x3e0293ee, v114
v_fmamk_f32 v97, v97, 0x3e0293ee, v114
v_fmamk_f32 v98, v98, 0x3e0293ee, v114
v_fmamk_f32 v99, v99, 0x3e0293ee, v114
v_fmamk_f32 v100, v100, 0x3e0293ee, v114
v_fmamk_f32 v101, v101, 0x3e0293ee, v114
v_exp_f32 v92, v92
v_exp_f32 v93, v93
v_exp_f32 v94, v94
v_exp_f32 v95, v95
v_exp_f32 v96, v96
v_exp_f32 v97, v97
v_exp_f32 v98, v98
v_exp_f32 v99, v99
v_exp_f32 v100, v100
v_exp_f32 v101, v101
v_mov_b32 v121, 0
v_mov_b32 v122, 0
v_cvt_pk_bf16_f32 v116, v92, v93
v_cvt_pk_bf16_f32 v117, v94, v95
v_cvt_pk_bf16_f32 v118, v96, v97
v_cvt_pk_bf16_f32 v119, v98, v99
v_cvt_pk_bf16_f32 v120, v100, v101
v_cvt_pk_bf16_f32 v123, v100, v101
v_mfma_f32_16x16x32_bf16 v[124:127], v[208:211], v[116:119], 0
v_mfma_f32_16x16x32_bf16 v[128:131], v[188:191], v[116:119], 0
v_mfma_f32_16x16x32_bf16 v[132:135], v[192:195], v[116:119], 0
v_mfma_f32_16x16x32_bf16 v[136:139], v[196:199], v[116:119], 0
v_mfma_f32_16x16x32_bf16 v[140:143], v[200:203], v[116:119], 0
v_mfma_f32_16x16x16_bf16 v[124:127], v[208:209], v[120:121], v[124:127]
v_mfma_f32_16x16x16_bf16 v[128:131], v[152:153], v[120:121], v[128:131]
v_mfma_f32_16x16x16_bf16 v[132:135], v[152:153], v[122:123], v[132:135]
v_mfma_f32_16x16x16_bf16 v[136:139], v[154:155], v[120:121], v[136:139]
v_mfma_f32_16x16x16_bf16 v[140:143], v[154:155], v[122:123], v[140:143]
v_rcp_f32 v124, v124
s_nop 0
v_mul_f32 v128, v128, v124
v_mul_f32 v129, v129, v124
v_mul_f32 v130, v130, v124
v_mul_f32 v131, v131, v124
v_mul_f32 v132, v132, v124
v_mul_f32 v133, v133, v124
v_mul_f32 v134, v134, v124
v_mul_f32 v135, v135, v124
v_cvt_pk_bf16_f32 v144, v128, v129
v_cvt_pk_bf16_f32 v145, v130, v131
v_cvt_pk_bf16_f32 v146, v132, v133
v_cvt_pk_bf16_f32 v147, v134, v135
v_mul_f32 v136, v136, v124
v_mul_f32 v137, v137, v124
v_mul_f32 v138, v138, v124
v_mul_f32 v139, v139, v124
v_mul_f32 v140, v140, v124
v_mul_f32 v141, v141, v124
v_mul_f32 v142, v142, v124
v_mul_f32 v143, v143, v124
v_cvt_pk_bf16_f32 v148, v136, v137
v_cvt_pk_bf16_f32 v149, v138, v139
v_cvt_pk_bf16_f32 v150, v140, v141
v_cvt_pk_bf16_f32 v151, v142, v143
v_mfma_f32_16x16x32_bf16 v[80:83], a[64:67], v[144:147], 0
s_nop 0
v_mfma_f32_16x16x32_bf16 v[80:83], a[68:71], v[148:151], v[80:83]
v_mfma_f32_16x16x32_bf16 v[84:87], a[72:75], v[144:147], 0
v_mfma_f32_16x16x32_bf16 v[84:87], a[76:79], v[148:151], v[84:87]
v_mfma_f32_16x16x32_bf16 v[88:91], a[80:83], v[144:147], 0
v_mfma_f32_16x16x32_bf16 v[88:91], a[84:87], v[148:151], v[88:91]
v_mfma_f32_16x16x32_bf16 v[92:95], a[88:91], v[144:147], 0
v_mfma_f32_16x16x32_bf16 v[92:95], a[92:95], v[148:151], v[92:95]
v_mfma_f32_16x16x32_bf16 v[96:99], a[96:99], v[144:147], 0
v_mfma_f32_16x16x32_bf16 v[96:99], a[100:103], v[148:151], v[96:99]
v_mfma_f32_16x16x32_bf16 v[100:103], a[104:107], v[144:147], 0
v_mfma_f32_16x16x32_bf16 v[100:103], a[108:111], v[148:151], v[100:103]
v_mfma_f32_16x16x32_bf16 v[104:107], a[112:115], v[144:147], 0
v_mfma_f32_16x16x32_bf16 v[104:107], a[116:119], v[148:151], v[104:107]
v_mfma_f32_16x16x32_bf16 v[108:111], a[120:123], v[144:147], 0
v_mfma_f32_16x16x32_bf16 v[108:111], a[124:127], v[148:151], v[108:111]
v_cvt_pk_bf16_f32 v80, v80, v81
v_cvt_pk_bf16_f32 v81, v82, v83
v_cvt_pk_bf16_f32 v82, v84, v85
v_cvt_pk_bf16_f32 v83, v86, v87
v_cndmask_b32 v80, v80, v82, s[78:79]
v_cndmask_b32 v81, v81, v83, s[78:79]
v_or_b32 v80, 1, v80
buffer_store_dwordx2 v[80:81], v223, s[44:47], s68 offen sc1
v_cvt_pk_bf16_f32 v88, v88, v89
v_cvt_pk_bf16_f32 v89, v90, v91
v_cvt_pk_bf16_f32 v90, v92, v93
v_cvt_pk_bf16_f32 v91, v94, v95
v_cndmask_b32 v88, v88, v90, s[78:79]
v_cndmask_b32 v89, v89, v91, s[78:79]
v_or_b32 v88, 1, v88
s_add_u32 s56, s68, 24576
buffer_store_dwordx2 v[88:89], v223, s[44:47], s56 offen sc1
v_cvt_pk_bf16_f32 v96, v96, v97
v_cvt_pk_bf16_f32 v97, v98, v99
v_cvt_pk_bf16_f32 v98, v100, v101
v_cvt_pk_bf16_f32 v99, v102, v103
v_cndmask_b32 v96, v96, v98, s[78:79]
v_cndmask_b32 v97, v97, v99, s[78:79]
v_or_b32 v96, 1, v96
s_add_u32 s56, s68, 49152
buffer_store_dwordx2 v[96:97], v223, s[44:47], s56 offen sc1
v_cvt_pk_bf16_f32 v104, v104, v105
v_cvt_pk_bf16_f32 v105, v106, v107
v_cvt_pk_bf16_f32 v106, v108, v109
v_cvt_pk_bf16_f32 v107, v110, v111
v_cndmask_b32 v104, v104, v106, s[78:79]
v_cndmask_b32 v105, v105, v107, s[78:79]
v_or_b32 v104, 1, v104
s_add_u32 s56, s68, 73728
buffer_store_dwordx2 v[104:105], v223, s[44:47], s56 offen sc1
s_waitcnt vmcnt(0)
buffer_load_dwordx4 v[112:115], v1, s[44:47], s74 offen sc1
L_x_q_194:
s_waitcnt vmcnt(0)
v_bitop3_b32 v124, v112, v114, 1 bitop3:0x80
v_cmp_eq_u32 vcc, 0, v124
s_cbranch_vccz L_x_r_195
s_mov_b64 exec, vcc
buffer_load_dwordx4 v[112:115], v1, s[44:47], s74 offen sc1
s_mov_b64 exec, -1
s_add_u32 s54, s54, 1
s_cmp_gt_u32 s54, 400000
s_cbranch_scc1 L_end
s_branch L_x_q_194
L_x_r_195:
v_mfma_f32_16x16x32_bf16 v[120:123], v[204:207], v[112:115], 0
s_nop 7
v_add_f32_dpp v120, v120, v120 row_ror:4 row_mask:0xf bank_mask:0xf
v_add_f32_dpp v121, v121, v121 row_ror:4 row_mask:0xf bank_mask:0xf
v_add_f32_dpp v122, v122, v122 row_ror:4 row_mask:0xf bank_mask:0xf
v_add_f32_dpp v123, v123, v123 row_ror:4 row_mask:0xf bank_mask:0xf
v_add_f32_dpp v120, v120, v120 row_ror:8 row_mask:0xf bank_mask:0xf
v_add_f32_dpp v121, v121, v121 row_ror:8 row_mask:0xf bank_mask:0xf
v_add_f32_dpp v122, v122, v122 row_ror:8 row_mask:0xf bank_mask:0xf
v_add_f32_dpp v123, v123, v123 row_ror:8 row_mask:0xf bank_mask:0xf
v_min_u32 v120, -2, v120
v_min_u32 v121, -2, v121
v_min_u32 v122, -2, v122
v_min_u32 v123, -2, v123
buffer_store_dwordx4 v[120:123], v224, s[44:47], s72 offen offset:0 sc1
v_mfma_f32_16x16x32_bf16 v[80:83], v[36:39], a[0:3], 0
v_mfma_f32_16x16x32_bf16 v[80:83], v[40:43], a[4:7], v[80:83]
v_mfma_f32_16x16x32_bf16 v[80:83], v[44:47], a[8:11], v[80:83]
v_mfma_f32_16x16x32_bf16 v[80:83], v[48:51], a[12:15], v[80:83]
v_mfma_f32_16x16x32_bf16 v[84:87], v[52:55], a[0:3], 0
v_mfma_f32_16x16x32_bf16 v[84:87], v[56:59], a[4:7], v[84:87]
v_mfma_f32_16x16x32_bf16 v[84:87], v[60:63], a[8:11], v[84:87]
v_mfma_f32_16x16x32_bf16 v[84:87], v[236:239], a[12:15], v[84:87]
v_mfma_f32_16x16x32_bf16 v[88:91], v[36:39], a[16:19], 0
v_mfma_f32_16x16x32_bf16 v[88:91], v[40:43], a[20:23], v[88:91]
ds_write_b128 v227, v[80:83] offset:0
v_mfma_f32_16x16x32_bf16 v[88:91], v[44:47], a[24:27], v[88:91]
v_mfma_f32_16x16x32_bf16 v[88:91], v[48:51], a[28:31], v[88:91]
v_mfma_f32_16x16x32_bf16 v[92:95], v[52:55], a[16:19], 0
v_mfma_f32_16x16x32_bf16 v[92:95], v[56:59], a[20:23], v[92:95]
ds_write_b128 v227, v[84:87] offset:1024
v_mfma_f32_16x16x32_bf16 v[92:95], v[60:63], a[24:27], v[92:95]
v_mfma_f32_16x16x32_bf16 v[92:95], v[236:239], a[28:31], v[92:95]
v_mfma_f32_16x16x32_bf16 v[96:99], v[36:39], a[32:35], 0
v_mfma_f32_16x16x32_bf16 v[96:99], v[40:43], a[36:39], v[96:99]
ds_write_b128 v227, v[88:91] offset:2048
v_mfma_f32_16x16x32_bf16 v[96:99], v[44:47], a[40:43], v[96:99]
v_mfma_f32_16x16x32_bf16 v[96:99], v[48:51], a[44:47], v[96:99]
v_mfma_f32_16x16x32_bf16 v[100:103], v[52:55], a[32:35], 0
v_mfma_f32_16x16x32_bf16 v[100:103], v[56:59], a[36:39], v[100:103]
ds_write_b128 v227, v[92:95] offset:3072
v_mfma_f32_16x16x32_bf16 v[100:103], v[60:63], a[40:43], v[100:103]
v_mfma_f32_16x16x32_bf16 v[100:103], v[236:239], a[44:47], v[100:103]
v_mfma_f32_16x16x32_bf16 v[104:107], v[36:39], a[48:51], 0
v_mfma_f32_16x16x32_bf16 v[104:107], v[40:43], a[52:55], v[104:107]
ds_write_b128 v227, v[96:99] offset:4096
v_mfma_f32_16x16x32_bf16 v[104:107], v[44:47], a[56:59], v[104:107]
v_mfma_f32_16x16x32_bf16 v[104:107], v[48:51], a[60:63], v[104:107]
v_mfma_f32_16x16x32_bf16 v[108:111], v[52:55], a[48:51], 0
v_mfma_f32_16x16x32_bf16 v[108:111], v[56:59], a[52:55], v[108:111]
ds_write_b128 v227, v[100:103] offset:5120
v_mfma_f32_16x16x32_bf16 v[108:111], v[60:63], a[56:59], v[108:111]
v_mfma_f32_16x16x32_bf16 v[108:111], v[236:239], a[60:63], v[108:111]
ds_write_b128 v227, v[104:107] offset:6144
s_nop 6
ds_write_b128 v227, v[108:111] offset:7168
s_waitcnt lgkmcnt(0)
s_barrier
ds_read_b128 v[112:115], v228 offset:0
ds_read_b128 v[116:119], v228 offset:32768
ds_read_b128 v[120:123], v229 offset:0
ds_read_b128 v[124:127], v229 offset:32768
ds_read_b128 v[128:131], v228 offset:1024
ds_read_b128 v[132:135], v228 offset:33792
ds_read_b128 v[136:139], v229 offset:1024
ds_read_b128 v[140:143], v229 offset:33792
s_waitcnt lgkmcnt(6)
v_pk_add_f32 v[112:113], v[112:113], v[116:117]
v_pk_add_f32 v[114:115], v[114:115], v[118:119]
s_waitcnt lgkmcnt(4)
v_pk_add_f32 v[120:121], v[120:121], v[124:125]
v_pk_add_f32 v[122:123], v[122:123], v[126:127]
v_pk_add_f32 v[112:113], v[112:113], v[120:121]
v_pk_add_f32 v[114:115], v[114:115], v[122:123]
v_cvt_pk_bf16_f32 v180, v112, v113
v_cvt_pk_bf16_f32 v181, v114, v115
s_waitcnt lgkmcnt(2)
v_pk_add_f32 v[128:129], v[128:129], v[132:133]
v_pk_add_f32 v[130:131], v[130:131], v[134:135]
s_waitcnt lgkmcnt(0)
v_pk_add_f32 v[136:137], v[136:137], v[140:141]
v_pk_add_f32 v[138:139], v[138:139], v[142:143]
v_pk_add_f32 v[128:129], v[128:129], v[136:137]
v_pk_add_f32 v[130:131], v[130:131], v[138:139]
v_cvt_pk_bf16_f32 v182, v128, v129
v_cvt_pk_bf16_f32 v183, v130, v131
ds_write_b128 v233, v[180:183] offset:4096
s_waitcnt lgkmcnt(0)
s_barrier
v_add_u32 v231, 0x10000, v230
ds_read_b128 v[188:191], v231 offset:4096
ds_read_b128 v[192:195], v231 offset:5120
ds_read_b128 v[196:199], v231 offset:6144
ds_read_b128 v[200:203], v231 offset:7168
buffer_load_dwordx4 v[144:147], v225, s[44:47], s71 offen offset:0 sc1
L_x_q_197:
s_waitcnt vmcnt(0)
v_cmp_eq_u32 vcc, -1, v144
s_cbranch_vccz L_x_r_198
s_mov_b64 exec, vcc
buffer_load_dwordx4 v[144:147], v225, s[44:47], s71 offen offset:0 sc1
s_mov_b64 exec, -1
s_add_u32 s54, s54, 1
s_cmp_gt_u32 s54, 400000
s_cbranch_scc1 L_end
s_branch L_x_q_197
L_x_r_198:
v_add_f32_dpp v144, v144, v144 row_ror:4 row_mask:0xf bank_mask:0xf
v_add_f32_dpp v145, v145, v145 row_ror:4 row_mask:0xf bank_mask:0xf
v_add_f32_dpp v146, v146, v146 row_ror:4 row_mask:0xf bank_mask:0xf
v_add_f32_dpp v147, v147, v147 row_ror:4 row_mask:0xf bank_mask:0xf
v_add_f32_dpp v144, v144, v144 row_ror:8 row_mask:0xf bank_mask:0xf
v_add_f32_dpp v145, v145, v145 row_ror:8 row_mask:0xf bank_mask:0xf
v_add_f32_dpp v146, v146, v146 row_ror:8 row_mask:0xf bank_mask:0xf
v_add_f32_dpp v147, v147, v147 row_ror:8 row_mask:0xf bank_mask:0xf
v_cvt_pk_bf16_f32 v144, v144, v145
v_cvt_pk_bf16_f32 v145, v146, v147
v_min_u32 v144, -2, v144
buffer_store_dwordx2 v[144:145], v226, s[44:47], s75 offen offset:0 sc1
s_add_u32 s56, s70, 24576
s_add_u32 s57, s70, 49152
s_add_u32 s58, s70, 73728
s_waitcnt vmcnt(0)
buffer_load_dwordx4 v[64:67], v219, s[44:47], s70 offen offset:0 sc1
buffer_load_dwordx4 v[68:71], v219, s[44:47], s56 offen offset:0 sc1
buffer_load_dwordx4 v[72:75], v219, s[44:47], s57 offen offset:0 sc1
buffer_load_dwordx4 v[76:79], v219, s[44:47], s58 offen offset:0 sc1
L_x_q_200:
s_waitcnt vmcnt(0)
v_max3_u32 v148, v64, v66, v68
v_max3_u32 v149, v70, v72, v74
v_max3_u32 v148, v148, v76, v78
v_max_u32 v148, v148, v149
v_cmp_eq_u32 vcc, -1, v148
s_cbranch_vccz L_x_r_201
s_mov_b64 exec, vcc
buffer_load_dwordx4 v[64:67], v219, s[44:47], s70 offen offset:0 sc1
buffer_load_dwordx4 v[68:71], v219, s[44:47], s56 offen offset:0 sc1
buffer_load_dwordx4 v[72:75], v219, s[44:47], s57 offen offset:0 sc1
buffer_load_dwordx4 v[76:79], v219, s[44:47], s58 offen offset:0 sc1
s_mov_b64 exec, -1
s_add_u32 s54, s54, 1
s_cmp_gt_u32 s54, 400000
s_cbranch_scc1 L_end
s_branch L_x_q_200
L_x_r_201:
v_mfma_f32_16x16x32_bf16 v[80:83], v[64:67], a[0:3], 0
v_mfma_f32_16x16x32_bf16 v[84:87], v[64:67], a[16:19], 0
v_mfma_f32_16x16x32_bf16 v[88:91], v[64:67], a[32:35], 0
v_mfma_f32_16x16x32_bf16 v[92:95], v[64:67], a[48:51], 0
v_mfma_f32_16x16x32_bf16 v[80:83], v[68:71], a[4:7], v[80:83]
v_mfma_f32_16x16x32_bf16 v[84:87], v[68:71], a[20:23], v[84:87]
v_mfma_f32_16x16x32_bf16 v[88:91], v[68:71], a[36:39], v[88:91]
v_mfma_f32_16x16x32_bf16 v[92:95], v[68:71], a[52:55], v[92:95]
v_mfma_f32_16x16x32_bf16 v[80:83], v[72:75], a[8:11], v[80:83]
v_mfma_f32_16x16x32_bf16 v[84:87], v[72:75], a[24:27], v[84:87]
v_mfma_f32_16x16x32_bf16 v[88:91], v[72:75], a[40:43], v[88:91]
v_mfma_f32_16x16x32_bf16 v[92:95], v[72:75], a[56:59], v[92:95]
v_mfma_f32_16x16x32_bf16 v[80:83], v[76:79], a[12:15], v[80:83]
v_mfma_f32_16x16x32_bf16 v[84:87], v[76:79], a[28:31], v[84:87]
v_mfma_f32_16x16x32_bf16 v[88:91], v[76:79], a[44:47], v[88:91]
v_mfma_f32_16x16x32_bf16 v[92:95], v[76:79], a[60:63], v[92:95]
ds_write_b64 v227, v[80:81] offset:8192
s_nop 2
ds_write_b64 v227, v[84:85] offset:8200
s_nop 1
ds_write_b64 v227, v[88:89] offset:9216
ds_write_b64 v227, v[92:93] offset:9224
s_waitcnt lgkmcnt(0)
s_barrier
ds_read_b128 v[80:83], v1 offset:8192
ds_read_b128 v[84:87], v1 offset:40960
ds_read_b128 v[88:91], v230 offset:8192
ds_read_b128 v[92:95], v230 offset:40960
ds_read_b128 v[96:99], v1 offset:9216
ds_read_b128 v[100:103], v1 offset:41984
ds_read_b128 v[104:107], v230 offset:9216
ds_read_b128 v[108:111], v230 offset:41984
s_waitcnt lgkmcnt(6)
v_pk_add_f32 v[80:81], v[80:81], v[84:85]
v_pk_add_f32 v[82:83], v[82:83], v[86:87]
s_waitcnt lgkmcnt(4)
v_pk_add_f32 v[88:89], v[88:89], v[92:93]
v_pk_add_f32 v[90:91], v[90:91], v[94:95]
v_pk_add_f32 v[80:81], v[80:81], v[88:89]
v_pk_add_f32 v[82:83], v[82:83], v[90:91]
v_cvt_pk_bf16_f32 v160, v80, v81
v_cvt_pk_bf16_f32 v161, v82, v83
s_waitcnt lgkmcnt(2)
v_pk_add_f32 v[96:97], v[96:97], v[100:101]
v_pk_add_f32 v[98:99], v[98:99], v[102:103]
s_waitcnt lgkmcnt(0)
v_pk_add_f32 v[104:105], v[104:105], v[108:109]
v_pk_add_f32 v[106:107], v[106:107], v[110:111]
v_pk_add_f32 v[96:97], v[96:97], v[104:105]
v_pk_add_f32 v[98:99], v[98:99], v[106:107]
v_cvt_pk_bf16_f32 v162, v96, v97
v_cvt_pk_bf16_f32 v163, v98, v99
s_waitcnt lgkmcnt(0)
buffer_load_dwordx4 v[92:95], v222, s[44:47], s66 offen offset:0 sc1
buffer_load_dwordx4 v[96:99], v222, s[44:47], s66 offen offset:512 sc1
buffer_load_dwordx2 v[100:101], v222, s[44:47], s66 offen offset:1024 sc1
L_x_q_203:
s_waitcnt vmcnt(0)
v_bitop3_b32 v116, v92, v96, v100 bitop3:0xfe
v_bitop3_b32 v116, v116, v92, 1 bitop3:0xa8
v_cmp_ne_u32 vcc, 0, v116
s_cbranch_vccz L_x_r_204
s_mov_b64 exec, vcc
buffer_load_dwordx4 v[92:95], v222, s[44:47], s66 offen offset:0 sc1
buffer_load_dwordx4 v[96:99], v222, s[44:47], s66 offen offset:512 sc1
buffer_load_dwordx2 v[100:101], v222, s[44:47], s66 offen offset:1024 sc1
s_mov_b64 exec, -1
s_add_u32 s54, s54, 1
s_cmp_gt_u32 s54, 400000
s_cbranch_scc1 L_end
s_branch L_x_q_203
L_x_r_204:
v_add_f32_dpp v92, v92, v92 quad_perm:[2,3,0,1] row_mask:0xf bank_mask:0xf
v_add_f32_dpp v93, v93, v93 quad_perm:[2,3,0,1] row_mask:0xf bank_mask:0xf
v_add_f32_dpp v94, v94, v94 quad_perm:[2,3,0,1] row_mask:0xf bank_mask:0xf
v_add_f32_dpp v95, v95, v95 quad_perm:[2,3,0,1] row_mask:0xf bank_mask:0xf
v_add_f32_dpp v96, v96, v96 quad_perm:[2,3,0,1] row_mask:0xf bank_mask:0xf
v_add_f32_dpp v97, v97, v97 quad_perm:[2,3,0,1] row_mask:0xf bank_mask:0xf
v_add_f32_dpp v98, v98, v98 quad_perm:[2,3,0,1] row_mask:0xf bank_mask:0xf
v_add_f32_dpp v99, v99, v99 quad_perm:[2,3,0,1] row_mask:0xf bank_mask:0xf
v_add_f32_dpp v100, v100, v100 quad_perm:[2,3,0,1] row_mask:0xf bank_mask:0xf
v_add_f32_dpp v101, v101, v101 quad_perm:[2,3,0,1] row_mask:0xf bank_mask:0xf
v_max3_f32 v114, v92, v93, v94
v_max3_f32 v114, v114, v95, v96
v_max3_f32 v114, v114, v97, v98
v_max3_f32 v114, v114, v99, v100
v_max_f32 v114, v114, v101
v_mov_b32 v115, v114
s_nop 1
v_permlane16_swap_b32 v114, v115
v_max_f32 v114, v114, v115
v_mov_b32 v115, v114
s_nop 1
v_permlane32_swap_b32 v114, v115
v_max_f32 v114, v114, v115
v_mul_f32 v114, 0xbe0293ee, v114
v_fmamk_f32 v92, v92, 0x3e0293ee, v114
v_fmamk_f32 v93, v93, 0x3e0293ee, v114
v_fmamk_f32 v94, v94, 0x3e0293ee, v114
v_fmamk_f32 v95, v95, 0x3e0293ee, v114
v_fmamk_f32 v96, v96, 0x3e0293ee, v114
v_fmamk_f32 v97, v97, 0x3e0293ee, v114
v_fmamk_f32 v98, v98, 0x3e0293ee, v114
v_fmamk_f32 v99, v99, 0x3e0293ee, v114
v_fmamk_f32 v100, v100, 0x3e0293ee, v114
v_fmamk_f32 v101, v101, 0x3e0293ee, v114
v_exp_f32 v92, v92
v_exp_f32 v93, v93
v_exp_f32 v94, v94
v_exp_f32 v95, v95
v_exp_f32 v96, v96
v_exp_f32 v97, v97
v_exp_f32 v98, v98
v_exp_f32 v99, v99
v_exp_f32 v100, v100
v_exp_f32 v101, v101
v_mov_b32 v121, 0
v_mov_b32 v122, 0
v_cvt_pk_bf16_f32 v116, v92, v93
v_cvt_pk_bf16_f32 v117, v94, v95
v_cvt_pk_bf16_f32 v118, v96, v97
v_cvt_pk_bf16_f32 v119, v98, v99
v_cvt_pk_bf16_f32 v120, v100, v101
v_cvt_pk_bf16_f32 v123, v100, v101
v_mfma_f32_16x16x32_bf16 v[124:127], v[208:211], v[116:119], 0
v_mfma_f32_16x16x32_bf16 v[128:131], v[188:191], v[116:119], 0
v_mfma_f32_16x16x32_bf16 v[132:135], v[192:195], v[116:119], 0
v_mfma_f32_16x16x32_bf16 v[136:139], v[196:199], v[116:119], 0
v_mfma_f32_16x16x32_bf16 v[140:143], v[200:203], v[116:119], 0
v_mfma_f32_16x16x16_bf16 v[124:127], v[208:209], v[120:121], v[124:127]
v_mfma_f32_16x16x16_bf16 v[128:131], v[160:161], v[120:121], v[128:131]
v_mfma_f32_16x16x16_bf16 v[132:135], v[160:161], v[122:123], v[132:135]
v_mfma_f32_16x16x16_bf16 v[136:139], v[162:163], v[120:121], v[136:139]
v_mfma_f32_16x16x16_bf16 v[140:143], v[162:163], v[122:123], v[140:143]
v_rcp_f32 v124, v124
s_nop 0
v_mul_f32 v128, v128, v124
v_mul_f32 v129, v129, v124
v_mul_f32 v130, v130, v124
v_mul_f32 v131, v131, v124
v_mul_f32 v132, v132, v124
v_mul_f32 v133, v133, v124
v_mul_f32 v134, v134, v124
v_mul_f32 v135, v135, v124
v_cvt_pk_bf16_f32 v144, v128, v129
v_cvt_pk_bf16_f32 v145, v130, v131
v_cvt_pk_bf16_f32 v146, v132, v133
v_cvt_pk_bf16_f32 v147, v134, v135
v_mul_f32 v136, v136, v124
v_mul_f32 v137, v137, v124
v_mul_f32 v138, v138, v124
v_mul_f32 v139, v139, v124
v_mul_f32 v140, v140, v124
v_mul_f32 v141, v141, v124
v_mul_f32 v142, v142, v124
v_mul_f32 v143, v143, v124
v_cvt_pk_bf16_f32 v148, v136, v137
v_cvt_pk_bf16_f32 v149, v138, v139
v_cvt_pk_bf16_f32 v150, v140, v141
v_cvt_pk_bf16_f32 v151, v142, v143
v_mfma_f32_16x16x32_bf16 v[80:83], a[64:67], v[144:147], 0
s_nop 0
v_mfma_f32_16x16x32_bf16 v[80:83], a[68:71], v[148:151], v[80:83]
v_mfma_f32_16x16x32_bf16 v[84:87], a[72:75], v[144:147], 0
v_mfma_f32_16x16x32_bf16 v[84:87], a[76:79], v[148:151], v[84:87]
v_mfma_f32_16x16x32_bf16 v[88:91], a[80:83], v[144:147], 0
v_mfma_f32_16x16x32_bf16 v[88:91], a[84:87], v[148:151], v[88:91]
v_mfma_f32_16x16x32_bf16 v[92:95], a[88:91], v[144:147], 0
v_mfma_f32_16x16x32_bf16 v[92:95], a[92:95], v[148:151], v[92:95]
v_mfma_f32_16x16x32_bf16 v[96:99], a[96:99], v[144:147], 0
v_mfma_f32_16x16x32_bf16 v[96:99], a[100:103], v[148:151], v[96:99]
v_mfma_f32_16x16x32_bf16 v[100:103], a[104:107], v[144:147], 0
v_mfma_f32_16x16x32_bf16 v[100:103], a[108:111], v[148:151], v[100:103]
v_mfma_f32_16x16x32_bf16 v[104:107], a[112:115], v[144:147], 0
v_mfma_f32_16x16x32_bf16 v[104:107], a[116:119], v[148:151], v[104:107]
v_mfma_f32_16x16x32_bf16 v[108:111], a[120:123], v[144:147], 0
v_mfma_f32_16x16x32_bf16 v[108:111], a[124:127], v[148:151], v[108:111]
v_cvt_pk_bf16_f32 v80, v80, v81
v_cvt_pk_bf16_f32 v81, v82, v83
v_cvt_pk_bf16_f32 v82, v84, v85
v_cvt_pk_bf16_f32 v83, v86, v87
v_cndmask_b32 v80, v80, v82, s[78:79]
v_cndmask_b32 v81, v81, v83, s[78:79]
v_and_b32 v80, -2, v80
buffer_store_dwordx2 v[80:81], v223, s[44:47], s68 offen sc1
v_cvt_pk_bf16_f32 v88, v88, v89
v_cvt_pk_bf16_f32 v89, v90, v91
v_cvt_pk_bf16_f32 v90, v92, v93
v_cvt_pk_bf16_f32 v91, v94, v95
v_cndmask_b32 v88, v88, v90, s[78:79]
v_cndmask_b32 v89, v89, v91, s[78:79]
v_and_b32 v88, -2, v88
s_add_u32 s56, s68, 24576
buffer_store_dwordx2 v[88:89], v223, s[44:47], s56 offen sc1
v_cvt_pk_bf16_f32 v96, v96, v97
v_cvt_pk_bf16_f32 v97, v98, v99
v_cvt_pk_bf16_f32 v98, v100, v101
v_cvt_pk_bf16_f32 v99, v102, v103
v_cndmask_b32 v96, v96, v98, s[78:79]
v_cndmask_b32 v97, v97, v99, s[78:79]
v_and_b32 v96, -2, v96
s_add_u32 s56, s68, 49152
buffer_store_dwordx2 v[96:97], v223, s[44:47], s56 offen sc1
v_cvt_pk_bf16_f32 v104, v104, v105
v_cvt_pk_bf16_f32 v105, v106, v107
v_cvt_pk_bf16_f32 v106, v108, v109
v_cvt_pk_bf16_f32 v107, v110, v111
v_cndmask_b32 v104, v104, v106, s[78:79]
v_cndmask_b32 v105, v105, v107, s[78:79]
v_and_b32 v104, -2, v104
s_add_u32 s56, s68, 73728
buffer_store_dwordx2 v[104:105], v223, s[44:47], s56 offen sc1
s_waitcnt vmcnt(0)
buffer_load_dwordx4 v[112:115], v1, s[44:47], s74 offen sc1
L_x_q_206:
s_waitcnt vmcnt(0)
v_bitop3_b32 v124, v112, v114, 1 bitop3:0xa8
v_cmp_ne_u32 vcc, 0, v124
s_cbranch_vccz L_x_r_207
s_mov_b64 exec, vcc
buffer_load_dwordx4 v[112:115], v1, s[44:47], s74 offen sc1
s_mov_b64 exec, -1
s_add_u32 s54, s54, 1
s_cmp_gt_u32 s54, 400000
s_cbranch_scc1 L_end
s_branch L_x_q_206
L_x_r_207:
v_mfma_f32_16x16x32_bf16 v[120:123], v[204:207], v[112:115], 0
s_nop 7
v_add_f32_dpp v120, v120, v120 row_ror:4 row_mask:0xf bank_mask:0xf
v_add_f32_dpp v121, v121, v121 row_ror:4 row_mask:0xf bank_mask:0xf
v_add_f32_dpp v122, v122, v122 row_ror:4 row_mask:0xf bank_mask:0xf
v_add_f32_dpp v123, v123, v123 row_ror:4 row_mask:0xf bank_mask:0xf
v_add_f32_dpp v120, v120, v120 row_ror:8 row_mask:0xf bank_mask:0xf
v_add_f32_dpp v121, v121, v121 row_ror:8 row_mask:0xf bank_mask:0xf
v_add_f32_dpp v122, v122, v122 row_ror:8 row_mask:0xf bank_mask:0xf
v_add_f32_dpp v123, v123, v123 row_ror:8 row_mask:0xf bank_mask:0xf
v_min_u32 v120, -2, v120
v_min_u32 v121, -2, v121
v_min_u32 v122, -2, v122
v_min_u32 v123, -2, v123
buffer_store_dwordx4 v[120:123], v224, s[44:47], s72 offen offset:512 sc1
s_branch L_x_fin1
L_end:
s_endpgm

.section .rodata,"a"
.p2align 6
.amdhsa_kernel sequential_preLN__memory_aug_recurrent_mem_tr__dense_activation_relu__prompt_kernel
  .amdhsa_next_free_vgpr 512
  .amdhsa_next_free_sgpr 102
  .amdhsa_accum_offset 256
  .amdhsa_group_segment_fixed_size 0
  .amdhsa_kernarg_size 104
  .amdhsa_user_sgpr_count 2
  .amdhsa_user_sgpr_kernarg_segment_ptr 1
  .amdhsa_system_sgpr_workgroup_id_x 1
.end_amdhsa_kernel
```
